```python
import torch

def _softmax(x, axis=-1):
    return torch.softmax(x, dim=axis)
def _gelu(x):
    return torch.nn.functional.gelu(x, approximate="tanh")
def _silu(x):
    return torch.nn.functional.silu(x)
def _sigmoid(x):
    return torch.sigmoid(x)
def _layernorm(x, axis=-1, eps=1e-5):
    m = x.mean(dim=axis, keepdim=True)
    v = x.var(dim=axis, keepdim=True, unbiased=False)
    return (x - m) / torch.sqrt(v + eps)
def _scatter_add(tgt, idx, src, axis=0):
    return tgt.clone().index_add_(axis, idx, src)
def _segment_sum(src, seg, n):
    out = torch.zeros((n,) + src.shape[1:], dtype=src.dtype)
    return out.index_add_(0, seg, src)
def _pad(x, pw):
    flat = tuple(v for pair in reversed(pw) for v in pair)
    return torch.nn.functional.pad(x, flat)

kernel_name = 'parallel_sum__linear_attn_block__dense_activation_squared_relu__prompt'

def setup_inputs():

    _w = (lambda a: (lambda t: t.to(torch.bfloat16) if t.is_floating_point() else t)(torch.as_tensor(a)))
    def _A_setup():
        B, S, D = 1, 2048, 576
        return {
            "x": _w((lambda *s: torch.randn(*s, dtype=torch.bfloat16) * 0.05)(B, S, D)),
            "wqkv": _w((lambda *s: torch.randn(*s, dtype=torch.bfloat16) * 0.4)(D, 3 * D)),
            "wo": _w((lambda *s: torch.randn(*s, dtype=torch.bfloat16) * 0.4)(D, D)),
        }
    _A_in = _A_setup()

    def _B_setup():
        B, S, D, F = 1, 2048, 576, 4608
        return {
            "x": _w((lambda *s: torch.randn(*s, dtype=torch.bfloat16) * 0.05)(B, S, D)),
            "w1": _w((lambda *s: torch.randn(*s, dtype=torch.bfloat16) * 0.05)(D, F)),
            "b1": _w((lambda *s: torch.randn(*s, dtype=torch.bfloat16) * 0.2)(F)),
            "w2": _w((lambda *s: torch.randn(*s, dtype=torch.bfloat16) * 0.05)(F, D)),
            "b2": _w((lambda *s: torch.randn(*s, dtype=torch.bfloat16) * 1.6)(D)),
        }
    _B_in = _B_setup()

    return {
        "A_x": _A_in["x"],
        "A_wqkv": _A_in["wqkv"],
        "A_wo": _A_in["wo"],
        "B_x": _B_in["x"],
        "B_w1": _B_in["w1"],
        "B_b1": _B_in["b1"],
        "B_w2": _B_in["w2"],
        "B_b2": _B_in["b2"],
    }

def reference(A_x, A_wqkv, A_wo, B_x, B_w1, B_b1, B_w2, B_b2):
    def _A_ref(x, wqkv, wo):
        B, S, D = x.shape
        H = 32; Dh = D // H
        qkv = (lambda x, *d: x.permute(*d))((x @ wqkv).reshape(B, S, 3, H, Dh), 2, 0, 3, 1, 4)
        q, k, v = qkv[0], qkv[1], qkv[2]
        phi = lambda t: torch.where(t > 0, t + 1, torch.exp(t)) + 1e-6
        pq, pk = phi(q), phi(k)
        kv = torch.einsum("bhsd,bhse->bhde", pk, v)
        z = torch.einsum("bhsd->bhd", pk)
        num = torch.einsum("bhqd,bhde->bhqe", pq, kv)
        den = torch.einsum("bhqd,bhd->bhq", pq, z)[..., None] + 1e-6
        o = num / den
        return (lambda x, *d: x.permute(*d))(o, 0, 2, 1, 3).reshape(B, S, D) @ wo

    def _B_ref(x, w1, b1, w2, b2):
        h = torch.einsum("bsd,df->bsf", x, w1) + b1
        zero = torch.zeros_like(h)
        r = torch.where(h > zero, h, zero)
        h = r * r
        out = torch.einsum("bsf,fd->bsd", h, w2) + b2
        return out

    x = A_x
    xn = _layernorm(x, axis=-1)
    return x + _A_ref(xn, A_wqkv, A_wo) + _B_ref(xn, B_w1, B_b1, B_w2, B_b2)
```

```asm
; @launch grid=(256,1,1) block=(256,1,1) lds=163840
.amdgcn_target "amdgcn-amd-amdhsa--gfx950"
.text
.globl parallel_sum__linear_attn_block__dense_activation_squared_relu__prompt_kernel
.p2align 12
.type parallel_sum__linear_attn_block__dense_activation_squared_relu__prompt_kernel,@function
parallel_sum__linear_attn_block__dense_activation_squared_relu__prompt_kernel:
  s_cmp_ge_u32 s2, 256
  s_cbranch_scc1 FF_END
  s_load_dwordx2 s[8:9], s[0:1], 0
  s_load_dwordx2 s[12:13], s[0:1], 8
  s_load_dwordx2 s[16:17], s[0:1], 32
  s_load_dwordx2 s[32:33], s[0:1], 40
  s_load_dwordx2 s[28:29], s[0:1], 80
  v_lshrrev_b32 v33, 6, v0
  v_and_b32 v32, 63, v0
  s_and_b32 s3, s2, 3
  s_bfe_u32 s48, s2, 0x20003
  v_readfirstlane_b32 s6, v33
  s_lshl_b32 s4, s3, 2
  s_add_u32 s4, s4, s48
  s_bfe_u32 s5, s2, 0x10002
  s_lshl_b32 s5, s5, 3
  s_lshr_b32 s49, s2, 5
  s_add_u32 s5, s5, s49
  s_lshl_b32 s7, s48, 1
  s_cmp_eq_u32 s48, 3
  s_cselect_b32 s100, s49, 0
  s_cselect_b32 s99, AT_START-K1_PC, 0
  s_add_u32 s7, s7, s100
  s_sub_u32 s100, s7, 9
  s_cmp_ge_u32 s7, 9
  s_cselect_b32 s7, s100, s7
  s_getpc_b64 s[46:47]
K1_PC:
  v_lshlrev_b32 v58, 5, v0
  v_and_b32 v58, 0x1f80, v58
  v_add_u32 v58, s99, v58
  v_mov_b32 v59, s47
  v_add_co_u32 v58, vcc, s46, v58
  v_addc_co_u32 v59, vcc, 0, v59, vcc
  global_load_dword a47, v[58:59], off
  v_lshrrev_b32 v34, 3, v32
  v_lshl_add_u32 v35, v33, 5, v34
  v_mul_u32_u24 v35, 1152, v35
  v_lshrrev_b32 v34, 1, v34
  v_and_b32 v36, 7, v32
  v_xor_b32 v36, v36, v34
  v_xor_b32 v37, 4, v36
  v_lshl_add_u32 v40, v36, 4, v35
  v_lshl_add_u32 v41, v37, 4, v35
  v_add_u32 v42, 16384, v40
  v_add_u32 v43, 24576, v41
  v_add_u32 v41, 8192, v41
  s_mul_i32 s98, s5, 147456
  s_mov_b32 s10, 2359296
  s_mov_b32 s11, 0x20000
  s_mul_i32 s40, s6, 39936
  s_add_u32 s40, s40, 4096
  s_mov_b32 m0, s40
  s_lshl_b32 s46, s7, 7
  s_add_u32 s46, s46, s98
  s_add_u32 s47, s46, 128
  s_cmp_eq_u32 s7, 8
  s_cselect_b32 s47, s98, s47
  s_waitcnt lgkmcnt(0)
  buffer_load_dwordx4 v40, s[8:11], s46 offen offset:0 lds
  buffer_load_dwordx4 v41, s[8:11], s46 offen offset:1024 lds
  buffer_load_dwordx4 v42, s[8:11], s46 offen offset:2048 lds
  buffer_load_dwordx4 v43, s[8:11], s46 offen offset:3072 lds
  s_add_u32 m0, s40, 4096
  s_cmp_eq_u32 s48, 3
  buffer_load_dwordx4 v40, s[8:11], s47 offen offset:0 lds
  buffer_load_dwordx4 v41, s[8:11], s47 offen offset:1024 lds
  buffer_load_dwordx4 v42, s[8:11], s47 offen offset:2048 lds
  buffer_load_dwordx4 v43, s[8:11], s47 offen offset:3072 lds
  s_cbranch_scc1 AT_START
FF_START:
  s_load_dwordx2 s[20:21], s[0:1], 48
  s_load_dwordx2 s[24:25], s[0:1], 16
  s_load_dwordx2 s[36:37], s[0:1], 72
  s_load_dwordx2 s[64:65], s[0:1], 64
  s_load_dwordx2 s[62:63], s[0:1], 56
  s_mul_i32 s3, s3, 3
  s_add_u32 s3, s3, s48
  s_lshl_b32 s100, s49, 0
  s_add_u32 s100, s100, 1
  s_cmp_eq_u32 s100, 8
  s_cselect_b32 s100, 1, s100
  s_lshl_b32 s99, s7, 7
  s_add_u32 s69, s99, s98
  s_mul_i32 s68, s7, 589824
  s_add_u32 s7, s7, 1
  s_lshl_b32 s99, s7, 7
  s_add_u32 s71, s99, s98
  s_mul_i32 s70, s7, 589824
  s_add_u32 s69, s68, 36864
  s_add_u32 s71, s70, 36864
  v_lshrrev_b32 v50, 5, v32
  v_bfe_u32 v51, v32, 4, 1
  v_bfe_u32 v52, v32, 2, 2
  v_and_b32 v53, 3, v32
  v_lshl_add_u32 v55, v33, 1, v51
  v_lshl_add_u32 v55, v55, 3, v52
  v_lshlrev_b32 v57, 4, v53
  v_lshl_add_u32 v56, v50, 6, v57
  s_mul_i32 s47, s3, 768
  v_mul_u32_u24 v34, 9216, v55
  v_add3_u32 v8, v34, v56, s47
  s_mov_b32 s18, 5308416
  s_mov_b32 s19, 0x20000
  s_mov_b32 s34, 9216
  s_mov_b32 s35, 0x20000
  v_mul_u32_u24 v49, 12, v32
  v_add_u32 v49, s47, v49
  buffer_load_dwordx3 v[60:62], v49, s[32:35], 0 offen
  s_add_u32 m0, s40, 20480
  s_nop 0
  buffer_load_dwordx4 v8, s[16:19], s68 offen  lds
  s_add_u32 m0, s40, 21504
  s_nop 0
  buffer_load_dwordx4 v8, s[16:19], s69 offen  lds
  s_getpc_b64 s[46:47]
FF_PC0:
  s_lshr_b32 s48, s2, 5
  s_lshl_b32 s48, s48, 2
  s_add_u32 s48, s48, s6
  s_mul_i32 s48, s48, 1536
  v_and_b32 v58, 63, v0
  v_min_u32 v58, 11, v58
  v_lshl_add_u32 v58, v58, 7, s48
  v_min_u32 v58, FF_LAST-FF_PC0, v58
  v_mov_b32 v59, s47
  v_add_co_u32 v58, vcc, s46, v58
  v_addc_co_u32 v59, vcc, 0, v59, vcc
  global_load_dword a240, v[58:59], off
  v_and_b32 v54, 31, v32
  v_lshlrev_b32 v4, 4, v32
  v_bfe_u32 v34, v54, 1, 3
  v_xor_b32 v34, v34, v50
  v_lshl_add_u32 v35, v54, 7, s40
  v_xor_b32 v36, 0, v34
  v_lshl_add_u32 v44, v36, 4, v35
  v_xor_b32 v36, 2, v34
  v_lshl_add_u32 v45, v36, 4, v35
  v_xor_b32 v36, 4, v34
  v_lshl_add_u32 v46, v36, 4, v35
  v_xor_b32 v36, 6, v34
  v_lshl_add_u32 v47, v36, 4, v35
  s_mov_b32 s41, 0xffff0000
  s_mov_b32 s30, 83886080
  s_mov_b32 s31, 0x20000
  v_lshlrev_b32 v1, 8, v50
  v_lshl_add_u32 v1, v52, 6, v1
  v_lshl_add_u32 v1, v51, 5, v1
  v_lshl_add_u32 v1, v53, 3, v1
  v_add_u32 v2, 0x10000, v1
  v_add_u32 v3, 0x20000, v1
  v_bfe_u32 v34, v32, 3, 2
  v_lshl_add_u32 v34, v33, 2, v34
  v_lshlrev_b32 v34, 12, v34
  v_lshl_add_u32 v34, v50, 7, v34
  v_and_b32 v35, 7, v32
  v_lshl_add_u32 v7, v35, 4, v34
  s_mul_i32 s90, s5, 589824
  s_lshr_b32 s49, s4, 2
  s_lshl_b32 s49, s49, 10
  s_add_u32 s90, s90, s49
  v_mov_b32 v100, 0
  v_mov_b32 v101, 0
  v_mov_b32 v102, 0
  v_mov_b32 v103, 0
  v_mov_b32 v104, 0
  v_mov_b32 v105, 0
  v_mov_b32 v106, 0
  v_mov_b32 v107, 0
  s_mov_b32 s101, 0x3f803f80
  s_add_u32 s72, s7, s100
  s_sub_u32 s99, s72, 9
  s_cmp_ge_u32 s72, 9
  s_cselect_b32 s72, s99, s72
  s_add_u32 s100, s100, 1
  s_cmp_eq_u32 s100, 8
  s_cselect_b32 s100, 1, s100
  s_lshl_b32 s99, s72, 7
  s_add_u32 s73, s99, s98
  s_mul_i32 s72, s72, 589824
  s_add_u32 s74, s7, s100
  s_sub_u32 s99, s74, 9
  s_cmp_ge_u32 s74, 9
  s_cselect_b32 s74, s99, s74
  s_add_u32 s100, s100, 1
  s_cmp_eq_u32 s100, 8
  s_cselect_b32 s100, 1, s100
  s_lshl_b32 s99, s74, 7
  s_add_u32 s75, s99, s98
  s_mul_i32 s74, s74, 589824
  s_add_u32 s76, s7, s100
  s_sub_u32 s99, s76, 9
  s_cmp_ge_u32 s76, 9
  s_cselect_b32 s76, s99, s76
  s_add_u32 s100, s100, 1
  s_cmp_eq_u32 s100, 8
  s_cselect_b32 s100, 1, s100
  s_lshl_b32 s99, s76, 7
  s_add_u32 s77, s99, s98
  s_mul_i32 s76, s76, 589824
  s_add_u32 s78, s7, s100
  s_sub_u32 s99, s78, 9
  s_cmp_ge_u32 s78, 9
  s_cselect_b32 s78, s99, s78
  s_add_u32 s100, s100, 1
  s_cmp_eq_u32 s100, 8
  s_cselect_b32 s100, 1, s100
  s_lshl_b32 s99, s78, 7
  s_add_u32 s79, s99, s98
  s_mul_i32 s78, s78, 589824
  s_add_u32 s80, s7, s100
  s_sub_u32 s99, s80, 9
  s_cmp_ge_u32 s80, 9
  s_cselect_b32 s80, s99, s80
  s_add_u32 s100, s100, 1
  s_cmp_eq_u32 s100, 8
  s_cselect_b32 s100, 1, s100
  s_lshl_b32 s99, s80, 7
  s_add_u32 s81, s99, s98
  s_mul_i32 s80, s80, 589824
  s_add_u32 s82, s7, s100
  s_sub_u32 s99, s82, 9
  s_cmp_ge_u32 s82, 9
  s_cselect_b32 s82, s99, s82
  s_add_u32 s100, s100, 1
  s_cmp_eq_u32 s100, 8
  s_cselect_b32 s100, 1, s100
  s_lshl_b32 s99, s82, 7
  s_add_u32 s83, s99, s98
  s_mul_i32 s82, s82, 589824
  s_add_u32 s84, s7, s100
  s_sub_u32 s99, s84, 9
  s_cmp_ge_u32 s84, 9
  s_cselect_b32 s84, s99, s84
  s_lshl_b32 s99, s84, 7
  s_add_u32 s85, s99, s98
  s_mul_i32 s84, s84, 589824
  s_mov_b32 s22, 5308416
  s_mov_b32 s23, 0x20000
  s_mov_b32 s14, 1990656
  s_mov_b32 s15, 0x20000
  s_mov_b32 s26, 663552
  s_mov_b32 s27, 0x20000
  s_mov_b32 s38, 256
  s_mov_b32 s39, 0x20000
  s_mov_b32 s66, 2359296
  s_mov_b32 s67, 0x20000
  v_lshl_add_u32 v36, v33, 1, v51
  v_lshl_add_u32 v36, v36, 2, v52
  v_mul_u32_u24 v36, 1152, v36
  v_lshlrev_b32 v10, 4, v50
  s_mul_i32 s87, s3, 442368
  s_and_b32 s46, s4, 3
  s_mul_i32 s47, s46, 384
  s_add_u32 s47, s47, s87
  v_add3_u32 v9, v36, v56, s47
  s_mul_i32 s48, s46, 196608
  s_add_u32 s90, s90, s48
  s_lshl_b32 s49, s5, 4
  s_add_u32 s49, s49, s4
  s_lshl_b32 s49, s49, 2
  s_add_u32 s49, s49, s6
  s_mul_i32 s49, s49, 24576
  s_add_u32 s44, s49, 50331648
  s_cmp_eq_u32 s46, 2
  s_cselect_b32 s47, -2, 1
  s_mul_i32 s48, s47, 98304
  s_add_u32 s45, s44, s48
  s_mul_i32 s48, s47, 442368
  v_add_u32 v11, s48, v9
  s_cmp_eq_u32 s46, 0
  s_cselect_b32 s47, 2, -1
  s_mul_i32 s48, s47, 98304
  s_add_u32 s86, s44, s48
  s_mul_i32 s48, s47, 442368
  v_add_u32 v12, s48, v9
  s_mov_b32 s50, 0
  s_mov_b32 s51, 36864
  s_mov_b32 s52, 73728
  s_mov_b32 s53, 110592
  s_mov_b32 s54, 147456
  s_mov_b32 s55, 184320
  s_mov_b32 s56, 221184
  s_mov_b32 s57, 258048
  s_mov_b32 s58, 294912
  s_mov_b32 s59, 331776
  s_mov_b32 s60, 368640
  s_mov_b32 s61, 405504
  s_add_u32 m0, s40, 22400
  s_nop 0
  buffer_load_dwordx4 v8, s[16:19], s68 offen offset:128  lds
  s_add_u32 m0, s40, 23424
  s_nop 0
  buffer_load_dwordx4 v8, s[16:19], s69 offen offset:128  lds
  s_waitcnt vmcnt(10)
  s_add_u32 m0, s40, 8192
  s_nop 0
  buffer_load_dwordx4 v40, s[8:11], s73 offen offset:0  lds
  buffer_load_dwordx4 v41, s[8:11], s73 offen offset:1024  lds
  buffer_load_dwordx4 v42, s[8:11], s73 offen offset:2048  lds
  buffer_load_dwordx4 v43, s[8:11], s73 offen offset:3072  lds
  s_add_u32 s73, s72, 36864
  s_add_u32 m0, s40, 12288
  s_nop 0
  buffer_load_dwordx4 v40, s[8:11], s75 offen offset:0  lds
  buffer_load_dwordx4 v41, s[8:11], s75 offen offset:1024  lds
  buffer_load_dwordx4 v42, s[8:11], s75 offen offset:2048  lds
  buffer_load_dwordx4 v43, s[8:11], s75 offen offset:3072  lds
  s_add_u32 s75, s74, 36864
  ds_read_b128 v[112:115], v44 offset:0
  ds_read_b128 v[116:119], v45 offset:0
  ds_read_b128 v[120:123], v46 offset:0
  ds_read_b128 v[124:127], v47 offset:0
  s_waitcnt vmcnt(13)
  v_lshlrev_b32 v34, 16, v60
  v_and_b32 v35, s41, v60
  v_lshlrev_b32 v36, 16, v61
  v_and_b32 v37, s41, v61
  v_lshlrev_b32 v38, 16, v62
  v_and_b32 v39, s41, v62
  v_mul_u32_u24 v48, 24, v32
  ds_write_b64 v48, v[34:35] offset:0
  ds_write_b64 v48, v[36:37] offset:8
  ds_write_b64 v48, v[38:39] offset:16
  ds_read_b128 v[64:67], v10 offset:0
  ds_read_b128 v[68:71], v10 offset:32
  ds_read_b128 v[72:75], v10 offset:64
  ds_read_b128 v[76:79], v10 offset:96
  ds_read_b128 v[80:83], v10 offset:128
  ds_read_b128 v[84:87], v10 offset:160
  ds_read_b128 v[88:91], v10 offset:192
  ds_read_b128 v[92:95], v10 offset:224
  ds_read_b128 a[128:131], v10 offset:256
  ds_read_b128 a[132:135], v10 offset:288
  ds_read_b128 a[136:139], v10 offset:320
  ds_read_b128 a[140:143], v10 offset:352
  ds_read_b128 a[144:147], v10 offset:384
  ds_read_b128 a[148:151], v10 offset:416
  ds_read_b128 a[152:155], v10 offset:448
  ds_read_b128 a[156:159], v10 offset:480
  ds_read_b128 a[160:163], v10 offset:512
  ds_read_b128 a[164:167], v10 offset:544
  ds_read_b128 a[168:171], v10 offset:576
  ds_read_b128 a[172:175], v10 offset:608
  s_mov_b64 exec, 0
  s_cmp_eq_u32 s6, 0
  s_cbranch_scc1 FF_H0
  s_cmp_eq_u32 s6, 1
  s_cbranch_scc1 FF_H1
  s_cmp_eq_u32 s6, 2
  s_cbranch_scc1 FF_H2
  s_branch FF_H3
FF_H10:
FF_H11:
FF_H12:
FF_H13:
FF_HB:
  s_mov_b64 exec, -1
  s_add_u32 m0, s40, 16384
  s_nop 0
  buffer_load_dwordx4 v40, s[8:11], s77 offen offset:0  lds
  buffer_load_dwordx4 v41, s[8:11], s77 offen offset:1024  lds
  buffer_load_dwordx4 v42, s[8:11], s77 offen offset:2048  lds
  buffer_load_dwordx4 v43, s[8:11], s77 offen offset:3072  lds
  s_add_u32 s77, s76, 36864
  ds_read_b128 v[128:131], v44 offset:4096
  ds_read_b128 v[132:135], v45 offset:4096
  ds_read_b128 v[136:139], v46 offset:4096
  ds_read_b128 v[140:143], v47 offset:4096
  s_waitcnt lgkmcnt(15)
  v_dot2c_f32_bf16 v100, s101, v112
  v_dot2c_f32_bf16 v101, s101, v113
  v_dot2c_f32_bf16 v102, s101, v114
  v_dot2c_f32_bf16 v103, s101, v115
  v_dot2c_f32_bf16 v104, v112, v112
  v_dot2c_f32_bf16 v105, v113, v113
  v_dot2c_f32_bf16 v106, v114, v114
  v_dot2c_f32_bf16 v107, v115, v115
  v_dot2c_f32_bf16 v100, s101, v116
  v_dot2c_f32_bf16 v101, s101, v117
  v_dot2c_f32_bf16 v102, s101, v118
  v_dot2c_f32_bf16 v103, s101, v119
  v_dot2c_f32_bf16 v104, v116, v116
  v_dot2c_f32_bf16 v105, v117, v117
  v_dot2c_f32_bf16 v106, v118, v118
  v_dot2c_f32_bf16 v107, v119, v119
  v_dot2c_f32_bf16 v100, s101, v120
  v_dot2c_f32_bf16 v101, s101, v121
  v_dot2c_f32_bf16 v102, s101, v122
  v_dot2c_f32_bf16 v103, s101, v123
  v_dot2c_f32_bf16 v104, v120, v120
  v_dot2c_f32_bf16 v105, v121, v121
  v_dot2c_f32_bf16 v106, v122, v122
  v_dot2c_f32_bf16 v107, v123, v123
  v_dot2c_f32_bf16 v100, s101, v124
  v_dot2c_f32_bf16 v101, s101, v125
  v_dot2c_f32_bf16 v102, s101, v126
  v_dot2c_f32_bf16 v103, s101, v127
  v_dot2c_f32_bf16 v104, v124, v124
  v_dot2c_f32_bf16 v105, v125, v125
  v_dot2c_f32_bf16 v106, v126, v126
  v_dot2c_f32_bf16 v107, v127, v127
  s_waitcnt vmcnt(8)
  s_add_u32 m0, s40, 0
  s_nop 0
  buffer_load_dwordx4 v40, s[8:11], s79 offen offset:0  lds
  buffer_load_dwordx4 v41, s[8:11], s79 offen offset:1024  lds
  buffer_load_dwordx4 v42, s[8:11], s79 offen offset:2048  lds
  buffer_load_dwordx4 v43, s[8:11], s79 offen offset:3072  lds
  s_add_u32 s79, s78, 36864
  ds_read_b128 v[144:147], v44 offset:8192
  ds_read_b128 v[148:151], v45 offset:8192
  ds_read_b128 v[152:155], v46 offset:8192
  ds_read_b128 v[156:159], v47 offset:8192
  s_waitcnt lgkmcnt(7)
  v_dot2c_f32_bf16 v100, s101, v128
  v_dot2c_f32_bf16 v101, s101, v129
  v_dot2c_f32_bf16 v102, s101, v130
  v_dot2c_f32_bf16 v103, s101, v131
  v_dot2c_f32_bf16 v104, v128, v128
  v_dot2c_f32_bf16 v105, v129, v129
  v_dot2c_f32_bf16 v106, v130, v130
  v_dot2c_f32_bf16 v107, v131, v131
  s_waitcnt lgkmcnt(6)
  v_dot2c_f32_bf16 v100, s101, v132
  v_dot2c_f32_bf16 v101, s101, v133
  v_dot2c_f32_bf16 v102, s101, v134
  v_dot2c_f32_bf16 v103, s101, v135
  v_dot2c_f32_bf16 v104, v132, v132
  v_dot2c_f32_bf16 v105, v133, v133
  v_dot2c_f32_bf16 v106, v134, v134
  v_dot2c_f32_bf16 v107, v135, v135
  s_waitcnt lgkmcnt(5)
  v_dot2c_f32_bf16 v100, s101, v136
  v_dot2c_f32_bf16 v101, s101, v137
  v_dot2c_f32_bf16 v102, s101, v138
  v_dot2c_f32_bf16 v103, s101, v139
  v_dot2c_f32_bf16 v104, v136, v136
  v_dot2c_f32_bf16 v105, v137, v137
  v_dot2c_f32_bf16 v106, v138, v138
  v_dot2c_f32_bf16 v107, v139, v139
  s_waitcnt lgkmcnt(4)
  v_dot2c_f32_bf16 v100, s101, v140
  v_dot2c_f32_bf16 v101, s101, v141
  v_dot2c_f32_bf16 v102, s101, v142
  v_dot2c_f32_bf16 v103, s101, v143
  v_dot2c_f32_bf16 v104, v140, v140
  v_dot2c_f32_bf16 v105, v141, v141
  v_dot2c_f32_bf16 v106, v142, v142
  v_dot2c_f32_bf16 v107, v143, v143
  s_waitcnt vmcnt(8)
  s_add_u32 m0, s40, 4096
  s_nop 0
  buffer_load_dwordx4 v40, s[8:11], s81 offen offset:0  lds
  buffer_load_dwordx4 v41, s[8:11], s81 offen offset:1024  lds
  buffer_load_dwordx4 v42, s[8:11], s81 offen offset:2048  lds
  buffer_load_dwordx4 v43, s[8:11], s81 offen offset:3072  lds
  s_add_u32 s81, s80, 36864
  ds_read_b128 v[160:163], v44 offset:12288
  ds_read_b128 v[164:167], v45 offset:12288
  ds_read_b128 v[168:171], v46 offset:12288
  ds_read_b128 v[172:175], v47 offset:12288
  s_waitcnt lgkmcnt(7)
  v_dot2c_f32_bf16 v100, s101, v144
  v_dot2c_f32_bf16 v101, s101, v145
  v_dot2c_f32_bf16 v102, s101, v146
  v_dot2c_f32_bf16 v103, s101, v147
  v_dot2c_f32_bf16 v104, v144, v144
  v_dot2c_f32_bf16 v105, v145, v145
  v_dot2c_f32_bf16 v106, v146, v146
  v_dot2c_f32_bf16 v107, v147, v147
  s_waitcnt lgkmcnt(6)
  v_dot2c_f32_bf16 v100, s101, v148
  v_dot2c_f32_bf16 v101, s101, v149
  v_dot2c_f32_bf16 v102, s101, v150
  v_dot2c_f32_bf16 v103, s101, v151
  v_dot2c_f32_bf16 v104, v148, v148
  v_dot2c_f32_bf16 v105, v149, v149
  v_dot2c_f32_bf16 v106, v150, v150
  v_dot2c_f32_bf16 v107, v151, v151
  s_waitcnt lgkmcnt(5)
  v_dot2c_f32_bf16 v100, s101, v152
  v_dot2c_f32_bf16 v101, s101, v153
  v_dot2c_f32_bf16 v102, s101, v154
  v_dot2c_f32_bf16 v103, s101, v155
  v_dot2c_f32_bf16 v104, v152, v152
  v_dot2c_f32_bf16 v105, v153, v153
  v_dot2c_f32_bf16 v106, v154, v154
  v_dot2c_f32_bf16 v107, v155, v155
  s_waitcnt lgkmcnt(4)
  v_dot2c_f32_bf16 v100, s101, v156
  v_dot2c_f32_bf16 v101, s101, v157
  v_dot2c_f32_bf16 v102, s101, v158
  v_dot2c_f32_bf16 v103, s101, v159
  v_dot2c_f32_bf16 v104, v156, v156
  v_dot2c_f32_bf16 v105, v157, v157
  v_dot2c_f32_bf16 v106, v158, v158
  v_dot2c_f32_bf16 v107, v159, v159
  s_waitcnt vmcnt(8)
  s_add_u32 m0, s40, 8192
  s_nop 0
  buffer_load_dwordx4 v40, s[8:11], s83 offen offset:0  lds
  buffer_load_dwordx4 v41, s[8:11], s83 offen offset:1024  lds
  buffer_load_dwordx4 v42, s[8:11], s83 offen offset:2048  lds
  buffer_load_dwordx4 v43, s[8:11], s83 offen offset:3072  lds
  s_add_u32 s83, s82, 36864
  ds_read_b128 v[176:179], v44 offset:16384
  ds_read_b128 v[180:183], v45 offset:16384
  ds_read_b128 v[184:187], v46 offset:16384
  ds_read_b128 v[188:191], v47 offset:16384
  s_waitcnt lgkmcnt(7)
  v_dot2c_f32_bf16 v100, s101, v160
  v_dot2c_f32_bf16 v101, s101, v161
  v_dot2c_f32_bf16 v102, s101, v162
  v_dot2c_f32_bf16 v103, s101, v163
  v_dot2c_f32_bf16 v104, v160, v160
  v_dot2c_f32_bf16 v105, v161, v161
  v_dot2c_f32_bf16 v106, v162, v162
  v_dot2c_f32_bf16 v107, v163, v163
  s_waitcnt lgkmcnt(6)
  v_dot2c_f32_bf16 v100, s101, v164
  v_dot2c_f32_bf16 v101, s101, v165
  v_dot2c_f32_bf16 v102, s101, v166
  v_dot2c_f32_bf16 v103, s101, v167
  v_dot2c_f32_bf16 v104, v164, v164
  v_dot2c_f32_bf16 v105, v165, v165
  v_dot2c_f32_bf16 v106, v166, v166
  v_dot2c_f32_bf16 v107, v167, v167
  s_waitcnt lgkmcnt(5)
  v_dot2c_f32_bf16 v100, s101, v168
  v_dot2c_f32_bf16 v101, s101, v169
  v_dot2c_f32_bf16 v102, s101, v170
  v_dot2c_f32_bf16 v103, s101, v171
  v_dot2c_f32_bf16 v104, v168, v168
  v_dot2c_f32_bf16 v105, v169, v169
  v_dot2c_f32_bf16 v106, v170, v170
  v_dot2c_f32_bf16 v107, v171, v171
  s_waitcnt lgkmcnt(4)
  v_dot2c_f32_bf16 v100, s101, v172
  v_dot2c_f32_bf16 v101, s101, v173
  v_dot2c_f32_bf16 v102, s101, v174
  v_dot2c_f32_bf16 v103, s101, v175
  v_dot2c_f32_bf16 v104, v172, v172
  v_dot2c_f32_bf16 v105, v173, v173
  v_dot2c_f32_bf16 v106, v174, v174
  v_dot2c_f32_bf16 v107, v175, v175
  s_waitcnt vmcnt(8)
  s_add_u32 m0, s40, 12288
  s_nop 0
  buffer_load_dwordx4 v40, s[8:11], s85 offen offset:0  lds
  buffer_load_dwordx4 v41, s[8:11], s85 offen offset:1024  lds
  buffer_load_dwordx4 v42, s[8:11], s85 offen offset:2048  lds
  buffer_load_dwordx4 v43, s[8:11], s85 offen offset:3072  lds
  s_add_u32 s85, s84, 36864
  ds_read_b128 v[192:195], v44 offset:0
  ds_read_b128 v[196:199], v45 offset:0
  ds_read_b128 v[200:203], v46 offset:0
  ds_read_b128 v[204:207], v47 offset:0
  s_waitcnt lgkmcnt(7)
  v_dot2c_f32_bf16 v100, s101, v176
  v_dot2c_f32_bf16 v101, s101, v177
  v_dot2c_f32_bf16 v102, s101, v178
  v_dot2c_f32_bf16 v103, s101, v179
  v_dot2c_f32_bf16 v104, v176, v176
  v_dot2c_f32_bf16 v105, v177, v177
  v_dot2c_f32_bf16 v106, v178, v178
  v_dot2c_f32_bf16 v107, v179, v179
  s_waitcnt lgkmcnt(6)
  v_dot2c_f32_bf16 v100, s101, v180
  v_dot2c_f32_bf16 v101, s101, v181
  v_dot2c_f32_bf16 v102, s101, v182
  v_dot2c_f32_bf16 v103, s101, v183
  v_dot2c_f32_bf16 v104, v180, v180
  v_dot2c_f32_bf16 v105, v181, v181
  v_dot2c_f32_bf16 v106, v182, v182
  v_dot2c_f32_bf16 v107, v183, v183
  s_waitcnt lgkmcnt(5)
  v_dot2c_f32_bf16 v100, s101, v184
  v_dot2c_f32_bf16 v101, s101, v185
  v_dot2c_f32_bf16 v102, s101, v186
  v_dot2c_f32_bf16 v103, s101, v187
  v_dot2c_f32_bf16 v104, v184, v184
  v_dot2c_f32_bf16 v105, v185, v185
  v_dot2c_f32_bf16 v106, v186, v186
  v_dot2c_f32_bf16 v107, v187, v187
  s_waitcnt lgkmcnt(4)
  v_dot2c_f32_bf16 v100, s101, v188
  v_dot2c_f32_bf16 v101, s101, v189
  v_dot2c_f32_bf16 v102, s101, v190
  v_dot2c_f32_bf16 v103, s101, v191
  v_dot2c_f32_bf16 v104, v188, v188
  v_dot2c_f32_bf16 v105, v189, v189
  v_dot2c_f32_bf16 v106, v190, v190
  v_dot2c_f32_bf16 v107, v191, v191
  s_waitcnt vmcnt(8)
  s_add_u32 m0, s40, 24320
  s_nop 0
  buffer_load_dwordx4 v8, s[16:19], s68 offen offset:256  lds
  s_add_u32 m0, s40, 25344
  s_nop 0
  buffer_load_dwordx4 v8, s[16:19], s69 offen offset:256  lds
  s_add_u32 m0, s40, 26240
  s_nop 0
  buffer_load_dwordx4 v8, s[16:19], s68 offen offset:384  lds
  s_add_u32 m0, s40, 27264
  s_nop 0
  buffer_load_dwordx4 v8, s[16:19], s69 offen offset:384  lds
  ds_read_b128 v[208:211], v44 offset:4096
  ds_read_b128 v[212:215], v45 offset:4096
  ds_read_b128 v[216:219], v46 offset:4096
  ds_read_b128 v[220:223], v47 offset:4096
  s_waitcnt lgkmcnt(7)
  v_dot2c_f32_bf16 v100, s101, v192
  v_dot2c_f32_bf16 v101, s101, v193
  v_dot2c_f32_bf16 v102, s101, v194
  v_dot2c_f32_bf16 v103, s101, v195
  v_dot2c_f32_bf16 v104, v192, v192
  v_dot2c_f32_bf16 v105, v193, v193
  v_dot2c_f32_bf16 v106, v194, v194
  v_dot2c_f32_bf16 v107, v195, v195
  s_waitcnt lgkmcnt(6)
  v_dot2c_f32_bf16 v100, s101, v196
  v_dot2c_f32_bf16 v101, s101, v197
  v_dot2c_f32_bf16 v102, s101, v198
  v_dot2c_f32_bf16 v103, s101, v199
  v_dot2c_f32_bf16 v104, v196, v196
  v_dot2c_f32_bf16 v105, v197, v197
  v_dot2c_f32_bf16 v106, v198, v198
  v_dot2c_f32_bf16 v107, v199, v199
  s_waitcnt lgkmcnt(5)
  v_dot2c_f32_bf16 v100, s101, v200
  v_dot2c_f32_bf16 v101, s101, v201
  v_dot2c_f32_bf16 v102, s101, v202
  v_dot2c_f32_bf16 v103, s101, v203
  v_dot2c_f32_bf16 v104, v200, v200
  v_dot2c_f32_bf16 v105, v201, v201
  v_dot2c_f32_bf16 v106, v202, v202
  v_dot2c_f32_bf16 v107, v203, v203
  s_waitcnt lgkmcnt(4)
  v_dot2c_f32_bf16 v100, s101, v204
  v_dot2c_f32_bf16 v101, s101, v205
  v_dot2c_f32_bf16 v102, s101, v206
  v_dot2c_f32_bf16 v103, s101, v207
  v_dot2c_f32_bf16 v104, v204, v204
  v_dot2c_f32_bf16 v105, v205, v205
  v_dot2c_f32_bf16 v106, v206, v206
  v_dot2c_f32_bf16 v107, v207, v207
  s_waitcnt vmcnt(8)
  s_add_u32 m0, s40, 28160
  s_nop 0
  buffer_load_dwordx4 v8, s[16:19], s68 offen offset:512  lds
  s_add_u32 m0, s40, 29184
  s_nop 0
  buffer_load_dwordx4 v8, s[16:19], s69 offen offset:512  lds
  s_add_u32 m0, s40, 30720
  s_nop 0
  buffer_load_dwordx4 v8, s[16:19], s70 offen  lds
  s_add_u32 m0, s40, 31744
  s_nop 0
  buffer_load_dwordx4 v8, s[16:19], s71 offen  lds
  ds_read_b128 v[224:227], v44 offset:8192
  ds_read_b128 v[228:231], v45 offset:8192
  ds_read_b128 v[232:235], v46 offset:8192
  ds_read_b128 v[236:239], v47 offset:8192
  s_waitcnt lgkmcnt(7)
  v_dot2c_f32_bf16 v100, s101, v208
  v_dot2c_f32_bf16 v101, s101, v209
  v_dot2c_f32_bf16 v102, s101, v210
  v_dot2c_f32_bf16 v103, s101, v211
  v_dot2c_f32_bf16 v104, v208, v208
  v_dot2c_f32_bf16 v105, v209, v209
  v_dot2c_f32_bf16 v106, v210, v210
  v_dot2c_f32_bf16 v107, v211, v211
  s_waitcnt lgkmcnt(6)
  v_dot2c_f32_bf16 v100, s101, v212
  v_dot2c_f32_bf16 v101, s101, v213
  v_dot2c_f32_bf16 v102, s101, v214
  v_dot2c_f32_bf16 v103, s101, v215
  v_dot2c_f32_bf16 v104, v212, v212
  v_dot2c_f32_bf16 v105, v213, v213
  v_dot2c_f32_bf16 v106, v214, v214
  v_dot2c_f32_bf16 v107, v215, v215
  s_waitcnt lgkmcnt(5)
  v_dot2c_f32_bf16 v100, s101, v216
  v_dot2c_f32_bf16 v101, s101, v217
  v_dot2c_f32_bf16 v102, s101, v218
  v_dot2c_f32_bf16 v103, s101, v219
  v_dot2c_f32_bf16 v104, v216, v216
  v_dot2c_f32_bf16 v105, v217, v217
  v_dot2c_f32_bf16 v106, v218, v218
  v_dot2c_f32_bf16 v107, v219, v219
  s_waitcnt lgkmcnt(4)
  v_dot2c_f32_bf16 v100, s101, v220
  v_dot2c_f32_bf16 v101, s101, v221
  v_dot2c_f32_bf16 v102, s101, v222
  v_dot2c_f32_bf16 v103, s101, v223
  v_dot2c_f32_bf16 v104, v220, v220
  v_dot2c_f32_bf16 v105, v221, v221
  v_dot2c_f32_bf16 v106, v222, v222
  v_dot2c_f32_bf16 v107, v223, v223
  s_waitcnt vmcnt(8)
  s_add_u32 m0, s40, 32640
  s_nop 0
  buffer_load_dwordx4 v8, s[16:19], s70 offen offset:128  lds
  s_add_u32 m0, s40, 33664
  s_nop 0
  buffer_load_dwordx4 v8, s[16:19], s71 offen offset:128  lds
  s_add_u32 m0, s40, 34560
  s_nop 0
  buffer_load_dwordx4 v8, s[16:19], s70 offen offset:256  lds
  s_add_u32 m0, s40, 35584
  s_nop 0
  buffer_load_dwordx4 v8, s[16:19], s71 offen offset:256  lds
  ds_read_b128 v[240:243], v44 offset:12288
  ds_read_b128 v[244:247], v45 offset:12288
  ds_read_b128 v[248:251], v46 offset:12288
  ds_read_b128 v[252:255], v47 offset:12288
  s_waitcnt lgkmcnt(7)
  v_dot2c_f32_bf16 v100, s101, v224
  v_dot2c_f32_bf16 v101, s101, v225
  v_dot2c_f32_bf16 v102, s101, v226
  v_dot2c_f32_bf16 v103, s101, v227
  v_dot2c_f32_bf16 v104, v224, v224
  v_dot2c_f32_bf16 v105, v225, v225
  v_dot2c_f32_bf16 v106, v226, v226
  v_dot2c_f32_bf16 v107, v227, v227
  s_waitcnt lgkmcnt(6)
  v_dot2c_f32_bf16 v100, s101, v228
  v_dot2c_f32_bf16 v101, s101, v229
  v_dot2c_f32_bf16 v102, s101, v230
  v_dot2c_f32_bf16 v103, s101, v231
  v_dot2c_f32_bf16 v104, v228, v228
  v_dot2c_f32_bf16 v105, v229, v229
  v_dot2c_f32_bf16 v106, v230, v230
  v_dot2c_f32_bf16 v107, v231, v231
  s_waitcnt lgkmcnt(5)
  v_dot2c_f32_bf16 v100, s101, v232
  v_dot2c_f32_bf16 v101, s101, v233
  v_dot2c_f32_bf16 v102, s101, v234
  v_dot2c_f32_bf16 v103, s101, v235
  v_dot2c_f32_bf16 v104, v232, v232
  v_dot2c_f32_bf16 v105, v233, v233
  v_dot2c_f32_bf16 v106, v234, v234
  v_dot2c_f32_bf16 v107, v235, v235
  s_waitcnt lgkmcnt(4)
  v_dot2c_f32_bf16 v100, s101, v236
  v_dot2c_f32_bf16 v101, s101, v237
  v_dot2c_f32_bf16 v102, s101, v238
  v_dot2c_f32_bf16 v103, s101, v239
  v_dot2c_f32_bf16 v104, v236, v236
  v_dot2c_f32_bf16 v105, v237, v237
  v_dot2c_f32_bf16 v106, v238, v238
  v_dot2c_f32_bf16 v107, v239, v239
  s_waitcnt lgkmcnt(0)
  s_barrier
  ds_read_b64_tr_b16 a[0:1], v1 offset:24576
  ds_read_b64_tr_b16 a[2:3], v1 offset:25600
  ds_read_b64_tr_b16 a[4:5], v1 offset:25088
  ds_read_b64_tr_b16 a[6:7], v1 offset:26112
  v_dot2c_f32_bf16 v100, s101, v240
  v_dot2c_f32_bf16 v101, s101, v241
  v_dot2c_f32_bf16 v102, s101, v242
  v_dot2c_f32_bf16 v103, s101, v243
  v_dot2c_f32_bf16 v104, v240, v240
  v_dot2c_f32_bf16 v105, v241, v241
  v_dot2c_f32_bf16 v106, v242, v242
  v_dot2c_f32_bf16 v107, v243, v243
  v_dot2c_f32_bf16 v100, s101, v244
  v_dot2c_f32_bf16 v101, s101, v245
  v_dot2c_f32_bf16 v102, s101, v246
  v_dot2c_f32_bf16 v103, s101, v247
  v_dot2c_f32_bf16 v104, v244, v244
  v_dot2c_f32_bf16 v105, v245, v245
  v_dot2c_f32_bf16 v106, v246, v246
  v_dot2c_f32_bf16 v107, v247, v247
  v_dot2c_f32_bf16 v100, s101, v248
FF_H0:
  s_cbranch_execz FF_H4
  v_dot2c_f32_bf16 v101, s101, v249
  v_dot2c_f32_bf16 v102, s101, v250
  v_dot2c_f32_bf16 v103, s101, v251
  v_dot2c_f32_bf16 v104, v248, v248
  v_dot2c_f32_bf16 v105, v249, v249
  v_dot2c_f32_bf16 v106, v250, v250
  v_dot2c_f32_bf16 v107, v251, v251
  v_dot2c_f32_bf16 v100, s101, v252
  v_dot2c_f32_bf16 v101, s101, v253
  v_dot2c_f32_bf16 v102, s101, v254
  v_dot2c_f32_bf16 v103, s101, v255
  v_dot2c_f32_bf16 v104, v252, v252
  v_dot2c_f32_bf16 v105, v253, v253
  v_dot2c_f32_bf16 v106, v254, v254
  v_dot2c_f32_bf16 v107, v255, v255
  v_add_f32 v100, v100, v102
  v_add_f32 v101, v101, v103
  v_add_f32 v104, v104, v106
  v_add_f32 v105, v105, v107
  v_add_f32 v26, v100, v101
  v_add_f32 v27, v104, v105
  v_add_f32 v5, v100, v101
  v_add_f32 v6, v104, v105
  s_nop 0
  v_permlane32_swap_b32 v26, v5
  v_permlane32_swap_b32 v27, v6
  v_add_f32 v26, v26, v5
  v_add_f32 v27, v27, v6
  v_mul_f32 v26, 0x3ae38e39, v26
  v_mul_f32 v27, 0x3ae38e39, v27
  v_fma_f32 v27, -v26, v26, v27
  v_max_f32 v27, 0, v27
  v_cvt_pk_bf16_f32 v26, v27, v26
  ds_read_b64_tr_b16 a[8:9], v1 offset:26624
  ds_read_b64_tr_b16 a[10:11], v1 offset:27648
  v_lshlrev_b32 v27, 16, v26
  v_and_b32 v26, s41, v26
  v_add_f32 v27, 0x3727c5ac, v27
  v_cvt_pk_bf16_f32 v27, v27, v27
  v_lshlrev_b32 v27, 16, v27
  v_sqrt_f32 v27, v27
  ds_read_b64_tr_b16 a[12:13], v1 offset:27136
  ds_read_b64_tr_b16 a[14:15], v1 offset:28160
  v_cvt_pk_bf16_f32 v27, v27, v27
  v_lshlrev_b32 v27, 16, v27
  v_mul_f32 v6, 0x3f800000, v27
  v_rcp_f32 v5, v6
  ds_read_b64_tr_b16 a[16:17], v1 offset:64512
  ds_read_b64_tr_b16 a[18:19], v2 offset:0
  v_mul_f32 v6, -v26, v5
  v_lshlrev_b32 v18, 16, v112
  v_and_b32 v19, s41, v112
  v_lshlrev_b32 v20, 16, v113
  v_and_b32 v21, s41, v113
  v_fma_f32 v18, v18, v5, v6
  v_fma_f32 v19, v19, v5, v6
  v_fma_f32 v20, v20, v5, v6
  v_fma_f32 v21, v21, v5, v6
  v_cvt_pk_bf16_f32 v112, v18, v19
  v_cvt_pk_bf16_f32 v113, v20, v21
  v_lshlrev_b32 v22, 16, v114
  v_and_b32 v23, s41, v114
  v_lshlrev_b32 v24, 16, v115
  v_and_b32 v25, s41, v115
  v_fma_f32 v22, v22, v5, v6
  v_fma_f32 v23, v23, v5, v6
  v_fma_f32 v24, v24, v5, v6
  v_fma_f32 v25, v25, v5, v6
  v_cvt_pk_bf16_f32 v114, v22, v23
  v_cvt_pk_bf16_f32 v115, v24, v25
  ds_read_b64_tr_b16 a[20:21], v1 offset:65024
  ds_read_b64_tr_b16 a[22:23], v2 offset:512
  ds_read_b64_tr_b16 a[24:25], v2 offset:1024
  ds_read_b64_tr_b16 a[26:27], v2 offset:2048
  s_add_u32 m0, s40, 36480
  s_waitcnt lgkmcnt(8)
  v_mfma_f32_32x32x16_bf16 v[64:79], a[0:3], v[112:115], v[64:79]
  buffer_load_dwordx4 v8, s[16:19], s70 offen offset:384  lds
  ds_read_b64_tr_b16 a[28:29], v2 offset:1536
  ds_read_b64_tr_b16 a[30:31], v2 offset:2560
  ds_read_b128 a[176:179], v10 offset:640
  ds_read_b128 a[180:183], v10 offset:672
  v_mfma_f32_32x32x16_bf16 v[80:95], a[4:7], v[112:115], v[80:95]
  ds_read_b64_tr_b16 a[0:1], v2 offset:38912
  ds_read_b64_tr_b16 a[2:3], v2 offset:39936
  ds_read_b128 a[184:187], v10 offset:704
  ds_read_b128 a[188:191], v10 offset:736
  ds_read_b128 a[192:195], v10 offset:768
  v_mfma_f32_32x32x16_bf16 a[128:143], a[8:11], v[112:115], a[128:143]
  ds_read_b64_tr_b16 a[4:5], v2 offset:39424
  ds_read_b64_tr_b16 a[6:7], v2 offset:40448
  ds_read_b128 a[196:199], v10 offset:800
  v_lshlrev_b32 v18, 16, v116
  v_and_b32 v19, s41, v116
  v_lshlrev_b32 v20, 16, v117
  v_and_b32 v21, s41, v117
  v_fma_f32 v18, v18, v5, v6
  v_fma_f32 v19, v19, v5, v6
  v_fma_f32 v20, v20, v5, v6
  v_fma_f32 v21, v21, v5, v6
  v_cvt_pk_bf16_f32 v116, v18, v19
  v_cvt_pk_bf16_f32 v117, v20, v21
  v_lshlrev_b32 v22, 16, v118
  v_and_b32 v23, s41, v118
  v_lshlrev_b32 v24, 16, v119
  v_and_b32 v25, s41, v119
  v_fma_f32 v22, v22, v5, v6
  v_fma_f32 v23, v23, v5, v6
  v_fma_f32 v24, v24, v5, v6
  v_fma_f32 v25, v25, v5, v6
  v_cvt_pk_bf16_f32 v118, v22, v23
  v_cvt_pk_bf16_f32 v119, v24, v25
  s_add_u32 m0, s40, 37504
  s_waitcnt lgkmcnt(14)
  v_mfma_f32_32x32x16_bf16 a[144:159], a[12:15], v[112:115], a[144:159]
  buffer_load_dwordx4 v8, s[16:19], s71 offen offset:384  lds
  ds_read_b64_tr_b16 a[8:9], v2 offset:40960
  ds_read_b64_tr_b16 a[10:11], v2 offset:41984
  ds_read_b128 a[200:203], v10 offset:832
  ds_read_b128 a[204:207], v10 offset:864
  v_mfma_f32_32x32x16_bf16 v[64:79], a[16:19], v[116:119], v[64:79]
  ds_read_b64_tr_b16 a[12:13], v2 offset:41472
  ds_read_b64_tr_b16 a[14:15], v2 offset:42496
  ds_read_b128 v[32:35], v10 offset:896
  ds_read_b128 v[36:39], v10 offset:928
  ds_read_b128 v[40:43], v10 offset:960
  v_mfma_f32_32x32x16_bf16 v[80:95], a[20:23], v[116:119], v[80:95]
  ds_read_b64_tr_b16 a[16:17], v3 offset:13312
  ds_read_b64_tr_b16 a[18:19], v3 offset:14336
  ds_read_b128 v[44:47], v10 offset:992
  s_add_u32 m0, s40, 38400
  s_waitcnt lgkmcnt(15)
  v_mfma_f32_32x32x16_bf16 a[128:143], a[24:27], v[116:119], a[128:143]
  buffer_load_dwordx4 v8, s[16:19], s70 offen offset:512  lds
  ds_read_b64_tr_b16 a[20:21], v3 offset:13824
  ds_read_b64_tr_b16 a[22:23], v3 offset:14848
  ds_read_b128 v[48:51], v10 offset:1024
  ds_read_b128 v[52:55], v10 offset:1056
  v_lshlrev_b32 v18, 16, v120
  v_and_b32 v19, s41, v120
  v_lshlrev_b32 v20, 16, v121
  v_and_b32 v21, s41, v121
  v_fma_f32 v18, v18, v5, v6
  v_fma_f32 v19, v19, v5, v6
  v_fma_f32 v20, v20, v5, v6
  v_fma_f32 v21, v21, v5, v6
  v_cvt_pk_bf16_f32 v120, v18, v19
  v_cvt_pk_bf16_f32 v121, v20, v21
  v_lshlrev_b32 v22, 16, v122
  v_and_b32 v23, s41, v122
  v_lshlrev_b32 v24, 16, v123
  v_and_b32 v25, s41, v123
  v_fma_f32 v22, v22, v5, v6
  v_fma_f32 v23, v23, v5, v6
  v_fma_f32 v24, v24, v5, v6
  v_fma_f32 v25, v25, v5, v6
  v_cvt_pk_bf16_f32 v122, v22, v23
  v_cvt_pk_bf16_f32 v123, v24, v25
  v_mfma_f32_32x32x16_bf16 a[144:159], a[28:31], v[116:119], a[144:159]
  ds_read_b64_tr_b16 a[24:25], v3 offset:15360
  ds_read_b64_tr_b16 a[26:27], v3 offset:16384
  ds_read_b128 v[56:59], v10 offset:1088
  ds_read_b128 v[60:63], v10 offset:1120
  ds_read_b128 v[96:99], v10 offset:1152
  v_mfma_f32_32x32x16_bf16 v[64:79], a[0:3], v[120:123], v[64:79]
  ds_read_b64_tr_b16 a[28:29], v3 offset:15872
  ds_read_b64_tr_b16 a[30:31], v3 offset:16896
  ds_read_b128 v[100:103], v10 offset:1184
  s_add_u32 m0, s40, -512
  s_waitcnt lgkmcnt(15)
  v_mfma_f32_32x32x16_bf16 v[80:95], a[4:7], v[120:123], v[80:95]
  buffer_load_dwordx4 v8, s[16:19], s71 offen offset:512  lds
  s_waitcnt vmcnt(10)
  s_barrier
  ds_read_b64_tr_b16 a[0:1], v1 offset:28672
  ds_read_b64_tr_b16 a[2:3], v1 offset:29696
  v_lshlrev_b32 v18, 16, v124
  v_mfma_f32_32x32x16_bf16 a[128:143], a[8:11], v[120:123], a[128:143]
  ds_read_b64_tr_b16 a[4:5], v1 offset:29184
  ds_read_b64_tr_b16 a[6:7], v1 offset:30208
  ds_read_b128 v[104:107], v10 offset:1216
  ds_read_b128 v[108:111], v10 offset:1248
  v_and_b32 v19, s41, v124
  v_lshlrev_b32 v20, 16, v125
  v_and_b32 v21, s41, v125
  v_fma_f32 v18, v18, v5, v6
  v_fma_f32 v19, v19, v5, v6
  v_fma_f32 v20, v20, v5, v6
  v_fma_f32 v21, v21, v5, v6
  v_cvt_pk_bf16_f32 v124, v18, v19
  v_cvt_pk_bf16_f32 v125, v20, v21
  v_lshlrev_b32 v22, 16, v126
  v_and_b32 v23, s41, v126
  v_lshlrev_b32 v24, 16, v127
  v_and_b32 v25, s41, v127
  v_fma_f32 v22, v22, v5, v6
  v_fma_f32 v23, v23, v5, v6
  v_fma_f32 v24, v24, v5, v6
  v_fma_f32 v25, v25, v5, v6
  v_cvt_pk_bf16_f32 v126, v22, v23
  v_cvt_pk_bf16_f32 v127, v24, v25
  v_mfma_f32_32x32x16_bf16 a[144:159], a[12:15], v[120:123], a[144:159]
  ds_read_b64_tr_b16 a[8:9], v1 offset:30720
  ds_read_b64_tr_b16 a[10:11], v1 offset:31744
  v_lshlrev_b32 v18, 16, v128
  v_and_b32 v19, s41, v128
  s_add_u32 m0, s40, 1024
  s_waitcnt lgkmcnt(14)
  v_mfma_f32_32x32x16_bf16 v[64:79], a[16:19], v[124:127], v[64:79]
  buffer_load_dwordx4 v8, s[16:19], s72 offen  lds
  ds_read_b64_tr_b16 a[12:13], v1 offset:31232
  ds_read_b64_tr_b16 a[14:15], v1 offset:32256
  v_lshlrev_b32 v20, 16, v129
  v_and_b32 v21, s41, v129
  v_mfma_f32_32x32x16_bf16 v[80:95], a[20:23], v[124:127], v[80:95]
  ds_read_b64_tr_b16 a[16:17], v1 offset:32768
  ds_read_b64_tr_b16 a[18:19], v1 offset:33792
  v_fma_f32 v18, v18, v5, v6
  v_fma_f32 v19, v19, v5, v6
  v_fma_f32 v20, v20, v5, v6
  v_mfma_f32_32x32x16_bf16 a[128:143], a[24:27], v[124:127], a[128:143]
  ds_read_b64_tr_b16 a[20:21], v1 offset:33280
  ds_read_b64_tr_b16 a[22:23], v1 offset:34304
  v_fma_f32 v21, v21, v5, v6
  s_add_u32 m0, s40, 2048
  s_waitcnt lgkmcnt(10)
  v_mfma_f32_32x32x16_bf16 a[144:159], a[28:31], v[124:127], a[144:159]
  buffer_load_dwordx4 v8, s[16:19], s73 offen  lds
  ds_read_b64_tr_b16 a[24:25], v2 offset:3072
  ds_read_b64_tr_b16 a[26:27], v2 offset:4096
  v_cvt_pk_bf16_f32 v128, v18, v19
  v_cvt_pk_bf16_f32 v129, v20, v21
  v_mfma_f32_32x32x16_bf16 a[160:175], a[0:3], v[112:115], a[160:175]
  ds_read_b64_tr_b16 a[28:29], v2 offset:3584
  ds_read_b64_tr_b16 a[30:31], v2 offset:4608
  v_lshlrev_b32 v22, 16, v130
  v_and_b32 v23, s41, v130
  v_lshlrev_b32 v24, 16, v131
  v_and_b32 v25, s41, v131
  v_mfma_f32_32x32x16_bf16 a[176:191], a[4:7], v[112:115], a[176:191]
  ds_read_b64_tr_b16 a[0:1], v2 offset:5120
  ds_read_b64_tr_b16 a[2:3], v2 offset:6144
  v_fma_f32 v22, v22, v5, v6
  s_add_u32 m0, s40, 2944
  s_waitcnt lgkmcnt(8)
  v_mfma_f32_32x32x16_bf16 a[192:207], a[8:11], v[112:115], a[192:207]
  buffer_load_dwordx4 v8, s[16:19], s72 offen offset:128  lds
  ds_read_b64_tr_b16 a[4:5], v2 offset:5632
  ds_read_b64_tr_b16 a[6:7], v2 offset:6656
  v_fma_f32 v23, v23, v5, v6
  v_fma_f32 v24, v24, v5, v6
  v_mfma_f32_32x32x16_bf16 v[32:47], a[12:15], v[112:115], v[32:47]
  ds_read_b64_tr_b16 a[8:9], v2 offset:7168
  ds_read_b64_tr_b16 a[10:11], v2 offset:8192
  v_fma_f32 v25, v25, v5, v6
  v_cvt_pk_bf16_f32 v130, v22, v23
  v_cvt_pk_bf16_f32 v131, v24, v25
  v_mfma_f32_32x32x16_bf16 v[48:63], a[16:19], v[112:115], v[48:63]
  ds_read_b64_tr_b16 a[12:13], v2 offset:7680
  ds_read_b64_tr_b16 a[14:15], v2 offset:8704
  v_lshlrev_b32 v18, 16, v132
  v_and_b32 v19, s41, v132
  s_add_u32 m0, s40, 3968
  s_waitcnt lgkmcnt(8)
  v_mfma_f32_32x32x16_bf16 v[96:111], a[20:23], v[112:115], v[96:111]
  buffer_load_dwordx4 v8, s[16:19], s73 offen offset:128  lds
  ds_read_b64_tr_b16 a[16:17], v2 offset:43008
  ds_read_b64_tr_b16 a[18:19], v2 offset:44032
  v_lshlrev_b32 v20, 16, v133
  v_and_b32 v21, s41, v133
  v_mfma_f32_32x32x16_bf16 a[160:175], a[24:27], v[116:119], a[160:175]
  ds_read_b64_tr_b16 a[20:21], v2 offset:43520
  ds_read_b64_tr_b16 a[22:23], v2 offset:44544
  v_fma_f32 v18, v18, v5, v6
  v_fma_f32 v19, v19, v5, v6
  v_fma_f32 v20, v20, v5, v6
  v_mfma_f32_32x32x16_bf16 a[176:191], a[28:31], v[116:119], a[176:191]
  ds_read_b64_tr_b16 a[24:25], v2 offset:45056
  ds_read_b64_tr_b16 a[26:27], v2 offset:46080
  v_fma_f32 v21, v21, v5, v6
  s_add_u32 m0, s40, 4864
  s_waitcnt lgkmcnt(8)
  v_mfma_f32_32x32x16_bf16 a[192:207], a[0:3], v[116:119], a[192:207]
  buffer_load_dwordx4 v8, s[16:19], s72 offen offset:256  lds
  ds_read_b64_tr_b16 a[28:29], v2 offset:45568
  ds_read_b64_tr_b16 a[30:31], v2 offset:46592
  v_cvt_pk_bf16_f32 v132, v18, v19
  v_cvt_pk_bf16_f32 v133, v20, v21
  v_mfma_f32_32x32x16_bf16 v[32:47], a[4:7], v[116:119], v[32:47]
  ds_read_b64_tr_b16 a[0:1], v2 offset:47104
  ds_read_b64_tr_b16 a[2:3], v2 offset:48128
  v_lshlrev_b32 v22, 16, v134
  v_and_b32 v23, s41, v134
  v_lshlrev_b32 v24, 16, v135
  v_and_b32 v25, s41, v135
  v_mfma_f32_32x32x16_bf16 v[48:63], a[8:11], v[116:119], v[48:63]
  ds_read_b64_tr_b16 a[4:5], v2 offset:47616
  ds_read_b64_tr_b16 a[6:7], v2 offset:48640
  v_fma_f32 v22, v22, v5, v6
  s_add_u32 m0, s40, 5888
  s_waitcnt lgkmcnt(8)
  v_mfma_f32_32x32x16_bf16 v[96:111], a[12:15], v[116:119], v[96:111]
  buffer_load_dwordx4 v8, s[16:19], s73 offen offset:256  lds
  ds_read_b64_tr_b16 a[8:9], v3 offset:17408
  ds_read_b64_tr_b16 a[10:11], v3 offset:18432
  v_fma_f32 v23, v23, v5, v6
  v_fma_f32 v24, v24, v5, v6
  v_mfma_f32_32x32x16_bf16 a[160:175], a[16:19], v[120:123], a[160:175]
  ds_read_b64_tr_b16 a[12:13], v3 offset:17920
  ds_read_b64_tr_b16 a[14:15], v3 offset:18944
  v_fma_f32 v25, v25, v5, v6
  v_cvt_pk_bf16_f32 v134, v22, v23
  v_cvt_pk_bf16_f32 v135, v24, v25
  v_mfma_f32_32x32x16_bf16 a[176:191], a[20:23], v[120:123], a[176:191]
  ds_read_b64_tr_b16 a[16:17], v3 offset:19456
  ds_read_b64_tr_b16 a[18:19], v3 offset:20480
  v_lshlrev_b32 v18, 16, v136
  v_and_b32 v19, s41, v136
  s_add_u32 m0, s40, 6784
  s_waitcnt lgkmcnt(8)
  v_mfma_f32_32x32x16_bf16 a[192:207], a[24:27], v[120:123], a[192:207]
  buffer_load_dwordx4 v8, s[16:19], s72 offen offset:384  lds
  ds_read_b64_tr_b16 a[20:21], v3 offset:19968
  ds_read_b64_tr_b16 a[22:23], v3 offset:20992
  s_lshl_b32 s42, s5, 4
  s_andn2_b32 s47, s4, 3
  s_add_u32 s42, s42, s47
  s_add_u32 s42, s42, s6
  s_mul_i32 s42, s42, 4352
  s_and_b32 s47, s4, 3
  s_lshl_b32 s47, s47, 2
  s_add_u32 s42, s42, s47
  s_add_u32 s42, s42, 46137344
  v_mov_b32 v28, 0
  buffer_store_dword v28, off, s[28:31], s42 sc1
  buffer_store_dword v28, off, s[28:31], s42 offset:2048 sc1
  v_mfma_f32_32x32x16_bf16 v[32:47], a[28:31], v[120:123], v[32:47]
  ds_read_b64_tr_b16 a[24:25], v3 offset:21504
  ds_read_b64_tr_b16 a[26:27], v3 offset:22528
  v_lshlrev_b32 v20, 16, v137
  v_mfma_f32_32x32x16_bf16 v[48:63], a[0:3], v[120:123], v[48:63]
  ds_read_b64_tr_b16 a[28:29], v3 offset:22016
  ds_read_b64_tr_b16 a[30:31], v3 offset:23040
  v_and_b32 v21, s41, v137
  s_add_u32 m0, s40, 7808
  s_waitcnt lgkmcnt(8)
  v_mfma_f32_32x32x16_bf16 v[96:111], a[4:7], v[120:123], v[96:111]
  buffer_load_dwordx4 v8, s[16:19], s73 offen offset:384  lds
  s_waitcnt vmcnt(10)
  s_barrier
  ds_read_b64_tr_b16 a[0:1], v1 offset:34816
  ds_read_b64_tr_b16 a[2:3], v1 offset:35840
  v_mfma_f32_32x32x16_bf16 a[160:175], a[8:11], v[124:127], a[160:175]
  ds_read_b64_tr_b16 a[4:5], v1 offset:35328
  ds_read_b64_tr_b16 a[6:7], v1 offset:36352
  v_fma_f32 v18, v18, v5, v6
  v_fma_f32 v19, v19, v5, v6
  v_fma_f32 v20, v20, v5, v6
  v_mfma_f32_32x32x16_bf16 a[176:191], a[12:15], v[124:127], a[176:191]
  ds_read_b64_tr_b16 a[8:9], v1 offset:36864
  ds_read_b64_tr_b16 a[10:11], v1 offset:37888
  v_fma_f32 v21, v21, v5, v6
  s_add_u32 m0, s40, 8704
  s_waitcnt lgkmcnt(8)
  v_mfma_f32_32x32x16_bf16 a[192:207], a[16:19], v[124:127], a[192:207]
  buffer_load_dwordx4 v8, s[16:19], s72 offen offset:512  lds
  ds_read_b64_tr_b16 a[12:13], v1 offset:37376
  ds_read_b64_tr_b16 a[14:15], v1 offset:38400
  v_cvt_pk_bf16_f32 v136, v18, v19
  v_cvt_pk_bf16_f32 v137, v20, v21
  v_mfma_f32_32x32x16_bf16 v[32:47], a[20:23], v[124:127], v[32:47]
  ds_read_b64_tr_b16 a[16:17], v1 offset:38912
  ds_read_b64_tr_b16 a[18:19], v1 offset:39936
  v_lshlrev_b32 v22, 16, v138
  v_and_b32 v23, s41, v138
  v_lshlrev_b32 v24, 16, v139
  v_and_b32 v25, s41, v139
  v_mfma_f32_32x32x16_bf16 v[48:63], a[24:27], v[124:127], v[48:63]
  ds_read_b64_tr_b16 a[20:21], v1 offset:39424
  ds_read_b64_tr_b16 a[22:23], v1 offset:40448
  v_fma_f32 v22, v22, v5, v6
  s_add_u32 m0, s40, 9728
  s_waitcnt lgkmcnt(8)
  v_mfma_f32_32x32x16_bf16 v[96:111], a[28:31], v[124:127], v[96:111]
  buffer_load_dwordx4 v8, s[16:19], s73 offen offset:512  lds
  ds_read_b64_tr_b16 a[24:25], v1 offset:40960
  ds_read_b64_tr_b16 a[26:27], v1 offset:41984
  v_fma_f32 v23, v23, v5, v6
  v_fma_f32 v24, v24, v5, v6
  v_mfma_f32_32x32x16_bf16 v[64:79], a[0:3], v[128:131], v[64:79]
  ds_read_b64_tr_b16 a[28:29], v1 offset:41472
  ds_read_b64_tr_b16 a[30:31], v1 offset:42496
  v_fma_f32 v25, v25, v5, v6
  v_cvt_pk_bf16_f32 v138, v22, v23
  v_cvt_pk_bf16_f32 v139, v24, v25
  v_mfma_f32_32x32x16_bf16 v[80:95], a[4:7], v[128:131], v[80:95]
  ds_read_b64_tr_b16 a[0:1], v1 offset:43008
  ds_read_b64_tr_b16 a[2:3], v1 offset:4096
  v_lshlrev_b32 v18, 16, v140
  v_and_b32 v19, s41, v140
  s_add_u32 m0, s40, 11264
  s_waitcnt lgkmcnt(8)
  v_mfma_f32_32x32x16_bf16 a[128:143], a[8:11], v[128:131], a[128:143]
  buffer_load_dwordx4 v8, s[16:19], s74 offen  lds
  ds_read_b64_tr_b16 a[4:5], v1 offset:43520
  ds_read_b64_tr_b16 a[6:7], v1 offset:4608
  v_lshlrev_b32 v20, 16, v141
  v_and_b32 v21, s41, v141
  v_mfma_f32_32x32x16_bf16 a[144:159], a[12:15], v[128:131], a[144:159]
  ds_read_b64_tr_b16 a[8:9], v2 offset:9216
  ds_read_b64_tr_b16 a[10:11], v2 offset:10240
  s_mov_b32 s32, s62
  s_mov_b32 s33, s63
  s_mov_b32 s34, 1152
  v_mfma_f32_32x32x16_bf16 a[160:175], a[16:19], v[128:131], a[160:175]
  ds_read_b64_tr_b16 a[12:13], v2 offset:9728
  ds_read_b64_tr_b16 a[14:15], v2 offset:10752
  v_fma_f32 v18, v18, v5, v6
  s_add_u32 m0, s40, 12288
  s_waitcnt lgkmcnt(8)
  v_mfma_f32_32x32x16_bf16 a[176:191], a[20:23], v[128:131], a[176:191]
  buffer_load_dwordx4 v8, s[16:19], s75 offen  lds
  ds_read_b64_tr_b16 a[16:17], v2 offset:11264
  ds_read_b64_tr_b16 a[18:19], v2 offset:12288
  v_fma_f32 v19, v19, v5, v6
  v_fma_f32 v20, v20, v5, v6
  v_mfma_f32_32x32x16_bf16 a[192:207], a[24:27], v[128:131], a[192:207]
  ds_read_b64_tr_b16 a[20:21], v2 offset:11776
  ds_read_b64_tr_b16 a[22:23], v2 offset:12800
  v_fma_f32 v21, v21, v5, v6
  v_cvt_pk_bf16_f32 v140, v18, v19
  v_cvt_pk_bf16_f32 v141, v20, v21
  v_mfma_f32_32x32x16_bf16 v[32:47], a[28:31], v[128:131], v[32:47]
  ds_read_b64_tr_b16 a[24:25], v2 offset:13312
  ds_read_b64_tr_b16 a[26:27], v2 offset:14336
  v_lshlrev_b32 v22, 16, v142
  v_and_b32 v23, s41, v142
  s_add_u32 m0, s40, 13184
  s_waitcnt lgkmcnt(8)
  v_mfma_f32_32x32x16_bf16 v[48:63], a[0:3], v[128:131], v[48:63]
  buffer_load_dwordx4 v8, s[16:19], s74 offen offset:128  lds
  ds_read_b64_tr_b16 a[28:29], v2 offset:13824
  ds_read_b64_tr_b16 a[30:31], v2 offset:14848
  v_lshlrev_b32 v24, 16, v143
  v_and_b32 v25, s41, v143
  v_mfma_f32_32x32x16_bf16 v[96:111], a[4:7], v[128:131], v[96:111]
  ds_read_b64_tr_b16 a[0:1], v2 offset:15360
  ds_read_b64_tr_b16 a[2:3], v2 offset:16384
  v_fma_f32 v22, v22, v5, v6
  v_fma_f32 v23, v23, v5, v6
  v_fma_f32 v24, v24, v5, v6
  v_mfma_f32_32x32x16_bf16 v[64:79], a[8:11], v[132:135], v[64:79]
  ds_read_b64_tr_b16 a[4:5], v2 offset:15872
  ds_read_b64_tr_b16 a[6:7], v2 offset:16896
  v_fma_f32 v25, v25, v5, v6
  s_add_u32 m0, s40, 14208
  s_waitcnt lgkmcnt(8)
  v_mfma_f32_32x32x16_bf16 v[80:95], a[12:15], v[132:135], v[80:95]
  buffer_load_dwordx4 v8, s[16:19], s75 offen offset:128  lds
  ds_read_b64_tr_b16 a[8:9], v2 offset:17408
  ds_read_b64_tr_b16 a[10:11], v1 offset:44032
  v_cvt_pk_bf16_f32 v142, v22, v23
  v_cvt_pk_bf16_f32 v143, v24, v25
  v_mfma_f32_32x32x16_bf16 a[128:143], a[16:19], v[132:135], a[128:143]
  ds_read_b64_tr_b16 a[12:13], v2 offset:17920
  ds_read_b64_tr_b16 a[14:15], v1 offset:44544
  v_lshlrev_b32 v18, 16, v144
  v_and_b32 v19, s41, v144
  v_lshlrev_b32 v20, 16, v145
  v_and_b32 v21, s41, v145
  v_mfma_f32_32x32x16_bf16 a[144:159], a[20:23], v[132:135], a[144:159]
  ds_read_b64_tr_b16 a[16:17], v2 offset:49152
  ds_read_b64_tr_b16 a[18:19], v2 offset:50176
  v_fma_f32 v18, v18, v5, v6
  s_add_u32 m0, s40, 15104
  s_waitcnt lgkmcnt(8)
  v_mfma_f32_32x32x16_bf16 a[160:175], a[24:27], v[132:135], a[160:175]
  buffer_load_dwordx4 v8, s[16:19], s74 offen offset:256  lds
  ds_read_b64_tr_b16 a[20:21], v2 offset:49664
  ds_read_b64_tr_b16 a[22:23], v2 offset:50688
  v_fma_f32 v19, v19, v5, v6
  v_fma_f32 v20, v20, v5, v6
  v_mfma_f32_32x32x16_bf16 a[176:191], a[28:31], v[132:135], a[176:191]
  ds_read_b64_tr_b16 a[24:25], v2 offset:51200
  ds_read_b64_tr_b16 a[26:27], v2 offset:52224
  v_fma_f32 v21, v21, v5, v6
  v_cvt_pk_bf16_f32 v144, v18, v19
  v_cvt_pk_bf16_f32 v145, v20, v21
  v_mfma_f32_32x32x16_bf16 a[192:207], a[0:3], v[132:135], a[192:207]
  ds_read_b64_tr_b16 a[28:29], v2 offset:51712
  ds_read_b64_tr_b16 a[30:31], v2 offset:52736
  v_lshlrev_b32 v22, 16, v146
  v_and_b32 v23, s41, v146
  s_add_u32 m0, s40, 16128
  s_waitcnt lgkmcnt(8)
  v_mfma_f32_32x32x16_bf16 v[32:47], a[4:7], v[132:135], v[32:47]
  buffer_load_dwordx4 v8, s[16:19], s75 offen offset:256  lds
  ds_read_b64_tr_b16 a[0:1], v2 offset:53248
  ds_read_b64_tr_b16 a[2:3], v2 offset:54272
  v_lshlrev_b32 v24, 16, v147
  v_and_b32 v25, s41, v147
  v_mfma_f32_32x32x16_bf16 v[48:63], a[8:11], v[132:135], v[48:63]
  ds_read_b64_tr_b16 a[4:5], v2 offset:53760
  ds_read_b64_tr_b16 a[6:7], v2 offset:54784
  v_fma_f32 v22, v22, v5, v6
  v_fma_f32 v23, v23, v5, v6
  v_fma_f32 v24, v24, v5, v6
  v_mfma_f32_32x32x16_bf16 v[96:111], a[12:15], v[132:135], v[96:111]
  ds_read_b64_tr_b16 a[8:9], v2 offset:55296
  ds_read_b64_tr_b16 a[10:11], v2 offset:56320
  v_fma_f32 v25, v25, v5, v6
  s_add_u32 m0, s40, 17024
  s_waitcnt lgkmcnt(8)
  v_mfma_f32_32x32x16_bf16 v[64:79], a[16:19], v[136:139], v[64:79]
  buffer_load_dwordx4 v8, s[16:19], s74 offen offset:384  lds
  ds_read_b64_tr_b16 a[12:13], v2 offset:55808
  ds_read_b64_tr_b16 a[14:15], v2 offset:56832
  v_cvt_pk_bf16_f32 v146, v22, v23
  v_cvt_pk_bf16_f32 v147, v24, v25
  v_mfma_f32_32x32x16_bf16 v[80:95], a[20:23], v[136:139], v[80:95]
  ds_read_b64_tr_b16 a[16:17], v2 offset:57344
  ds_read_b64_tr_b16 a[18:19], v2 offset:18432
  v_lshlrev_b32 v18, 16, v148
  v_and_b32 v19, s41, v148
  v_lshlrev_b32 v20, 16, v149
  v_and_b32 v21, s41, v149
  v_mfma_f32_32x32x16_bf16 a[128:143], a[24:27], v[136:139], a[128:143]
  ds_read_b64_tr_b16 a[20:21], v2 offset:57856
  ds_read_b64_tr_b16 a[22:23], v2 offset:18944
  v_fma_f32 v18, v18, v5, v6
  s_add_u32 m0, s40, 18048
  s_waitcnt lgkmcnt(8)
  v_mfma_f32_32x32x16_bf16 a[144:159], a[28:31], v[136:139], a[144:159]
  buffer_load_dwordx4 v8, s[16:19], s75 offen offset:384  lds
  ds_read_b64_tr_b16 a[24:25], v3 offset:23552
  ds_read_b64_tr_b16 a[26:27], v3 offset:24576
  v_fma_f32 v19, v19, v5, v6
  v_fma_f32 v20, v20, v5, v6
  v_mfma_f32_32x32x16_bf16 a[160:175], a[0:3], v[136:139], a[160:175]
  ds_read_b64_tr_b16 a[28:29], v3 offset:24064
  ds_read_b64_tr_b16 a[30:31], v3 offset:25088
  v_fma_f32 v21, v21, v5, v6
  v_cvt_pk_bf16_f32 v148, v18, v19
  v_cvt_pk_bf16_f32 v149, v20, v21
  v_mfma_f32_32x32x16_bf16 a[176:191], a[4:7], v[136:139], a[176:191]
  ds_read_b64_tr_b16 a[0:1], v3 offset:25600
  ds_read_b64_tr_b16 a[2:3], v3 offset:26624
  v_lshlrev_b32 v22, 16, v150
  v_and_b32 v23, s41, v150
  s_add_u32 m0, s40, 18944
  s_waitcnt lgkmcnt(8)
  v_mfma_f32_32x32x16_bf16 a[192:207], a[8:11], v[136:139], a[192:207]
  buffer_load_dwordx4 v8, s[16:19], s74 offen offset:512  lds
  ds_read_b64_tr_b16 a[4:5], v3 offset:26112
  ds_read_b64_tr_b16 a[6:7], v3 offset:27136
  v_lshlrev_b32 v24, 16, v151
  v_and_b32 v25, s41, v151
  v_mfma_f32_32x32x16_bf16 v[32:47], a[12:15], v[136:139], v[32:47]
  ds_read_b64_tr_b16 a[8:9], v3 offset:27648
  ds_read_b64_tr_b16 a[10:11], v3 offset:28672
  v_fma_f32 v22, v22, v5, v6
  v_fma_f32 v23, v23, v5, v6
  v_fma_f32 v24, v24, v5, v6
  v_mfma_f32_32x32x16_bf16 v[48:63], a[16:19], v[136:139], v[48:63]
  ds_read_b64_tr_b16 a[12:13], v3 offset:28160
  ds_read_b64_tr_b16 a[14:15], v3 offset:29184
  v_fma_f32 v25, v25, v5, v6
  s_add_u32 m0, s40, 19968
  s_waitcnt lgkmcnt(8)
  v_mfma_f32_32x32x16_bf16 v[96:111], a[20:23], v[136:139], v[96:111]
  buffer_load_dwordx4 v8, s[16:19], s75 offen offset:512  lds
  ds_read_b64_tr_b16 a[16:17], v3 offset:29696
  ds_read_b64_tr_b16 a[18:19], v3 offset:30720
  v_cvt_pk_bf16_f32 v150, v22, v23
  v_cvt_pk_bf16_f32 v151, v24, v25
  v_mfma_f32_32x32x16_bf16 v[64:79], a[24:27], v[140:143], v[64:79]
  ds_read_b64_tr_b16 a[20:21], v3 offset:30208
  ds_read_b64_tr_b16 a[22:23], v3 offset:31232
  v_lshlrev_b32 v18, 16, v152
  v_and_b32 v19, s41, v152
  v_lshlrev_b32 v20, 16, v153
  v_and_b32 v21, s41, v153
  v_mfma_f32_32x32x16_bf16 v[80:95], a[28:31], v[140:143], v[80:95]
  ds_read_b64_tr_b16 a[24:25], v3 offset:31744
  ds_read_b64_tr_b16 a[26:27], v2 offset:58368
  v_fma_f32 v18, v18, v5, v6
  s_add_u32 m0, s40, 21504
  s_waitcnt lgkmcnt(8)
  v_mfma_f32_32x32x16_bf16 a[128:143], a[0:3], v[140:143], a[128:143]
  buffer_load_dwordx4 v8, s[16:19], s76 offen  lds
  ds_read_b64_tr_b16 a[28:29], v3 offset:32256
FF_H1:
  s_cbranch_execz FF_H5
  ds_read_b64_tr_b16 a[30:31], v2 offset:58880
  v_fma_f32 v19, v19, v5, v6
  v_fma_f32 v20, v20, v5, v6
  v_mfma_f32_32x32x16_bf16 a[144:159], a[4:7], v[140:143], a[144:159]
  s_waitcnt vmcnt(11)
  s_barrier
  ds_read_b64_tr_b16 a[0:1], v1 offset:5120
  ds_read_b64_tr_b16 a[2:3], v1 offset:6144
  v_lshlrev_b32 v28, 12, v0
  v_mov_b32 v29, 1
  s_and_b32 s47, s2, 1
  s_lshl_b32 s47, s47, 7
  buffer_atomic_add v29, v28, s[36:39], s47 offen sc1
  v_mfma_f32_32x32x16_bf16 a[160:175], a[8:11], v[140:143], a[160:175]
  ds_read_b64_tr_b16 a[4:5], v1 offset:5632
  ds_read_b64_tr_b16 a[6:7], v1 offset:6656
  s_add_u32 m0, s40, 22528
  s_waitcnt lgkmcnt(8)
  v_mfma_f32_32x32x16_bf16 a[176:191], a[12:15], v[140:143], a[176:191]
  buffer_load_dwordx4 v8, s[16:19], s77 offen  lds
  ds_read_b64_tr_b16 a[8:9], v1 offset:7168
  ds_read_b64_tr_b16 a[10:11], v1 offset:8192
  v_fma_f32 v21, v21, v5, v6
  v_cvt_pk_bf16_f32 v152, v18, v19
  v_mfma_f32_32x32x16_bf16 a[192:207], a[16:19], v[140:143], a[192:207]
  ds_read_b64_tr_b16 a[12:13], v1 offset:7680
  ds_read_b64_tr_b16 a[14:15], v1 offset:8704
  v_cvt_pk_bf16_f32 v153, v20, v21
  v_lshlrev_b32 v22, 16, v154
  v_and_b32 v23, s41, v154
  v_lshlrev_b32 v24, 16, v155
  v_mfma_f32_32x32x16_bf16 v[32:47], a[20:23], v[140:143], v[32:47]
  ds_read_b64_tr_b16 a[16:17], v1 offset:9216
  ds_read_b64_tr_b16 a[18:19], v1 offset:10240
  v_and_b32 v25, s41, v155
  s_add_u32 m0, s40, 23424
  s_waitcnt lgkmcnt(8)
  v_mfma_f32_32x32x16_bf16 v[48:63], a[24:27], v[140:143], v[48:63]
  buffer_load_dwordx4 v8, s[16:19], s76 offen offset:128  lds
  ds_read_b64_tr_b16 a[20:21], v1 offset:9728
  ds_read_b64_tr_b16 a[22:23], v1 offset:10752
  v_fma_f32 v22, v22, v5, v6
  v_fma_f32 v23, v23, v5, v6
  v_mfma_f32_32x32x16_bf16 v[96:111], a[28:31], v[140:143], v[96:111]
  ds_read_b64_tr_b16 a[24:25], v1 offset:11264
  ds_read_b64_tr_b16 a[26:27], v1 offset:12288
  v_fma_f32 v24, v24, v5, v6
  v_fma_f32 v25, v25, v5, v6
  v_cvt_pk_bf16_f32 v154, v22, v23
  v_mfma_f32_32x32x16_bf16 v[64:79], a[0:3], v[144:147], v[64:79]
  ds_read_b64_tr_b16 a[28:29], v1 offset:11776
  ds_read_b64_tr_b16 a[30:31], v1 offset:12800
  v_cvt_pk_bf16_f32 v155, v24, v25
  s_add_u32 m0, s40, 24448
  s_waitcnt lgkmcnt(8)
  v_mfma_f32_32x32x16_bf16 v[80:95], a[4:7], v[144:147], v[80:95]
  buffer_load_dwordx4 v8, s[16:19], s77 offen offset:128  lds
  ds_read_b64_tr_b16 a[0:1], v1 offset:13312
  ds_read_b64_tr_b16 a[2:3], v1 offset:14336
  v_lshlrev_b32 v18, 16, v156
  v_and_b32 v19, s41, v156
  v_lshlrev_b32 v20, 16, v157
  v_mfma_f32_32x32x16_bf16 a[128:143], a[8:11], v[144:147], a[128:143]
  ds_read_b64_tr_b16 a[4:5], v1 offset:13824
  ds_read_b64_tr_b16 a[6:7], v1 offset:14848
  v_and_b32 v21, s41, v157
  v_fma_f32 v18, v18, v5, v6
  v_fma_f32 v19, v19, v5, v6
  v_mfma_f32_32x32x16_bf16 a[144:159], a[12:15], v[144:147], a[144:159]
  ds_read_b64_tr_b16 a[8:9], v1 offset:45056
  ds_read_b64_tr_b16 a[10:11], v1 offset:46080
  v_fma_f32 v20, v20, v5, v6
  s_add_u32 m0, s40, 25344
  s_waitcnt lgkmcnt(8)
  v_mfma_f32_32x32x16_bf16 a[160:175], a[16:19], v[144:147], a[160:175]
  buffer_load_dwordx4 v8, s[16:19], s76 offen offset:256  lds
  ds_read_b64_tr_b16 a[12:13], v1 offset:45568
  ds_read_b64_tr_b16 a[14:15], v1 offset:46592
  v_fma_f32 v21, v21, v5, v6
  v_cvt_pk_bf16_f32 v156, v18, v19
  v_mfma_f32_32x32x16_bf16 a[176:191], a[20:23], v[144:147], a[176:191]
  ds_read_b64_tr_b16 a[16:17], v1 offset:47104
  ds_read_b64_tr_b16 a[18:19], v1 offset:48128
  v_cvt_pk_bf16_f32 v157, v20, v21
  v_lshlrev_b32 v22, 16, v158
  v_and_b32 v23, s41, v158
  v_lshlrev_b32 v24, 16, v159
  v_mfma_f32_32x32x16_bf16 a[192:207], a[24:27], v[144:147], a[192:207]
  ds_read_b64_tr_b16 a[20:21], v1 offset:47616
  ds_read_b64_tr_b16 a[22:23], v1 offset:48640
  v_and_b32 v25, s41, v159
  s_add_u32 m0, s40, 26368
  s_waitcnt lgkmcnt(8)
  v_mfma_f32_32x32x16_bf16 v[32:47], a[28:31], v[144:147], v[32:47]
  buffer_load_dwordx4 v8, s[16:19], s77 offen offset:256  lds
  ds_read_b64_tr_b16 a[24:25], v1 offset:49152
  ds_read_b64_tr_b16 a[26:27], v1 offset:50176
  v_fma_f32 v22, v22, v5, v6
  v_fma_f32 v23, v23, v5, v6
  v_mfma_f32_32x32x16_bf16 v[48:63], a[0:3], v[144:147], v[48:63]
  ds_read_b64_tr_b16 a[28:29], v1 offset:49664
  ds_read_b64_tr_b16 a[30:31], v1 offset:50688
  v_fma_f32 v24, v24, v5, v6
  v_fma_f32 v25, v25, v5, v6
  v_cvt_pk_bf16_f32 v158, v22, v23
  v_mfma_f32_32x32x16_bf16 v[96:111], a[4:7], v[144:147], v[96:111]
  ds_read_b64_tr_b16 a[0:1], v1 offset:51200
  ds_read_b64_tr_b16 a[2:3], v1 offset:52224
  v_cvt_pk_bf16_f32 v159, v24, v25
  s_add_u32 m0, s40, 27264
  s_waitcnt lgkmcnt(8)
  v_mfma_f32_32x32x16_bf16 v[64:79], a[8:11], v[148:151], v[64:79]
  buffer_load_dwordx4 v8, s[16:19], s76 offen offset:384  lds
  ds_read_b64_tr_b16 a[4:5], v1 offset:51712
  ds_read_b64_tr_b16 a[6:7], v1 offset:52736
  v_lshlrev_b32 v18, 16, v160
  v_and_b32 v19, s41, v160
  v_lshlrev_b32 v20, 16, v161
  v_mfma_f32_32x32x16_bf16 v[80:95], a[12:15], v[148:151], v[80:95]
  ds_read_b64_tr_b16 a[8:9], v1 offset:53248
  ds_read_b64_tr_b16 a[10:11], v1 offset:54272
  v_and_b32 v21, s41, v161
  v_fma_f32 v18, v18, v5, v6
  v_fma_f32 v19, v19, v5, v6
  v_mfma_f32_32x32x16_bf16 a[128:143], a[16:19], v[148:151], a[128:143]
  ds_read_b64_tr_b16 a[12:13], v1 offset:53760
  ds_read_b64_tr_b16 a[14:15], v1 offset:54784
  v_fma_f32 v20, v20, v5, v6
  s_add_u32 m0, s40, 28288
  s_waitcnt lgkmcnt(8)
  v_mfma_f32_32x32x16_bf16 a[144:159], a[20:23], v[148:151], a[144:159]
  buffer_load_dwordx4 v8, s[16:19], s77 offen offset:384  lds
  ds_read_b64_tr_b16 a[16:17], v2 offset:19456
  ds_read_b64_tr_b16 a[18:19], v2 offset:20480
  v_fma_f32 v21, v21, v5, v6
  v_cvt_pk_bf16_f32 v160, v18, v19
  v_mfma_f32_32x32x16_bf16 a[160:175], a[24:27], v[148:151], a[160:175]
  ds_read_b64_tr_b16 a[20:21], v2 offset:19968
  ds_read_b64_tr_b16 a[22:23], v2 offset:20992
  v_cvt_pk_bf16_f32 v161, v20, v21
  v_lshlrev_b32 v22, 16, v162
  v_and_b32 v23, s41, v162
  v_lshlrev_b32 v24, 16, v163
  v_mfma_f32_32x32x16_bf16 a[176:191], a[28:31], v[148:151], a[176:191]
  ds_read_b64_tr_b16 a[24:25], v2 offset:21504
  ds_read_b64_tr_b16 a[26:27], v2 offset:22528
  v_and_b32 v25, s41, v163
  s_add_u32 m0, s40, 29184
  s_waitcnt lgkmcnt(8)
  v_mfma_f32_32x32x16_bf16 a[192:207], a[0:3], v[148:151], a[192:207]
  buffer_load_dwordx4 v8, s[16:19], s76 offen offset:512  lds
  ds_read_b64_tr_b16 a[28:29], v2 offset:22016
  ds_read_b64_tr_b16 a[30:31], v2 offset:23040
  v_fma_f32 v22, v22, v5, v6
  v_fma_f32 v23, v23, v5, v6
  v_mfma_f32_32x32x16_bf16 v[32:47], a[4:7], v[148:151], v[32:47]
  ds_read_b64_tr_b16 a[0:1], v2 offset:23552
  ds_read_b64_tr_b16 a[2:3], v2 offset:24576
  v_fma_f32 v24, v24, v5, v6
  v_fma_f32 v25, v25, v5, v6
  v_cvt_pk_bf16_f32 v162, v22, v23
  v_mfma_f32_32x32x16_bf16 v[48:63], a[8:11], v[148:151], v[48:63]
  ds_read_b64_tr_b16 a[4:5], v2 offset:24064
  ds_read_b64_tr_b16 a[6:7], v2 offset:25088
  v_cvt_pk_bf16_f32 v163, v24, v25
  s_add_u32 m0, s40, 30208
  s_waitcnt lgkmcnt(8)
  v_mfma_f32_32x32x16_bf16 v[96:111], a[12:15], v[148:151], v[96:111]
  buffer_load_dwordx4 v8, s[16:19], s77 offen offset:512  lds
  ds_read_b64_tr_b16 a[8:9], v2 offset:25600
  ds_read_b64_tr_b16 a[10:11], v2 offset:26624
  v_lshlrev_b32 v18, 16, v164
  v_and_b32 v19, s41, v164
  v_lshlrev_b32 v20, 16, v165
  v_mfma_f32_32x32x16_bf16 v[64:79], a[16:19], v[152:155], v[64:79]
  ds_read_b64_tr_b16 a[12:13], v2 offset:26112
  ds_read_b64_tr_b16 a[14:15], v2 offset:27136
  v_and_b32 v21, s41, v165
  v_fma_f32 v18, v18, v5, v6
  v_fma_f32 v19, v19, v5, v6
  v_mfma_f32_32x32x16_bf16 v[80:95], a[20:23], v[152:155], v[80:95]
  ds_read_b64_tr_b16 a[16:17], v2 offset:27648
  ds_read_b64_tr_b16 a[18:19], v2 offset:28672
  v_fma_f32 v20, v20, v5, v6
  s_add_u32 m0, s40, 31744
  s_waitcnt lgkmcnt(8)
  v_mfma_f32_32x32x16_bf16 a[128:143], a[24:27], v[152:155], a[128:143]
  buffer_load_dwordx4 v8, s[16:19], s78 offen  lds
  ds_read_b64_tr_b16 a[20:21], v2 offset:28160
  ds_read_b64_tr_b16 a[22:23], v2 offset:29184
  v_fma_f32 v21, v21, v5, v6
  v_cvt_pk_bf16_f32 v164, v18, v19
  v_mfma_f32_32x32x16_bf16 a[144:159], a[28:31], v[152:155], a[144:159]
  ds_read_b64_tr_b16 a[24:25], v2 offset:59392
  ds_read_b64_tr_b16 a[26:27], v2 offset:60416
  v_cvt_pk_bf16_f32 v165, v20, v21
  v_lshlrev_b32 v22, 16, v166
  v_and_b32 v23, s41, v166
  v_lshlrev_b32 v24, 16, v167
  v_mfma_f32_32x32x16_bf16 a[160:175], a[0:3], v[152:155], a[160:175]
  ds_read_b64_tr_b16 a[28:29], v2 offset:59904
  ds_read_b64_tr_b16 a[30:31], v2 offset:60928
  v_and_b32 v25, s41, v167
  v_fma_f32 v22, v22, v5, v6
  s_add_u32 m0, s40, 32768
  s_waitcnt lgkmcnt(8)
  v_mfma_f32_32x32x16_bf16 a[176:191], a[4:7], v[152:155], a[176:191]
  buffer_load_dwordx4 v8, s[16:19], s79 offen  lds
  ds_read_b64_tr_b16 a[0:1], v2 offset:61440
  ds_read_b64_tr_b16 a[2:3], v2 offset:62464
  v_fma_f32 v23, v23, v5, v6
  v_fma_f32 v24, v24, v5, v6
  v_mfma_f32_32x32x16_bf16 a[192:207], a[8:11], v[152:155], a[192:207]
  ds_read_b64_tr_b16 a[4:5], v2 offset:61952
  ds_read_b64_tr_b16 a[6:7], v2 offset:62976
  v_fma_f32 v25, v25, v5, v6
  v_cvt_pk_bf16_f32 v166, v22, v23
  v_cvt_pk_bf16_f32 v167, v24, v25
  v_mfma_f32_32x32x16_bf16 v[32:47], a[12:15], v[152:155], v[32:47]
  ds_read_b64_tr_b16 a[8:9], v2 offset:63488
  ds_read_b64_tr_b16 a[10:11], v2 offset:64512
  v_lshlrev_b32 v18, 16, v168
  v_and_b32 v19, s41, v168
  s_add_u32 m0, s40, 33664
  s_waitcnt lgkmcnt(8)
  v_mfma_f32_32x32x16_bf16 v[48:63], a[16:19], v[152:155], v[48:63]
  buffer_load_dwordx4 v8, s[16:19], s78 offen offset:128  lds
  ds_read_b64_tr_b16 a[12:13], v2 offset:64000
  ds_read_b64_tr_b16 a[14:15], v2 offset:65024
  v_lshlrev_b32 v20, 16, v169
  v_and_b32 v21, s41, v169
  v_mfma_f32_32x32x16_bf16 v[96:111], a[20:23], v[152:155], v[96:111]
  ds_read_b64_tr_b16 a[16:17], v3 offset:0
  ds_read_b64_tr_b16 a[18:19], v3 offset:1024
  v_fma_f32 v18, v18, v5, v6
  v_fma_f32 v19, v19, v5, v6
  v_fma_f32 v20, v20, v5, v6
  v_mfma_f32_32x32x16_bf16 v[64:79], a[24:27], v[156:159], v[64:79]
  ds_read_b64_tr_b16 a[20:21], v3 offset:512
  ds_read_b64_tr_b16 a[22:23], v3 offset:1536
  s_lshr_b32 s46, s2, 5
  s_lshl_b32 s46, s46, 2
  s_add_u32 s46, s46, s6
  s_mul_i32 s46, s46, 13824
  s_add_u32 s46, s46, s87
  v_lshlrev_b32 v26, 3, v4
  v_min_u32 v26, 4480, v26
  s_add_u32 s46, s46, 0
  buffer_load_dword a242, v26, s[20:23], s46 offen
  s_waitcnt lgkmcnt(8)
  v_mfma_f32_32x32x16_bf16 v[80:95], a[28:31], v[156:159], v[80:95]
  ds_read_b64_tr_b16 a[24:25], v3 offset:2048
  ds_read_b64_tr_b16 a[26:27], v3 offset:3072
  s_lshr_b32 s46, s2, 5
  s_mul_i32 s46, s46, 3
  s_and_b32 s47, s4, 3
  s_add_u32 s46, s46, s47
  s_lshl_b32 s46, s46, 2
  s_add_u32 s46, s46, s6
  s_lshr_b32 s47, s4, 2
  s_mul_i32 s46, s46, 20736
  s_lshl_b32 s47, s47, 8
  s_add_u32 s46, s46, s47
  v_and_b32 v26, 63, v0
  v_min_u32 v26, 17, v26
  v_mul_u32_u24 v27, 43, v26
  v_lshrrev_b32 v27, 7, v27
  v_mul_u32_u24 v27, 3072, v27
  v_lshl_add_u32 v26, v26, 7, v27
  buffer_load_dword a251, v26, s[12:15], s46 offen
  v_mfma_f32_32x32x16_bf16 a[128:143], a[0:3], v[156:159], a[128:143]
  ds_read_b64_tr_b16 a[28:29], v3 offset:2560
  ds_read_b64_tr_b16 a[30:31], v3 offset:3584
  v_fma_f32 v21, v21, v5, v6
  v_mfma_f32_32x32x16_bf16 a[144:159], a[4:7], v[156:159], a[144:159]
  s_waitcnt vmcnt(16)
  s_barrier
  ds_read_b64_tr_b16 a[0:1], v1 offset:15360
  ds_read_b64_tr_b16 a[2:3], v1 offset:16384
  v_cvt_pk_bf16_f32 v168, v18, v19
  s_waitcnt lgkmcnt(8)
  v_mfma_f32_32x32x16_bf16 a[160:175], a[8:11], v[156:159], a[160:175]
  ds_read_b64_tr_b16 a[4:5], v1 offset:15872
  ds_read_b64_tr_b16 a[6:7], v1 offset:16896
  v_cvt_pk_bf16_f32 v169, v20, v21
  v_lshlrev_b32 v22, 16, v170
  v_and_b32 v23, s41, v170
  v_lshlrev_b32 v24, 16, v171
  v_mfma_f32_32x32x16_bf16 a[176:191], a[12:15], v[156:159], a[176:191]
  ds_read_b64_tr_b16 a[8:9], v1 offset:17408
  ds_read_b64_tr_b16 a[10:11], v1 offset:18432
  v_and_b32 v25, s41, v171
  v_fma_f32 v22, v22, v5, v6
  v_fma_f32 v23, v23, v5, v6
  v_mfma_f32_32x32x16_bf16 a[192:207], a[16:19], v[156:159], a[192:207]
  ds_read_b64_tr_b16 a[12:13], v1 offset:17920
  ds_read_b64_tr_b16 a[14:15], v1 offset:18944
  v_fma_f32 v24, v24, v5, v6
  v_fma_f32 v25, v25, v5, v6
  s_waitcnt lgkmcnt(8)
  v_mfma_f32_32x32x16_bf16 v[32:47], a[20:23], v[156:159], v[32:47]
  ds_read_b64_tr_b16 a[16:17], v1 offset:19456
  ds_read_b64_tr_b16 a[18:19], v1 offset:20480
  v_cvt_pk_bf16_f32 v170, v22, v23
  v_cvt_pk_bf16_f32 v171, v24, v25
  v_lshlrev_b32 v18, 16, v172
  v_mfma_f32_32x32x16_bf16 v[48:63], a[24:27], v[156:159], v[48:63]
  ds_read_b64_tr_b16 a[20:21], v1 offset:19968
  ds_read_b64_tr_b16 a[22:23], v1 offset:20992
  v_and_b32 v19, s41, v172
  v_lshlrev_b32 v20, 16, v173
  v_and_b32 v21, s41, v173
  v_fma_f32 v18, v18, v5, v6
  v_mfma_f32_32x32x16_bf16 v[96:111], a[28:31], v[156:159], v[96:111]
  ds_read_b64_tr_b16 a[24:25], v1 offset:21504
  ds_read_b64_tr_b16 a[26:27], v1 offset:22528
  v_fma_f32 v19, v19, v5, v6
  v_fma_f32 v20, v20, v5, v6
  s_waitcnt lgkmcnt(8)
  v_mfma_f32_32x32x16_bf16 v[64:79], a[0:3], v[160:163], v[64:79]
  ds_read_b64_tr_b16 a[28:29], v1 offset:22016
  ds_read_b64_tr_b16 a[30:31], v1 offset:23040
  v_fma_f32 v21, v21, v5, v6
  v_cvt_pk_bf16_f32 v172, v18, v19
  v_cvt_pk_bf16_f32 v173, v20, v21
  v_mfma_f32_32x32x16_bf16 v[80:95], a[4:7], v[160:163], v[80:95]
  ds_read_b64_tr_b16 a[0:1], v1 offset:23552
  ds_read_b64_tr_b16 a[2:3], v1 offset:24576
  v_lshlrev_b32 v22, 16, v174
  v_and_b32 v23, s41, v174
  v_lshlrev_b32 v24, 16, v175
  v_and_b32 v25, s41, v175
  v_mfma_f32_32x32x16_bf16 a[128:143], a[8:11], v[160:163], a[128:143]
  ds_read_b64_tr_b16 a[4:5], v1 offset:24064
  ds_read_b64_tr_b16 a[6:7], v1 offset:25088
  v_fma_f32 v22, v22, v5, v6
  v_fma_f32 v23, v23, v5, v6
  s_waitcnt lgkmcnt(8)
  v_mfma_f32_32x32x16_bf16 a[144:159], a[12:15], v[160:163], a[144:159]
  ds_read_b64_tr_b16 a[8:9], v1 offset:55296
  ds_read_b64_tr_b16 a[10:11], v1 offset:56320
  v_fma_f32 v24, v24, v5, v6
  v_fma_f32 v25, v25, v5, v6
  v_cvt_pk_bf16_f32 v174, v22, v23
  v_mfma_f32_32x32x16_bf16 a[160:175], a[16:19], v[160:163], a[160:175]
  ds_read_b64_tr_b16 a[12:13], v1 offset:55808
  ds_read_b64_tr_b16 a[14:15], v1 offset:56832
  v_cvt_pk_bf16_f32 v175, v24, v25
  v_lshlrev_b32 v18, 16, v176
  v_and_b32 v19, s41, v176
  v_lshlrev_b32 v20, 16, v177
  v_mfma_f32_32x32x16_bf16 a[176:191], a[20:23], v[160:163], a[176:191]
  ds_read_b64_tr_b16 a[16:17], v1 offset:57344
  ds_read_b64_tr_b16 a[18:19], v1 offset:58368
  v_and_b32 v21, s41, v177
  v_fma_f32 v18, v18, v5, v6
  s_waitcnt lgkmcnt(8)
  v_mfma_f32_32x32x16_bf16 a[192:207], a[24:27], v[160:163], a[192:207]
  ds_read_b64_tr_b16 a[20:21], v1 offset:57856
  ds_read_b64_tr_b16 a[22:23], v1 offset:58880
  v_fma_f32 v19, v19, v5, v6
  v_fma_f32 v20, v20, v5, v6
  v_fma_f32 v21, v21, v5, v6
  v_mfma_f32_32x32x16_bf16 v[32:47], a[28:31], v[160:163], v[32:47]
  ds_read_b64_tr_b16 a[24:25], v1 offset:59392
  ds_read_b64_tr_b16 a[26:27], v1 offset:60416
  v_cvt_pk_bf16_f32 v176, v18, v19
  v_cvt_pk_bf16_f32 v177, v20, v21
  v_lshlrev_b32 v22, 16, v178
  v_mfma_f32_32x32x16_bf16 v[48:63], a[0:3], v[160:163], v[48:63]
  ds_read_b64_tr_b16 a[28:29], v1 offset:59904
  ds_read_b64_tr_b16 a[30:31], v1 offset:60928
  v_and_b32 v23, s41, v178
  v_lshlrev_b32 v24, 16, v179
  v_and_b32 v25, s41, v179
  s_waitcnt lgkmcnt(8)
  v_mfma_f32_32x32x16_bf16 v[96:111], a[4:7], v[160:163], v[96:111]
  ds_read_b64_tr_b16 a[0:1], v1 offset:61440
  ds_read_b64_tr_b16 a[2:3], v1 offset:62464
  v_fma_f32 v22, v22, v5, v6
  v_fma_f32 v23, v23, v5, v6
  s_add_u32 m0, s40, 34688
  v_mfma_f32_32x32x16_bf16 v[64:79], a[8:11], v[164:167], v[64:79]
  buffer_load_dwordx4 v8, s[16:19], s79 offen offset:128  lds
  ds_read_b64_tr_b16 a[4:5], v1 offset:61952
  ds_read_b64_tr_b16 a[6:7], v1 offset:62976
  v_fma_f32 v24, v24, v5, v6
  v_fma_f32 v25, v25, v5, v6
  v_mfma_f32_32x32x16_bf16 v[80:95], a[12:15], v[164:167], v[80:95]
  ds_read_b64_tr_b16 a[8:9], v1 offset:63488
  ds_read_b64_tr_b16 a[10:11], v1 offset:64512
  v_cvt_pk_bf16_f32 v178, v22, v23
  v_cvt_pk_bf16_f32 v179, v24, v25
  s_waitcnt lgkmcnt(8)
  v_mfma_f32_32x32x16_bf16 a[128:143], a[16:19], v[164:167], a[128:143]
  ds_read_b64_tr_b16 a[12:13], v1 offset:64000
  ds_read_b64_tr_b16 a[14:15], v1 offset:65024
  v_lshlrev_b32 v18, 16, v180
  v_and_b32 v19, s41, v180
  v_lshlrev_b32 v20, 16, v181
  s_add_u32 m0, s40, 35584
  v_mfma_f32_32x32x16_bf16 a[144:159], a[20:23], v[164:167], a[144:159]
  buffer_load_dwordx4 v8, s[16:19], s78 offen offset:256  lds
  ds_read_b64_tr_b16 a[16:17], v2 offset:29696
  ds_read_b64_tr_b16 a[18:19], v2 offset:30720
  v_and_b32 v21, s41, v181
  v_fma_f32 v18, v18, v5, v6
  v_mfma_f32_32x32x16_bf16 a[160:175], a[24:27], v[164:167], a[160:175]
  ds_read_b64_tr_b16 a[20:21], v2 offset:30208
  ds_read_b64_tr_b16 a[22:23], v2 offset:31232
  v_fma_f32 v19, v19, v5, v6
  v_fma_f32 v20, v20, v5, v6
  s_waitcnt lgkmcnt(8)
  v_mfma_f32_32x32x16_bf16 a[176:191], a[28:31], v[164:167], a[176:191]
  ds_read_b64_tr_b16 a[24:25], v2 offset:31744
  ds_read_b64_tr_b16 a[26:27], v2 offset:32768
  v_fma_f32 v21, v21, v5, v6
  v_cvt_pk_bf16_f32 v180, v18, v19
  s_add_u32 m0, s40, 36608
  v_mfma_f32_32x32x16_bf16 a[192:207], a[0:3], v[164:167], a[192:207]
  buffer_load_dwordx4 v8, s[16:19], s79 offen offset:256  lds
  ds_read_b64_tr_b16 a[28:29], v2 offset:32256
  ds_read_b64_tr_b16 a[30:31], v2 offset:33280
  v_cvt_pk_bf16_f32 v181, v20, v21
  v_lshlrev_b32 v22, 16, v182
  v_mfma_f32_32x32x16_bf16 v[32:47], a[4:7], v[164:167], v[32:47]
  ds_read_b64_tr_b16 a[0:1], v2 offset:33792
  ds_read_b64_tr_b16 a[2:3], v2 offset:34816
  v_and_b32 v23, s41, v182
  v_lshlrev_b32 v24, 16, v183
  v_and_b32 v25, s41, v183
  s_waitcnt lgkmcnt(8)
  v_mfma_f32_32x32x16_bf16 v[48:63], a[8:11], v[164:167], v[48:63]
  ds_read_b64_tr_b16 a[4:5], v2 offset:34304
  ds_read_b64_tr_b16 a[6:7], v2 offset:35328
  v_fma_f32 v22, v22, v5, v6
  v_fma_f32 v23, v23, v5, v6
  s_add_u32 m0, s40, 37504
  v_mfma_f32_32x32x16_bf16 v[96:111], a[12:15], v[164:167], v[96:111]
  buffer_load_dwordx4 v8, s[16:19], s78 offen offset:384  lds
  ds_read_b64_tr_b16 a[8:9], v2 offset:35840
  ds_read_b64_tr_b16 a[10:11], v2 offset:36864
  v_fma_f32 v24, v24, v5, v6
  v_fma_f32 v25, v25, v5, v6
  v_mfma_f32_32x32x16_bf16 v[64:79], a[16:19], v[168:171], v[64:79]
  ds_read_b64_tr_b16 a[12:13], v2 offset:36352
  ds_read_b64_tr_b16 a[14:15], v2 offset:37376
  v_cvt_pk_bf16_f32 v182, v22, v23
  v_cvt_pk_bf16_f32 v183, v24, v25
  s_waitcnt lgkmcnt(8)
  v_mfma_f32_32x32x16_bf16 v[80:95], a[20:23], v[168:171], v[80:95]
  ds_read_b64_tr_b16 a[16:17], v2 offset:37888
  ds_read_b64_tr_b16 a[18:19], v2 offset:38912
  v_lshlrev_b32 v18, 16, v184
  v_and_b32 v19, s41, v184
  v_lshlrev_b32 v20, 16, v185
  s_add_u32 m0, s40, 38528
  v_mfma_f32_32x32x16_bf16 a[128:143], a[24:27], v[168:171], a[128:143]
  buffer_load_dwordx4 v8, s[16:19], s79 offen offset:384  lds
  ds_read_b64_tr_b16 a[20:21], v2 offset:38400
  ds_read_b64_tr_b16 a[22:23], v2 offset:39424
  v_and_b32 v21, s41, v185
  v_fma_f32 v18, v18, v5, v6
  v_mfma_f32_32x32x16_bf16 a[144:159], a[28:31], v[168:171], a[144:159]
  ds_read_b64_tr_b16 a[24:25], v3 offset:4096
  ds_read_b64_tr_b16 a[26:27], v3 offset:5120
  v_fma_f32 v19, v19, v5, v6
  v_fma_f32 v20, v20, v5, v6
  s_waitcnt lgkmcnt(8)
  v_mfma_f32_32x32x16_bf16 a[160:175], a[0:3], v[168:171], a[160:175]
  ds_read_b64_tr_b16 a[28:29], v3 offset:4608
  ds_read_b64_tr_b16 a[30:31], v3 offset:5632
  v_fma_f32 v21, v21, v5, v6
  v_cvt_pk_bf16_f32 v184, v18, v19
  s_add_u32 m0, s40, -512
  v_mfma_f32_32x32x16_bf16 a[176:191], a[4:7], v[168:171], a[176:191]
  buffer_load_dwordx4 v8, s[16:19], s78 offen offset:512  lds
  ds_read_b64_tr_b16 a[0:1], v3 offset:6144
  ds_read_b64_tr_b16 a[2:3], v3 offset:7168
  v_cvt_pk_bf16_f32 v185, v20, v21
  v_lshlrev_b32 v22, 16, v186
  v_mfma_f32_32x32x16_bf16 a[192:207], a[8:11], v[168:171], a[192:207]
  ds_read_b64_tr_b16 a[4:5], v3 offset:6656
  ds_read_b64_tr_b16 a[6:7], v3 offset:7680
  v_and_b32 v23, s41, v186
  v_lshlrev_b32 v24, 16, v187
  v_and_b32 v25, s41, v187
  s_waitcnt lgkmcnt(8)
  v_mfma_f32_32x32x16_bf16 v[32:47], a[12:15], v[168:171], v[32:47]
  ds_read_b64_tr_b16 a[8:9], v3 offset:8192
  ds_read_b64_tr_b16 a[10:11], v3 offset:9216
  v_fma_f32 v22, v22, v5, v6
  v_fma_f32 v23, v23, v5, v6
  s_add_u32 m0, s40, 512
  v_mfma_f32_32x32x16_bf16 v[48:63], a[16:19], v[168:171], v[48:63]
  buffer_load_dwordx4 v8, s[16:19], s79 offen offset:512  lds
  ds_read_b64_tr_b16 a[12:13], v3 offset:8704
  ds_read_b64_tr_b16 a[14:15], v3 offset:9728
  v_fma_f32 v24, v24, v5, v6
  v_fma_f32 v25, v25, v5, v6
  v_mfma_f32_32x32x16_bf16 v[96:111], a[20:23], v[168:171], v[96:111]
  ds_read_b64_tr_b16 a[16:17], v3 offset:10240
  ds_read_b64_tr_b16 a[18:19], v3 offset:11264
  v_cvt_pk_bf16_f32 v186, v22, v23
  v_cvt_pk_bf16_f32 v187, v24, v25
  s_waitcnt lgkmcnt(8)
  v_mfma_f32_32x32x16_bf16 v[64:79], a[24:27], v[172:175], v[64:79]
  ds_read_b64_tr_b16 a[20:21], v3 offset:10752
  ds_read_b64_tr_b16 a[22:23], v3 offset:11776
  v_lshlrev_b32 v18, 16, v188
  v_and_b32 v19, s41, v188
  v_lshlrev_b32 v20, 16, v189
  s_add_u32 m0, s40, 2048
  v_mfma_f32_32x32x16_bf16 v[80:95], a[28:31], v[172:175], v[80:95]
  buffer_load_dwordx4 v8, s[16:19], s80 offen  lds
  ds_read_b64_tr_b16 a[24:25], v3 offset:12288
  ds_read_b64_tr_b16 a[26:27], v3 offset:13312
  v_and_b32 v21, s41, v189
  v_fma_f32 v18, v18, v5, v6
  v_mfma_f32_32x32x16_bf16 a[128:143], a[0:3], v[172:175], a[128:143]
  ds_read_b64_tr_b16 a[28:29], v3 offset:12800
  ds_read_b64_tr_b16 a[30:31], v3 offset:13824
  v_fma_f32 v19, v19, v5, v6
  v_fma_f32 v20, v20, v5, v6
  s_waitcnt lgkmcnt(8)
  v_mfma_f32_32x32x16_bf16 a[144:159], a[4:7], v[172:175], a[144:159]
  s_waitcnt vmcnt(13)
  s_barrier
  ds_read_b64_tr_b16 a[0:1], v1 offset:25600
  ds_read_b64_tr_b16 a[2:3], v1 offset:26624
  s_add_u32 m0, s40, 3072
  v_mfma_f32_32x32x16_bf16 a[160:175], a[8:11], v[172:175], a[160:175]
  buffer_load_dwordx4 v8, s[16:19], s81 offen  lds
  ds_read_b64_tr_b16 a[4:5], v1 offset:26112
  ds_read_b64_tr_b16 a[6:7], v1 offset:27136
  v_fma_f32 v21, v21, v5, v6
  v_cvt_pk_bf16_f32 v188, v18, v19
  v_mfma_f32_32x32x16_bf16 a[176:191], a[12:15], v[172:175], a[176:191]
  ds_read_b64_tr_b16 a[8:9], v1 offset:27648
  ds_read_b64_tr_b16 a[10:11], v1 offset:28672
  v_cvt_pk_bf16_f32 v189, v20, v21
  v_lshlrev_b32 v22, 16, v190
  v_and_b32 v23, s41, v190
  s_waitcnt lgkmcnt(8)
  v_mfma_f32_32x32x16_bf16 a[192:207], a[16:19], v[172:175], a[192:207]
  ds_read_b64_tr_b16 a[12:13], v1 offset:28160
  ds_read_b64_tr_b16 a[14:15], v1 offset:29184
  v_lshlrev_b32 v24, 16, v191
  v_and_b32 v25, s41, v191
  s_add_u32 m0, s40, 3968
  v_mfma_f32_32x32x16_bf16 v[32:47], a[20:23], v[172:175], v[32:47]
  buffer_load_dwordx4 v8, s[16:19], s80 offen offset:128  lds
  ds_read_b64_tr_b16 a[16:17], v1 offset:29696
  ds_read_b64_tr_b16 a[18:19], v1 offset:30720
  v_fma_f32 v22, v22, v5, v6
  v_fma_f32 v23, v23, v5, v6
  v_mfma_f32_32x32x16_bf16 v[48:63], a[24:27], v[172:175], v[48:63]
  ds_read_b64_tr_b16 a[20:21], v1 offset:30208
  ds_read_b64_tr_b16 a[22:23], v1 offset:31232
  v_fma_f32 v24, v24, v5, v6
  v_fma_f32 v25, v25, v5, v6
  s_waitcnt lgkmcnt(8)
  v_mfma_f32_32x32x16_bf16 v[96:111], a[28:31], v[172:175], v[96:111]
  ds_read_b64_tr_b16 a[24:25], v1 offset:31744
  ds_read_b64_tr_b16 a[26:27], v1 offset:32768
  v_cvt_pk_bf16_f32 v190, v22, v23
  v_cvt_pk_bf16_f32 v191, v24, v25
  s_add_u32 m0, s40, 4992
  v_mfma_f32_32x32x16_bf16 v[64:79], a[0:3], v[176:179], v[64:79]
  buffer_load_dwordx4 v8, s[16:19], s81 offen offset:128  lds
  ds_read_b64_tr_b16 a[28:29], v1 offset:32256
  ds_read_b64_tr_b16 a[30:31], v1 offset:33280
  v_lshlrev_b32 v18, 16, v192
  v_and_b32 v19, s41, v192
  v_lshlrev_b32 v20, 16, v193
  v_mfma_f32_32x32x16_bf16 v[80:95], a[4:7], v[176:179], v[80:95]
  ds_read_b64_tr_b16 a[0:1], v1 offset:33792
  ds_read_b64_tr_b16 a[2:3], v1 offset:34816
  v_and_b32 v21, s41, v193
  v_fma_f32 v18, v18, v5, v6
  s_waitcnt lgkmcnt(8)
FF_H2:
  s_cbranch_execz FF_H6
  v_mfma_f32_32x32x16_bf16 a[128:143], a[8:11], v[176:179], a[128:143]
  ds_read_b64_tr_b16 a[4:5], v1 offset:34304
  ds_read_b64_tr_b16 a[6:7], v1 offset:35328
  v_fma_f32 v19, v19, v5, v6
  v_fma_f32 v20, v20, v5, v6
  s_add_u32 m0, s40, 5888
  v_mfma_f32_32x32x16_bf16 a[144:159], a[12:15], v[176:179], a[144:159]
  buffer_load_dwordx4 v8, s[16:19], s80 offen offset:256  lds
  ds_read_b64_tr_b16 a[8:9], v2 offset:0
  ds_read_b64_tr_b16 a[10:11], v2 offset:1024
  v_fma_f32 v21, v21, v5, v6
  v_cvt_pk_bf16_f32 v192, v18, v19
  v_mfma_f32_32x32x16_bf16 a[160:175], a[16:19], v[176:179], a[160:175]
  ds_read_b64_tr_b16 a[12:13], v2 offset:512
  ds_read_b64_tr_b16 a[14:15], v2 offset:1536
  v_cvt_pk_bf16_f32 v193, v20, v21
  v_lshlrev_b32 v22, 16, v194
  v_and_b32 v23, s41, v194
  s_waitcnt lgkmcnt(8)
  v_mfma_f32_32x32x16_bf16 a[176:191], a[20:23], v[176:179], a[176:191]
  ds_read_b64_tr_b16 a[16:17], v2 offset:2048
  ds_read_b64_tr_b16 a[18:19], v2 offset:3072
  v_lshlrev_b32 v24, 16, v195
  v_and_b32 v25, s41, v195
  s_add_u32 m0, s40, 6912
  v_mfma_f32_32x32x16_bf16 a[192:207], a[24:27], v[176:179], a[192:207]
  buffer_load_dwordx4 v8, s[16:19], s81 offen offset:256  lds
  ds_read_b64_tr_b16 a[20:21], v2 offset:2560
  ds_read_b64_tr_b16 a[22:23], v2 offset:3584
  v_fma_f32 v22, v22, v5, v6
  v_fma_f32 v23, v23, v5, v6
  v_mfma_f32_32x32x16_bf16 v[32:47], a[28:31], v[176:179], v[32:47]
  ds_read_b64_tr_b16 a[24:25], v2 offset:4096
  ds_read_b64_tr_b16 a[26:27], v2 offset:5120
  v_fma_f32 v24, v24, v5, v6
  v_fma_f32 v25, v25, v5, v6
  s_waitcnt lgkmcnt(8)
  v_mfma_f32_32x32x16_bf16 v[48:63], a[0:3], v[176:179], v[48:63]
  ds_read_b64_tr_b16 a[28:29], v2 offset:4608
  ds_read_b64_tr_b16 a[30:31], v2 offset:5632
  v_cvt_pk_bf16_f32 v194, v22, v23
  v_cvt_pk_bf16_f32 v195, v24, v25
  s_add_u32 m0, s40, 7808
  v_mfma_f32_32x32x16_bf16 v[96:111], a[4:7], v[176:179], v[96:111]
  buffer_load_dwordx4 v8, s[16:19], s80 offen offset:384  lds
  ds_read_b64_tr_b16 a[0:1], v2 offset:6144
  ds_read_b64_tr_b16 a[2:3], v2 offset:7168
  v_lshlrev_b32 v18, 16, v196
  v_and_b32 v19, s41, v196
  v_lshlrev_b32 v20, 16, v197
  v_mfma_f32_32x32x16_bf16 v[64:79], a[8:11], v[180:183], v[64:79]
  ds_read_b64_tr_b16 a[4:5], v2 offset:6656
  ds_read_b64_tr_b16 a[6:7], v2 offset:7680
  v_and_b32 v21, s41, v197
  v_fma_f32 v18, v18, v5, v6
  s_waitcnt lgkmcnt(8)
  v_mfma_f32_32x32x16_bf16 v[80:95], a[12:15], v[180:183], v[80:95]
  ds_read_b64_tr_b16 a[8:9], v2 offset:8192
  ds_read_b64_tr_b16 a[10:11], v2 offset:9216
  v_fma_f32 v19, v19, v5, v6
  v_fma_f32 v20, v20, v5, v6
  s_add_u32 m0, s40, 8832
  v_mfma_f32_32x32x16_bf16 a[128:143], a[16:19], v[180:183], a[128:143]
  buffer_load_dwordx4 v8, s[16:19], s81 offen offset:384  lds
  ds_read_b64_tr_b16 a[12:13], v2 offset:8704
  ds_read_b64_tr_b16 a[14:15], v2 offset:9728
  v_fma_f32 v21, v21, v5, v6
  v_cvt_pk_bf16_f32 v196, v18, v19
  v_mfma_f32_32x32x16_bf16 a[144:159], a[20:23], v[180:183], a[144:159]
  ds_read_b64_tr_b16 a[16:17], v2 offset:39936
  ds_read_b64_tr_b16 a[18:19], v2 offset:40960
  v_cvt_pk_bf16_f32 v197, v20, v21
  v_lshlrev_b32 v22, 16, v198
  v_and_b32 v23, s41, v198
  s_waitcnt lgkmcnt(8)
  v_mfma_f32_32x32x16_bf16 a[160:175], a[24:27], v[180:183], a[160:175]
  ds_read_b64_tr_b16 a[20:21], v2 offset:40448
  ds_read_b64_tr_b16 a[22:23], v2 offset:41472
  v_lshlrev_b32 v24, 16, v199
  v_and_b32 v25, s41, v199
  s_add_u32 m0, s40, 9728
  v_mfma_f32_32x32x16_bf16 a[176:191], a[28:31], v[180:183], a[176:191]
  buffer_load_dwordx4 v8, s[16:19], s80 offen offset:512  lds
  ds_read_b64_tr_b16 a[24:25], v2 offset:41984
  ds_read_b64_tr_b16 a[26:27], v2 offset:43008
  v_fma_f32 v22, v22, v5, v6
  v_fma_f32 v23, v23, v5, v6
  v_mfma_f32_32x32x16_bf16 a[192:207], a[0:3], v[180:183], a[192:207]
  ds_read_b64_tr_b16 a[28:29], v2 offset:42496
  ds_read_b64_tr_b16 a[30:31], v2 offset:43520
  v_fma_f32 v24, v24, v5, v6
  v_fma_f32 v25, v25, v5, v6
  s_waitcnt lgkmcnt(8)
  v_mfma_f32_32x32x16_bf16 v[32:47], a[4:7], v[180:183], v[32:47]
  ds_read_b64_tr_b16 a[0:1], v2 offset:44032
  ds_read_b64_tr_b16 a[2:3], v2 offset:45056
  v_cvt_pk_bf16_f32 v198, v22, v23
  v_cvt_pk_bf16_f32 v199, v24, v25
  s_add_u32 m0, s40, 10752
  v_mfma_f32_32x32x16_bf16 v[48:63], a[8:11], v[180:183], v[48:63]
  buffer_load_dwordx4 v8, s[16:19], s81 offen offset:512  lds
  ds_read_b64_tr_b16 a[4:5], v2 offset:44544
  ds_read_b64_tr_b16 a[6:7], v2 offset:45568
  v_lshlrev_b32 v18, 16, v200
  v_and_b32 v19, s41, v200
  v_lshlrev_b32 v20, 16, v201
  v_mfma_f32_32x32x16_bf16 v[96:111], a[12:15], v[180:183], v[96:111]
  ds_read_b64_tr_b16 a[8:9], v2 offset:46080
  ds_read_b64_tr_b16 a[10:11], v2 offset:47104
  v_and_b32 v21, s41, v201
  v_fma_f32 v18, v18, v5, v6
  s_waitcnt lgkmcnt(8)
  v_mfma_f32_32x32x16_bf16 v[64:79], a[16:19], v[184:187], v[64:79]
  ds_read_b64_tr_b16 a[12:13], v2 offset:46592
  ds_read_b64_tr_b16 a[14:15], v2 offset:47616
  s_lshr_b32 s46, s2, 5
  s_lshl_b32 s46, s46, 2
  s_add_u32 s46, s46, s6
  s_mul_i32 s46, s46, 13824
  s_add_u32 s46, s46, s87
  v_lshlrev_b32 v26, 3, v4
  v_min_u32 v26, 4480, v26
  s_add_u32 s46, s46, 4608
  buffer_load_dword a243, v26, s[20:23], s46 offen
  v_mfma_f32_32x32x16_bf16 v[80:95], a[20:23], v[184:187], v[80:95]
  ds_read_b64_tr_b16 a[16:17], v2 offset:48128
  ds_read_b64_tr_b16 a[18:19], v2 offset:49152
  s_lshr_b32 s46, s2, 5
  s_lshl_b32 s46, s46, 2
  s_add_u32 s46, s46, s6
  s_mul_i32 s46, s46, 165888
  s_mul_i32 s47, s3, 768
  s_add_u32 s46, s46, s47
  v_and_b32 v26, 63, v0
  v_min_u32 v26, 17, v26
  v_mul_u32_u24 v26, 9216, v26
  buffer_load_dword a253, v26, s[16:19], s46 offen offset:640
  v_mfma_f32_32x32x16_bf16 a[128:143], a[24:27], v[184:187], a[128:143]
  ds_read_b64_tr_b16 a[20:21], v2 offset:48640
  ds_read_b64_tr_b16 a[22:23], v2 offset:49664
  s_waitcnt lgkmcnt(8)
  v_mfma_f32_32x32x16_bf16 a[144:159], a[28:31], v[184:187], a[144:159]
  ds_read_b64_tr_b16 a[24:25], v3 offset:14336
  ds_read_b64_tr_b16 a[26:27], v3 offset:15360
  v_lshlrev_b32 v26, 3, v4
  buffer_load_dword a252, v26, s[32:35], 0 offen
  v_fma_f32 v19, v19, v5, v6
  v_mfma_f32_32x32x16_bf16 a[160:175], a[0:3], v[184:187], a[160:175]
  ds_read_b64_tr_b16 a[28:29], v3 offset:14848
  ds_read_b64_tr_b16 a[30:31], v3 offset:15872
  v_fma_f32 v20, v20, v5, v6
  v_fma_f32 v21, v21, v5, v6
  v_cvt_pk_bf16_f32 v200, v18, v19
  v_mfma_f32_32x32x16_bf16 a[176:191], a[4:7], v[184:187], a[176:191]
  ds_read_b64_tr_b16 a[0:1], v3 offset:16384
  ds_read_b64_tr_b16 a[2:3], v3 offset:17408
  v_cvt_pk_bf16_f32 v201, v20, v21
  v_lshlrev_b32 v22, 16, v202
  v_and_b32 v23, s41, v202
  s_waitcnt lgkmcnt(8)
  v_mfma_f32_32x32x16_bf16 a[192:207], a[8:11], v[184:187], a[192:207]
  ds_read_b64_tr_b16 a[4:5], v3 offset:16896
  ds_read_b64_tr_b16 a[6:7], v3 offset:17920
  v_lshlrev_b32 v24, 16, v203
  v_and_b32 v25, s41, v203
  v_fma_f32 v22, v22, v5, v6
  v_mfma_f32_32x32x16_bf16 v[32:47], a[12:15], v[184:187], v[32:47]
  ds_read_b64_tr_b16 a[8:9], v3 offset:18432
  ds_read_b64_tr_b16 a[10:11], v3 offset:19456
  v_fma_f32 v23, v23, v5, v6
  v_fma_f32 v24, v24, v5, v6
  v_fma_f32 v25, v25, v5, v6
  v_mfma_f32_32x32x16_bf16 v[48:63], a[16:19], v[184:187], v[48:63]
  ds_read_b64_tr_b16 a[12:13], v3 offset:18944
  ds_read_b64_tr_b16 a[14:15], v3 offset:19968
  v_cvt_pk_bf16_f32 v202, v22, v23
  v_cvt_pk_bf16_f32 v203, v24, v25
  s_waitcnt lgkmcnt(8)
  v_mfma_f32_32x32x16_bf16 v[96:111], a[20:23], v[184:187], v[96:111]
  ds_read_b64_tr_b16 a[16:17], v3 offset:20480
  ds_read_b64_tr_b16 a[18:19], v3 offset:21504
  v_lshlrev_b32 v18, 16, v204
  v_and_b32 v19, s41, v204
  v_lshlrev_b32 v20, 16, v205
  v_and_b32 v21, s41, v205
  v_mfma_f32_32x32x16_bf16 v[64:79], a[24:27], v[188:191], v[64:79]
  ds_read_b64_tr_b16 a[20:21], v3 offset:20992
  ds_read_b64_tr_b16 a[22:23], v3 offset:22016
  v_fma_f32 v18, v18, v5, v6
  v_fma_f32 v19, v19, v5, v6
  v_fma_f32 v20, v20, v5, v6
  v_mfma_f32_32x32x16_bf16 v[80:95], a[28:31], v[188:191], v[80:95]
  ds_read_b64_tr_b16 a[24:25], v3 offset:22528
  ds_read_b64_tr_b16 a[26:27], v3 offset:23552
  v_fma_f32 v21, v21, v5, v6
  v_cvt_pk_bf16_f32 v204, v18, v19
  s_waitcnt lgkmcnt(8)
  v_mfma_f32_32x32x16_bf16 a[128:143], a[0:3], v[188:191], a[128:143]
  ds_read_b64_tr_b16 a[28:29], v3 offset:23040
  ds_read_b64_tr_b16 a[30:31], v3 offset:24064
  v_cvt_pk_bf16_f32 v205, v20, v21
  v_lshlrev_b32 v22, 16, v206
  v_and_b32 v23, s41, v206
  v_lshlrev_b32 v24, 16, v207
  v_mfma_f32_32x32x16_bf16 a[144:159], a[4:7], v[188:191], a[144:159]
  s_waitcnt vmcnt(13)
  s_barrier
  ds_read_b64_tr_b16 a[0:1], v1 offset:35840
  ds_read_b64_tr_b16 a[2:3], v1 offset:36864
  v_and_b32 v25, s41, v207
  v_fma_f32 v22, v22, v5, v6
  v_mfma_f32_32x32x16_bf16 a[160:175], a[8:11], v[188:191], a[160:175]
  ds_read_b64_tr_b16 a[4:5], v1 offset:36352
  ds_read_b64_tr_b16 a[6:7], v1 offset:37376
  v_fma_f32 v23, v23, v5, v6
  v_fma_f32 v24, v24, v5, v6
  s_waitcnt lgkmcnt(8)
  v_mfma_f32_32x32x16_bf16 a[176:191], a[12:15], v[188:191], a[176:191]
  ds_read_b64_tr_b16 a[8:9], v1 offset:37888
  ds_read_b64_tr_b16 a[10:11], v1 offset:38912
  v_fma_f32 v25, v25, v5, v6
  v_cvt_pk_bf16_f32 v206, v22, v23
  v_cvt_pk_bf16_f32 v207, v24, v25
  v_mfma_f32_32x32x16_bf16 a[192:207], a[16:19], v[188:191], a[192:207]
  ds_read_b64_tr_b16 a[12:13], v1 offset:38400
  ds_read_b64_tr_b16 a[14:15], v1 offset:39424
  v_lshlrev_b32 v18, 16, v208
  v_and_b32 v19, s41, v208
  v_lshlrev_b32 v20, 16, v209
  v_and_b32 v21, s41, v209
  v_mfma_f32_32x32x16_bf16 v[32:47], a[20:23], v[188:191], v[32:47]
  ds_read_b64_tr_b16 a[16:17], v1 offset:39936
  ds_read_b64_tr_b16 a[18:19], v1 offset:40960
  v_fma_f32 v18, v18, v5, v6
  v_fma_f32 v19, v19, v5, v6
  s_waitcnt lgkmcnt(8)
  v_mfma_f32_32x32x16_bf16 v[48:63], a[24:27], v[188:191], v[48:63]
  ds_read_b64_tr_b16 a[20:21], v1 offset:40448
  ds_read_b64_tr_b16 a[22:23], v1 offset:41472
  v_fma_f32 v20, v20, v5, v6
  v_fma_f32 v21, v21, v5, v6
  v_cvt_pk_bf16_f32 v208, v18, v19
  v_mfma_f32_32x32x16_bf16 v[96:111], a[28:31], v[188:191], v[96:111]
  ds_read_b64_tr_b16 a[24:25], v1 offset:41984
  ds_read_b64_tr_b16 a[26:27], v1 offset:43008
  v_cvt_pk_bf16_f32 v209, v20, v21
  v_lshlrev_b32 v22, 16, v210
  s_add_u32 m0, s40, 12288
  v_mfma_f32_32x32x16_bf16 v[64:79], a[0:3], v[192:195], v[64:79]
  buffer_load_dwordx4 v8, s[16:19], s82 offen  lds
  ds_read_b64_tr_b16 a[28:29], v1 offset:42496
  ds_read_b64_tr_b16 a[30:31], v1 offset:43520
  v_and_b32 v23, s41, v210
  v_lshlrev_b32 v24, 16, v211
  s_waitcnt lgkmcnt(8)
  v_mfma_f32_32x32x16_bf16 v[80:95], a[4:7], v[192:195], v[80:95]
  ds_read_b64_tr_b16 a[0:1], v1 offset:4096
  ds_read_b64_tr_b16 a[2:3], v1 offset:5120
  v_and_b32 v25, s41, v211
  v_fma_f32 v22, v22, v5, v6
  v_fma_f32 v23, v23, v5, v6
  v_mfma_f32_32x32x16_bf16 a[128:143], a[8:11], v[192:195], a[128:143]
  ds_read_b64_tr_b16 a[4:5], v1 offset:4608
  ds_read_b64_tr_b16 a[6:7], v1 offset:5632
  v_fma_f32 v24, v24, v5, v6
  v_fma_f32 v25, v25, v5, v6
  s_add_u32 m0, s40, 13312
  v_mfma_f32_32x32x16_bf16 a[144:159], a[12:15], v[192:195], a[144:159]
  buffer_load_dwordx4 v8, s[16:19], s83 offen  lds
  ds_read_b64_tr_b16 a[8:9], v2 offset:10240
  ds_read_b64_tr_b16 a[10:11], v2 offset:11264
  v_cvt_pk_bf16_f32 v210, v22, v23
  s_waitcnt lgkmcnt(8)
  v_mfma_f32_32x32x16_bf16 a[160:175], a[16:19], v[192:195], a[160:175]
  ds_read_b64_tr_b16 a[12:13], v2 offset:10752
  ds_read_b64_tr_b16 a[14:15], v2 offset:11776
  v_cvt_pk_bf16_f32 v211, v24, v25
  v_lshlrev_b32 v18, 16, v212
  v_and_b32 v19, s41, v212
  v_lshlrev_b32 v20, 16, v213
  v_mfma_f32_32x32x16_bf16 a[176:191], a[20:23], v[192:195], a[176:191]
  ds_read_b64_tr_b16 a[16:17], v2 offset:12288
  ds_read_b64_tr_b16 a[18:19], v2 offset:13312
  v_and_b32 v21, s41, v213
  v_fma_f32 v18, v18, v5, v6
  s_add_u32 m0, s40, 14208
  v_mfma_f32_32x32x16_bf16 a[192:207], a[24:27], v[192:195], a[192:207]
  buffer_load_dwordx4 v8, s[16:19], s82 offen offset:128  lds
  ds_read_b64_tr_b16 a[20:21], v2 offset:12800
  ds_read_b64_tr_b16 a[22:23], v2 offset:13824
  v_fma_f32 v19, v19, v5, v6
  s_waitcnt lgkmcnt(8)
  v_mfma_f32_32x32x16_bf16 v[32:47], a[28:31], v[192:195], v[32:47]
  ds_read_b64_tr_b16 a[24:25], v2 offset:14336
  ds_read_b64_tr_b16 a[26:27], v2 offset:15360
  v_fma_f32 v20, v20, v5, v6
  v_fma_f32 v21, v21, v5, v6
  v_cvt_pk_bf16_f32 v212, v18, v19
  v_mfma_f32_32x32x16_bf16 v[48:63], a[0:3], v[192:195], v[48:63]
  ds_read_b64_tr_b16 a[28:29], v2 offset:14848
  ds_read_b64_tr_b16 a[30:31], v2 offset:15872
  v_cvt_pk_bf16_f32 v213, v20, v21
  v_lshlrev_b32 v22, 16, v214
  s_add_u32 m0, s40, 15232
  v_mfma_f32_32x32x16_bf16 v[96:111], a[4:7], v[192:195], v[96:111]
  buffer_load_dwordx4 v8, s[16:19], s83 offen offset:128  lds
  ds_read_b64_tr_b16 a[0:1], v2 offset:16384
  ds_read_b64_tr_b16 a[2:3], v2 offset:17408
  v_and_b32 v23, s41, v214
  v_lshlrev_b32 v24, 16, v215
  s_waitcnt lgkmcnt(8)
  v_mfma_f32_32x32x16_bf16 v[64:79], a[8:11], v[196:199], v[64:79]
  ds_read_b64_tr_b16 a[4:5], v2 offset:16896
  ds_read_b64_tr_b16 a[6:7], v2 offset:17920
  v_and_b32 v25, s41, v215
  v_fma_f32 v22, v22, v5, v6
  v_fma_f32 v23, v23, v5, v6
  v_mfma_f32_32x32x16_bf16 v[80:95], a[12:15], v[196:199], v[80:95]
  ds_read_b64_tr_b16 a[8:9], v1 offset:44032
  ds_read_b64_tr_b16 a[10:11], v1 offset:45056
  v_fma_f32 v24, v24, v5, v6
  v_fma_f32 v25, v25, v5, v6
  s_add_u32 m0, s40, 16128
  v_mfma_f32_32x32x16_bf16 a[128:143], a[16:19], v[196:199], a[128:143]
  buffer_load_dwordx4 v8, s[16:19], s82 offen offset:256  lds
  ds_read_b64_tr_b16 a[12:13], v1 offset:44544
  ds_read_b64_tr_b16 a[14:15], v1 offset:45568
  v_cvt_pk_bf16_f32 v214, v22, v23
  s_waitcnt lgkmcnt(8)
  v_mfma_f32_32x32x16_bf16 a[144:159], a[20:23], v[196:199], a[144:159]
  ds_read_b64_tr_b16 a[16:17], v2 offset:50176
  ds_read_b64_tr_b16 a[18:19], v2 offset:51200
  v_cvt_pk_bf16_f32 v215, v24, v25
  v_lshlrev_b32 v18, 16, v216
  v_and_b32 v19, s41, v216
  v_lshlrev_b32 v20, 16, v217
  v_mfma_f32_32x32x16_bf16 a[160:175], a[24:27], v[196:199], a[160:175]
  ds_read_b64_tr_b16 a[20:21], v2 offset:50688
  ds_read_b64_tr_b16 a[22:23], v2 offset:51712
  v_and_b32 v21, s41, v217
  v_fma_f32 v18, v18, v5, v6
  s_add_u32 m0, s40, 17152
  v_mfma_f32_32x32x16_bf16 a[176:191], a[28:31], v[196:199], a[176:191]
  buffer_load_dwordx4 v8, s[16:19], s83 offen offset:256  lds
  ds_read_b64_tr_b16 a[24:25], v2 offset:52224
  ds_read_b64_tr_b16 a[26:27], v2 offset:53248
  v_fma_f32 v19, v19, v5, v6
  s_waitcnt lgkmcnt(8)
  v_mfma_f32_32x32x16_bf16 a[192:207], a[0:3], v[196:199], a[192:207]
  ds_read_b64_tr_b16 a[28:29], v2 offset:52736
  ds_read_b64_tr_b16 a[30:31], v2 offset:53760
  v_fma_f32 v20, v20, v5, v6
  v_fma_f32 v21, v21, v5, v6
  v_cvt_pk_bf16_f32 v216, v18, v19
  v_mfma_f32_32x32x16_bf16 v[32:47], a[4:7], v[196:199], v[32:47]
  ds_read_b64_tr_b16 a[0:1], v2 offset:54272
  ds_read_b64_tr_b16 a[2:3], v2 offset:55296
  v_cvt_pk_bf16_f32 v217, v20, v21
  v_lshlrev_b32 v22, 16, v218
  s_add_u32 m0, s40, 18048
  v_mfma_f32_32x32x16_bf16 v[48:63], a[8:11], v[196:199], v[48:63]
  buffer_load_dwordx4 v8, s[16:19], s82 offen offset:384  lds
  ds_read_b64_tr_b16 a[4:5], v2 offset:54784
  ds_read_b64_tr_b16 a[6:7], v2 offset:55808
  v_and_b32 v23, s41, v218
  v_lshlrev_b32 v24, 16, v219
  s_waitcnt lgkmcnt(8)
  v_mfma_f32_32x32x16_bf16 v[96:111], a[12:15], v[196:199], v[96:111]
  ds_read_b64_tr_b16 a[8:9], v2 offset:56320
  ds_read_b64_tr_b16 a[10:11], v2 offset:57344
  v_and_b32 v25, s41, v219
  v_fma_f32 v22, v22, v5, v6
  v_fma_f32 v23, v23, v5, v6
  v_mfma_f32_32x32x16_bf16 v[64:79], a[16:19], v[200:203], v[64:79]
  ds_read_b64_tr_b16 a[12:13], v2 offset:56832
  ds_read_b64_tr_b16 a[14:15], v2 offset:57856
  v_fma_f32 v24, v24, v5, v6
  v_fma_f32 v25, v25, v5, v6
  s_add_u32 m0, s40, 19072
  v_mfma_f32_32x32x16_bf16 v[80:95], a[20:23], v[200:203], v[80:95]
  buffer_load_dwordx4 v8, s[16:19], s83 offen offset:384  lds
  ds_read_b64_tr_b16 a[16:17], v2 offset:18432
  ds_read_b64_tr_b16 a[18:19], v2 offset:19456
  v_cvt_pk_bf16_f32 v218, v22, v23
  s_waitcnt lgkmcnt(8)
  v_mfma_f32_32x32x16_bf16 a[128:143], a[24:27], v[200:203], a[128:143]
  ds_read_b64_tr_b16 a[20:21], v2 offset:18944
  ds_read_b64_tr_b16 a[22:23], v2 offset:19968
  v_cvt_pk_bf16_f32 v219, v24, v25
  v_lshlrev_b32 v18, 16, v220
  v_and_b32 v19, s41, v220
  v_lshlrev_b32 v20, 16, v221
  v_mfma_f32_32x32x16_bf16 a[144:159], a[28:31], v[200:203], a[144:159]
  ds_read_b64_tr_b16 a[24:25], v3 offset:24576
  ds_read_b64_tr_b16 a[26:27], v3 offset:25600
  v_and_b32 v21, s41, v221
  v_fma_f32 v18, v18, v5, v6
  s_add_u32 m0, s40, 19968
  v_mfma_f32_32x32x16_bf16 a[160:175], a[0:3], v[200:203], a[160:175]
  buffer_load_dwordx4 v8, s[16:19], s82 offen offset:512  lds
  ds_read_b64_tr_b16 a[28:29], v3 offset:25088
  ds_read_b64_tr_b16 a[30:31], v3 offset:26112
  v_fma_f32 v19, v19, v5, v6
  s_waitcnt lgkmcnt(8)
  v_mfma_f32_32x32x16_bf16 a[176:191], a[4:7], v[200:203], a[176:191]
  ds_read_b64_tr_b16 a[0:1], v3 offset:26624
  ds_read_b64_tr_b16 a[2:3], v3 offset:27648
  v_fma_f32 v20, v20, v5, v6
  v_fma_f32 v21, v21, v5, v6
  v_cvt_pk_bf16_f32 v220, v18, v19
  v_mfma_f32_32x32x16_bf16 a[192:207], a[8:11], v[200:203], a[192:207]
  ds_read_b64_tr_b16 a[4:5], v3 offset:27136
  ds_read_b64_tr_b16 a[6:7], v3 offset:28160
  v_cvt_pk_bf16_f32 v221, v20, v21
  v_lshlrev_b32 v22, 16, v222
  s_add_u32 m0, s40, 20992
  v_mfma_f32_32x32x16_bf16 v[32:47], a[12:15], v[200:203], v[32:47]
  buffer_load_dwordx4 v8, s[16:19], s83 offen offset:512  lds
  ds_read_b64_tr_b16 a[8:9], v3 offset:28672
  ds_read_b64_tr_b16 a[10:11], v3 offset:29696
  v_and_b32 v23, s41, v222
  v_lshlrev_b32 v24, 16, v223
  s_waitcnt lgkmcnt(8)
  v_mfma_f32_32x32x16_bf16 v[48:63], a[16:19], v[200:203], v[48:63]
  ds_read_b64_tr_b16 a[12:13], v3 offset:29184
  ds_read_b64_tr_b16 a[14:15], v3 offset:30208
  v_and_b32 v25, s41, v223
  v_fma_f32 v22, v22, v5, v6
  v_fma_f32 v23, v23, v5, v6
  v_mfma_f32_32x32x16_bf16 v[96:111], a[20:23], v[200:203], v[96:111]
  ds_read_b64_tr_b16 a[16:17], v3 offset:30720
  ds_read_b64_tr_b16 a[18:19], v3 offset:31744
  v_fma_f32 v24, v24, v5, v6
  v_fma_f32 v25, v25, v5, v6
  s_add_u32 m0, s40, 22528
  v_mfma_f32_32x32x16_bf16 v[64:79], a[24:27], v[204:207], v[64:79]
  buffer_load_dwordx4 v8, s[16:19], s84 offen  lds
  ds_read_b64_tr_b16 a[20:21], v3 offset:31232
  ds_read_b64_tr_b16 a[22:23], v3 offset:32256
  v_cvt_pk_bf16_f32 v222, v22, v23
  s_waitcnt lgkmcnt(8)
  v_mfma_f32_32x32x16_bf16 v[80:95], a[28:31], v[204:207], v[80:95]
  ds_read_b64_tr_b16 a[24:25], v2 offset:58368
  ds_read_b64_tr_b16 a[26:27], v2 offset:59392
  v_cvt_pk_bf16_f32 v223, v24, v25
  v_lshlrev_b32 v18, 16, v224
  v_and_b32 v19, s41, v224
  v_lshlrev_b32 v20, 16, v225
  v_mfma_f32_32x32x16_bf16 a[128:143], a[0:3], v[204:207], a[128:143]
  ds_read_b64_tr_b16 a[28:29], v2 offset:58880
  ds_read_b64_tr_b16 a[30:31], v2 offset:59904
  v_and_b32 v21, s41, v225
  v_fma_f32 v18, v18, v5, v6
  s_add_u32 m0, s40, 23552
  v_mfma_f32_32x32x16_bf16 a[144:159], a[4:7], v[204:207], a[144:159]
  buffer_load_dwordx4 v8, s[16:19], s85 offen  lds
  s_waitcnt vmcnt(15)
  s_barrier
  ds_read_b64_tr_b16 a[0:1], v1 offset:6144
  ds_read_b64_tr_b16 a[2:3], v1 offset:7168
  s_waitcnt lgkmcnt(8)
  v_mfma_f32_32x32x16_bf16 a[160:175], a[8:11], v[204:207], a[160:175]
  ds_read_b64_tr_b16 a[4:5], v1 offset:6656
  ds_read_b64_tr_b16 a[6:7], v1 offset:7680
  v_fma_f32 v19, v19, v5, v6
  v_fma_f32 v20, v20, v5, v6
  v_fma_f32 v21, v21, v5, v6
  v_mfma_f32_32x32x16_bf16 a[176:191], a[12:15], v[204:207], a[176:191]
  ds_read_b64_tr_b16 a[8:9], v1 offset:8192
  ds_read_b64_tr_b16 a[10:11], v1 offset:9216
  v_cvt_pk_bf16_f32 v224, v18, v19
  v_cvt_pk_bf16_f32 v225, v20, v21
  s_add_u32 m0, s40, 24448
  v_mfma_f32_32x32x16_bf16 a[192:207], a[16:19], v[204:207], a[192:207]
  buffer_load_dwordx4 v8, s[16:19], s84 offen offset:128  lds
  ds_read_b64_tr_b16 a[12:13], v1 offset:8704
  ds_read_b64_tr_b16 a[14:15], v1 offset:9728
  v_lshlrev_b32 v22, 16, v226
  v_and_b32 v23, s41, v226
  s_waitcnt lgkmcnt(8)
  v_mfma_f32_32x32x16_bf16 v[32:47], a[20:23], v[204:207], v[32:47]
  ds_read_b64_tr_b16 a[16:17], v1 offset:10240
  ds_read_b64_tr_b16 a[18:19], v1 offset:11264
  v_lshlrev_b32 v24, 16, v227
  v_and_b32 v25, s41, v227
  v_fma_f32 v22, v22, v5, v6
  v_mfma_f32_32x32x16_bf16 v[48:63], a[24:27], v[204:207], v[48:63]
  ds_read_b64_tr_b16 a[20:21], v1 offset:10752
  ds_read_b64_tr_b16 a[22:23], v1 offset:11776
  v_fma_f32 v23, v23, v5, v6
  v_fma_f32 v24, v24, v5, v6
  s_add_u32 m0, s40, 25472
  v_mfma_f32_32x32x16_bf16 v[96:111], a[28:31], v[204:207], v[96:111]
  buffer_load_dwordx4 v8, s[16:19], s85 offen offset:128  lds
  ds_read_b64_tr_b16 a[24:25], v1 offset:12288
  ds_read_b64_tr_b16 a[26:27], v1 offset:13312
  v_fma_f32 v25, v25, v5, v6
  s_waitcnt lgkmcnt(8)
  v_mfma_f32_32x32x16_bf16 v[64:79], a[0:3], v[208:211], v[64:79]
  ds_read_b64_tr_b16 a[28:29], v1 offset:12800
  ds_read_b64_tr_b16 a[30:31], v1 offset:13824
  v_cvt_pk_bf16_f32 v226, v22, v23
  v_cvt_pk_bf16_f32 v227, v24, v25
  v_lshlrev_b32 v18, 16, v228
  v_mfma_f32_32x32x16_bf16 v[80:95], a[4:7], v[208:211], v[80:95]
  ds_read_b64_tr_b16 a[0:1], v1 offset:14336
  ds_read_b64_tr_b16 a[2:3], v1 offset:15360
  v_and_b32 v19, s41, v228
  v_lshlrev_b32 v20, 16, v229
  v_and_b32 v21, s41, v229
  s_add_u32 m0, s40, 26368
  v_mfma_f32_32x32x16_bf16 a[128:143], a[8:11], v[208:211], a[128:143]
  buffer_load_dwordx4 v8, s[16:19], s84 offen offset:256  lds
  ds_read_b64_tr_b16 a[4:5], v1 offset:14848
  ds_read_b64_tr_b16 a[6:7], v1 offset:15872
  v_fma_f32 v18, v18, v5, v6
  s_waitcnt lgkmcnt(8)
  v_mfma_f32_32x32x16_bf16 a[144:159], a[12:15], v[208:211], a[144:159]
  ds_read_b64_tr_b16 a[8:9], v1 offset:46080
  ds_read_b64_tr_b16 a[10:11], v1 offset:47104
  v_fma_f32 v19, v19, v5, v6
  v_fma_f32 v20, v20, v5, v6
  v_fma_f32 v21, v21, v5, v6
  v_mfma_f32_32x32x16_bf16 a[160:175], a[16:19], v[208:211], a[160:175]
  ds_read_b64_tr_b16 a[12:13], v1 offset:46592
  ds_read_b64_tr_b16 a[14:15], v1 offset:47616
  v_cvt_pk_bf16_f32 v228, v18, v19
  v_cvt_pk_bf16_f32 v229, v20, v21
  s_add_u32 m0, s40, 27392
  v_mfma_f32_32x32x16_bf16 a[176:191], a[20:23], v[208:211], a[176:191]
  buffer_load_dwordx4 v8, s[16:19], s85 offen offset:256  lds
  ds_read_b64_tr_b16 a[16:17], v1 offset:48128
  ds_read_b64_tr_b16 a[18:19], v1 offset:49152
  v_lshlrev_b32 v22, 16, v230
  v_and_b32 v23, s41, v230
  s_waitcnt lgkmcnt(8)
  v_mfma_f32_32x32x16_bf16 a[192:207], a[24:27], v[208:211], a[192:207]
  ds_read_b64_tr_b16 a[20:21], v1 offset:48640
  ds_read_b64_tr_b16 a[22:23], v1 offset:49664
  v_lshlrev_b32 v24, 16, v231
  v_and_b32 v25, s41, v231
  v_fma_f32 v22, v22, v5, v6
  v_mfma_f32_32x32x16_bf16 v[32:47], a[28:31], v[208:211], v[32:47]
  ds_read_b64_tr_b16 a[24:25], v1 offset:50176
  ds_read_b64_tr_b16 a[26:27], v1 offset:51200
  v_fma_f32 v23, v23, v5, v6
  v_fma_f32 v24, v24, v5, v6
  s_add_u32 m0, s40, 28288
  v_mfma_f32_32x32x16_bf16 v[48:63], a[0:3], v[208:211], v[48:63]
  buffer_load_dwordx4 v8, s[16:19], s84 offen offset:384  lds
  ds_read_b64_tr_b16 a[28:29], v1 offset:50688
  ds_read_b64_tr_b16 a[30:31], v1 offset:51712
  v_fma_f32 v25, v25, v5, v6
  s_waitcnt lgkmcnt(8)
  v_mfma_f32_32x32x16_bf16 v[96:111], a[4:7], v[208:211], v[96:111]
  ds_read_b64_tr_b16 a[0:1], v1 offset:52224
  ds_read_b64_tr_b16 a[2:3], v1 offset:53248
  v_cvt_pk_bf16_f32 v230, v22, v23
  v_cvt_pk_bf16_f32 v231, v24, v25
  v_lshlrev_b32 v18, 16, v232
  v_mfma_f32_32x32x16_bf16 v[64:79], a[8:11], v[212:215], v[64:79]
  ds_read_b64_tr_b16 a[4:5], v1 offset:52736
  ds_read_b64_tr_b16 a[6:7], v1 offset:53760
  s_lshr_b32 s46, s2, 5
  s_lshl_b32 s46, s46, 2
  s_add_u32 s46, s46, s6
  s_mul_i32 s46, s46, 13824
  s_add_u32 s46, s46, s87
  v_lshlrev_b32 v26, 3, v4
  v_min_u32 v26, 4480, v26
  s_add_u32 s46, s46, 9216
  buffer_load_dword a244, v26, s[20:23], s46 offen
  v_mfma_f32_32x32x16_bf16 v[80:95], a[12:15], v[212:215], v[80:95]
  ds_read_b64_tr_b16 a[8:9], v1 offset:54272
  ds_read_b64_tr_b16 a[10:11], v1 offset:55296
FF_H3:
  s_cbranch_execz FF_H7
  s_waitcnt lgkmcnt(8)
  v_mfma_f32_32x32x16_bf16 a[128:143], a[16:19], v[212:215], a[128:143]
  ds_read_b64_tr_b16 a[12:13], v1 offset:54784
  ds_read_b64_tr_b16 a[14:15], v1 offset:55808
  s_lshr_b32 s46, s2, 5
  s_mul_i32 s46, s46, 3
  s_and_b32 s47, s4, 3
  s_add_u32 s46, s46, s47
  s_lshl_b32 s46, s46, 2
  s_add_u32 s46, s46, s6
  s_lshr_b32 s47, s4, 2
  s_mul_i32 s46, s46, 1792
  s_mul_i32 s47, s47, 165888
  s_add_u32 s46, s46, s47
  v_lshlrev_b32 v26, 3, v4
  v_min_u32 v26, 1664, v26
  buffer_load_dword a250, v26, s[24:27], s46 offen
  v_mfma_f32_32x32x16_bf16 a[144:159], a[20:23], v[212:215], a[144:159]
  ds_read_b64_tr_b16 a[16:17], v2 offset:20480
  ds_read_b64_tr_b16 a[18:19], v2 offset:21504
  s_getpc_b64 s[46:47]
FF_PC1:
  s_lshr_b32 s48, s2, 5
  s_lshl_b32 s48, s48, 2
  s_add_u32 s48, s48, s6
  s_mul_i32 s48, s48, 1536
  v_and_b32 v26, 63, v0
  v_min_u32 v26, 11, v26
  v_lshl_add_u32 v26, v26, 7, s48
  v_min_u32 v26, FF_LAST-FF_PC1, v26
  v_mov_b32 v27, s47
  v_add_co_u32 v26, vcc, s46, v26
  v_addc_co_u32 v27, vcc, 0, v27, vcc
  global_load_dword a241, v[26:27], off
  v_mfma_f32_32x32x16_bf16 a[160:175], a[24:27], v[212:215], a[160:175]
  ds_read_b64_tr_b16 a[20:21], v2 offset:20992
  ds_read_b64_tr_b16 a[22:23], v2 offset:22016
  s_waitcnt lgkmcnt(8)
  v_mfma_f32_32x32x16_bf16 a[176:191], a[28:31], v[212:215], a[176:191]
  ds_read_b64_tr_b16 a[24:25], v2 offset:22528
  ds_read_b64_tr_b16 a[26:27], v2 offset:23552
  v_and_b32 v19, s41, v232
  v_lshlrev_b32 v20, 16, v233
  v_and_b32 v21, s41, v233
  v_fma_f32 v18, v18, v5, v6
  v_mfma_f32_32x32x16_bf16 a[192:207], a[0:3], v[212:215], a[192:207]
  ds_read_b64_tr_b16 a[28:29], v2 offset:23040
  ds_read_b64_tr_b16 a[30:31], v2 offset:24064
  v_fma_f32 v19, v19, v5, v6
  v_fma_f32 v20, v20, v5, v6
  v_fma_f32 v21, v21, v5, v6
  v_mfma_f32_32x32x16_bf16 v[32:47], a[4:7], v[212:215], v[32:47]
  ds_read_b64_tr_b16 a[0:1], v2 offset:24576
  ds_read_b64_tr_b16 a[2:3], v2 offset:25600
  v_cvt_pk_bf16_f32 v232, v18, v19
  v_cvt_pk_bf16_f32 v233, v20, v21
  s_waitcnt lgkmcnt(8)
  v_mfma_f32_32x32x16_bf16 v[48:63], a[8:11], v[212:215], v[48:63]
  ds_read_b64_tr_b16 a[4:5], v2 offset:25088
  ds_read_b64_tr_b16 a[6:7], v2 offset:26112
  v_lshlrev_b32 v22, 16, v234
  v_and_b32 v23, s41, v234
  v_lshlrev_b32 v24, 16, v235
  v_and_b32 v25, s41, v235
  v_mfma_f32_32x32x16_bf16 v[96:111], a[12:15], v[212:215], v[96:111]
  ds_read_b64_tr_b16 a[8:9], v2 offset:26624
  ds_read_b64_tr_b16 a[10:11], v2 offset:27648
  v_fma_f32 v22, v22, v5, v6
  v_fma_f32 v23, v23, v5, v6
  v_fma_f32 v24, v24, v5, v6
  v_mfma_f32_32x32x16_bf16 v[64:79], a[16:19], v[216:219], v[64:79]
  ds_read_b64_tr_b16 a[12:13], v2 offset:27136
  ds_read_b64_tr_b16 a[14:15], v2 offset:28160
  v_fma_f32 v25, v25, v5, v6
  v_cvt_pk_bf16_f32 v234, v22, v23
  s_waitcnt lgkmcnt(8)
  v_mfma_f32_32x32x16_bf16 v[80:95], a[20:23], v[216:219], v[80:95]
  ds_read_b64_tr_b16 a[16:17], v2 offset:28672
  ds_read_b64_tr_b16 a[18:19], v2 offset:29696
  v_cvt_pk_bf16_f32 v235, v24, v25
  v_lshlrev_b32 v18, 16, v236
  v_and_b32 v19, s41, v236
  v_lshlrev_b32 v20, 16, v237
  v_mfma_f32_32x32x16_bf16 a[128:143], a[24:27], v[216:219], a[128:143]
  ds_read_b64_tr_b16 a[20:21], v2 offset:29184
  ds_read_b64_tr_b16 a[22:23], v2 offset:30208
  v_and_b32 v21, s41, v237
  v_fma_f32 v18, v18, v5, v6
  v_fma_f32 v19, v19, v5, v6
  v_mfma_f32_32x32x16_bf16 a[144:159], a[28:31], v[216:219], a[144:159]
  ds_read_b64_tr_b16 a[24:25], v2 offset:60416
  ds_read_b64_tr_b16 a[26:27], v2 offset:61440
  v_fma_f32 v20, v20, v5, v6
  v_fma_f32 v21, v21, v5, v6
  s_waitcnt lgkmcnt(8)
  v_mfma_f32_32x32x16_bf16 a[160:175], a[0:3], v[216:219], a[160:175]
  ds_read_b64_tr_b16 a[28:29], v2 offset:60928
  ds_read_b64_tr_b16 a[30:31], v2 offset:61952
  v_cvt_pk_bf16_f32 v236, v18, v19
  v_cvt_pk_bf16_f32 v237, v20, v21
  v_lshlrev_b32 v22, 16, v238
  v_mfma_f32_32x32x16_bf16 a[176:191], a[4:7], v[216:219], a[176:191]
  ds_read_b64_tr_b16 a[0:1], v2 offset:62464
  ds_read_b64_tr_b16 a[2:3], v2 offset:63488
  v_and_b32 v23, s41, v238
  v_lshlrev_b32 v24, 16, v239
  v_and_b32 v25, s41, v239
  v_fma_f32 v22, v22, v5, v6
  v_mfma_f32_32x32x16_bf16 a[192:207], a[8:11], v[216:219], a[192:207]
  ds_read_b64_tr_b16 a[4:5], v2 offset:62976
  ds_read_b64_tr_b16 a[6:7], v2 offset:64000
  v_fma_f32 v23, v23, v5, v6
  v_fma_f32 v24, v24, v5, v6
  s_waitcnt lgkmcnt(8)
  v_mfma_f32_32x32x16_bf16 v[32:47], a[12:15], v[216:219], v[32:47]
  ds_read_b64_tr_b16 a[8:9], v2 offset:64512
  ds_read_b64_tr_b16 a[10:11], v3 offset:0
  v_fma_f32 v25, v25, v5, v6
  v_cvt_pk_bf16_f32 v238, v22, v23
  v_cvt_pk_bf16_f32 v239, v24, v25
  v_mfma_f32_32x32x16_bf16 v[48:63], a[16:19], v[216:219], v[48:63]
  ds_read_b64_tr_b16 a[12:13], v2 offset:65024
  ds_read_b64_tr_b16 a[14:15], v3 offset:512
  v_lshlrev_b32 v18, 16, v240
  v_and_b32 v19, s41, v240
  v_lshlrev_b32 v20, 16, v241
  v_and_b32 v21, s41, v241
  v_mfma_f32_32x32x16_bf16 v[96:111], a[20:23], v[216:219], v[96:111]
  ds_read_b64_tr_b16 a[16:17], v3 offset:1024
  ds_read_b64_tr_b16 a[18:19], v3 offset:2048
  v_fma_f32 v18, v18, v5, v6
  s_add_u32 m0, s40, 29312
  s_waitcnt lgkmcnt(8)
  v_mfma_f32_32x32x16_bf16 v[64:79], a[24:27], v[220:223], v[64:79]
  buffer_load_dwordx4 v8, s[16:19], s85 offen offset:384  lds
  ds_read_b64_tr_b16 a[20:21], v3 offset:1536
  ds_read_b64_tr_b16 a[22:23], v3 offset:2560
  v_fma_f32 v19, v19, v5, v6
  v_fma_f32 v20, v20, v5, v6
  v_mfma_f32_32x32x16_bf16 v[80:95], a[28:31], v[220:223], v[80:95]
  ds_read_b64_tr_b16 a[24:25], v3 offset:3072
  ds_read_b64_tr_b16 a[26:27], v3 offset:4096
  v_fma_f32 v21, v21, v5, v6
  v_cvt_pk_bf16_f32 v240, v18, v19
  v_cvt_pk_bf16_f32 v241, v20, v21
  v_mfma_f32_32x32x16_bf16 a[128:143], a[0:3], v[220:223], a[128:143]
  ds_read_b64_tr_b16 a[28:29], v3 offset:3584
  ds_read_b64_tr_b16 a[30:31], v3 offset:4608
  v_lshlrev_b32 v22, 16, v242
  v_and_b32 v23, s41, v242
  s_add_u32 m0, s40, 30208
  s_waitcnt lgkmcnt(8)
  v_mfma_f32_32x32x16_bf16 a[144:159], a[4:7], v[220:223], a[144:159]
  buffer_load_dwordx4 v8, s[16:19], s84 offen offset:512  lds
  s_waitcnt vmcnt(12)
  s_barrier
  ds_read_b64_tr_b16 a[0:1], v1 offset:16384
  ds_read_b64_tr_b16 a[2:3], v1 offset:17408
  v_lshlrev_b32 v24, 16, v243
  v_mfma_f32_32x32x16_bf16 a[160:175], a[8:11], v[220:223], a[160:175]
  ds_read_b64_tr_b16 a[4:5], v1 offset:16896
  ds_read_b64_tr_b16 a[6:7], v1 offset:17920
  v_and_b32 v25, s41, v243
  v_fma_f32 v22, v22, v5, v6
  v_fma_f32 v23, v23, v5, v6
  v_mfma_f32_32x32x16_bf16 a[176:191], a[12:15], v[220:223], a[176:191]
  ds_read_b64_tr_b16 a[8:9], v1 offset:18432
  ds_read_b64_tr_b16 a[10:11], v1 offset:19456
  v_fma_f32 v24, v24, v5, v6
  s_add_u32 m0, s40, 31232
  s_waitcnt lgkmcnt(8)
  v_mfma_f32_32x32x16_bf16 a[192:207], a[16:19], v[220:223], a[192:207]
  buffer_load_dwordx4 v8, s[16:19], s85 offen offset:512  lds
  ds_read_b64_tr_b16 a[12:13], v1 offset:18944
  ds_read_b64_tr_b16 a[14:15], v1 offset:19968
  v_fma_f32 v25, v25, v5, v6
  v_cvt_pk_bf16_f32 v242, v22, v23
  v_mfma_f32_32x32x16_bf16 v[32:47], a[20:23], v[220:223], v[32:47]
  ds_read_b64_tr_b16 a[16:17], v1 offset:20480
  ds_read_b64_tr_b16 a[18:19], v1 offset:21504
  v_cvt_pk_bf16_f32 v243, v24, v25
  v_lshlrev_b32 v18, 16, v244
  v_and_b32 v19, s41, v244
  v_lshlrev_b32 v20, 16, v245
  v_mfma_f32_32x32x16_bf16 v[48:63], a[24:27], v[220:223], v[48:63]
  ds_read_b64_tr_b16 a[20:21], v1 offset:20992
  ds_read_b64_tr_b16 a[22:23], v1 offset:22016
  v_and_b32 v21, s41, v245
  s_add_u32 m0, s40, 32128
  s_waitcnt lgkmcnt(8)
  v_mfma_f32_32x32x16_bf16 v[96:111], a[28:31], v[220:223], v[96:111]
  buffer_load_dwordx4 v8, s[16:19], s68 offen offset:640  lds
  ds_read_b64_tr_b16 a[24:25], v1 offset:22528
  ds_read_b64_tr_b16 a[26:27], v1 offset:23552
  v_fma_f32 v18, v18, v5, v6
  v_fma_f32 v19, v19, v5, v6
  v_mfma_f32_32x32x16_bf16 v[64:79], a[0:3], v[224:227], v[64:79]
  ds_read_b64_tr_b16 a[28:29], v1 offset:23040
  ds_read_b64_tr_b16 a[30:31], v1 offset:24064
  v_fma_f32 v20, v20, v5, v6
  v_fma_f32 v21, v21, v5, v6
  v_cvt_pk_bf16_f32 v244, v18, v19
  v_mfma_f32_32x32x16_bf16 v[80:95], a[4:7], v[224:227], v[80:95]
  ds_read_b64_tr_b16 a[0:1], v1 offset:24576
  ds_read_b64_tr_b16 a[2:3], v1 offset:25600
  v_cvt_pk_bf16_f32 v245, v20, v21
  s_add_u32 m0, s40, 33152
  s_waitcnt lgkmcnt(8)
  v_mfma_f32_32x32x16_bf16 a[128:143], a[8:11], v[224:227], a[128:143]
  buffer_load_dwordx4 v8, s[16:19], s69 offen offset:640  lds
  ds_read_b64_tr_b16 a[4:5], v1 offset:25088
  ds_read_b64_tr_b16 a[6:7], v1 offset:26112
  v_lshlrev_b32 v22, 16, v246
  v_and_b32 v23, s41, v246
  v_lshlrev_b32 v24, 16, v247
  v_mfma_f32_32x32x16_bf16 a[144:159], a[12:15], v[224:227], a[144:159]
  ds_read_b64_tr_b16 a[8:9], v1 offset:56320
  ds_read_b64_tr_b16 a[10:11], v1 offset:57344
  v_and_b32 v25, s41, v247
  v_fma_f32 v22, v22, v5, v6
  v_fma_f32 v23, v23, v5, v6
  v_mfma_f32_32x32x16_bf16 a[160:175], a[16:19], v[224:227], a[160:175]
  ds_read_b64_tr_b16 a[12:13], v1 offset:56832
  ds_read_b64_tr_b16 a[14:15], v1 offset:57856
  v_fma_f32 v24, v24, v5, v6
  s_add_u32 m0, s40, 34176
  s_waitcnt lgkmcnt(8)
  v_mfma_f32_32x32x16_bf16 a[176:191], a[20:23], v[224:227], a[176:191]
  buffer_load_dwordx4 v8, s[16:19], s70 offen offset:640  lds
  ds_read_b64_tr_b16 a[16:17], v1 offset:58368
  ds_read_b64_tr_b16 a[18:19], v1 offset:59392
  v_fma_f32 v25, v25, v5, v6
  v_cvt_pk_bf16_f32 v246, v22, v23
  v_mfma_f32_32x32x16_bf16 a[192:207], a[24:27], v[224:227], a[192:207]
  ds_read_b64_tr_b16 a[20:21], v1 offset:58880
  ds_read_b64_tr_b16 a[22:23], v1 offset:59904
  v_cvt_pk_bf16_f32 v247, v24, v25
  v_lshlrev_b32 v18, 16, v248
  v_and_b32 v19, s41, v248
  v_lshlrev_b32 v20, 16, v249
  v_mfma_f32_32x32x16_bf16 v[32:47], a[28:31], v[224:227], v[32:47]
  ds_read_b64_tr_b16 a[24:25], v1 offset:60416
  ds_read_b64_tr_b16 a[26:27], v1 offset:61440
  v_and_b32 v21, s41, v249
  s_add_u32 m0, s40, 35200
  s_waitcnt lgkmcnt(8)
  v_mfma_f32_32x32x16_bf16 v[48:63], a[0:3], v[224:227], v[48:63]
  buffer_load_dwordx4 v8, s[16:19], s71 offen offset:640  lds
  ds_read_b64_tr_b16 a[28:29], v1 offset:60928
  ds_read_b64_tr_b16 a[30:31], v1 offset:61952
  v_fma_f32 v18, v18, v5, v6
  v_fma_f32 v19, v19, v5, v6
  v_mfma_f32_32x32x16_bf16 v[96:111], a[4:7], v[224:227], v[96:111]
  ds_read_b64_tr_b16 a[0:1], v1 offset:62464
  ds_read_b64_tr_b16 a[2:3], v1 offset:63488
  v_fma_f32 v20, v20, v5, v6
  v_fma_f32 v21, v21, v5, v6
  v_cvt_pk_bf16_f32 v248, v18, v19
  v_mfma_f32_32x32x16_bf16 v[64:79], a[8:11], v[228:231], v[64:79]
  ds_read_b64_tr_b16 a[4:5], v1 offset:62976
  ds_read_b64_tr_b16 a[6:7], v1 offset:64000
  v_and_b32 v29, 0xc1, v0
  v_lshlrev_b32 v29, 7, v29
  buffer_load_dword v29, v29, s[36:39], 0 offen sc1
  s_add_u32 m0, s40, 36224
  s_waitcnt lgkmcnt(8)
  v_mfma_f32_32x32x16_bf16 v[80:95], a[12:15], v[228:231], v[80:95]
  buffer_load_dwordx4 v8, s[16:19], s72 offen offset:640  lds
  ds_read_b64_tr_b16 a[8:9], v1 offset:64512
  ds_read_b64_tr_b16 a[10:11], v2 offset:0
  v_cvt_pk_bf16_f32 v249, v20, v21
  v_mfma_f32_32x32x16_bf16 a[128:143], a[16:19], v[228:231], a[128:143]
  ds_read_b64_tr_b16 a[12:13], v1 offset:65024
  ds_read_b64_tr_b16 a[14:15], v2 offset:512
  v_lshlrev_b32 v22, 16, v250
  v_and_b32 v23, s41, v250
  v_lshlrev_b32 v24, 16, v251
  v_and_b32 v25, s41, v251
  v_mfma_f32_32x32x16_bf16 a[144:159], a[20:23], v[228:231], a[144:159]
  ds_read_b64_tr_b16 a[16:17], v2 offset:30720
  ds_read_b64_tr_b16 a[18:19], v2 offset:31744
  v_fma_f32 v22, v22, v5, v6
  s_add_u32 m0, s40, 37248
  s_waitcnt lgkmcnt(8)
  v_mfma_f32_32x32x16_bf16 a[160:175], a[24:27], v[228:231], a[160:175]
  buffer_load_dwordx4 v8, s[16:19], s73 offen offset:640  lds
  ds_read_b64_tr_b16 a[20:21], v2 offset:31232
  ds_read_b64_tr_b16 a[22:23], v2 offset:32256
  v_fma_f32 v23, v23, v5, v6
  v_fma_f32 v24, v24, v5, v6
  v_mfma_f32_32x32x16_bf16 a[176:191], a[28:31], v[228:231], a[176:191]
  ds_read_b64_tr_b16 a[24:25], v2 offset:32768
  ds_read_b64_tr_b16 a[26:27], v2 offset:33792
  v_fma_f32 v25, v25, v5, v6
  v_cvt_pk_bf16_f32 v250, v22, v23
  v_cvt_pk_bf16_f32 v251, v24, v25
  v_mfma_f32_32x32x16_bf16 a[192:207], a[0:3], v[228:231], a[192:207]
  ds_read_b64_tr_b16 a[28:29], v2 offset:33280
  ds_read_b64_tr_b16 a[30:31], v2 offset:34304
  v_lshlrev_b32 v18, 16, v252
  v_and_b32 v19, s41, v252
  s_add_u32 m0, s40, 38272
  s_waitcnt lgkmcnt(8)
  v_mfma_f32_32x32x16_bf16 v[32:47], a[4:7], v[228:231], v[32:47]
  buffer_load_dwordx4 v8, s[16:19], s74 offen offset:640  lds
  ds_read_b64_tr_b16 a[0:1], v2 offset:34816
  ds_read_b64_tr_b16 a[2:3], v2 offset:35840
  v_lshlrev_b32 v20, 16, v253
  v_and_b32 v21, s41, v253
  v_mfma_f32_32x32x16_bf16 v[48:63], a[8:11], v[228:231], v[48:63]
  ds_read_b64_tr_b16 a[4:5], v2 offset:35328
  ds_read_b64_tr_b16 a[6:7], v2 offset:36352
  v_fma_f32 v18, v18, v5, v6
  v_fma_f32 v19, v19, v5, v6
  v_fma_f32 v20, v20, v5, v6
  v_mfma_f32_32x32x16_bf16 v[96:111], a[12:15], v[228:231], v[96:111]
  ds_read_b64_tr_b16 a[8:9], v2 offset:36864
  ds_read_b64_tr_b16 a[10:11], v2 offset:37888
  v_fma_f32 v21, v21, v5, v6
  s_add_u32 m0, s40, -640
  s_waitcnt lgkmcnt(8)
  v_mfma_f32_32x32x16_bf16 v[64:79], a[16:19], v[232:235], v[64:79]
  buffer_load_dwordx4 v8, s[16:19], s75 offen offset:640  lds
  ds_read_b64_tr_b16 a[12:13], v2 offset:37376
  ds_read_b64_tr_b16 a[14:15], v2 offset:38400
  v_cvt_pk_bf16_f32 v252, v18, v19
  v_cvt_pk_bf16_f32 v253, v20, v21
  v_mfma_f32_32x32x16_bf16 v[80:95], a[20:23], v[232:235], v[80:95]
  ds_read_b64_tr_b16 a[16:17], v2 offset:38912
  ds_read_b64_tr_b16 a[18:19], v2 offset:39936
  v_lshlrev_b32 v22, 16, v254
  v_and_b32 v23, s41, v254
  v_lshlrev_b32 v24, 16, v255
  v_and_b32 v25, s41, v255
  v_mfma_f32_32x32x16_bf16 a[128:143], a[24:27], v[232:235], a[128:143]
  ds_read_b64_tr_b16 a[20:21], v2 offset:39424
  ds_read_b64_tr_b16 a[22:23], v2 offset:40448
  v_fma_f32 v22, v22, v5, v6
  s_add_u32 m0, s40, 384
  s_waitcnt lgkmcnt(8)
  v_mfma_f32_32x32x16_bf16 a[144:159], a[28:31], v[232:235], a[144:159]
  buffer_load_dwordx4 v8, s[16:19], s76 offen offset:640  lds
  ds_read_b64_tr_b16 a[24:25], v3 offset:5120
  ds_read_b64_tr_b16 a[26:27], v3 offset:6144
  v_fma_f32 v23, v23, v5, v6
  v_fma_f32 v24, v24, v5, v6
  v_mfma_f32_32x32x16_bf16 a[160:175], a[0:3], v[232:235], a[160:175]
  ds_read_b64_tr_b16 a[28:29], v3 offset:5632
  ds_read_b64_tr_b16 a[30:31], v3 offset:6656
  v_fma_f32 v25, v25, v5, v6
  v_cvt_pk_bf16_f32 v254, v22, v23
  v_cvt_pk_bf16_f32 v255, v24, v25
  v_mfma_f32_32x32x16_bf16 a[176:191], a[4:7], v[232:235], a[176:191]
  ds_read_b64_tr_b16 a[0:1], v3 offset:7168
  ds_read_b64_tr_b16 a[2:3], v3 offset:8192
  s_add_u32 m0, s40, 1408
  s_waitcnt lgkmcnt(8)
  v_mfma_f32_32x32x16_bf16 a[192:207], a[8:11], v[232:235], a[192:207]
  buffer_load_dwordx4 v8, s[16:19], s77 offen offset:640  lds
  ds_read_b64_tr_b16 a[4:5], v3 offset:7680
  ds_read_b64_tr_b16 a[6:7], v3 offset:8704
  v_mfma_f32_32x32x16_bf16 v[32:47], a[12:15], v[232:235], v[32:47]
  ds_read_b64_tr_b16 a[8:9], v3 offset:9216
  ds_read_b64_tr_b16 a[10:11], v3 offset:10240
  v_mfma_f32_32x32x16_bf16 v[48:63], a[16:19], v[232:235], v[48:63]
  ds_read_b64_tr_b16 a[12:13], v3 offset:9728
  ds_read_b64_tr_b16 a[14:15], v3 offset:10752
  s_add_u32 m0, s40, 2432
  s_waitcnt lgkmcnt(8)
  v_mfma_f32_32x32x16_bf16 v[96:111], a[20:23], v[232:235], v[96:111]
  buffer_load_dwordx4 v8, s[16:19], s78 offen offset:640  lds
  ds_read_b64_tr_b16 a[16:17], v3 offset:11264
  ds_read_b64_tr_b16 a[18:19], v3 offset:12288
  v_mfma_f32_32x32x16_bf16 v[64:79], a[24:27], v[236:239], v[64:79]
  ds_read_b64_tr_b16 a[20:21], v3 offset:11776
  ds_read_b64_tr_b16 a[22:23], v3 offset:12800
  v_mfma_f32_32x32x16_bf16 v[80:95], a[28:31], v[236:239], v[80:95]
  ds_read_b64_tr_b16 a[24:25], v3 offset:13312
  ds_read_b64_tr_b16 a[26:27], v3 offset:14336
  s_add_u32 m0, s40, 3456
  s_waitcnt lgkmcnt(8)
  v_mfma_f32_32x32x16_bf16 a[128:143], a[0:3], v[236:239], a[128:143]
  buffer_load_dwordx4 v8, s[16:19], s79 offen offset:640  lds
  ds_read_b64_tr_b16 a[28:29], v3 offset:13824
  ds_read_b64_tr_b16 a[30:31], v3 offset:14848
  v_mfma_f32_32x32x16_bf16 a[144:159], a[4:7], v[236:239], a[144:159]
  s_waitcnt vmcnt(13)
  s_barrier
  ds_read_b64_tr_b16 a[0:1], v1 offset:26624
  ds_read_b64_tr_b16 a[2:3], v1 offset:27648
  v_mfma_f32_32x32x16_bf16 a[160:175], a[8:11], v[236:239], a[160:175]
  ds_read_b64_tr_b16 a[4:5], v2 offset:1024
  ds_read_b64_tr_b16 a[6:7], v2 offset:2048
  s_add_u32 m0, s40, 4480
  s_waitcnt lgkmcnt(8)
  v_mfma_f32_32x32x16_bf16 a[176:191], a[12:15], v[236:239], a[176:191]
  buffer_load_dwordx4 v8, s[16:19], s80 offen offset:640  lds
  ds_read_b64_tr_b16 a[8:9], v2 offset:40960
  ds_read_b64_tr_b16 a[10:11], v2 offset:41984
  v_mfma_f32_32x32x16_bf16 a[192:207], a[16:19], v[236:239], a[192:207]
  ds_read_b64_tr_b16 a[12:13], v3 offset:15360
  ds_read_b64_tr_b16 a[14:15], v3 offset:16384
  v_mfma_f32_32x32x16_bf16 v[32:47], a[20:23], v[236:239], v[32:47]
  ds_read_b64_tr_b16 a[16:17], v1 offset:27136
  ds_read_b64_tr_b16 a[18:19], v1 offset:28160
  s_add_u32 m0, s40, 5504
  s_waitcnt lgkmcnt(8)
  v_mfma_f32_32x32x16_bf16 v[48:63], a[24:27], v[236:239], v[48:63]
  buffer_load_dwordx4 v8, s[16:19], s81 offen offset:640  lds
  ds_read_b64_tr_b16 a[20:21], v2 offset:1536
  ds_read_b64_tr_b16 a[22:23], v2 offset:2560
  v_mfma_f32_32x32x16_bf16 v[96:111], a[28:31], v[236:239], v[96:111]
  ds_read_b64_tr_b16 a[24:25], v2 offset:41472
  ds_read_b64_tr_b16 a[26:27], v2 offset:42496
  v_mfma_f32_32x32x16_bf16 v[64:79], a[0:3], v[240:243], v[64:79]
  ds_read_b64_tr_b16 a[28:29], v3 offset:15872
  ds_read_b64_tr_b16 a[30:31], v3 offset:16896
  s_add_u32 m0, s40, 6528
  s_waitcnt lgkmcnt(8)
  v_mfma_f32_32x32x16_bf16 v[64:79], a[4:7], v[244:247], v[64:79]
  buffer_load_dwordx4 v8, s[16:19], s82 offen offset:640  lds
  ds_read_b64_tr_b16 a[0:1], v1 offset:33280
  ds_read_b64_tr_b16 a[2:3], v1 offset:34304
  v_mfma_f32_32x32x16_bf16 v[64:79], a[8:11], v[248:251], v[64:79]
  ds_read_b64_tr_b16 a[4:5], v2 offset:7680
  ds_read_b64_tr_b16 a[6:7], v2 offset:8704
  v_mfma_f32_32x32x16_bf16 v[64:79], a[12:15], v[252:255], v[64:79]
  ds_read_b64_tr_b16 a[8:9], v2 offset:47616
  ds_read_b64_tr_b16 a[10:11], v2 offset:48640
  s_add_u32 m0, s40, 7552
  s_waitcnt lgkmcnt(8)
  v_mfma_f32_32x32x16_bf16 v[80:95], a[16:19], v[240:243], v[80:95]
  buffer_load_dwordx4 v8, s[16:19], s83 offen offset:640  lds
  ds_read_b64_tr_b16 a[12:13], v3 offset:22016
  ds_read_b64_tr_b16 a[14:15], v3 offset:23040
  v_mfma_f32_32x32x16_bf16 v[80:95], a[20:23], v[244:247], v[80:95]
  ds_read_b64_tr_b16 a[16:17], v1 offset:34816
  ds_read_b64_tr_b16 a[18:19], v1 offset:35840
  v_mfma_f32_32x32x16_bf16 v[80:95], a[24:27], v[248:251], v[80:95]
  ds_read_b64_tr_b16 a[20:21], v2 offset:9216
  ds_read_b64_tr_b16 a[22:23], v2 offset:10240
  v_mul_f32 v64, v64, abs(v64)
  v_mul_f32 v65, v65, abs(v65)
  v_mul_f32 v66, v66, abs(v66)
  s_add_u32 m0, s40, 8576
  s_waitcnt lgkmcnt(8)
  v_mfma_f32_32x32x16_bf16 v[80:95], a[28:31], v[252:255], v[80:95]
  buffer_load_dwordx4 v8, s[16:19], s84 offen offset:640  lds
  ds_read_b64_tr_b16 a[24:25], v2 offset:49152
  ds_read_b64_tr_b16 a[26:27], v2 offset:50176
  v_mul_f32 v67, v67, abs(v67)
  v_cvt_pk_bf16_f32 v18, v64, v65
  v_cvt_pk_bf16_f32 v20, v66, v67
  v_mul_f32 v68, v68, abs(v68)
  v_mfma_f32_32x32x16_bf16 v[32:47], a[0:3], v[240:243], v[32:47]
  ds_read_b64_tr_b16 a[28:29], v3 offset:23552
  ds_read_b64_tr_b16 a[30:31], v3 offset:24576
  v_mul_f32 v69, v69, abs(v69)
  v_pk_max_i16 v64, v18, 0
  v_pk_max_i16 v65, v20, 0
  v_mul_f32 v70, v70, abs(v70)
  v_mul_f32 v71, v71, abs(v71)
  v_mfma_f32_32x32x16_bf16 v[32:47], a[4:7], v[244:247], v[32:47]
  ds_read_b64_tr_b16 a[0:1], v1 offset:35328
  ds_read_b64_tr_b16 a[2:3], v1 offset:36352
  v_cvt_pk_bf16_f32 v22, v68, v69
  v_cvt_pk_bf16_f32 v24, v70, v71
  v_mul_f32 v72, v72, abs(v72)
  s_add_u32 m0, s40, 9600
  s_waitcnt lgkmcnt(8)
  v_mfma_f32_32x32x16_bf16 v[32:47], a[8:11], v[248:251], v[32:47]
  buffer_load_dwordx4 v8, s[16:19], s85 offen offset:640  lds
  ds_read_b64_tr_b16 a[4:5], v2 offset:9728
  ds_read_b64_tr_b16 a[6:7], v2 offset:10752
  v_mul_f32 v73, v73, abs(v73)
  v_pk_max_i16 v66, v22, 0
  v_pk_max_i16 v67, v24, 0
  v_mul_f32 v74, v74, abs(v74)
  v_mfma_f32_32x32x16_bf16 v[32:47], a[12:15], v[252:255], v[32:47]
  ds_read_b64_tr_b16 a[8:9], v2 offset:49664
  ds_read_b64_tr_b16 a[10:11], v2 offset:50688
  v_mul_f32 v75, v75, abs(v75)
  v_cvt_pk_bf16_f32 v18, v72, v73
  v_cvt_pk_bf16_f32 v20, v74, v75
  v_mul_f32 v76, v76, abs(v76)
  v_mul_f32 v77, v77, abs(v77)
  v_mfma_f32_32x32x16_bf16 v[48:63], a[16:19], v[240:243], v[48:63]
  ds_read_b64_tr_b16 a[12:13], v3 offset:24064
  ds_read_b64_tr_b16 a[14:15], v3 offset:25088
  v_pk_max_i16 v68, v18, 0
  v_pk_max_i16 v69, v20, 0
  v_mul_f32 v78, v78, abs(v78)
  s_add_u32 m0, s40, 11264
  s_waitcnt lgkmcnt(8)
  v_mfma_f32_32x32x16_bf16 v[48:63], a[20:23], v[244:247], v[48:63]
  buffer_load_dwordx4 v9, s[20:23], s50 offen  lds
  ds_read_b64_tr_b16 a[16:17], v1 offset:28672
  ds_read_b64_tr_b16 a[18:19], v1 offset:29696
  v_mul_f32 v79, v79, abs(v79)
  v_cvt_pk_bf16_f32 v22, v76, v77
  v_cvt_pk_bf16_f32 v24, v78, v79
  v_pk_max_i16 v70, v22, 0
  v_mfma_f32_32x32x16_bf16 v[48:63], a[24:27], v[248:251], v[48:63]
  ds_read_b64_tr_b16 a[20:21], v2 offset:3072
  ds_read_b64_tr_b16 a[22:23], v2 offset:4096
  v_pk_max_i16 v71, v24, 0
  v_mul_f32 v80, v80, abs(v80)
  v_mul_f32 v81, v81, abs(v81)
  v_mul_f32 v82, v82, abs(v82)
  v_mul_f32 v83, v83, abs(v83)
  v_mfma_f32_32x32x16_bf16 v[48:63], a[28:31], v[252:255], v[48:63]
  ds_read_b64_tr_b16 a[24:25], v2 offset:43008
  ds_read_b64_tr_b16 a[26:27], v2 offset:44032
  s_add_u32 s46, s44, 0
  buffer_store_dwordx4 v[64:67], v4, s[28:31], s46 offen offset:0 sc1
  s_add_u32 m0, s40, 12160
  s_waitcnt lgkmcnt(8)
  v_mfma_f32_32x32x16_bf16 v[96:111], a[0:3], v[240:243], v[96:111]
  buffer_load_dwordx4 v9, s[20:23], s50 offen offset:128  lds
  ds_read_b64_tr_b16 a[28:29], v3 offset:17408
  ds_read_b64_tr_b16 a[30:31], v3 offset:18432
  v_cvt_pk_bf16_f32 v18, v80, v81
  v_cvt_pk_bf16_f32 v20, v82, v83
  v_mul_f32 v84, v84, abs(v84)
  v_mfma_f32_32x32x16_bf16 v[96:111], a[4:7], v[244:247], v[96:111]
  ds_read_b64_tr_b16 a[0:1], v1 offset:29184
  ds_read_b64_tr_b16 a[2:3], v1 offset:30208
  s_add_u32 s46, s44, 0
  buffer_store_dwordx4 v[68:71], v4, s[28:31], s46 offen offset:1024 sc1
  v_mul_f32 v85, v85, abs(v85)
  v_mfma_f32_32x32x16_bf16 v[96:111], a[8:11], v[248:251], v[96:111]
  ds_read_b64_tr_b16 a[4:5], v2 offset:3584
  ds_read_b64_tr_b16 a[6:7], v2 offset:4608
  v_pk_max_i16 v72, v18, 0
  v_pk_max_i16 v73, v20, 0
  v_mul_f32 v86, v86, abs(v86)
  s_add_u32 m0, s40, 13056
  s_waitcnt lgkmcnt(8)
  v_mfma_f32_32x32x16_bf16 v[96:111], a[12:15], v[252:255], v[96:111]
  buffer_load_dwordx4 v9, s[20:23], s50 offen offset:256  lds
  ds_read_b64_tr_b16 a[8:9], v2 offset:43520
  ds_read_b64_tr_b16 a[10:11], v2 offset:44544
  v_mul_f32 v87, v87, abs(v87)
  v_cvt_pk_bf16_f32 v22, v84, v85
  v_cvt_pk_bf16_f32 v24, v86, v87
  v_mul_f32 v88, v88, abs(v88)
  v_mfma_f32_32x32x16_bf16 a[128:143], a[16:19], v[240:243], a[128:143]
  ds_read_b64_tr_b16 a[12:13], v3 offset:17920
  ds_read_b64_tr_b16 a[14:15], v3 offset:18944
  s_cmp_eq_u32 s6, 0
  s_cselect_b32 s100, 128, 0
  s_waitcnt vmcnt(19)
  v_cmp_gt_u32 vcc, s100, v29
  s_nop 4
  s_cmp_lg_u64 vcc, 0
  s_cbranch_scc1 FF_SP0
FF_SP0_B:
  s_andn2_b32 s43, s42, 15
  v_and_b32 v15, 3, v0
  v_min_u32 v15, 2, v15
  v_lshlrev_b32 v15, 2, v15
  v_mfma_f32_32x32x16_bf16 a[128:143], a[20:23], v[244:247], a[128:143]
  ds_read_b64_tr_b16 a[16:17], v1 offset:30720
  ds_read_b64_tr_b16 a[18:19], v1 offset:31744
  v_mul_f32 v89, v89, abs(v89)
  s_add_u32 m0, s40, 14336
  s_waitcnt lgkmcnt(8)
  v_mfma_f32_32x32x16_bf16 a[128:143], a[24:27], v[248:251], a[128:143]
  buffer_load_dwordx4 v9, s[20:23], s51 offen  lds
  ds_read_b64_tr_b16 a[20:21], v2 offset:5120
FF_H4:
  s_cbranch_execz FF_H8
  ds_read_b64_tr_b16 a[22:23], v2 offset:6144
  v_pk_max_i16 v74, v22, 0
  v_pk_max_i16 v75, v24, 0
  v_mul_f32 v90, v90, abs(v90)
  v_mul_f32 v91, v91, abs(v91)
  v_mfma_f32_32x32x16_bf16 a[128:143], a[28:31], v[252:255], a[128:143]
  ds_read_b64_tr_b16 a[24:25], v2 offset:45056
  ds_read_b64_tr_b16 a[26:27], v2 offset:46080
  v_cvt_pk_bf16_f32 v18, v88, v89
  v_cvt_pk_bf16_f32 v20, v90, v91
  v_mul_f32 v92, v92, abs(v92)
  v_mul_f32 v93, v93, abs(v93)
  v_pk_max_i16 v76, v18, 0
  v_mfma_f32_32x32x16_bf16 a[144:159], a[0:3], v[240:243], a[144:159]
  ds_read_b64_tr_b16 a[28:29], v3 offset:19456
  ds_read_b64_tr_b16 a[30:31], v3 offset:20480
  v_pk_max_i16 v77, v20, 0
  v_mul_f32 v94, v94, abs(v94)
  v_mul_f32 v95, v95, abs(v95)
  s_add_u32 m0, s40, 15232
  s_waitcnt lgkmcnt(8)
  v_mfma_f32_32x32x16_bf16 a[144:159], a[4:7], v[244:247], a[144:159]
  buffer_load_dwordx4 v9, s[20:23], s51 offen offset:128  lds
  ds_read_b64_tr_b16 a[0:1], v1 offset:31232
  ds_read_b64_tr_b16 a[2:3], v1 offset:32256
  v_cvt_pk_bf16_f32 v22, v92, v93
  v_cvt_pk_bf16_f32 v24, v94, v95
  v_pk_max_i16 v78, v22, 0
  v_pk_max_i16 v79, v24, 0
  v_mfma_f32_32x32x16_bf16 a[144:159], a[8:11], v[248:251], a[144:159]
  ds_read_b64_tr_b16 a[4:5], v2 offset:5632
  ds_read_b64_tr_b16 a[6:7], v2 offset:6656
  ds_read_b128 v[80:83], v10 offset:1280
  ds_read_b128 v[84:87], v10 offset:1312
  ds_read_b128 v[88:91], v10 offset:1344
  ds_read_b128 v[92:95], v10 offset:1376
  s_add_u32 s46, s44, 2048
  buffer_store_dwordx4 v[72:75], v4, s[28:31], s46 offen offset:0 sc1
  v_mfma_f32_32x32x16_bf16 a[144:159], a[12:15], v[252:255], a[144:159]
  ds_read_b64_tr_b16 a[8:9], v2 offset:45568
  ds_read_b64_tr_b16 a[10:11], v2 offset:46592
  v_mul_f32 v32, v32, abs(v32)
  v_mul_f32 v33, v33, abs(v33)
  s_waitcnt lgkmcnt(12)
  v_mfma_f32_32x32x16_bf16 a[160:175], a[16:19], v[240:243], a[160:175]
  ds_read_b64_tr_b16 a[12:13], v3 offset:19968
  ds_read_b64_tr_b16 a[14:15], v3 offset:20992
  s_add_u32 s46, s44, 2048
  buffer_store_dwordx4 v[76:79], v4, s[28:31], s46 offen offset:1024 sc1
  v_mul_f32 v34, v34, abs(v34)
  v_mfma_f32_32x32x16_bf16 a[160:175], a[20:23], v[244:247], a[160:175]
  ds_read_b64_tr_b16 a[16:17], v1 offset:32768
  ds_read_b64_tr_b16 a[18:19], v1 offset:33792
  v_mul_f32 v35, v35, abs(v35)
  v_cvt_pk_bf16_f32 v18, v32, v33
  v_cvt_pk_bf16_f32 v20, v34, v35
  v_mul_f32 v36, v36, abs(v36)
  v_mul_f32 v37, v37, abs(v37)
  v_mfma_f32_32x32x16_bf16 a[160:175], a[24:27], v[248:251], a[160:175]
  ds_read_b64_tr_b16 a[20:21], v2 offset:7168
  ds_read_b64_tr_b16 a[22:23], v2 offset:8192
  v_pk_max_i16 v32, v18, 0
  v_pk_max_i16 v33, v20, 0
  v_mul_f32 v38, v38, abs(v38)
  v_mul_f32 v39, v39, abs(v39)
  s_waitcnt lgkmcnt(12)
  v_mfma_f32_32x32x16_bf16 a[160:175], a[28:31], v[252:255], a[160:175]
  ds_read_b64_tr_b16 a[24:25], v2 offset:47104
  ds_read_b64_tr_b16 a[26:27], v2 offset:48128
  v_cvt_pk_bf16_f32 v22, v36, v37
  v_cvt_pk_bf16_f32 v24, v38, v39
  v_mul_f32 v40, v40, abs(v40)
  v_mul_f32 v41, v41, abs(v41)
  v_pk_max_i16 v34, v22, 0
  v_mfma_f32_32x32x16_bf16 a[176:191], a[0:3], v[240:243], a[176:191]
  ds_read_b64_tr_b16 a[28:29], v3 offset:21504
  ds_read_b64_tr_b16 a[30:31], v3 offset:22528
  v_pk_max_i16 v35, v24, 0
  v_mul_f32 v42, v42, abs(v42)
  v_mul_f32 v43, v43, abs(v43)
  v_cvt_pk_bf16_f32 v18, v40, v41
  v_cvt_pk_bf16_f32 v20, v42, v43
  v_mfma_f32_32x32x16_bf16 a[176:191], a[4:7], v[244:247], a[176:191]
  s_waitcnt vmcnt(21)
  s_barrier
  ds_read_b64_tr_b16 a[0:1], v1 offset:36864
  ds_read_b64_tr_b16 a[2:3], v1 offset:37888
  v_mul_f32 v44, v44, abs(v44)
  v_mul_f32 v45, v45, abs(v45)
  v_pk_max_i16 v36, v18, 0
  v_pk_max_i16 v37, v20, 0
  v_mul_f32 v46, v46, abs(v46)
  v_mul_f32 v47, v47, abs(v47)
  v_cvt_pk_bf16_f32 v22, v44, v45
  v_cvt_pk_bf16_f32 v24, v46, v47
  v_pk_max_i16 v38, v22, 0
  v_pk_max_i16 v39, v24, 0
  v_mul_f32 v48, v48, abs(v48)
  v_mul_f32 v49, v49, abs(v49)
  v_mul_f32 v50, v50, abs(v50)
  v_mul_f32 v51, v51, abs(v51)
  v_cvt_pk_bf16_f32 v18, v48, v49
  v_cvt_pk_bf16_f32 v20, v50, v51
  v_mul_f32 v52, v52, abs(v52)
  v_mul_f32 v53, v53, abs(v53)
  v_pk_max_i16 v40, v18, 0
  v_pk_max_i16 v41, v20, 0
  v_mul_f32 v54, v54, abs(v54)
  v_mul_f32 v55, v55, abs(v55)
  v_cvt_pk_bf16_f32 v22, v52, v53
  v_cvt_pk_bf16_f32 v24, v54, v55
  v_mul_f32 v56, v56, abs(v56)
  v_mul_f32 v57, v57, abs(v57)
  v_pk_max_i16 v42, v22, 0
  v_pk_max_i16 v43, v24, 0
  v_mul_f32 v58, v58, abs(v58)
  v_mul_f32 v59, v59, abs(v59)
  v_cvt_pk_bf16_f32 v18, v56, v57
  v_cvt_pk_bf16_f32 v20, v58, v59
  v_mul_f32 v60, v60, abs(v60)
  v_mul_f32 v61, v61, abs(v61)
  v_pk_max_i16 v44, v18, 0
  v_pk_max_i16 v45, v20, 0
  v_mul_f32 v62, v62, abs(v62)
  v_mul_f32 v63, v63, abs(v63)
  v_cvt_pk_bf16_f32 v22, v60, v61
  v_cvt_pk_bf16_f32 v24, v62, v63
  v_pk_max_i16 v46, v22, 0
  v_pk_max_i16 v47, v24, 0
  s_add_u32 m0, s40, 16128
  s_waitcnt lgkmcnt(8)
  v_mfma_f32_32x32x16_bf16 a[176:191], a[8:11], v[248:251], a[176:191]
  buffer_load_dwordx4 v9, s[20:23], s51 offen offset:256  lds
  ds_read_b64_tr_b16 a[4:5], v1 offset:37376
  ds_read_b64_tr_b16 a[6:7], v1 offset:38400
  ds_read_b128 v[48:51], v10 offset:1408
  ds_read_b128 v[52:55], v10 offset:1440
  ds_read_b128 v[56:59], v10 offset:1472
  ds_read_b128 v[60:63], v10 offset:1504
  v_mfma_f32_32x32x16_bf16 a[176:191], a[12:15], v[252:255], a[176:191]
  ds_read_b64_tr_b16 a[8:9], v2 offset:11264
  ds_read_b64_tr_b16 a[10:11], v2 offset:12288
  s_add_u32 s46, s44, 14336
  buffer_store_dwordx4 v[32:35], v4, s[28:31], s46 offen offset:0 sc1
  v_mul_f32 v96, v96, abs(v96)
  v_mfma_f32_32x32x16_bf16 a[192:207], a[16:19], v[240:243], a[192:207]
  ds_read_b64_tr_b16 a[12:13], v2 offset:11776
  ds_read_b64_tr_b16 a[14:15], v2 offset:12800
  v_mul_f32 v97, v97, abs(v97)
  v_mul_f32 v98, v98, abs(v98)
  v_mul_f32 v99, v99, abs(v99)
  s_add_u32 m0, s40, 17408
  s_waitcnt lgkmcnt(12)
  v_mfma_f32_32x32x16_bf16 a[192:207], a[20:23], v[244:247], a[192:207]
  buffer_load_dwordx4 v9, s[20:23], s57 offen  lds
  ds_read_b64_tr_b16 a[16:17], v2 offset:51200
  ds_read_b64_tr_b16 a[18:19], v2 offset:52224
  s_add_u32 s46, s44, 14336
  buffer_store_dwordx4 v[36:39], v4, s[28:31], s46 offen offset:1024 sc1
  v_mfma_f32_32x32x16_bf16 a[192:207], a[24:27], v[248:251], a[192:207]
  ds_read_b64_tr_b16 a[20:21], v2 offset:51712
  ds_read_b64_tr_b16 a[22:23], v2 offset:52736
  v_cvt_pk_bf16_f32 v18, v96, v97
  v_cvt_pk_bf16_f32 v20, v98, v99
  v_mul_f32 v100, v100, abs(v100)
  v_mul_f32 v101, v101, abs(v101)
  v_pk_max_i16 v96, v18, 0
  v_mfma_f32_32x32x16_bf16 a[192:207], a[28:31], v[252:255], a[192:207]
  ds_read_b64_tr_b16 a[24:25], v3 offset:25600
  ds_read_b64_tr_b16 a[26:27], v3 offset:26624
  s_add_u32 s46, s44, 16384
  buffer_store_dwordx4 v[40:43], v4, s[28:31], s46 offen offset:0 sc1
  s_add_u32 m0, s40, 18304
  s_waitcnt lgkmcnt(8)
  v_mfma_f32_32x32x16_bf16 v[80:95], a[0:3], v[112:115], v[80:95]
  buffer_load_dwordx4 v9, s[20:23], s57 offen offset:128  lds
  ds_read_b64_tr_b16 a[28:29], v3 offset:26112
  ds_read_b64_tr_b16 a[30:31], v3 offset:27136
  v_pk_max_i16 v97, v20, 0
  v_mfma_f32_32x32x16_bf16 v[48:63], a[4:7], v[112:115], v[48:63]
  ds_read_b64_tr_b16 a[0:1], v1 offset:38912
  ds_read_b64_tr_b16 a[2:3], v1 offset:39936
  s_add_u32 s46, s44, 16384
  buffer_store_dwordx4 v[44:47], v4, s[28:31], s46 offen offset:1024 sc1
  v_mfma_f32_32x32x16_bf16 v[80:95], a[8:11], v[116:119], v[80:95]
  ds_read_b64_tr_b16 a[4:5], v1 offset:39424
  ds_read_b64_tr_b16 a[6:7], v1 offset:40448
  s_add_u32 m0, s40, 19200
  s_waitcnt lgkmcnt(8)
  v_mfma_f32_32x32x16_bf16 v[48:63], a[12:15], v[116:119], v[48:63]
  buffer_load_dwordx4 v9, s[20:23], s57 offen offset:256  lds
  ds_read_b64_tr_b16 a[8:9], v2 offset:13312
  ds_read_b64_tr_b16 a[10:11], v2 offset:14336
  v_mul_f32 v102, v102, abs(v102)
  v_mul_f32 v103, v103, abs(v103)
  v_mfma_f32_32x32x16_bf16 v[80:95], a[16:19], v[120:123], v[80:95]
  ds_read_b64_tr_b16 a[12:13], v2 offset:13824
  ds_read_b64_tr_b16 a[14:15], v2 offset:14848
  v_cvt_pk_bf16_f32 v22, v100, v101
  v_cvt_pk_bf16_f32 v24, v102, v103
  v_mul_f32 v104, v104, abs(v104)
  v_mfma_f32_32x32x16_bf16 v[48:63], a[20:23], v[120:123], v[48:63]
  ds_read_b64_tr_b16 a[16:17], v2 offset:53248
  ds_read_b64_tr_b16 a[18:19], v2 offset:54272
  v_mul_f32 v105, v105, abs(v105)
  s_add_u32 m0, s40, 20480
  s_waitcnt lgkmcnt(8)
  v_mfma_f32_32x32x16_bf16 v[80:95], a[24:27], v[124:127], v[80:95]
  buffer_load_dwordx4 v9, s[20:23], s58 offen  lds
  ds_read_b64_tr_b16 a[20:21], v2 offset:53760
  ds_read_b64_tr_b16 a[22:23], v2 offset:54784
  v_pk_max_i16 v98, v22, 0
  v_pk_max_i16 v99, v24, 0
  v_mfma_f32_32x32x16_bf16 v[48:63], a[28:31], v[124:127], v[48:63]
  ds_read_b64_tr_b16 a[24:25], v3 offset:27648
  ds_read_b64_tr_b16 a[26:27], v3 offset:28672
  v_mul_f32 v106, v106, abs(v106)
  v_mul_f32 v107, v107, abs(v107)
  v_cvt_pk_bf16_f32 v18, v104, v105
  v_mfma_f32_32x32x16_bf16 v[80:95], a[0:3], v[128:131], v[80:95]
  ds_read_b64_tr_b16 a[28:29], v3 offset:28160
  ds_read_b64_tr_b16 a[30:31], v3 offset:29184
  v_cvt_pk_bf16_f32 v20, v106, v107
  s_add_u32 m0, s40, 21376
  s_waitcnt lgkmcnt(8)
  v_mfma_f32_32x32x16_bf16 v[48:63], a[4:7], v[128:131], v[48:63]
  buffer_load_dwordx4 v9, s[20:23], s58 offen offset:128  lds
  ds_read_b64_tr_b16 a[0:1], v1 offset:40960
  ds_read_b64_tr_b16 a[2:3], v1 offset:41984
  v_mul_f32 v108, v108, abs(v108)
  v_mul_f32 v109, v109, abs(v109)
  v_mfma_f32_32x32x16_bf16 v[80:95], a[8:11], v[132:135], v[80:95]
  ds_read_b64_tr_b16 a[4:5], v1 offset:41472
  ds_read_b64_tr_b16 a[6:7], v1 offset:42496
  v_pk_max_i16 v100, v18, 0
  v_pk_max_i16 v101, v20, 0
  v_mul_f32 v110, v110, abs(v110)
  v_mfma_f32_32x32x16_bf16 v[48:63], a[12:15], v[132:135], v[48:63]
  ds_read_b64_tr_b16 a[8:9], v2 offset:15360
  ds_read_b64_tr_b16 a[10:11], v2 offset:16384
  v_mul_f32 v111, v111, abs(v111)
  s_add_u32 m0, s40, 22272
  s_waitcnt lgkmcnt(8)
  v_mfma_f32_32x32x16_bf16 v[80:95], a[16:19], v[136:139], v[80:95]
  buffer_load_dwordx4 v9, s[20:23], s58 offen offset:256  lds
  ds_read_b64_tr_b16 a[12:13], v2 offset:15872
  ds_read_b64_tr_b16 a[14:15], v2 offset:16896
  v_cvt_pk_bf16_f32 v22, v108, v109
  v_cvt_pk_bf16_f32 v24, v110, v111
  v_mfma_f32_32x32x16_bf16 v[48:63], a[20:23], v[136:139], v[48:63]
  ds_read_b64_tr_b16 a[16:17], v2 offset:55296
  ds_read_b64_tr_b16 a[18:19], v2 offset:56320
  v_pk_max_i16 v102, v22, 0
  v_pk_max_i16 v103, v24, 0
  v_accvgpr_read_b32 v18, a128
  v_mfma_f32_32x32x16_bf16 v[80:95], a[24:27], v[140:143], v[80:95]
  ds_read_b64_tr_b16 a[20:21], v2 offset:55808
  ds_read_b64_tr_b16 a[22:23], v2 offset:56832
  s_add_u32 s46, s44, 18432
  buffer_store_dwordx4 v[96:99], v4, s[28:31], s46 offen offset:0 sc1
  s_add_u32 m0, s40, 23552
  s_waitcnt lgkmcnt(8)
  v_mfma_f32_32x32x16_bf16 v[48:63], a[28:31], v[140:143], v[48:63]
  buffer_load_dwordx4 v9, s[20:23], s59 offen  lds
  ds_read_b64_tr_b16 a[24:25], v3 offset:29696
  ds_read_b64_tr_b16 a[26:27], v3 offset:30720
  v_mfma_f32_32x32x16_bf16 v[80:95], a[0:3], v[144:147], v[80:95]
  ds_read_b64_tr_b16 a[28:29], v3 offset:30208
  ds_read_b64_tr_b16 a[30:31], v3 offset:31232
  s_add_u32 s46, s44, 18432
  buffer_store_dwordx4 v[100:103], v4, s[28:31], s46 offen offset:1024 sc1
  v_mfma_f32_32x32x16_bf16 v[48:63], a[4:7], v[144:147], v[48:63]
  s_waitcnt vmcnt(29)
  s_barrier
  ds_read_b64_tr_b16 a[0:1], v1 offset:43008
  ds_read_b64_tr_b16 a[2:3], v1 offset:4096
  s_add_u32 m0, s40, 24448
  s_waitcnt lgkmcnt(8)
  v_mfma_f32_32x32x16_bf16 v[80:95], a[8:11], v[148:151], v[80:95]
  buffer_load_dwordx4 v9, s[20:23], s59 offen offset:128  lds
  ds_read_b64_tr_b16 a[4:5], v1 offset:43520
  ds_read_b64_tr_b16 a[6:7], v1 offset:4608
  v_accvgpr_read_b32 v19, a129
  v_mfma_f32_32x32x16_bf16 v[48:63], a[12:15], v[148:151], v[48:63]
  ds_read_b64_tr_b16 a[8:9], v2 offset:17408
  ds_read_b64_tr_b16 a[10:11], v1 offset:44032
  v_accvgpr_read_b32 v20, a130
  v_accvgpr_read_b32 v21, a131
  v_mul_f32 v18, v18, abs(v18)
  v_mfma_f32_32x32x16_bf16 v[80:95], a[16:19], v[152:155], v[80:95]
  ds_read_b64_tr_b16 a[12:13], v2 offset:17920
  ds_read_b64_tr_b16 a[14:15], v1 offset:44544
  v_mul_f32 v19, v19, abs(v19)
  s_add_u32 m0, s40, 25344
  s_waitcnt lgkmcnt(8)
  v_mfma_f32_32x32x16_bf16 v[48:63], a[20:23], v[152:155], v[48:63]
  buffer_load_dwordx4 v9, s[20:23], s59 offen offset:256  lds
  ds_read_b64_tr_b16 a[16:17], v2 offset:57344
  ds_read_b64_tr_b16 a[18:19], v2 offset:18432
  v_mul_f32 v20, v20, abs(v20)
  v_mul_f32 v21, v21, abs(v21)
  v_mfma_f32_32x32x16_bf16 v[80:95], a[24:27], v[156:159], v[80:95]
  ds_read_b64_tr_b16 a[20:21], v2 offset:57856
  ds_read_b64_tr_b16 a[22:23], v2 offset:18944
  v_accvgpr_read_b32 v22, a132
  v_accvgpr_read_b32 v23, a133
  v_cvt_pk_bf16_f32 v18, v18, v19
  v_mfma_f32_32x32x16_bf16 v[48:63], a[28:31], v[156:159], v[48:63]
  ds_read_b64_tr_b16 a[24:25], v3 offset:31744
  ds_read_b64_tr_b16 a[26:27], v2 offset:58368
  v_cvt_pk_bf16_f32 v20, v20, v21
  s_add_u32 m0, s40, 26624
  s_waitcnt lgkmcnt(8)
  v_mfma_f32_32x32x16_bf16 v[80:95], a[0:3], v[160:163], v[80:95]
  buffer_load_dwordx4 v9, s[20:23], s52 offen  lds
  ds_read_b64_tr_b16 a[28:29], v3 offset:32256
  ds_read_b64_tr_b16 a[30:31], v2 offset:58880
  v_accvgpr_read_b32 v24, a134
  v_accvgpr_read_b32 v25, a135
  v_mfma_f32_32x32x16_bf16 v[48:63], a[4:7], v[160:163], v[48:63]
  ds_read_b64_tr_b16 a[0:1], v1 offset:5120
  ds_read_b64_tr_b16 a[2:3], v1 offset:6144
  v_mul_f32 v22, v22, abs(v22)
  v_mul_f32 v23, v23, abs(v23)
  v_pk_max_i16 v104, v18, 0
  v_mfma_f32_32x32x16_bf16 v[80:95], a[8:11], v[164:167], v[80:95]
  ds_read_b64_tr_b16 a[4:5], v1 offset:5632
  ds_read_b64_tr_b16 a[6:7], v1 offset:6656
  v_pk_max_i16 v105, v20, 0
  s_add_u32 m0, s40, 27520
  s_waitcnt lgkmcnt(8)
  v_mfma_f32_32x32x16_bf16 v[48:63], a[12:15], v[164:167], v[48:63]
  buffer_load_dwordx4 v9, s[20:23], s52 offen offset:128  lds
  ds_read_b64_tr_b16 a[8:9], v1 offset:45056
  ds_read_b64_tr_b16 a[10:11], v1 offset:46080
  v_mul_f32 v24, v24, abs(v24)
  v_mul_f32 v25, v25, abs(v25)
  v_mfma_f32_32x32x16_bf16 v[80:95], a[16:19], v[168:171], v[80:95]
  ds_read_b64_tr_b16 a[12:13], v1 offset:45568
  ds_read_b64_tr_b16 a[14:15], v1 offset:46592
  v_accvgpr_read_b32 v18, a136
  v_accvgpr_read_b32 v19, a137
  v_cvt_pk_bf16_f32 v22, v22, v23
  v_mfma_f32_32x32x16_bf16 v[48:63], a[20:23], v[168:171], v[48:63]
  ds_read_b64_tr_b16 a[16:17], v2 offset:19456
  ds_read_b64_tr_b16 a[18:19], v2 offset:20480
  v_cvt_pk_bf16_f32 v24, v24, v25
  s_add_u32 m0, s40, 28416
  s_waitcnt lgkmcnt(8)
  v_mfma_f32_32x32x16_bf16 v[80:95], a[24:27], v[172:175], v[80:95]
  buffer_load_dwordx4 v9, s[20:23], s52 offen offset:256  lds
  ds_read_b64_tr_b16 a[20:21], v2 offset:19968
  ds_read_b64_tr_b16 a[22:23], v2 offset:20992
  v_accvgpr_read_b32 v20, a138
  v_accvgpr_read_b32 v21, a139
  v_mfma_f32_32x32x16_bf16 v[48:63], a[28:31], v[172:175], v[48:63]
  ds_read_b64_tr_b16 a[24:25], v2 offset:59392
  ds_read_b64_tr_b16 a[26:27], v2 offset:60416
  v_mul_f32 v18, v18, abs(v18)
  v_mul_f32 v19, v19, abs(v19)
  v_pk_max_i16 v106, v22, 0
  v_mfma_f32_32x32x16_bf16 v[80:95], a[0:3], v[176:179], v[80:95]
  ds_read_b64_tr_b16 a[28:29], v2 offset:59904
  ds_read_b64_tr_b16 a[30:31], v2 offset:60928
  v_pk_max_i16 v107, v24, 0
  s_add_u32 m0, s40, 29696
  s_waitcnt lgkmcnt(8)
  v_mfma_f32_32x32x16_bf16 v[48:63], a[4:7], v[176:179], v[48:63]
  buffer_load_dwordx4 v9, s[20:23], s53 offen  lds
  ds_read_b64_tr_b16 a[0:1], v1 offset:7168
  ds_read_b64_tr_b16 a[2:3], v1 offset:8192
  v_mul_f32 v20, v20, abs(v20)
  v_mul_f32 v21, v21, abs(v21)
  v_mfma_f32_32x32x16_bf16 v[80:95], a[8:11], v[180:183], v[80:95]
  ds_read_b64_tr_b16 a[4:5], v1 offset:7680
  ds_read_b64_tr_b16 a[6:7], v1 offset:8704
  v_accvgpr_read_b32 v22, a140
  v_accvgpr_read_b32 v23, a141
  v_cvt_pk_bf16_f32 v18, v18, v19
  v_mfma_f32_32x32x16_bf16 v[48:63], a[12:15], v[180:183], v[48:63]
  ds_read_b64_tr_b16 a[8:9], v1 offset:47104
  ds_read_b64_tr_b16 a[10:11], v1 offset:48128
  v_cvt_pk_bf16_f32 v20, v20, v21
  s_add_u32 m0, s40, 30592
  s_waitcnt lgkmcnt(8)
  v_mfma_f32_32x32x16_bf16 v[80:95], a[16:19], v[184:187], v[80:95]
  buffer_load_dwordx4 v9, s[20:23], s53 offen offset:128  lds
  ds_read_b64_tr_b16 a[12:13], v1 offset:47616
  ds_read_b64_tr_b16 a[14:15], v1 offset:48640
  v_accvgpr_read_b32 v24, a142
  v_accvgpr_read_b32 v25, a143
  v_mfma_f32_32x32x16_bf16 v[48:63], a[20:23], v[184:187], v[48:63]
  ds_read_b64_tr_b16 a[16:17], v2 offset:21504
  ds_read_b64_tr_b16 a[18:19], v2 offset:22528
  v_mul_f32 v22, v22, abs(v22)
  v_mul_f32 v23, v23, abs(v23)
  v_pk_max_i16 v108, v18, 0
  v_mfma_f32_32x32x16_bf16 v[80:95], a[24:27], v[188:191], v[80:95]
  ds_read_b64_tr_b16 a[20:21], v2 offset:22016
  ds_read_b64_tr_b16 a[22:23], v2 offset:23040
  v_pk_max_i16 v109, v20, 0
  s_add_u32 m0, s40, 31488
  s_waitcnt lgkmcnt(8)
  v_mfma_f32_32x32x16_bf16 v[48:63], a[28:31], v[188:191], v[48:63]
  buffer_load_dwordx4 v9, s[20:23], s53 offen offset:256  lds
  ds_read_b64_tr_b16 a[24:25], v2 offset:61440
  ds_read_b64_tr_b16 a[26:27], v2 offset:62464
  v_mul_f32 v24, v24, abs(v24)
  v_mul_f32 v25, v25, abs(v25)
  v_mfma_f32_32x32x16_bf16 v[80:95], a[0:3], v[192:195], v[80:95]
  ds_read_b64_tr_b16 a[28:29], v2 offset:61952
  ds_read_b64_tr_b16 a[30:31], v2 offset:62976
  v_cvt_pk_bf16_f32 v22, v22, v23
  v_cvt_pk_bf16_f32 v24, v24, v25
  v_pk_max_i16 v110, v22, 0
  v_mfma_f32_32x32x16_bf16 v[48:63], a[4:7], v[192:195], v[48:63]
  s_waitcnt vmcnt(31)
  s_barrier
  ds_read_b64_tr_b16 a[0:1], v1 offset:9216
  ds_read_b64_tr_b16 a[2:3], v1 offset:10240
  s_add_u32 m0, s40, 32768
  s_waitcnt lgkmcnt(8)
  v_mfma_f32_32x32x16_bf16 v[80:95], a[8:11], v[196:199], v[80:95]
  buffer_load_dwordx4 v9, s[20:23], s54 offen  lds
  ds_read_b64_tr_b16 a[4:5], v1 offset:9728
  ds_read_b64_tr_b16 a[6:7], v1 offset:10752
  v_pk_max_i16 v111, v24, 0
  v_accvgpr_read_b32 v18, a144
  v_mfma_f32_32x32x16_bf16 v[48:63], a[12:15], v[196:199], v[48:63]
  ds_read_b64_tr_b16 a[8:9], v1 offset:49152
  ds_read_b64_tr_b16 a[10:11], v1 offset:50176
  s_add_u32 s46, s44, 4096
  buffer_store_dwordx4 v[104:107], v4, s[28:31], s46 offen offset:0 sc1
  v_mfma_f32_32x32x16_bf16 v[80:95], a[16:19], v[200:203], v[80:95]
  ds_read_b64_tr_b16 a[12:13], v1 offset:49664
  ds_read_b64_tr_b16 a[14:15], v1 offset:50688
  s_add_u32 m0, s40, 33664
  s_waitcnt lgkmcnt(8)
  v_mfma_f32_32x32x16_bf16 v[48:63], a[20:23], v[200:203], v[48:63]
  buffer_load_dwordx4 v9, s[20:23], s54 offen offset:128  lds
  ds_read_b64_tr_b16 a[16:17], v2 offset:23552
  ds_read_b64_tr_b16 a[18:19], v2 offset:24576
  s_add_u32 s46, s44, 4096
  buffer_store_dwordx4 v[108:111], v4, s[28:31], s46 offen offset:1024 sc1
  v_mfma_f32_32x32x16_bf16 v[80:95], a[24:27], v[204:207], v[80:95]
  ds_read_b64_tr_b16 a[20:21], v2 offset:24064
  ds_read_b64_tr_b16 a[22:23], v2 offset:25088
  v_accvgpr_read_b32 v19, a145
  v_mfma_f32_32x32x16_bf16 v[48:63], a[28:31], v[204:207], v[48:63]
  ds_read_b64_tr_b16 a[24:25], v2 offset:63488
  ds_read_b64_tr_b16 a[26:27], v2 offset:64512
  v_accvgpr_read_b32 v20, a146
  s_add_u32 m0, s40, 34560
  s_waitcnt lgkmcnt(8)
  v_mfma_f32_32x32x16_bf16 v[80:95], a[0:3], v[208:211], v[80:95]
  buffer_load_dwordx4 v9, s[20:23], s54 offen offset:256  lds
  ds_read_b64_tr_b16 a[28:29], v2 offset:64000
  ds_read_b64_tr_b16 a[30:31], v2 offset:65024
  v_accvgpr_read_b32 v21, a147
  v_mul_f32 v18, v18, abs(v18)
  v_mfma_f32_32x32x16_bf16 v[48:63], a[4:7], v[208:211], v[48:63]
  ds_read_b64_tr_b16 a[0:1], v1 offset:11264
  ds_read_b64_tr_b16 a[2:3], v1 offset:12288
  v_mul_f32 v19, v19, abs(v19)
  v_mul_f32 v20, v20, abs(v20)
  v_mul_f32 v21, v21, abs(v21)
  v_mfma_f32_32x32x16_bf16 v[80:95], a[8:11], v[212:215], v[80:95]
  ds_read_b64_tr_b16 a[4:5], v1 offset:11776
  ds_read_b64_tr_b16 a[6:7], v1 offset:12800
  v_accvgpr_read_b32 v22, a148
  s_add_u32 m0, s40, 35840
  s_waitcnt lgkmcnt(8)
  v_mfma_f32_32x32x16_bf16 v[48:63], a[12:15], v[212:215], v[48:63]
  buffer_load_dwordx4 v9, s[20:23], s55 offen  lds
  ds_read_b64_tr_b16 a[8:9], v1 offset:51200
  ds_read_b64_tr_b16 a[10:11], v1 offset:52224
  v_accvgpr_read_b32 v23, a149
  v_cvt_pk_bf16_f32 v18, v18, v19
  v_mfma_f32_32x32x16_bf16 v[80:95], a[16:19], v[216:219], v[80:95]
  ds_read_b64_tr_b16 a[12:13], v1 offset:51712
  ds_read_b64_tr_b16 a[14:15], v1 offset:52736
  v_cvt_pk_bf16_f32 v20, v20, v21
  v_accvgpr_read_b32 v24, a150
  v_accvgpr_read_b32 v25, a151
  v_mfma_f32_32x32x16_bf16 v[48:63], a[20:23], v[216:219], v[48:63]
  ds_read_b64_tr_b16 a[16:17], v2 offset:25600
  ds_read_b64_tr_b16 a[18:19], v2 offset:26624
  v_mul_f32 v22, v22, abs(v22)
  s_add_u32 m0, s40, 36736
  s_waitcnt lgkmcnt(8)
  v_mfma_f32_32x32x16_bf16 v[80:95], a[24:27], v[220:223], v[80:95]
  buffer_load_dwordx4 v9, s[20:23], s55 offen offset:128  lds
  ds_read_b64_tr_b16 a[20:21], v2 offset:26112
  ds_read_b64_tr_b16 a[22:23], v2 offset:27136
  v_mul_f32 v23, v23, abs(v23)
  v_pk_max_i16 v18, v18, 0
  v_mfma_f32_32x32x16_bf16 v[48:63], a[28:31], v[220:223], v[48:63]
  ds_read_b64_tr_b16 a[24:25], v3 offset:0
  ds_read_b64_tr_b16 a[26:27], v3 offset:1024
  v_pk_max_i16 v20, v20, 0
  v_mul_f32 v24, v24, abs(v24)
  v_mul_f32 v25, v25, abs(v25)
  v_mfma_f32_32x32x16_bf16 v[80:95], a[0:3], v[224:227], v[80:95]
  ds_read_b64_tr_b16 a[28:29], v3 offset:512
  ds_read_b64_tr_b16 a[30:31], v3 offset:1536
  v_accvgpr_write_b32 a144, v18
  s_add_u32 m0, s40, 37632
  s_waitcnt lgkmcnt(8)
  v_mfma_f32_32x32x16_bf16 v[48:63], a[4:7], v[224:227], v[48:63]
  buffer_load_dwordx4 v9, s[20:23], s55 offen offset:256  lds
  ds_read_b64_tr_b16 a[0:1], v1 offset:13312
  ds_read_b64_tr_b16 a[2:3], v1 offset:14336
  s_waitcnt vmcnt(23)
  v_mov_b32 v14, 1
  buffer_store_dword v14, off, s[28:31], s42 sc1
  v_mfma_f32_32x32x16_bf16 v[80:95], a[8:11], v[228:231], v[80:95]
  ds_read_b64_tr_b16 a[4:5], v1 offset:13824
  ds_read_b64_tr_b16 a[6:7], v1 offset:14848
  v_accvgpr_write_b32 a145, v20
  v_mfma_f32_32x32x16_bf16 v[48:63], a[12:15], v[228:231], v[48:63]
  ds_read_b64_tr_b16 a[8:9], v1 offset:53248
  ds_read_b64_tr_b16 a[10:11], v1 offset:54272
  v_accvgpr_read_b32 v18, a152
  s_add_u32 m0, s40, 38912
  s_waitcnt lgkmcnt(8)
  v_mfma_f32_32x32x16_bf16 v[80:95], a[16:19], v[232:235], v[80:95]
  buffer_load_dwordx4 v9, s[20:23], s56 offen  lds
  ds_read_b64_tr_b16 a[12:13], v1 offset:53760
  ds_read_b64_tr_b16 a[14:15], v1 offset:54784
FF_H5:
  s_cbranch_execz FF_H9
  v_accvgpr_read_b32 v19, a153
  v_cvt_pk_bf16_f32 v22, v22, v23
  v_mfma_f32_32x32x16_bf16 v[48:63], a[20:23], v[232:235], v[48:63]
  ds_read_b64_tr_b16 a[16:17], v2 offset:27648
  ds_read_b64_tr_b16 a[18:19], v2 offset:28672
  v_cvt_pk_bf16_f32 v24, v24, v25
  v_accvgpr_read_b32 v20, a154
  v_accvgpr_read_b32 v21, a155
  v_mfma_f32_32x32x16_bf16 v[80:95], a[24:27], v[236:239], v[80:95]
  ds_read_b64_tr_b16 a[20:21], v2 offset:28160
  ds_read_b64_tr_b16 a[22:23], v2 offset:29184
  v_mul_f32 v18, v18, abs(v18)
  s_add_u32 m0, s40, -128
  s_waitcnt lgkmcnt(8)
  v_mfma_f32_32x32x16_bf16 v[48:63], a[28:31], v[236:239], v[48:63]
  buffer_load_dwordx4 v9, s[20:23], s56 offen offset:128  lds
  ds_read_b64_tr_b16 a[24:25], v3 offset:2048
  ds_read_b64_tr_b16 a[26:27], v3 offset:3072
  v_mul_f32 v19, v19, abs(v19)
  v_pk_max_i16 v22, v22, 0
  v_mfma_f32_32x32x16_bf16 v[80:95], a[0:3], v[240:243], v[80:95]
  ds_read_b64_tr_b16 a[28:29], v3 offset:2560
  ds_read_b64_tr_b16 a[30:31], v3 offset:3584
  v_pk_max_i16 v24, v24, 0
  v_mul_f32 v20, v20, abs(v20)
  v_mul_f32 v21, v21, abs(v21)
  v_mfma_f32_32x32x16_bf16 v[48:63], a[4:7], v[240:243], v[48:63]
  s_waitcnt vmcnt(22)
  s_barrier
  ds_read_b64_tr_b16 a[0:1], v1 offset:15360
  ds_read_b64_tr_b16 a[2:3], v1 offset:55296
  s_add_u32 m0, s40, 768
  s_waitcnt lgkmcnt(8)
  v_mfma_f32_32x32x16_bf16 v[80:95], a[8:11], v[244:247], v[80:95]
  buffer_load_dwordx4 v9, s[20:23], s56 offen offset:256  lds
  ds_read_b64_tr_b16 a[4:5], v1 offset:15872
  ds_read_b64_tr_b16 a[6:7], v1 offset:55808
  v_accvgpr_write_b32 a146, v22
  v_accvgpr_write_b32 a147, v24
  v_mfma_f32_32x32x16_bf16 v[48:63], a[12:15], v[244:247], v[48:63]
  ds_read_b64_tr_b16 a[8:9], v2 offset:29696
  ds_read_b64_tr_b16 a[10:11], v3 offset:4096
  v_accvgpr_read_b32 v22, a156
  v_accvgpr_read_b32 v23, a157
  v_cvt_pk_bf16_f32 v18, v18, v19
  v_mfma_f32_32x32x16_bf16 v[80:95], a[16:19], v[248:251], v[80:95]
  ds_read_b64_tr_b16 a[12:13], v2 offset:30208
  ds_read_b64_tr_b16 a[14:15], v3 offset:4608
  v_cvt_pk_bf16_f32 v20, v20, v21
  s_add_u32 m0, s40, 2048
  s_waitcnt lgkmcnt(8)
  v_mfma_f32_32x32x16_bf16 v[48:63], a[20:23], v[248:251], v[48:63]
  buffer_load_dwordx4 v9, s[20:23], s60 offen  lds
  ds_read_b64_tr_b16 a[16:17], v1 offset:16384
  ds_read_b64_tr_b16 a[18:19], v1 offset:56320
  v_accvgpr_read_b32 v24, a158
  v_accvgpr_read_b32 v25, a159
  v_mfma_f32_32x32x16_bf16 v[80:95], a[24:27], v[252:255], v[80:95]
  ds_read_b64_tr_b16 a[20:21], v1 offset:16896
  ds_read_b64_tr_b16 a[22:23], v1 offset:56832
  v_mul_f32 v22, v22, abs(v22)
  v_mul_f32 v23, v23, abs(v23)
  v_pk_max_i16 v18, v18, 0
  v_mfma_f32_32x32x16_bf16 v[48:63], a[28:31], v[252:255], v[48:63]
  ds_read_b64_tr_b16 a[24:25], v2 offset:30720
  ds_read_b64_tr_b16 a[26:27], v3 offset:5120
  v_pk_max_i16 v20, v20, 0
  s_add_u32 m0, s40, 2944
  s_waitcnt lgkmcnt(8)
  v_mfma_f32_32x32x16_bf16 v[112:127], a[0:3], v[64:67], 0
  buffer_load_dwordx4 v9, s[20:23], s60 offen offset:128  lds
  ds_read_b64_tr_b16 a[28:29], v2 offset:31232
  ds_read_b64_tr_b16 a[30:31], v3 offset:5632
  v_mul_f32 v24, v24, abs(v24)
  v_mul_f32 v25, v25, abs(v25)
  v_mfma_f32_32x32x16_bf16 v[128:143], a[4:7], v[64:67], 0
  ds_read_b64_tr_b16 a[0:1], v1 offset:17408
  ds_read_b64_tr_b16 a[2:3], v1 offset:57344
  v_accvgpr_write_b32 a148, v18
  v_accvgpr_write_b32 a149, v20
  v_cvt_pk_bf16_f32 v22, v22, v23
  v_mfma_f32_32x32x16_bf16 v[112:127], a[8:11], v[68:71], v[112:127]
  ds_read_b64_tr_b16 a[4:5], v1 offset:17920
  ds_read_b64_tr_b16 a[6:7], v1 offset:57856
  v_cvt_pk_bf16_f32 v24, v24, v25
  s_add_u32 m0, s40, 3840
  s_waitcnt lgkmcnt(8)
  v_mfma_f32_32x32x16_bf16 v[128:143], a[12:15], v[68:71], v[128:143]
  buffer_load_dwordx4 v9, s[20:23], s60 offen offset:256  lds
  ds_read_b64_tr_b16 a[8:9], v2 offset:31744
  ds_read_b64_tr_b16 a[10:11], v3 offset:6144
  v_pk_max_i16 v22, v22, 0
  v_pk_max_i16 v24, v24, 0
  v_mfma_f32_32x32x16_bf16 v[144:159], a[16:19], v[64:67], 0
  ds_read_b64_tr_b16 a[12:13], v2 offset:32256
  ds_read_b64_tr_b16 a[14:15], v3 offset:6656
  v_accvgpr_write_b32 a150, v22
  v_accvgpr_write_b32 a151, v24
  v_accvgpr_read_b32 v18, a160
  v_mfma_f32_32x32x16_bf16 v[160:175], a[20:23], v[64:67], 0
  ds_read_b64_tr_b16 a[16:17], v1 offset:18432
  ds_read_b64_tr_b16 a[18:19], v1 offset:58368
  s_add_u32 s46, s44, 6144
  buffer_store_dwordx4 a[144:147], v4, s[28:31], s46 offen offset:0 sc1
  s_add_u32 m0, s40, 5120
  s_waitcnt lgkmcnt(8)
  v_mfma_f32_32x32x16_bf16 v[144:159], a[24:27], v[68:71], v[144:159]
  buffer_load_dwordx4 v9, s[20:23], s61 offen  lds
  ds_read_b64_tr_b16 a[20:21], v1 offset:18944
  ds_read_b64_tr_b16 a[22:23], v1 offset:58880
  v_mfma_f32_32x32x16_bf16 v[160:175], a[28:31], v[68:71], v[160:175]
  ds_read_b64_tr_b16 a[24:25], v2 offset:32768
  ds_read_b64_tr_b16 a[26:27], v3 offset:7168
  s_add_u32 s46, s44, 6144
  buffer_store_dwordx4 a[148:151], v4, s[28:31], s46 offen offset:1024 sc1
  v_mfma_f32_32x32x16_bf16 v[176:191], a[0:3], v[64:67], 0
  ds_read_b64_tr_b16 a[28:29], v2 offset:33280
  ds_read_b64_tr_b16 a[30:31], v3 offset:7680
  v_accvgpr_read_b32 v19, a161
  s_add_u32 m0, s40, 6016
  s_waitcnt lgkmcnt(8)
  v_mfma_f32_32x32x16_bf16 v[192:207], a[4:7], v[64:67], 0
  buffer_load_dwordx4 v9, s[20:23], s61 offen offset:128  lds
  ds_read_b64_tr_b16 a[0:1], v1 offset:19456
  ds_read_b64_tr_b16 a[2:3], v1 offset:59392
  v_accvgpr_read_b32 v20, a162
  v_accvgpr_read_b32 v21, a163
  v_mfma_f32_32x32x16_bf16 v[176:191], a[8:11], v[68:71], v[176:191]
  ds_read_b64_tr_b16 a[4:5], v1 offset:19968
  ds_read_b64_tr_b16 a[6:7], v1 offset:59904
  v_mul_f32 v18, v18, abs(v18)
  v_mul_f32 v19, v19, abs(v19)
  v_mul_f32 v20, v20, abs(v20)
  v_mfma_f32_32x32x16_bf16 v[192:207], a[12:15], v[68:71], v[192:207]
  ds_read_b64_tr_b16 a[8:9], v2 offset:33792
  ds_read_b64_tr_b16 a[10:11], v3 offset:8192
  v_mul_f32 v21, v21, abs(v21)
  v_accvgpr_read_b32 v22, a164
  s_waitcnt lgkmcnt(8)
  v_mfma_f32_32x32x16_bf16 v[112:127], a[16:19], v[72:75], v[112:127]
  ds_read_b64_tr_b16 a[12:13], v2 offset:34304
  ds_read_b64_tr_b16 a[14:15], v3 offset:8704
  v_accvgpr_read_b32 v23, a165
  v_cvt_pk_bf16_f32 v18, v18, v19
  v_cvt_pk_bf16_f32 v20, v20, v21
  s_add_u32 m0, s40, 6912
  v_mfma_f32_32x32x16_bf16 v[128:143], a[20:23], v[72:75], v[128:143]
  buffer_load_dwordx4 v9, s[20:23], s61 offen offset:256  lds
  ds_read_b64_tr_b16 a[16:17], v1 offset:20480
  ds_read_b64_tr_b16 a[18:19], v1 offset:60416
  v_accvgpr_read_b32 v24, a166
  v_accvgpr_read_b32 v25, a167
  v_mfma_f32_32x32x16_bf16 v[112:127], a[24:27], v[76:79], v[112:127]
  ds_read_b64_tr_b16 a[20:21], v1 offset:20992
  ds_read_b64_tr_b16 a[22:23], v1 offset:60928
  v_mul_f32 v22, v22, abs(v22)
  v_mul_f32 v23, v23, abs(v23)
  s_waitcnt lgkmcnt(8)
  v_mfma_f32_32x32x16_bf16 v[128:143], a[28:31], v[76:79], v[128:143]
  ds_read_b64_tr_b16 a[24:25], v2 offset:34816
  ds_read_b64_tr_b16 a[26:27], v3 offset:9216
  v_pk_max_i16 v18, v18, 0
  v_pk_max_i16 v20, v20, 0
  v_mul_f32 v24, v24, abs(v24)
  v_mfma_f32_32x32x16_bf16 v[144:159], a[0:3], v[72:75], v[144:159]
  ds_read_b64_tr_b16 a[28:29], v2 offset:35328
  ds_read_b64_tr_b16 a[30:31], v3 offset:9728
  v_mul_f32 v25, v25, abs(v25)
  v_accvgpr_write_b32 a160, v18
  v_accvgpr_write_b32 a161, v20
  s_add_u32 m0, s40, 8192
  v_mfma_f32_32x32x16_bf16 v[160:175], a[4:7], v[72:75], v[160:175]
  buffer_load_dwordx4 v11, s[20:23], s50 offen  lds
  ds_read_b64_tr_b16 a[0:1], v1 offset:21504
  ds_read_b64_tr_b16 a[2:3], v1 offset:61440
  v_accvgpr_read_b32 v18, a168
  s_waitcnt lgkmcnt(8)
  v_mfma_f32_32x32x16_bf16 v[144:159], a[8:11], v[76:79], v[144:159]
  ds_read_b64_tr_b16 a[4:5], v1 offset:22016
  ds_read_b64_tr_b16 a[6:7], v1 offset:61952
  v_accvgpr_read_b32 v19, a169
  v_cvt_pk_bf16_f32 v22, v22, v23
  v_cvt_pk_bf16_f32 v24, v24, v25
  v_mfma_f32_32x32x16_bf16 v[160:175], a[12:15], v[76:79], v[160:175]
  ds_read_b64_tr_b16 a[8:9], v2 offset:35840
  ds_read_b64_tr_b16 a[10:11], v3 offset:10240
  v_accvgpr_read_b32 v20, a170
  v_accvgpr_read_b32 v21, a171
  v_mul_f32 v18, v18, abs(v18)
  v_mfma_f32_32x32x16_bf16 v[176:191], a[16:19], v[72:75], v[176:191]
  ds_read_b64_tr_b16 a[12:13], v2 offset:36352
  ds_read_b64_tr_b16 a[14:15], v3 offset:10752
  v_mul_f32 v19, v19, abs(v19)
  v_pk_max_i16 v22, v22, 0
  s_waitcnt lgkmcnt(8)
  v_mfma_f32_32x32x16_bf16 v[192:207], a[20:23], v[72:75], v[192:207]
  ds_read_b64_tr_b16 a[16:17], v1 offset:22528
  ds_read_b64_tr_b16 a[18:19], v1 offset:62464
  v_pk_max_i16 v24, v24, 0
  v_mul_f32 v20, v20, abs(v20)
  v_mul_f32 v21, v21, abs(v21)
  v_mfma_f32_32x32x16_bf16 v[176:191], a[24:27], v[76:79], v[176:191]
  ds_read_b64_tr_b16 a[20:21], v1 offset:23040
  ds_read_b64_tr_b16 a[22:23], v1 offset:62976
  v_accvgpr_write_b32 a162, v22
  v_accvgpr_write_b32 a163, v24
  v_accvgpr_read_b32 v22, a172
  v_mfma_f32_32x32x16_bf16 v[192:207], a[28:31], v[76:79], v[192:207]
  ds_read_b64_tr_b16 a[24:25], v2 offset:36864
  ds_read_b64_tr_b16 a[26:27], v3 offset:11264
  v_accvgpr_read_b32 v23, a173
  v_cvt_pk_bf16_f32 v18, v18, v19
  s_waitcnt lgkmcnt(8)
  v_mfma_f32_32x32x16_bf16 v[112:127], a[0:3], v[32:35], v[112:127]
  ds_read_b64_tr_b16 a[28:29], v2 offset:37376
  ds_read_b64_tr_b16 a[30:31], v3 offset:11776
  v_cvt_pk_bf16_f32 v20, v20, v21
  v_accvgpr_read_b32 v24, a174
  v_accvgpr_read_b32 v25, a175
  v_mfma_f32_32x32x16_bf16 v[128:143], a[4:7], v[32:35], v[128:143]
  ds_read_b64_tr_b16 a[0:1], v1 offset:23552
  ds_read_b64_tr_b16 a[2:3], v1 offset:63488
  v_mul_f32 v22, v22, abs(v22)
  v_mul_f32 v23, v23, abs(v23)
  v_pk_max_i16 v18, v18, 0
  v_mfma_f32_32x32x16_bf16 v[112:127], a[8:11], v[36:39], v[112:127]
  ds_read_b64_tr_b16 a[4:5], v1 offset:24064
  ds_read_b64_tr_b16 a[6:7], v1 offset:64000
  v_pk_max_i16 v20, v20, 0
  v_mul_f32 v24, v24, abs(v24)
  s_waitcnt lgkmcnt(8)
  v_mfma_f32_32x32x16_bf16 v[128:143], a[12:15], v[36:39], v[128:143]
  ds_read_b64_tr_b16 a[8:9], v2 offset:37888
  ds_read_b64_tr_b16 a[10:11], v3 offset:12288
  v_mul_f32 v25, v25, abs(v25)
  v_accvgpr_write_b32 a164, v18
  v_accvgpr_write_b32 a165, v20
  v_mfma_f32_32x32x16_bf16 v[144:159], a[16:19], v[32:35], v[144:159]
  ds_read_b64_tr_b16 a[12:13], v2 offset:38400
  ds_read_b64_tr_b16 a[14:15], v3 offset:12800
  v_cvt_pk_bf16_f32 v22, v22, v23
  v_cvt_pk_bf16_f32 v24, v24, v25
  v_pk_max_i16 v22, v22, 0
  v_mfma_f32_32x32x16_bf16 v[160:175], a[20:23], v[32:35], v[160:175]
  ds_read_b64_tr_b16 a[16:17], v1 offset:24576
  ds_read_b64_tr_b16 a[18:19], v1 offset:64512
  v_pk_max_i16 v24, v24, 0
  v_accvgpr_write_b32 a166, v22
  s_waitcnt lgkmcnt(8)
  v_mfma_f32_32x32x16_bf16 v[144:159], a[24:27], v[36:39], v[144:159]
  ds_read_b64_tr_b16 a[20:21], v1 offset:25088
  ds_read_b64_tr_b16 a[22:23], v1 offset:65024
  v_accvgpr_write_b32 a167, v24
  v_accvgpr_read_b32 v18, a176
  v_accvgpr_read_b32 v19, a177
  v_mfma_f32_32x32x16_bf16 v[160:175], a[28:31], v[36:39], v[160:175]
  ds_read_b64_tr_b16 a[24:25], v2 offset:38912
  ds_read_b64_tr_b16 a[26:27], v3 offset:13312
  s_add_u32 s46, s44, 8192
  buffer_store_dwordx4 a[160:163], v4, s[28:31], s46 offen offset:0 sc1
  v_mfma_f32_32x32x16_bf16 v[176:191], a[0:3], v[32:35], v[176:191]
  ds_read_b64_tr_b16 a[28:29], v2 offset:39424
  ds_read_b64_tr_b16 a[30:31], v3 offset:13824
  v_accvgpr_read_b32 v20, a178
  s_waitcnt lgkmcnt(8)
  v_mfma_f32_32x32x16_bf16 v[192:207], a[4:7], v[32:35], v[192:207]
  ds_read_b64_tr_b16 a[0:1], v1 offset:25600
  ds_read_b64_tr_b16 a[2:3], v2 offset:0
  s_add_u32 s46, s44, 8192
  buffer_store_dwordx4 a[164:167], v4, s[28:31], s46 offen offset:1024 sc1
  v_mfma_f32_32x32x16_bf16 v[176:191], a[8:11], v[36:39], v[176:191]
  ds_read_b64_tr_b16 a[4:5], v1 offset:26112
  ds_read_b64_tr_b16 a[6:7], v2 offset:512
  v_accvgpr_read_b32 v21, a179
  v_mul_f32 v18, v18, abs(v18)
  v_mfma_f32_32x32x16_bf16 v[192:207], a[12:15], v[36:39], v[192:207]
  ds_read_b64_tr_b16 a[8:9], v2 offset:39936
  ds_read_b64_tr_b16 a[10:11], v3 offset:14336
  v_mul_f32 v19, v19, abs(v19)
  v_mul_f32 v20, v20, abs(v20)
  s_waitcnt lgkmcnt(8)
  v_mfma_f32_32x32x16_bf16 v[112:127], a[16:19], v[40:43], v[112:127]
  ds_read_b64_tr_b16 a[12:13], v2 offset:40448
  ds_read_b64_tr_b16 a[14:15], v3 offset:14848
  v_mul_f32 v21, v21, abs(v21)
  v_accvgpr_read_b32 v22, a180
  v_accvgpr_read_b32 v23, a181
  v_mfma_f32_32x32x16_bf16 v[128:143], a[20:23], v[40:43], v[128:143]
  ds_read_b64_tr_b16 a[16:17], v1 offset:26624
  ds_read_b64_tr_b16 a[18:19], v2 offset:1024
  v_cvt_pk_bf16_f32 v18, v18, v19
  v_cvt_pk_bf16_f32 v20, v20, v21
  v_accvgpr_read_b32 v24, a182
  v_mfma_f32_32x32x16_bf16 v[112:127], a[24:27], v[44:47], v[112:127]
  ds_read_b64_tr_b16 a[20:21], v1 offset:27136
  ds_read_b64_tr_b16 a[22:23], v2 offset:1536
  v_accvgpr_read_b32 v25, a183
  v_mul_f32 v22, v22, abs(v22)
  s_waitcnt lgkmcnt(8)
  v_mfma_f32_32x32x16_bf16 v[128:143], a[28:31], v[44:47], v[128:143]
  ds_read_b64_tr_b16 a[24:25], v2 offset:40960
  ds_read_b64_tr_b16 a[26:27], v3 offset:15360
  v_mul_f32 v23, v23, abs(v23)
  v_pk_max_i16 v208, v18, 0
  v_pk_max_i16 v209, v20, 0
  v_mfma_f32_32x32x16_bf16 v[144:159], a[0:3], v[40:43], v[144:159]
  ds_read_b64_tr_b16 a[28:29], v2 offset:41472
  ds_read_b64_tr_b16 a[30:31], v3 offset:15872
  v_mul_f32 v24, v24, abs(v24)
  v_mul_f32 v25, v25, abs(v25)
  v_accvgpr_read_b32 v18, a184
  v_mfma_f32_32x32x16_bf16 v[160:175], a[4:7], v[40:43], v[160:175]
  s_waitcnt vmcnt(18)
  s_barrier
  ds_read_b64_tr_b16 a[0:1], v1 offset:27648
  ds_read_b64_tr_b16 a[2:3], v2 offset:2048
  s_add_u32 m0, s40, 9088
  s_waitcnt lgkmcnt(8)
  v_mfma_f32_32x32x16_bf16 v[144:159], a[8:11], v[44:47], v[144:159]
  buffer_load_dwordx4 v11, s[20:23], s50 offen offset:128  lds
  ds_read_b64_tr_b16 a[4:5], v1 offset:28160
  ds_read_b64_tr_b16 a[6:7], v2 offset:2560
  v_accvgpr_read_b32 v19, a185
  v_cvt_pk_bf16_f32 v22, v22, v23
  v_mfma_f32_32x32x16_bf16 v[160:175], a[12:15], v[44:47], v[160:175]
  ds_read_b64_tr_b16 a[8:9], v2 offset:41984
  ds_read_b64_tr_b16 a[10:11], v3 offset:16384
  v_cvt_pk_bf16_f32 v24, v24, v25
  v_accvgpr_read_b32 v20, a186
  v_accvgpr_read_b32 v21, a187
  v_mfma_f32_32x32x16_bf16 v[176:191], a[16:19], v[40:43], v[176:191]
  ds_read_b64_tr_b16 a[12:13], v2 offset:42496
  ds_read_b64_tr_b16 a[14:15], v3 offset:16896
  v_mul_f32 v18, v18, abs(v18)
  s_add_u32 m0, s40, 9984
  s_waitcnt lgkmcnt(8)
  v_mfma_f32_32x32x16_bf16 v[192:207], a[20:23], v[40:43], v[192:207]
  buffer_load_dwordx4 v11, s[20:23], s50 offen offset:256  lds
  ds_read_b64_tr_b16 a[16:17], v1 offset:28672
  ds_read_b64_tr_b16 a[18:19], v2 offset:3072
  v_mul_f32 v19, v19, abs(v19)
  v_pk_max_i16 v210, v22, 0
  v_mfma_f32_32x32x16_bf16 v[176:191], a[24:27], v[44:47], v[176:191]
  ds_read_b64_tr_b16 a[20:21], v1 offset:29184
  ds_read_b64_tr_b16 a[22:23], v2 offset:3584
  v_pk_max_i16 v211, v24, 0
  v_mul_f32 v20, v20, abs(v20)
  v_mul_f32 v21, v21, abs(v21)
  v_mfma_f32_32x32x16_bf16 v[192:207], a[28:31], v[44:47], v[192:207]
  ds_read_b64_tr_b16 a[24:25], v2 offset:43008
  ds_read_b64_tr_b16 a[26:27], v3 offset:17408
  buffer_load_dword v16, v15, s[28:31], s43 offen sc1
  s_add_u32 m0, s40, 11264
  s_waitcnt lgkmcnt(8)
  v_mfma_f32_32x32x16_bf16 v[112:127], a[0:3], v[96:99], v[112:127]
  buffer_load_dwordx4 v11, s[20:23], s51 offen  lds
  ds_read_b64_tr_b16 a[28:29], v2 offset:43520
  ds_read_b64_tr_b16 a[30:31], v3 offset:17920
  v_accvgpr_read_b32 v22, a188
  v_accvgpr_read_b32 v23, a189
  v_mfma_f32_32x32x16_bf16 v[128:143], a[4:7], v[96:99], v[128:143]
  ds_read_b64_tr_b16 a[0:1], v1 offset:29696
  ds_read_b64_tr_b16 a[2:3], v2 offset:4096
  v_cvt_pk_bf16_f32 v18, v18, v19
  v_cvt_pk_bf16_f32 v20, v20, v21
  v_accvgpr_read_b32 v24, a190
  v_mfma_f32_32x32x16_bf16 v[112:127], a[8:11], v[100:103], v[112:127]
  ds_read_b64_tr_b16 a[4:5], v1 offset:30208
  ds_read_b64_tr_b16 a[6:7], v2 offset:4608
  v_accvgpr_read_b32 v25, a191
  s_add_u32 m0, s40, 12160
  s_waitcnt lgkmcnt(8)
  v_mfma_f32_32x32x16_bf16 v[128:143], a[12:15], v[100:103], v[128:143]
  buffer_load_dwordx4 v11, s[20:23], s51 offen offset:128  lds
  ds_read_b64_tr_b16 a[8:9], v2 offset:44032
  ds_read_b64_tr_b16 a[10:11], v3 offset:18432
  v_mul_f32 v22, v22, abs(v22)
  v_mul_f32 v23, v23, abs(v23)
  v_mfma_f32_32x32x16_bf16 v[144:159], a[16:19], v[96:99], v[144:159]
  ds_read_b64_tr_b16 a[12:13], v2 offset:44544
  ds_read_b64_tr_b16 a[14:15], v3 offset:18944
  v_pk_max_i16 v212, v18, 0
  v_pk_max_i16 v213, v20, 0
  v_mul_f32 v24, v24, abs(v24)
  v_mfma_f32_32x32x16_bf16 v[160:175], a[20:23], v[96:99], v[160:175]
  ds_read_b64_tr_b16 a[16:17], v1 offset:30720
  ds_read_b64_tr_b16 a[18:19], v2 offset:5120
  v_mul_f32 v25, v25, abs(v25)
  s_add_u32 m0, s40, 13056
  s_waitcnt lgkmcnt(8)
  v_mfma_f32_32x32x16_bf16 v[144:159], a[24:27], v[100:103], v[144:159]
  buffer_load_dwordx4 v11, s[20:23], s51 offen offset:256  lds
  ds_read_b64_tr_b16 a[20:21], v1 offset:31232
  ds_read_b64_tr_b16 a[22:23], v2 offset:5632
  v_cvt_pk_bf16_f32 v22, v22, v23
  v_cvt_pk_bf16_f32 v24, v24, v25
  v_mfma_f32_32x32x16_bf16 v[160:175], a[28:31], v[100:103], v[160:175]
  ds_read_b64_tr_b16 a[24:25], v2 offset:45056
  ds_read_b64_tr_b16 a[26:27], v3 offset:19456
  v_pk_max_i16 v214, v22, 0
  v_pk_max_i16 v215, v24, 0
  v_accvgpr_read_b32 v18, a192
  v_mfma_f32_32x32x16_bf16 v[176:191], a[0:3], v[96:99], v[176:191]
  ds_read_b64_tr_b16 a[28:29], v2 offset:45568
  ds_read_b64_tr_b16 a[30:31], v3 offset:19968
  s_add_u32 s46, s44, 10240
  buffer_store_dwordx4 v[208:211], v4, s[28:31], s46 offen offset:0 sc1
  s_add_u32 m0, s40, 14336
  s_waitcnt lgkmcnt(8)
  v_mfma_f32_32x32x16_bf16 v[192:207], a[4:7], v[96:99], v[192:207]
  buffer_load_dwordx4 v12, s[20:23], s57 offen  lds
  ds_read_b64_tr_b16 a[0:1], v1 offset:31744
  ds_read_b64_tr_b16 a[2:3], v2 offset:6144
  v_mfma_f32_32x32x16_bf16 v[176:191], a[8:11], v[100:103], v[176:191]
  ds_read_b64_tr_b16 a[4:5], v1 offset:32256
  ds_read_b64_tr_b16 a[6:7], v2 offset:6656
  s_add_u32 s46, s44, 10240
  buffer_store_dwordx4 v[212:215], v4, s[28:31], s46 offen offset:1024 sc1
  v_mfma_f32_32x32x16_bf16 v[192:207], a[12:15], v[100:103], v[192:207]
  ds_read_b64_tr_b16 a[8:9], v2 offset:46080
  ds_read_b64_tr_b16 a[10:11], v3 offset:20480
  s_add_u32 m0, s40, 15232
  s_waitcnt lgkmcnt(8)
  v_mfma_f32_32x32x16_bf16 v[112:127], a[16:19], v[104:107], v[112:127]
  buffer_load_dwordx4 v12, s[20:23], s57 offen offset:128  lds
  ds_read_b64_tr_b16 a[12:13], v2 offset:46592
  ds_read_b64_tr_b16 a[14:15], v3 offset:20992
  v_accvgpr_read_b32 v19, a193
  v_accvgpr_read_b32 v20, a194
  v_mfma_f32_32x32x16_bf16 v[128:143], a[20:23], v[104:107], v[128:143]
  ds_read_b64_tr_b16 a[16:17], v1 offset:32768
  ds_read_b64_tr_b16 a[18:19], v2 offset:7168
  v_accvgpr_read_b32 v21, a195
  v_mul_f32 v18, v18, abs(v18)
  v_mul_f32 v19, v19, abs(v19)
  v_mfma_f32_32x32x16_bf16 v[112:127], a[24:27], v[108:111], v[112:127]
  ds_read_b64_tr_b16 a[20:21], v1 offset:33280
  ds_read_b64_tr_b16 a[22:23], v2 offset:7680
  v_mul_f32 v20, v20, abs(v20)
  s_add_u32 m0, s40, 16128
  s_waitcnt lgkmcnt(8)
  v_mfma_f32_32x32x16_bf16 v[128:143], a[28:31], v[108:111], v[128:143]
  buffer_load_dwordx4 v12, s[20:23], s57 offen offset:256  lds
  ds_read_b64_tr_b16 a[24:25], v2 offset:47104
  ds_read_b64_tr_b16 a[26:27], v3 offset:21504
  v_mul_f32 v21, v21, abs(v21)
  v_accvgpr_read_b32 v22, a196
  v_mfma_f32_32x32x16_bf16 v[144:159], a[0:3], v[104:107], v[144:159]
  ds_read_b64_tr_b16 a[28:29], v2 offset:47616
  ds_read_b64_tr_b16 a[30:31], v3 offset:22016
  v_accvgpr_read_b32 v23, a197
  v_cvt_pk_bf16_f32 v18, v18, v19
  v_cvt_pk_bf16_f32 v20, v20, v21
  v_mfma_f32_32x32x16_bf16 v[160:175], a[4:7], v[104:107], v[160:175]
  ds_read_b64_tr_b16 a[0:1], v1 offset:33792
  ds_read_b64_tr_b16 a[2:3], v2 offset:8192
  v_accvgpr_read_b32 v24, a198
  s_add_u32 m0, s40, 17408
  s_waitcnt lgkmcnt(8)
  v_mfma_f32_32x32x16_bf16 v[144:159], a[8:11], v[108:111], v[144:159]
  buffer_load_dwordx4 v12, s[20:23], s58 offen  lds
  ds_read_b64_tr_b16 a[4:5], v1 offset:34304
  ds_read_b64_tr_b16 a[6:7], v2 offset:8704
  v_accvgpr_read_b32 v25, a199
  v_mul_f32 v22, v22, abs(v22)
  v_mfma_f32_32x32x16_bf16 v[160:175], a[12:15], v[108:111], v[160:175]
  ds_read_b64_tr_b16 a[8:9], v2 offset:48128
  ds_read_b64_tr_b16 a[10:11], v3 offset:22528
  v_mul_f32 v23, v23, abs(v23)
  v_pk_max_i16 v216, v18, 0
  v_pk_max_i16 v217, v20, 0
  v_mfma_f32_32x32x16_bf16 v[176:191], a[16:19], v[104:107], v[176:191]
  ds_read_b64_tr_b16 a[12:13], v2 offset:48640
  ds_read_b64_tr_b16 a[14:15], v3 offset:23040
  v_mul_f32 v24, v24, abs(v24)
  s_add_u32 m0, s40, 18304
  s_waitcnt lgkmcnt(8)
  v_mfma_f32_32x32x16_bf16 v[192:207], a[20:23], v[104:107], v[192:207]
  buffer_load_dwordx4 v12, s[20:23], s58 offen offset:128  lds
  ds_read_b64_tr_b16 a[16:17], v1 offset:34816
  ds_read_b64_tr_b16 a[18:19], v2 offset:9216
  v_mul_f32 v25, v25, abs(v25)
  v_accvgpr_read_b32 v18, a200
  v_mfma_f32_32x32x16_bf16 v[176:191], a[24:27], v[108:111], v[176:191]
  ds_read_b64_tr_b16 a[20:21], v1 offset:35328
  ds_read_b64_tr_b16 a[22:23], v2 offset:9728
  v_accvgpr_read_b32 v19, a201
  v_cvt_pk_bf16_f32 v22, v22, v23
  v_cvt_pk_bf16_f32 v24, v24, v25
  v_mfma_f32_32x32x16_bf16 v[192:207], a[28:31], v[108:111], v[192:207]
  ds_read_b64_tr_b16 a[24:25], v2 offset:49152
  ds_read_b64_tr_b16 a[26:27], v3 offset:23552
  v_accvgpr_read_b32 v20, a202
  s_add_u32 m0, s40, 19200
  s_waitcnt lgkmcnt(8)
  v_mfma_f32_32x32x16_bf16 v[112:127], a[0:3], a[144:147], v[112:127]
  buffer_load_dwordx4 v12, s[20:23], s58 offen offset:256  lds
  ds_read_b64_tr_b16 a[28:29], v2 offset:49664
  ds_read_b64_tr_b16 a[30:31], v3 offset:24064
  v_accvgpr_read_b32 v21, a203
  v_mul_f32 v18, v18, abs(v18)
  v_mfma_f32_32x32x16_bf16 v[128:143], a[4:7], a[144:147], v[128:143]
  ds_read_b64_tr_b16 a[0:1], v1 offset:35840
  ds_read_b64_tr_b16 a[2:3], v2 offset:10240
  v_mul_f32 v19, v19, abs(v19)
  v_pk_max_i16 v218, v22, 0
  v_pk_max_i16 v219, v24, 0
  v_mfma_f32_32x32x16_bf16 v[112:127], a[8:11], a[148:151], v[112:127]
  ds_read_b64_tr_b16 a[4:5], v1 offset:36352
  ds_read_b64_tr_b16 a[6:7], v2 offset:10752
  v_mul_f32 v20, v20, abs(v20)
  s_add_u32 m0, s40, 20480
  s_waitcnt lgkmcnt(8)
  v_mfma_f32_32x32x16_bf16 v[128:143], a[12:15], a[148:151], v[128:143]
  buffer_load_dwordx4 v11, s[20:23], s57 offen  lds
  ds_read_b64_tr_b16 a[8:9], v2 offset:50176
  ds_read_b64_tr_b16 a[10:11], v3 offset:24576
  v_mul_f32 v21, v21, abs(v21)
  v_accvgpr_read_b32 v22, a204
  v_mfma_f32_32x32x16_bf16 v[144:159], a[16:19], a[144:147], v[144:159]
  ds_read_b64_tr_b16 a[12:13], v2 offset:50688
  ds_read_b64_tr_b16 a[14:15], v3 offset:25088
  v_accvgpr_read_b32 v23, a205
  v_cvt_pk_bf16_f32 v18, v18, v19
  v_cvt_pk_bf16_f32 v20, v20, v21
  v_mfma_f32_32x32x16_bf16 v[160:175], a[20:23], a[144:147], v[160:175]
  ds_read_b64_tr_b16 a[16:17], v1 offset:36864
  ds_read_b64_tr_b16 a[18:19], v2 offset:11264
FF_H6:
  s_cbranch_execz FF_H10
  v_accvgpr_read_b32 v24, a206
  v_accvgpr_read_b32 v25, a207
  s_waitcnt lgkmcnt(8)
  v_mfma_f32_32x32x16_bf16 v[144:159], a[24:27], a[148:151], v[144:159]
  ds_read_b64_tr_b16 a[20:21], v1 offset:37376
  ds_read_b64_tr_b16 a[22:23], v2 offset:11776
  v_mul_f32 v22, v22, abs(v22)
  v_mul_f32 v23, v23, abs(v23)
  v_pk_max_i16 v220, v18, 0
  v_mfma_f32_32x32x16_bf16 v[160:175], a[28:31], a[148:151], v[160:175]
  ds_read_b64_tr_b16 a[24:25], v2 offset:51200
  ds_read_b64_tr_b16 a[26:27], v3 offset:25600
  v_pk_max_i16 v221, v20, 0
  v_mul_f32 v24, v24, abs(v24)
  v_mul_f32 v25, v25, abs(v25)
  v_mfma_f32_32x32x16_bf16 v[176:191], a[0:3], a[144:147], v[176:191]
  ds_read_b64_tr_b16 a[28:29], v2 offset:51712
  ds_read_b64_tr_b16 a[30:31], v3 offset:26112
  v_cvt_pk_bf16_f32 v22, v22, v23
  v_cvt_pk_bf16_f32 v24, v24, v25
  s_waitcnt lgkmcnt(8)
  v_mfma_f32_32x32x16_bf16 v[192:207], a[4:7], a[144:147], v[192:207]
  ds_read_b64_tr_b16 a[0:1], v1 offset:37888
  ds_read_b64_tr_b16 a[2:3], v2 offset:12288
  v_pk_max_i16 v222, v22, 0
  v_pk_max_i16 v223, v24, 0
  v_mul_f32 v80, v80, abs(v80)
  v_mfma_f32_32x32x16_bf16 v[176:191], a[8:11], a[148:151], v[176:191]
  ds_read_b64_tr_b16 a[4:5], v1 offset:38400
  ds_read_b64_tr_b16 a[6:7], v2 offset:12800
  s_add_u32 s46, s44, 12288
  buffer_store_dwordx4 v[216:219], v4, s[28:31], s46 offen offset:0 sc1
  v_mfma_f32_32x32x16_bf16 v[192:207], a[12:15], a[148:151], v[192:207]
  ds_read_b64_tr_b16 a[8:9], v2 offset:52224
  ds_read_b64_tr_b16 a[10:11], v3 offset:26624
  v_mul_f32 v81, v81, abs(v81)
  s_waitcnt lgkmcnt(8)
  v_mfma_f32_32x32x16_bf16 v[112:127], a[16:19], a[160:163], v[112:127]
  ds_read_b64_tr_b16 a[12:13], v2 offset:52736
  ds_read_b64_tr_b16 a[14:15], v3 offset:27136
  s_add_u32 s46, s44, 12288
  buffer_store_dwordx4 v[220:223], v4, s[28:31], s46 offen offset:1024 sc1
  v_mfma_f32_32x32x16_bf16 v[128:143], a[20:23], a[160:163], v[128:143]
  ds_read_b64_tr_b16 a[16:17], v1 offset:38912
  ds_read_b64_tr_b16 a[18:19], v2 offset:13312
  v_mul_f32 v82, v82, abs(v82)
  v_mul_f32 v83, v83, abs(v83)
  v_mfma_f32_32x32x16_bf16 v[112:127], a[24:27], a[164:167], v[112:127]
  ds_read_b64_tr_b16 a[20:21], v1 offset:39424
  ds_read_b64_tr_b16 a[22:23], v2 offset:13824
  v_cvt_pk_bf16_f32 v18, v80, v81
  v_cvt_pk_bf16_f32 v20, v82, v83
  s_waitcnt lgkmcnt(8)
  v_mfma_f32_32x32x16_bf16 v[128:143], a[28:31], a[164:167], v[128:143]
  ds_read_b64_tr_b16 a[24:25], v2 offset:53248
  ds_read_b64_tr_b16 a[26:27], v3 offset:27648
  v_mul_f32 v84, v84, abs(v84)
  v_mul_f32 v85, v85, abs(v85)
  v_pk_max_i16 v80, v18, 0
  v_mfma_f32_32x32x16_bf16 v[144:159], a[0:3], a[160:163], v[144:159]
  ds_read_b64_tr_b16 a[28:29], v2 offset:53760
  ds_read_b64_tr_b16 a[30:31], v3 offset:28160
  v_pk_max_i16 v81, v20, 0
  v_mul_f32 v86, v86, abs(v86)
  v_mul_f32 v87, v87, abs(v87)
  v_mfma_f32_32x32x16_bf16 v[160:175], a[4:7], a[160:163], v[160:175]
  s_waitcnt vmcnt(20)
  s_barrier
  ds_read_b64_tr_b16 a[0:1], v1 offset:39936
  ds_read_b64_tr_b16 a[2:3], v2 offset:14336
  s_add_u32 m0, s40, 21376
  s_waitcnt lgkmcnt(8)
  v_mfma_f32_32x32x16_bf16 v[144:159], a[8:11], a[164:167], v[144:159]
  buffer_load_dwordx4 v11, s[20:23], s57 offen offset:128  lds
  ds_read_b64_tr_b16 a[4:5], v1 offset:40448
  ds_read_b64_tr_b16 a[6:7], v2 offset:14848
  s_waitcnt vmcnt(18)
  v_mov_b32 v14, 2
  buffer_store_dword v14, off, s[28:31], s42 sc1
  v_mfma_f32_32x32x16_bf16 v[160:175], a[12:15], a[164:167], v[160:175]
  ds_read_b64_tr_b16 a[8:9], v2 offset:54272
  ds_read_b64_tr_b16 a[10:11], v3 offset:28672
  v_cvt_pk_bf16_f32 v22, v84, v85
  v_mfma_f32_32x32x16_bf16 v[176:191], a[16:19], a[160:163], v[176:191]
  ds_read_b64_tr_b16 a[12:13], v2 offset:54784
  ds_read_b64_tr_b16 a[14:15], v3 offset:29184
  v_cvt_pk_bf16_f32 v24, v86, v87
  s_add_u32 m0, s40, 22272
  s_waitcnt lgkmcnt(8)
  v_mfma_f32_32x32x16_bf16 v[192:207], a[20:23], a[160:163], v[192:207]
  buffer_load_dwordx4 v11, s[20:23], s57 offen offset:256  lds
  ds_read_b64_tr_b16 a[16:17], v1 offset:40960
  ds_read_b64_tr_b16 a[18:19], v2 offset:15360
  s_waitcnt vmcnt(17)
  v_cmp_gt_u32 vcc, 1, v16
  s_nop 4
  s_and_b32 s46, vcc_lo, 7
  s_cbranch_scc1 FF_SP1
FF_SP1_B:
  v_mfma_f32_32x32x16_bf16 v[176:191], a[24:27], a[164:167], v[176:191]
  ds_read_b64_tr_b16 a[20:21], v1 offset:41472
  ds_read_b64_tr_b16 a[22:23], v2 offset:15872
  s_add_u32 s46, s45, 0
  buffer_load_dwordx4 a[32:35], v4, s[28:31], s46 offen offset:0 sc1
  v_mul_f32 v88, v88, abs(v88)
  v_mfma_f32_32x32x16_bf16 v[192:207], a[28:31], a[164:167], v[192:207]
  ds_read_b64_tr_b16 a[24:25], v2 offset:55296
  ds_read_b64_tr_b16 a[26:27], v3 offset:29696
  v_mul_f32 v89, v89, abs(v89)
  s_add_u32 m0, s40, 23552
  s_waitcnt lgkmcnt(8)
  v_mfma_f32_32x32x16_bf16 v[112:127], a[0:3], v[208:211], v[112:127]
  buffer_load_dwordx4 v11, s[20:23], s58 offen  lds
  ds_read_b64_tr_b16 a[28:29], v2 offset:55808
  ds_read_b64_tr_b16 a[30:31], v3 offset:30208
  v_pk_max_i16 v82, v22, 0
  v_pk_max_i16 v83, v24, 0
  v_mfma_f32_32x32x16_bf16 v[128:143], a[4:7], v[208:211], v[128:143]
  ds_read_b64_tr_b16 a[0:1], v1 offset:41984
  ds_read_b64_tr_b16 a[2:3], v2 offset:16384
  v_mul_f32 v90, v90, abs(v90)
  v_mul_f32 v91, v91, abs(v91)
  v_cvt_pk_bf16_f32 v18, v88, v89
  v_mfma_f32_32x32x16_bf16 v[112:127], a[8:11], v[212:215], v[112:127]
  ds_read_b64_tr_b16 a[4:5], v1 offset:42496
  ds_read_b64_tr_b16 a[6:7], v2 offset:16896
  v_cvt_pk_bf16_f32 v20, v90, v91
  s_add_u32 m0, s40, 24448
  s_waitcnt lgkmcnt(8)
  v_mfma_f32_32x32x16_bf16 v[128:143], a[12:15], v[212:215], v[128:143]
  buffer_load_dwordx4 v11, s[20:23], s58 offen offset:128  lds
  ds_read_b64_tr_b16 a[8:9], v2 offset:56320
  ds_read_b64_tr_b16 a[10:11], v3 offset:30720
  v_mul_f32 v92, v92, abs(v92)
  v_mul_f32 v93, v93, abs(v93)
  v_mfma_f32_32x32x16_bf16 v[144:159], a[16:19], v[208:211], v[144:159]
  ds_read_b64_tr_b16 a[12:13], v2 offset:56832
  ds_read_b64_tr_b16 a[14:15], v3 offset:31232
  s_add_u32 s46, s45, 0
  buffer_load_dwordx4 a[36:39], v4, s[28:31], s46 offen offset:1024 sc1
  v_pk_max_i16 v84, v18, 0
  v_mfma_f32_32x32x16_bf16 v[160:175], a[20:23], v[208:211], v[160:175]
  ds_read_b64_tr_b16 a[16:17], v1 offset:43008
  ds_read_b64_tr_b16 a[18:19], v2 offset:17408
  v_pk_max_i16 v85, v20, 0
  s_add_u32 m0, s40, 25344
  s_waitcnt lgkmcnt(8)
  v_mfma_f32_32x32x16_bf16 v[144:159], a[24:27], v[212:215], v[144:159]
  buffer_load_dwordx4 v11, s[20:23], s58 offen offset:256  lds
  ds_read_b64_tr_b16 a[20:21], v1 offset:43520
  ds_read_b64_tr_b16 a[22:23], v2 offset:17920
  v_mul_f32 v94, v94, abs(v94)
  v_mul_f32 v95, v95, abs(v95)
  v_mfma_f32_32x32x16_bf16 v[160:175], a[28:31], v[212:215], v[160:175]
  ds_read_b64_tr_b16 a[24:25], v2 offset:57344
  ds_read_b64_tr_b16 a[26:27], v3 offset:31744
  v_cvt_pk_bf16_f32 v22, v92, v93
  v_cvt_pk_bf16_f32 v24, v94, v95
  v_pk_max_i16 v86, v22, 0
  v_mfma_f32_32x32x16_bf16 v[176:191], a[0:3], v[208:211], v[176:191]
  ds_read_b64_tr_b16 a[28:29], v2 offset:57856
  ds_read_b64_tr_b16 a[30:31], v3 offset:32256
  v_pk_max_i16 v87, v24, 0
  s_add_u32 m0, s40, 26624
  s_waitcnt lgkmcnt(8)
  v_mfma_f32_32x32x16_bf16 v[192:207], a[4:7], v[208:211], v[192:207]
  buffer_load_dwordx4 v12, s[20:23], s50 offen  lds
  ds_read_b64_tr_b16 a[0:1], v1 offset:4096
  ds_read_b64_tr_b16 a[2:3], v1 offset:44032
  s_add_u32 s46, s44, 20480
  buffer_store_dwordx4 v[80:83], v4, s[28:31], s46 offen offset:0 sc1
  v_mfma_f32_32x32x16_bf16 v[176:191], a[8:11], v[212:215], v[176:191]
  ds_read_b64_tr_b16 a[4:5], v1 offset:4608
  ds_read_b64_tr_b16 a[6:7], v1 offset:44544
  s_add_u32 s46, s45, 2048
  buffer_load_dwordx4 a[40:43], v4, s[28:31], s46 offen offset:0 sc1
  v_mfma_f32_32x32x16_bf16 v[192:207], a[12:15], v[212:215], v[192:207]
  ds_read_b64_tr_b16 a[8:9], v2 offset:18432
  ds_read_b64_tr_b16 a[10:11], v2 offset:58368
  s_add_u32 s46, s44, 20480
  buffer_store_dwordx4 v[84:87], v4, s[28:31], s46 offen offset:1024 sc1
  s_add_u32 m0, s40, 27520
  s_waitcnt lgkmcnt(8)
  v_mfma_f32_32x32x16_bf16 v[112:127], a[16:19], v[216:219], v[112:127]
  buffer_load_dwordx4 v12, s[20:23], s50 offen offset:128  lds
  ds_read_b64_tr_b16 a[12:13], v2 offset:18944
  ds_read_b64_tr_b16 a[14:15], v2 offset:58880
  v_mfma_f32_32x32x16_bf16 v[128:143], a[20:23], v[216:219], v[128:143]
  ds_read_b64_tr_b16 a[16:17], v1 offset:5120
  ds_read_b64_tr_b16 a[18:19], v1 offset:45056
  v_mul_f32 v48, v48, abs(v48)
  v_mul_f32 v49, v49, abs(v49)
  v_mul_f32 v50, v50, abs(v50)
  v_mfma_f32_32x32x16_bf16 v[112:127], a[24:27], v[220:223], v[112:127]
  ds_read_b64_tr_b16 a[20:21], v1 offset:5632
  ds_read_b64_tr_b16 a[22:23], v1 offset:45568
  v_mul_f32 v51, v51, abs(v51)
  s_add_u32 m0, s40, 28416
  s_waitcnt lgkmcnt(8)
  v_mfma_f32_32x32x16_bf16 v[128:143], a[28:31], v[220:223], v[128:143]
  buffer_load_dwordx4 v12, s[20:23], s50 offen offset:256  lds
  ds_read_b64_tr_b16 a[24:25], v2 offset:19456
  ds_read_b64_tr_b16 a[26:27], v2 offset:59392
  v_cvt_pk_bf16_f32 v18, v48, v49
  v_cvt_pk_bf16_f32 v20, v50, v51
  v_mfma_f32_32x32x16_bf16 v[144:159], a[0:3], v[216:219], v[144:159]
  ds_read_b64_tr_b16 a[28:29], v2 offset:19968
  ds_read_b64_tr_b16 a[30:31], v2 offset:59904
  s_add_u32 s46, s45, 2048
  buffer_load_dwordx4 a[44:47], v4, s[28:31], s46 offen offset:1024 sc1
  v_mul_f32 v52, v52, abs(v52)
  v_mfma_f32_32x32x16_bf16 v[160:175], a[4:7], v[216:219], v[160:175]
  ds_read_b64_tr_b16 a[0:1], v1 offset:6144
  ds_read_b64_tr_b16 a[2:3], v1 offset:46080
  v_mul_f32 v53, v53, abs(v53)
  s_add_u32 m0, s40, 29696
  s_waitcnt lgkmcnt(8)
  v_mfma_f32_32x32x16_bf16 v[144:159], a[8:11], v[220:223], v[144:159]
  buffer_load_dwordx4 v12, s[20:23], s51 offen  lds
  ds_read_b64_tr_b16 a[4:5], v1 offset:6656
  ds_read_b64_tr_b16 a[6:7], v1 offset:46592
  v_pk_max_i16 v88, v18, 0
  v_pk_max_i16 v89, v20, 0
  v_mfma_f32_32x32x16_bf16 v[160:175], a[12:15], v[220:223], v[160:175]
  ds_read_b64_tr_b16 a[8:9], v2 offset:20480
  ds_read_b64_tr_b16 a[10:11], v2 offset:60416
  v_mul_f32 v54, v54, abs(v54)
  v_mul_f32 v55, v55, abs(v55)
  v_cvt_pk_bf16_f32 v22, v52, v53
  v_mfma_f32_32x32x16_bf16 v[176:191], a[16:19], v[216:219], v[176:191]
  ds_read_b64_tr_b16 a[12:13], v2 offset:20992
  ds_read_b64_tr_b16 a[14:15], v2 offset:60928
  v_cvt_pk_bf16_f32 v24, v54, v55
  s_add_u32 m0, s40, 30592
  s_waitcnt lgkmcnt(8)
  v_mfma_f32_32x32x16_bf16 v[192:207], a[20:23], v[216:219], v[192:207]
  buffer_load_dwordx4 v12, s[20:23], s51 offen offset:128  lds
  ds_read_b64_tr_b16 a[16:17], v1 offset:7168
  ds_read_b64_tr_b16 a[18:19], v1 offset:47104
  v_mul_f32 v56, v56, abs(v56)
  v_mul_f32 v57, v57, abs(v57)
  v_mfma_f32_32x32x16_bf16 v[176:191], a[24:27], v[220:223], v[176:191]
  ds_read_b64_tr_b16 a[20:21], v1 offset:7680
  ds_read_b64_tr_b16 a[22:23], v1 offset:47616
  s_add_u32 s46, s86, 14336
  buffer_load_dwordx4 a[48:51], v4, s[28:31], s46 offen offset:0 sc1
  v_pk_max_i16 v90, v22, 0
  v_mfma_f32_32x32x16_bf16 v[192:207], a[28:31], v[220:223], v[192:207]
  ds_read_b64_tr_b16 a[24:25], v2 offset:21504
  ds_read_b64_tr_b16 a[26:27], v2 offset:61440
  v_pk_max_i16 v91, v24, 0
  s_add_u32 m0, s40, 31488
  s_waitcnt lgkmcnt(8)
  v_mfma_f32_32x32x16_bf16 v[112:127], a[0:3], v[80:83], v[112:127]
  buffer_load_dwordx4 v12, s[20:23], s51 offen offset:256  lds
  ds_read_b64_tr_b16 a[28:29], v2 offset:22016
  ds_read_b64_tr_b16 a[30:31], v2 offset:61952
  v_mul_f32 v58, v58, abs(v58)
  v_mul_f32 v59, v59, abs(v59)
  v_mfma_f32_32x32x16_bf16 v[128:143], a[4:7], v[80:83], v[128:143]
  ds_read_b64_tr_b16 a[0:1], v1 offset:8192
  ds_read_b64_tr_b16 a[2:3], v1 offset:48128
  v_cvt_pk_bf16_f32 v18, v56, v57
  v_cvt_pk_bf16_f32 v20, v58, v59
  v_mul_f32 v60, v60, abs(v60)
  v_mfma_f32_32x32x16_bf16 v[112:127], a[8:11], v[84:87], v[112:127]
  ds_read_b64_tr_b16 a[4:5], v1 offset:8704
  ds_read_b64_tr_b16 a[6:7], v1 offset:48640
  v_mul_f32 v61, v61, abs(v61)
  s_add_u32 m0, s40, 32768
  s_waitcnt lgkmcnt(8)
  v_mfma_f32_32x32x16_bf16 v[128:143], a[12:15], v[84:87], v[128:143]
  buffer_load_dwordx4 v11, s[20:23], s59 offen  lds
  ds_read_b64_tr_b16 a[8:9], v2 offset:22528
  ds_read_b64_tr_b16 a[10:11], v2 offset:62464
  v_pk_max_i16 v92, v18, 0
  v_pk_max_i16 v93, v20, 0
  v_mfma_f32_32x32x16_bf16 v[144:159], a[16:19], v[80:83], v[144:159]
  ds_read_b64_tr_b16 a[12:13], v2 offset:23040
  ds_read_b64_tr_b16 a[14:15], v2 offset:62976
  s_add_u32 s46, s86, 14336
  buffer_load_dwordx4 a[52:55], v4, s[28:31], s46 offen offset:1024 sc1
  v_mul_f32 v62, v62, abs(v62)
  v_mfma_f32_32x32x16_bf16 v[160:175], a[20:23], v[80:83], v[160:175]
  ds_read_b64_tr_b16 a[16:17], v1 offset:9216
  ds_read_b64_tr_b16 a[18:19], v1 offset:49152
  v_mul_f32 v63, v63, abs(v63)
  v_cvt_pk_bf16_f32 v22, v60, v61
  s_waitcnt lgkmcnt(8)
  v_mfma_f32_32x32x16_bf16 v[144:159], a[24:27], v[84:87], v[144:159]
  ds_read_b64_tr_b16 a[20:21], v1 offset:9728
  ds_read_b64_tr_b16 a[22:23], v1 offset:49664
  v_cvt_pk_bf16_f32 v24, v62, v63
  v_pk_max_i16 v94, v22, 0
  v_pk_max_i16 v95, v24, 0
  v_mfma_f32_32x32x16_bf16 v[160:175], a[28:31], v[84:87], v[160:175]
  ds_read_b64_tr_b16 a[24:25], v2 offset:23552
  ds_read_b64_tr_b16 a[26:27], v2 offset:63488
  s_add_u32 s46, s44, 22528
  buffer_store_dwordx4 v[88:91], v4, s[28:31], s46 offen offset:0 sc1
  v_mfma_f32_32x32x16_bf16 v[176:191], a[0:3], v[80:83], v[176:191]
  ds_read_b64_tr_b16 a[28:29], v2 offset:24064
  ds_read_b64_tr_b16 a[30:31], v2 offset:64000
  s_waitcnt lgkmcnt(8)
  v_mfma_f32_32x32x16_bf16 v[192:207], a[4:7], v[80:83], v[192:207]
  ds_read_b64_tr_b16 a[0:1], v1 offset:10240
  ds_read_b64_tr_b16 a[2:3], v1 offset:50176
  s_add_u32 s46, s44, 22528
  buffer_store_dwordx4 v[92:95], v4, s[28:31], s46 offen offset:1024 sc1
  v_mfma_f32_32x32x16_bf16 v[176:191], a[8:11], v[84:87], v[176:191]
  ds_read_b64_tr_b16 a[4:5], v1 offset:10752
  ds_read_b64_tr_b16 a[6:7], v1 offset:50688
  s_add_u32 s46, s86, 16384
  buffer_load_dwordx4 a[56:59], v4, s[28:31], s46 offen offset:0 sc1
  v_mfma_f32_32x32x16_bf16 v[192:207], a[12:15], v[84:87], v[192:207]
  ds_read_b64_tr_b16 a[8:9], v2 offset:24576
  ds_read_b64_tr_b16 a[10:11], v2 offset:64512
  s_waitcnt lgkmcnt(8)
  v_mfma_f32_32x32x16_bf16 v[112:127], a[16:19], v[88:91], v[112:127]
  ds_read_b64_tr_b16 a[12:13], v2 offset:25088
  ds_read_b64_tr_b16 a[14:15], v2 offset:65024
  v_subrev_u32 v8, s87, v9
  s_lshr_b32 s46, s4, 2
  s_mul_i32 s68, s46, 165888
  s_add_u32 s69, s68, 41472
  s_add_u32 s70, s68, 82944
  s_add_u32 s71, s68, 124416
  v_mfma_f32_32x32x16_bf16 v[128:143], a[20:23], v[88:91], v[128:143]
  ds_read_b64_tr_b16 a[16:17], v1 offset:11264
  ds_read_b64_tr_b16 a[18:19], v1 offset:51200
  v_mfma_f32_32x32x16_bf16 v[112:127], a[24:27], v[92:95], v[112:127]
  ds_read_b64_tr_b16 a[20:21], v1 offset:11776
  ds_read_b64_tr_b16 a[22:23], v1 offset:51712
  s_waitcnt lgkmcnt(8)
  v_mfma_f32_32x32x16_bf16 v[128:143], a[28:31], v[92:95], v[128:143]
  ds_read_b64_tr_b16 a[24:25], v2 offset:25600
  ds_read_b64_tr_b16 a[26:27], v3 offset:0
  v_bfe_u32 v26, v0, 4, 1
  v_bfe_u32 v27, v0, 6, 1
  v_lshl_add_u32 v26, v27, 1, v26
  v_lshl_add_u32 v26, v26, 5, 32
  v_lshrrev_b32 v27, 7, v0
  v_mfma_f32_32x32x16_bf16 v[144:159], a[0:3], v[88:91], v[144:159]
  ds_read_b64_tr_b16 a[28:29], v2 offset:26112
  ds_read_b64_tr_b16 a[30:31], v3 offset:512
  s_add_u32 s46, s86, 16384
  buffer_load_dwordx4 a[60:63], v4, s[28:31], s46 offen offset:1024 sc1
  v_mfma_f32_32x32x16_bf16 v[160:175], a[4:7], v[88:91], v[160:175]
  s_waitcnt vmcnt(28)
  s_barrier
  ds_read_b64_tr_b16 a[0:1], v1 offset:12288
  ds_read_b64_tr_b16 a[2:3], v1 offset:52224
  s_add_u32 m0, s40, 33664
  s_waitcnt lgkmcnt(8)
  v_mfma_f32_32x32x16_bf16 v[144:159], a[8:11], v[92:95], v[144:159]
  buffer_load_dwordx4 v11, s[20:23], s59 offen offset:128  lds
  ds_read_b64_tr_b16 a[4:5], v1 offset:12800
  ds_read_b64_tr_b16 a[6:7], v1 offset:52736
  v_mfma_f32_32x32x16_bf16 v[160:175], a[12:15], v[92:95], v[160:175]
  ds_read_b64_tr_b16 a[8:9], v2 offset:26624
  ds_read_b64_tr_b16 a[10:11], v3 offset:1024
  v_mul_u32_u24 v26, 1152, v26
  v_mul_u32_u24 v27, 18304, v27
  v_add_u32 v26, v26, v8
  v_sub_u32 v10, v26, v27
  v_mfma_f32_32x32x16_bf16 v[176:191], a[16:19], v[88:91], v[176:191]
  ds_read_b64_tr_b16 a[12:13], v2 offset:27136
  ds_read_b64_tr_b16 a[14:15], v3 offset:1536
  s_add_u32 m0, s40, 34560
  s_waitcnt lgkmcnt(8)
  v_mfma_f32_32x32x16_bf16 v[192:207], a[20:23], v[88:91], v[192:207]
  buffer_load_dwordx4 v11, s[20:23], s59 offen offset:256  lds
  ds_read_b64_tr_b16 a[16:17], v1 offset:13312
  ds_read_b64_tr_b16 a[18:19], v1 offset:53248
  v_mfma_f32_32x32x16_bf16 v[176:191], a[24:27], v[92:95], v[176:191]
  ds_read_b64_tr_b16 a[20:21], v1 offset:13824
  ds_read_b64_tr_b16 a[22:23], v1 offset:53760
  s_add_u32 s46, s45, 14336
  buffer_load_dwordx4 a[64:67], v4, s[28:31], s46 offen offset:0 sc1
  v_mfma_f32_32x32x16_bf16 v[192:207], a[28:31], v[92:95], v[192:207]
  ds_read_b64_tr_b16 a[24:25], v2 offset:27648
  ds_read_b64_tr_b16 a[26:27], v3 offset:2048
  s_add_u32 m0, s40, 35840
  s_waitcnt vmcnt(24) lgkmcnt(8)
  v_mfma_f32_32x32x16_bf16 v[112:127], a[0:3], a[32:35], v[112:127]
  buffer_load_dwordx4 v11, s[20:23], s52 offen  lds
  ds_read_b64_tr_b16 a[28:29], v2 offset:28160
  ds_read_b64_tr_b16 a[30:31], v3 offset:2560
  v_mfma_f32_32x32x16_bf16 v[128:143], a[4:7], a[32:35], v[128:143]
  ds_read_b64_tr_b16 a[0:1], v1 offset:14336
  ds_read_b64_tr_b16 a[2:3], v1 offset:54272
  s_waitcnt vmcnt(22)
  v_mfma_f32_32x32x16_bf16 v[112:127], a[8:11], a[36:39], v[112:127]
  ds_read_b64_tr_b16 a[4:5], v1 offset:14848
  ds_read_b64_tr_b16 a[6:7], v1 offset:54784
  s_add_u32 m0, s40, 36736
  s_waitcnt lgkmcnt(8)
  v_mfma_f32_32x32x16_bf16 v[128:143], a[12:15], a[36:39], v[128:143]
  buffer_load_dwordx4 v11, s[20:23], s52 offen offset:128  lds
  ds_read_b64_tr_b16 a[8:9], v2 offset:28672
  ds_read_b64_tr_b16 a[10:11], v3 offset:3072
  v_mfma_f32_32x32x16_bf16 v[144:159], a[16:19], a[32:35], v[144:159]
  ds_read_b64_tr_b16 a[12:13], v2 offset:29184
  ds_read_b64_tr_b16 a[14:15], v3 offset:3584
  s_add_u32 s46, s45, 14336
  buffer_load_dwordx4 a[68:71], v4, s[28:31], s46 offen offset:1024 sc1
  v_mfma_f32_32x32x16_bf16 v[160:175], a[20:23], a[32:35], v[160:175]
  ds_read_b64_tr_b16 a[16:17], v1 offset:15360
  ds_read_b64_tr_b16 a[18:19], v1 offset:55296
  s_add_u32 m0, s40, 37632
  s_waitcnt lgkmcnt(8)
  v_mfma_f32_32x32x16_bf16 v[144:159], a[24:27], a[36:39], v[144:159]
  buffer_load_dwordx4 v11, s[20:23], s52 offen offset:256  lds
  ds_read_b64_tr_b16 a[20:21], v1 offset:15872
  ds_read_b64_tr_b16 a[22:23], v1 offset:55808
  v_mfma_f32_32x32x16_bf16 v[160:175], a[28:31], a[36:39], v[160:175]
  ds_read_b64_tr_b16 a[24:25], v2 offset:29696
  ds_read_b64_tr_b16 a[26:27], v3 offset:4096
  v_and_b32 v20, 15, v0
  v_lshlrev_b32 v18, 4, v20
  v_and_b32 v21, 48, v0
  v_lshl_add_u32 v18, v21, 6, v18
  s_lshl_b32 s46, s6, 8
  v_add_u32 v18, s46, v18
  v_mfma_f32_32x32x16_bf16 v[176:191], a[0:3], a[32:35], v[176:191]
  ds_read_b64_tr_b16 a[28:29], v2 offset:30208
  ds_read_b64_tr_b16 a[30:31], v3 offset:4608
  s_add_u32 m0, s40, 38912
  s_waitcnt lgkmcnt(8)
  v_mfma_f32_32x32x16_bf16 v[192:207], a[4:7], a[32:35], v[192:207]
  buffer_load_dwordx4 v12, s[20:23], s53 offen  lds
  ds_read_b64_tr_b16 a[0:1], v1 offset:16384
  ds_read_b64_tr_b16 a[2:3], v1 offset:56320
  buffer_load_dword v17, v15, s[28:31], s43 offen sc1
  v_mfma_f32_32x32x16_bf16 v[176:191], a[8:11], a[36:39], v[176:191]
  ds_read_b64_tr_b16 a[4:5], v1 offset:16896
  ds_read_b64_tr_b16 a[6:7], v1 offset:56832
  s_add_u32 s46, s45, 16384
  buffer_load_dwordx4 a[72:75], v4, s[28:31], s46 offen offset:0 sc1
  v_mfma_f32_32x32x16_bf16 v[192:207], a[12:15], a[36:39], v[192:207]
  ds_read_b64_tr_b16 a[8:9], v2 offset:30720
  ds_read_b64_tr_b16 a[10:11], v3 offset:5120
  s_add_u32 m0, s40, -128
  s_waitcnt vmcnt(24) lgkmcnt(8)
  v_mfma_f32_32x32x16_bf16 v[112:127], a[16:19], a[40:43], v[112:127]
  buffer_load_dwordx4 v12, s[20:23], s53 offen offset:128  lds
  ds_read_b64_tr_b16 a[12:13], v2 offset:31232
  ds_read_b64_tr_b16 a[14:15], v3 offset:5632
  v_mfma_f32_32x32x16_bf16 v[128:143], a[20:23], a[40:43], v[128:143]
  ds_read_b64_tr_b16 a[16:17], v1 offset:17408
  ds_read_b64_tr_b16 a[18:19], v1 offset:57344
  v_and_b32 v22, 24, v0
  v_and_b32 v19, 32, v0
  v_lshl_add_u32 v22, v19, 2, v22
  s_lshl_b32 s46, s6, 5
  v_add_u32 v22, s46, v22
  s_waitcnt vmcnt(21)
  v_mfma_f32_32x32x16_bf16 v[112:127], a[24:27], a[44:47], v[112:127]
  ds_read_b64_tr_b16 a[20:21], v1 offset:17920
  ds_read_b64_tr_b16 a[22:23], v1 offset:57856
  s_add_u32 m0, s40, 768
  s_waitcnt lgkmcnt(8)
  v_mfma_f32_32x32x16_bf16 v[128:143], a[28:31], a[44:47], v[128:143]
  buffer_load_dwordx4 v12, s[20:23], s53 offen offset:256  lds
  ds_read_b64_tr_b16 a[24:25], v2 offset:31744
  ds_read_b64_tr_b16 a[26:27], v3 offset:6144
  v_mfma_f32_32x32x16_bf16 v[144:159], a[0:3], a[40:43], v[144:159]
  ds_read_b64_tr_b16 a[28:29], v2 offset:32256
  ds_read_b64_tr_b16 a[30:31], v3 offset:6656
  s_add_u32 s46, s45, 16384
  buffer_load_dwordx4 a[76:79], v4, s[28:31], s46 offen offset:1024 sc1
  v_mfma_f32_32x32x16_bf16 v[160:175], a[4:7], a[40:43], v[160:175]
  ds_read_b64_tr_b16 a[0:1], v1 offset:18432
  ds_read_b64_tr_b16 a[2:3], v1 offset:58368
  s_add_u32 m0, s40, 2048
  s_waitcnt lgkmcnt(8)
  v_mfma_f32_32x32x16_bf16 v[144:159], a[8:11], a[44:47], v[144:159]
  buffer_load_dwordx4 v12, s[20:23], s54 offen  lds
  ds_read_b64_tr_b16 a[4:5], v1 offset:18944
  ds_read_b64_tr_b16 a[6:7], v1 offset:58880
  v_mfma_f32_32x32x16_bf16 v[160:175], a[12:15], a[44:47], v[160:175]
  ds_read_b64_tr_b16 a[8:9], v2 offset:32768
  ds_read_b64_tr_b16 a[10:11], v3 offset:7168
  v_and_b32 v19, 7, v0
  v_mul_u32_u24 v19, 1152, v19
  s_lshl_b32 s46, s5, 4
  s_add_u32 s46, s46, s4
  s_mul_i32 s46, s46, 9216
  v_add3_u32 v19, v19, v22, s46
  v_mfma_f32_32x32x16_bf16 v[176:191], a[16:19], a[40:43], v[176:191]
  ds_read_b64_tr_b16 a[12:13], v2 offset:33280
  ds_read_b64_tr_b16 a[14:15], v3 offset:7680
  s_add_u32 m0, s40, 2944
  s_waitcnt lgkmcnt(8)
  v_mfma_f32_32x32x16_bf16 v[192:207], a[20:23], a[40:43], v[192:207]
  buffer_load_dwordx4 v12, s[20:23], s54 offen offset:128  lds
  ds_read_b64_tr_b16 a[16:17], v1 offset:19456
  ds_read_b64_tr_b16 a[18:19], v1 offset:59392
  v_mfma_f32_32x32x16_bf16 v[176:191], a[24:27], a[44:47], v[176:191]
  ds_read_b64_tr_b16 a[20:21], v1 offset:19968
  ds_read_b64_tr_b16 a[22:23], v1 offset:59904
  s_add_u32 s46, s86, 0
  buffer_load_dwordx4 a[80:83], v4, s[28:31], s46 offen offset:0 sc1
  v_mfma_f32_32x32x16_bf16 v[192:207], a[28:31], a[44:47], v[192:207]
  ds_read_b64_tr_b16 a[24:25], v2 offset:33792
  ds_read_b64_tr_b16 a[26:27], v3 offset:8192
  s_add_u32 m0, s40, 3840
  s_waitcnt vmcnt(23) lgkmcnt(8)
  v_mfma_f32_32x32x16_bf16 v[112:127], a[0:3], a[48:51], v[112:127]
  buffer_load_dwordx4 v12, s[20:23], s54 offen offset:256  lds
  ds_read_b64_tr_b16 a[28:29], v2 offset:34304
  ds_read_b64_tr_b16 a[30:31], v3 offset:8704
  v_mfma_f32_32x32x16_bf16 v[128:143], a[4:7], a[48:51], v[128:143]
  ds_read_b64_tr_b16 a[0:1], v1 offset:20480
  ds_read_b64_tr_b16 a[2:3], v1 offset:60416
  v_and_b32 v21, 12, v0
  v_mul_u32_u24 v21, 4348, v21
  v_lshl_add_u32 v20, v20, 2, v21
  s_mul_i32 s89, s5, 589824
  s_lshl_b32 s46, s4, 12
  s_add_u32 s89, s89, s46
  s_waitcnt vmcnt(21)
  v_mfma_f32_32x32x16_bf16 v[112:127], a[8:11], a[52:55], v[112:127]
  ds_read_b64_tr_b16 a[4:5], v1 offset:20992
  ds_read_b64_tr_b16 a[6:7], v1 offset:60928
  s_add_u32 m0, s40, 5120
  s_waitcnt lgkmcnt(8)
  v_mfma_f32_32x32x16_bf16 v[128:143], a[12:15], a[52:55], v[128:143]
  buffer_load_dwordx4 v11, s[20:23], s53 offen  lds
  ds_read_b64_tr_b16 a[8:9], v2 offset:34816
  ds_read_b64_tr_b16 a[10:11], v3 offset:9216
  v_mfma_f32_32x32x16_bf16 v[144:159], a[16:19], a[48:51], v[144:159]
  ds_read_b64_tr_b16 a[12:13], v2 offset:35328
  ds_read_b64_tr_b16 a[14:15], v3 offset:9728
  s_add_u32 s46, s86, 0
  buffer_load_dwordx4 a[84:87], v4, s[28:31], s46 offen offset:1024 sc1
  v_mfma_f32_32x32x16_bf16 v[160:175], a[20:23], a[48:51], v[160:175]
  ds_read_b64_tr_b16 a[16:17], v1 offset:21504
  ds_read_b64_tr_b16 a[18:19], v1 offset:61440
  s_waitcnt lgkmcnt(8)
  v_mfma_f32_32x32x16_bf16 v[144:159], a[24:27], a[52:55], v[144:159]
  ds_read_b64_tr_b16 a[20:21], v1 offset:22016
  ds_read_b64_tr_b16 a[22:23], v1 offset:61952
  s_lshl_b32 s88, s5, 4
  s_lshr_b32 s46, s4, 2
  s_add_u32 s88, s88, s46
  s_mul_i32 s88, s88, 4352
  s_add_u32 s88, s88, 46139392
  s_cmp_eq_u32 s6, 0
  s_cselect_b32 s88, s88, 1879048192
FF_H7:
  s_cbranch_execz FF_H11
  v_mfma_f32_32x32x16_bf16 v[160:175], a[28:31], a[52:55], v[160:175]
  ds_read_b64_tr_b16 a[24:25], v2 offset:35840
  ds_read_b64_tr_b16 a[26:27], v3 offset:10240
  v_mfma_f32_32x32x16_bf16 v[176:191], a[0:3], a[48:51], v[176:191]
  ds_read_b64_tr_b16 a[28:29], v2 offset:36352
  ds_read_b64_tr_b16 a[30:31], v3 offset:10752
  s_mov_b32 s74, 0x7777
  s_bitset0_b32 s74, s4
  s_waitcnt lgkmcnt(8)
  v_mfma_f32_32x32x16_bf16 v[192:207], a[4:7], a[48:51], v[192:207]
  ds_read_b64_tr_b16 a[0:1], v1 offset:22528
  ds_read_b64_tr_b16 a[2:3], v1 offset:62464
  v_mfma_f32_32x32x16_bf16 v[176:191], a[8:11], a[52:55], v[176:191]
  ds_read_b64_tr_b16 a[4:5], v1 offset:23040
  ds_read_b64_tr_b16 a[6:7], v1 offset:62976
  s_add_u32 s46, s86, 2048
  buffer_load_dwordx4 a[88:91], v4, s[28:31], s46 offen offset:0 sc1
  v_mfma_f32_32x32x16_bf16 v[192:207], a[12:15], a[52:55], v[192:207]
  ds_read_b64_tr_b16 a[8:9], v2 offset:36864
  ds_read_b64_tr_b16 a[10:11], v3 offset:11264
  s_waitcnt vmcnt(21) lgkmcnt(8)
  v_mfma_f32_32x32x16_bf16 v[112:127], a[16:19], a[56:59], v[112:127]
  ds_read_b64_tr_b16 a[12:13], v2 offset:37376
  ds_read_b64_tr_b16 a[14:15], v3 offset:11776
  v_mfma_f32_32x32x16_bf16 v[128:143], a[20:23], a[56:59], v[128:143]
  ds_read_b64_tr_b16 a[16:17], v1 offset:23552
  ds_read_b64_tr_b16 a[18:19], v1 offset:63488
  s_waitcnt vmcnt(20)
  v_mfma_f32_32x32x16_bf16 v[112:127], a[24:27], a[60:63], v[112:127]
  ds_read_b64_tr_b16 a[20:21], v1 offset:24064
  ds_read_b64_tr_b16 a[22:23], v1 offset:64000
  s_waitcnt lgkmcnt(8)
  v_mfma_f32_32x32x16_bf16 v[128:143], a[28:31], a[60:63], v[128:143]
  ds_read_b64_tr_b16 a[24:25], v2 offset:37888
  ds_read_b64_tr_b16 a[26:27], v3 offset:12288
  v_mfma_f32_32x32x16_bf16 v[144:159], a[0:3], a[56:59], v[144:159]
  ds_read_b64_tr_b16 a[28:29], v2 offset:38400
  ds_read_b64_tr_b16 a[30:31], v3 offset:12800
  s_add_u32 s46, s86, 2048
  buffer_load_dwordx4 a[92:95], v4, s[28:31], s46 offen offset:1024 sc1
  v_mfma_f32_32x32x16_bf16 v[160:175], a[4:7], a[56:59], v[160:175]
  s_barrier
  ds_read_b64_tr_b16 a[0:1], v1 offset:24576
  ds_read_b64_tr_b16 a[2:3], v1 offset:64512
  s_add_u32 m0, s40, 6016
  s_waitcnt lgkmcnt(8)
  v_mfma_f32_32x32x16_bf16 v[144:159], a[8:11], a[60:63], v[144:159]
  buffer_load_dwordx4 v11, s[20:23], s53 offen offset:128  lds
  ds_read_b64_tr_b16 a[4:5], v1 offset:25088
  ds_read_b64_tr_b16 a[6:7], v1 offset:65024
  v_mov_b32 v14, 3
  buffer_store_dword v14, off, s[28:31], s42 sc1
  v_mfma_f32_32x32x16_bf16 v[160:175], a[12:15], a[60:63], v[160:175]
  ds_read_b64_tr_b16 a[8:9], v2 offset:38912
  ds_read_b64_tr_b16 a[10:11], v3 offset:13312
  v_mfma_f32_32x32x16_bf16 v[176:191], a[16:19], a[56:59], v[176:191]
  ds_read_b64_tr_b16 a[12:13], v2 offset:39424
  ds_read_b64_tr_b16 a[14:15], v3 offset:13824
  s_add_u32 m0, s40, 6912
  s_waitcnt lgkmcnt(8)
  v_mfma_f32_32x32x16_bf16 v[192:207], a[20:23], a[56:59], v[192:207]
  buffer_load_dwordx4 v11, s[20:23], s53 offen offset:256  lds
  ds_read_b64_tr_b16 a[16:17], v1 offset:25600
  ds_read_b64_tr_b16 a[18:19], v2 offset:0
  v_mfma_f32_32x32x16_bf16 v[176:191], a[24:27], a[60:63], v[176:191]
  ds_read_b64_tr_b16 a[20:21], v1 offset:26112
  ds_read_b64_tr_b16 a[22:23], v2 offset:512
  v_mfma_f32_32x32x16_bf16 v[192:207], a[28:31], a[60:63], v[192:207]
  ds_read_b64_tr_b16 a[24:25], v2 offset:39936
  ds_read_b64_tr_b16 a[26:27], v3 offset:14336
  s_add_u32 m0, s40, 8192
  s_waitcnt vmcnt(21) lgkmcnt(8)
  v_mfma_f32_32x32x16_bf16 v[112:127], a[0:3], a[64:67], v[112:127]
  buffer_load_dwordx4 v11, s[20:23], s54 offen  lds
  ds_read_b64_tr_b16 a[28:29], v2 offset:40448
  ds_read_b64_tr_b16 a[30:31], v3 offset:14848
  v_mfma_f32_32x32x16_bf16 v[128:143], a[4:7], a[64:67], v[128:143]
  ds_read_b64_tr_b16 a[0:1], v1 offset:26624
  ds_read_b64_tr_b16 a[2:3], v2 offset:1024
  s_waitcnt vmcnt(19)
  v_mfma_f32_32x32x16_bf16 v[112:127], a[8:11], a[68:71], v[112:127]
  ds_read_b64_tr_b16 a[4:5], v1 offset:27136
  ds_read_b64_tr_b16 a[6:7], v2 offset:1536
  s_add_u32 m0, s40, 9088
  s_waitcnt lgkmcnt(8)
  v_mfma_f32_32x32x16_bf16 v[128:143], a[12:15], a[68:71], v[128:143]
  buffer_load_dwordx4 v11, s[20:23], s54 offen offset:128  lds
  ds_read_b64_tr_b16 a[8:9], v2 offset:40960
  ds_read_b64_tr_b16 a[10:11], v3 offset:15360
  v_mfma_f32_32x32x16_bf16 v[144:159], a[16:19], a[64:67], v[144:159]
  ds_read_b64_tr_b16 a[12:13], v2 offset:41472
  ds_read_b64_tr_b16 a[14:15], v3 offset:15872
  v_mfma_f32_32x32x16_bf16 v[160:175], a[20:23], a[64:67], v[160:175]
  ds_read_b64_tr_b16 a[16:17], v1 offset:27648
  ds_read_b64_tr_b16 a[18:19], v2 offset:2048
  s_add_u32 m0, s40, 9984
  s_waitcnt lgkmcnt(8)
  v_mfma_f32_32x32x16_bf16 v[144:159], a[24:27], a[68:71], v[144:159]
  buffer_load_dwordx4 v11, s[20:23], s54 offen offset:256  lds
  ds_read_b64_tr_b16 a[20:21], v1 offset:28160
  ds_read_b64_tr_b16 a[22:23], v2 offset:2560
  v_mfma_f32_32x32x16_bf16 v[160:175], a[28:31], a[68:71], v[160:175]
  ds_read_b64_tr_b16 a[24:25], v2 offset:41984
  ds_read_b64_tr_b16 a[26:27], v3 offset:16384
  s_waitcnt vmcnt(18)
  v_cmp_gt_u32 vcc, 2, v17
  s_nop 4
  s_and_b32 s46, vcc_lo, 7
  s_cbranch_scc1 FF_SP2
FF_SP2_B:
  s_add_u32 s46, s45, 18432
  buffer_load_dwordx4 a[96:99], v4, s[28:31], s46 offen offset:0 sc1
  v_mfma_f32_32x32x16_bf16 v[176:191], a[0:3], a[64:67], v[176:191]
  ds_read_b64_tr_b16 a[28:29], v2 offset:42496
  ds_read_b64_tr_b16 a[30:31], v3 offset:16896
  s_add_u32 m0, s40, 11264
  s_waitcnt lgkmcnt(8)
  v_mfma_f32_32x32x16_bf16 v[192:207], a[4:7], a[64:67], v[192:207]
  buffer_load_dwordx4 v12, s[20:23], s59 offen  lds
  ds_read_b64_tr_b16 a[0:1], v1 offset:28672
  ds_read_b64_tr_b16 a[2:3], v2 offset:3072
  v_mfma_f32_32x32x16_bf16 v[176:191], a[8:11], a[68:71], v[176:191]
  ds_read_b64_tr_b16 a[4:5], v1 offset:29184
  ds_read_b64_tr_b16 a[6:7], v2 offset:3584
  v_mfma_f32_32x32x16_bf16 v[192:207], a[12:15], a[68:71], v[192:207]
  ds_read_b64_tr_b16 a[8:9], v2 offset:43008
  ds_read_b64_tr_b16 a[10:11], v3 offset:17408
  s_add_u32 m0, s40, 12160
  s_waitcnt vmcnt(19) lgkmcnt(8)
  v_mfma_f32_32x32x16_bf16 v[112:127], a[16:19], a[72:75], v[112:127]
  buffer_load_dwordx4 v12, s[20:23], s59 offen offset:128  lds
  ds_read_b64_tr_b16 a[12:13], v2 offset:43520
  ds_read_b64_tr_b16 a[14:15], v3 offset:17920
  v_mfma_f32_32x32x16_bf16 v[128:143], a[20:23], a[72:75], v[128:143]
  ds_read_b64_tr_b16 a[16:17], v1 offset:29696
  ds_read_b64_tr_b16 a[18:19], v2 offset:4096
  s_add_u32 s46, s45, 18432
  buffer_load_dwordx4 a[100:103], v4, s[28:31], s46 offen offset:1024 sc1
  s_waitcnt vmcnt(18)
  v_mfma_f32_32x32x16_bf16 v[112:127], a[24:27], a[76:79], v[112:127]
  ds_read_b64_tr_b16 a[20:21], v1 offset:30208
  ds_read_b64_tr_b16 a[22:23], v2 offset:4608
  s_add_u32 m0, s40, 13056
  s_waitcnt lgkmcnt(8)
  v_mfma_f32_32x32x16_bf16 v[128:143], a[28:31], a[76:79], v[128:143]
  buffer_load_dwordx4 v12, s[20:23], s59 offen offset:256  lds
  ds_read_b64_tr_b16 a[24:25], v2 offset:44032
  ds_read_b64_tr_b16 a[26:27], v3 offset:18432
  v_mfma_f32_32x32x16_bf16 v[144:159], a[0:3], a[72:75], v[144:159]
  ds_read_b64_tr_b16 a[28:29], v2 offset:44544
  ds_read_b64_tr_b16 a[30:31], v3 offset:18944
  v_mfma_f32_32x32x16_bf16 v[160:175], a[4:7], a[72:75], v[160:175]
  ds_read_b64_tr_b16 a[0:1], v1 offset:30720
  ds_read_b64_tr_b16 a[2:3], v2 offset:5120
  s_add_u32 m0, s40, 14336
  s_waitcnt lgkmcnt(8)
  v_mfma_f32_32x32x16_bf16 v[144:159], a[8:11], a[76:79], v[144:159]
  buffer_load_dwordx4 v12, s[20:23], s52 offen  lds
  ds_read_b64_tr_b16 a[4:5], v1 offset:31232
  ds_read_b64_tr_b16 a[6:7], v2 offset:5632
  v_mfma_f32_32x32x16_bf16 v[160:175], a[12:15], a[76:79], v[160:175]
  ds_read_b64_tr_b16 a[8:9], v2 offset:45056
  ds_read_b64_tr_b16 a[10:11], v3 offset:19456
  s_add_u32 s46, s45, 4096
  buffer_load_dwordx4 a[104:107], v4, s[28:31], s46 offen offset:0 sc1
  v_mfma_f32_32x32x16_bf16 v[176:191], a[16:19], a[72:75], v[176:191]
  ds_read_b64_tr_b16 a[12:13], v2 offset:45568
  ds_read_b64_tr_b16 a[14:15], v3 offset:19968
  s_add_u32 m0, s40, 15232
  s_waitcnt lgkmcnt(8)
  v_mfma_f32_32x32x16_bf16 v[192:207], a[20:23], a[72:75], v[192:207]
  buffer_load_dwordx4 v12, s[20:23], s52 offen offset:128  lds
  ds_read_b64_tr_b16 a[16:17], v1 offset:31744
  ds_read_b64_tr_b16 a[18:19], v2 offset:6144
  v_mfma_f32_32x32x16_bf16 v[176:191], a[24:27], a[76:79], v[176:191]
  ds_read_b64_tr_b16 a[20:21], v1 offset:32256
  ds_read_b64_tr_b16 a[22:23], v2 offset:6656
  v_mfma_f32_32x32x16_bf16 v[192:207], a[28:31], a[76:79], v[192:207]
  ds_read_b64_tr_b16 a[24:25], v2 offset:46080
  ds_read_b64_tr_b16 a[26:27], v3 offset:20480
  s_add_u32 m0, s40, 16128
  s_waitcnt vmcnt(19) lgkmcnt(8)
  v_mfma_f32_32x32x16_bf16 v[112:127], a[0:3], a[80:83], v[112:127]
  buffer_load_dwordx4 v12, s[20:23], s52 offen offset:256  lds
  ds_read_b64_tr_b16 a[28:29], v2 offset:46592
  ds_read_b64_tr_b16 a[30:31], v3 offset:20992
  v_mfma_f32_32x32x16_bf16 v[128:143], a[4:7], a[80:83], v[128:143]
  ds_read_b64_tr_b16 a[0:1], v1 offset:32768
  ds_read_b64_tr_b16 a[2:3], v2 offset:7168
  s_add_u32 s46, s45, 4096
  buffer_load_dwordx4 a[108:111], v4, s[28:31], s46 offen offset:1024 sc1
  s_waitcnt vmcnt(18)
  v_mfma_f32_32x32x16_bf16 v[112:127], a[8:11], a[84:87], v[112:127]
  ds_read_b64_tr_b16 a[4:5], v1 offset:33280
  ds_read_b64_tr_b16 a[6:7], v2 offset:7680
  s_add_u32 m0, s40, 17408
  s_waitcnt lgkmcnt(8)
  v_mfma_f32_32x32x16_bf16 v[128:143], a[12:15], a[84:87], v[128:143]
  buffer_load_dwordx4 v11, s[20:23], s55 offen  lds
  ds_read_b64_tr_b16 a[8:9], v2 offset:47104
  ds_read_b64_tr_b16 a[10:11], v3 offset:21504
  v_mfma_f32_32x32x16_bf16 v[144:159], a[16:19], a[80:83], v[144:159]
  ds_read_b64_tr_b16 a[12:13], v2 offset:47616
  ds_read_b64_tr_b16 a[14:15], v3 offset:22016
  v_and_b32 v23, 15, v0
  v_and_b32 v24, 1, v0
  v_lshlrev_b32 v24, 4, v24
  v_mov_b32 v25, 0x3f80
  v_lshlrev_b32 v24, v24, v25
  v_lshrrev_b32 v23, 1, v23
  v_mfma_f32_32x32x16_bf16 v[160:175], a[20:23], a[80:83], v[160:175]
  ds_read_b64_tr_b16 a[16:17], v1 offset:33792
  ds_read_b64_tr_b16 a[18:19], v2 offset:8192
  s_waitcnt lgkmcnt(8)
  v_mfma_f32_32x32x16_bf16 v[144:159], a[24:27], a[84:87], v[144:159]
  ds_read_b64_tr_b16 a[20:21], v1 offset:34304
  ds_read_b64_tr_b16 a[22:23], v2 offset:8704
  v_cmp_eq_u32 vcc, 0, v23
  v_cmp_eq_u32 s[46:47], 1, v23
  s_nop 0
  v_cndmask_b32 v25, 0, v24, vcc
  v_cndmask_b32 v26, 0, v24, s[46:47]
  v_accvgpr_write_b32 a32, v25
  v_accvgpr_write_b32 a33, v26
  v_mfma_f32_32x32x16_bf16 v[160:175], a[28:31], a[84:87], v[160:175]
  ds_read_b64_tr_b16 a[24:25], v2 offset:48128
  ds_read_b64_tr_b16 a[26:27], v3 offset:22528
  s_add_u32 s46, s86, 6144
  buffer_load_dwordx4 a[112:115], v4, s[28:31], s46 offen offset:0 sc1
  v_mfma_f32_32x32x16_bf16 v[176:191], a[0:3], a[80:83], v[176:191]
  ds_read_b64_tr_b16 a[28:29], v2 offset:48640
  ds_read_b64_tr_b16 a[30:31], v3 offset:23040
  s_waitcnt lgkmcnt(8)
  v_mfma_f32_32x32x16_bf16 v[192:207], a[4:7], a[80:83], v[192:207]
  ds_read_b64_tr_b16 a[0:1], v1 offset:34816
  ds_read_b64_tr_b16 a[2:3], v2 offset:9216
  v_cmp_eq_u32 vcc, 2, v23
  v_cmp_eq_u32 s[46:47], 3, v23
  s_nop 0
  v_cndmask_b32 v25, 0, v24, vcc
  v_cndmask_b32 v26, 0, v24, s[46:47]
  v_accvgpr_write_b32 a34, v25
  v_accvgpr_write_b32 a35, v26
  v_mfma_f32_32x32x16_bf16 v[176:191], a[8:11], a[84:87], v[176:191]
  ds_read_b64_tr_b16 a[4:5], v1 offset:35328
  ds_read_b64_tr_b16 a[6:7], v2 offset:9728
  v_mfma_f32_32x32x16_bf16 v[192:207], a[12:15], a[84:87], v[192:207]
  ds_read_b64_tr_b16 a[8:9], v2 offset:49152
  ds_read_b64_tr_b16 a[10:11], v3 offset:23552
  s_waitcnt vmcnt(19) lgkmcnt(8)
  v_mfma_f32_32x32x16_bf16 v[112:127], a[16:19], a[88:91], v[112:127]
  ds_read_b64_tr_b16 a[12:13], v2 offset:49664
  ds_read_b64_tr_b16 a[14:15], v3 offset:24064
  v_cmp_eq_u32 vcc, 4, v23
  v_cmp_eq_u32 s[46:47], 5, v23
  s_nop 0
  v_cndmask_b32 v25, 0, v24, vcc
  v_cndmask_b32 v26, 0, v24, s[46:47]
  v_accvgpr_write_b32 a36, v25
  v_accvgpr_write_b32 a37, v26
  v_mfma_f32_32x32x16_bf16 v[128:143], a[20:23], a[88:91], v[128:143]
  ds_read_b64_tr_b16 a[16:17], v1 offset:35840
  ds_read_b64_tr_b16 a[18:19], v2 offset:10240
  s_add_u32 s46, s86, 6144
  buffer_load_dwordx4 a[116:119], v4, s[28:31], s46 offen offset:1024 sc1
  s_waitcnt vmcnt(19)
  v_mfma_f32_32x32x16_bf16 v[112:127], a[24:27], a[92:95], v[112:127]
  ds_read_b64_tr_b16 a[20:21], v1 offset:36352
  ds_read_b64_tr_b16 a[22:23], v2 offset:10752
  s_waitcnt lgkmcnt(8)
  v_mfma_f32_32x32x16_bf16 v[128:143], a[28:31], a[92:95], v[128:143]
  ds_read_b64_tr_b16 a[24:25], v2 offset:50176
  ds_read_b64_tr_b16 a[26:27], v3 offset:24576
  v_cmp_eq_u32 vcc, 6, v23
  v_cmp_eq_u32 s[46:47], 7, v23
  s_nop 0
  v_cndmask_b32 v25, 0, v24, vcc
  v_cndmask_b32 v26, 0, v24, s[46:47]
  v_accvgpr_write_b32 a38, v25
  v_accvgpr_write_b32 a39, v26
  v_mfma_f32_32x32x16_bf16 v[144:159], a[0:3], a[88:91], v[144:159]
  ds_read_b64_tr_b16 a[28:29], v2 offset:50688
  ds_read_b64_tr_b16 a[30:31], v3 offset:25088
  v_mfma_f32_32x32x16_bf16 v[160:175], a[4:7], a[88:91], v[160:175]
  s_barrier
  ds_read_b64_tr_b16 a[0:1], v1 offset:36864
  ds_read_b64_tr_b16 a[2:3], v2 offset:11264
  s_add_u32 m0, s40, 18304
  s_waitcnt lgkmcnt(8)
  v_mfma_f32_32x32x16_bf16 v[144:159], a[8:11], a[92:95], v[144:159]
  buffer_load_dwordx4 v11, s[20:23], s55 offen offset:128  lds
  ds_read_b64_tr_b16 a[4:5], v1 offset:37376
  ds_read_b64_tr_b16 a[6:7], v2 offset:11776
  v_mfma_f32_32x32x16_bf16 v[160:175], a[12:15], a[92:95], v[160:175]
  ds_read_b64_tr_b16 a[8:9], v2 offset:51200
  ds_read_b64_tr_b16 a[10:11], v3 offset:25600
  s_add_u32 s46, s86, 8192
  buffer_load_dwordx4 a[120:123], v4, s[28:31], s46 offen offset:0 sc1
  v_mfma_f32_32x32x16_bf16 v[176:191], a[16:19], a[88:91], v[176:191]
  ds_read_b64_tr_b16 a[12:13], v2 offset:51712
  ds_read_b64_tr_b16 a[14:15], v3 offset:26112
  s_add_u32 m0, s40, 19200
  s_waitcnt lgkmcnt(8)
  v_mfma_f32_32x32x16_bf16 v[192:207], a[20:23], a[88:91], v[192:207]
  buffer_load_dwordx4 v11, s[20:23], s55 offen offset:256  lds
  ds_read_b64_tr_b16 a[16:17], v1 offset:37888
  ds_read_b64_tr_b16 a[18:19], v2 offset:12288
  v_mfma_f32_32x32x16_bf16 v[176:191], a[24:27], a[92:95], v[176:191]
  ds_read_b64_tr_b16 a[20:21], v1 offset:38400
  ds_read_b64_tr_b16 a[22:23], v2 offset:12800
  v_mfma_f32_32x32x16_bf16 v[192:207], a[28:31], a[92:95], v[192:207]
  ds_read_b64_tr_b16 a[24:25], v2 offset:52224
  ds_read_b64_tr_b16 a[26:27], v3 offset:26624
  s_add_u32 m0, s40, 20480
  s_waitcnt vmcnt(15) lgkmcnt(8)
  v_mfma_f32_32x32x16_bf16 v[112:127], a[0:3], a[96:99], v[112:127]
  buffer_load_dwordx4 v11, s[20:23], s56 offen  lds
  ds_read_b64_tr_b16 a[28:29], v2 offset:52736
  ds_read_b64_tr_b16 a[30:31], v3 offset:27136
  v_mfma_f32_32x32x16_bf16 v[128:143], a[4:7], a[96:99], v[128:143]
  ds_read_b64_tr_b16 a[0:1], v1 offset:38912
  ds_read_b64_tr_b16 a[2:3], v2 offset:13312
  s_add_u32 s46, s86, 8192
  buffer_load_dwordx4 a[124:127], v4, s[28:31], s46 offen offset:1024 sc1
  s_waitcnt vmcnt(14)
  v_mfma_f32_32x32x16_bf16 v[112:127], a[8:11], a[100:103], v[112:127]
  ds_read_b64_tr_b16 a[4:5], v1 offset:39424
  ds_read_b64_tr_b16 a[6:7], v2 offset:13824
  s_add_u32 m0, s40, 21376
  s_waitcnt lgkmcnt(8)
  v_mfma_f32_32x32x16_bf16 v[128:143], a[12:15], a[100:103], v[128:143]
  buffer_load_dwordx4 v11, s[20:23], s56 offen offset:128  lds
  ds_read_b64_tr_b16 a[8:9], v2 offset:53248
  ds_read_b64_tr_b16 a[10:11], v3 offset:27648
  v_mfma_f32_32x32x16_bf16 v[144:159], a[16:19], a[96:99], v[144:159]
  ds_read_b64_tr_b16 a[12:13], v2 offset:53760
  ds_read_b64_tr_b16 a[14:15], v3 offset:28160
  v_mfma_f32_32x32x16_bf16 v[160:175], a[20:23], a[96:99], v[160:175]
  ds_read_b64_tr_b16 a[16:17], v1 offset:39936
  ds_read_b64_tr_b16 a[18:19], v2 offset:14336
  s_add_u32 m0, s40, 22272
  s_waitcnt lgkmcnt(8)
  v_mfma_f32_32x32x16_bf16 v[144:159], a[24:27], a[100:103], v[144:159]
  buffer_load_dwordx4 v11, s[20:23], s56 offen offset:256  lds
  ds_read_b64_tr_b16 a[20:21], v1 offset:40448
  ds_read_b64_tr_b16 a[22:23], v2 offset:14848
  v_mfma_f32_32x32x16_bf16 v[160:175], a[28:31], a[100:103], v[160:175]
  ds_read_b64_tr_b16 a[24:25], v2 offset:54272
  ds_read_b64_tr_b16 a[26:27], v3 offset:28672
  s_add_u32 s46, s45, 6144
  buffer_load_dwordx4 a[208:211], v4, s[28:31], s46 offen offset:0 sc1
  v_mfma_f32_32x32x16_bf16 v[176:191], a[0:3], a[96:99], v[176:191]
  ds_read_b64_tr_b16 a[28:29], v2 offset:54784
  ds_read_b64_tr_b16 a[30:31], v3 offset:29184
  buffer_load_dword v13, v15, s[28:31], s43 offen sc1
  s_add_u32 m0, s40, 23552
  s_waitcnt lgkmcnt(8)
  v_mfma_f32_32x32x16_bf16 v[192:207], a[4:7], a[96:99], v[192:207]
  buffer_load_dwordx4 v12, s[20:23], s60 offen  lds
  ds_read_b64_tr_b16 a[0:1], v1 offset:40960
  ds_read_b64_tr_b16 a[2:3], v2 offset:15360
  v_mfma_f32_32x32x16_bf16 v[176:191], a[8:11], a[100:103], v[176:191]
  ds_read_b64_tr_b16 a[4:5], v1 offset:41472
  ds_read_b64_tr_b16 a[6:7], v2 offset:15872
  v_mfma_f32_32x32x16_bf16 v[192:207], a[12:15], a[100:103], v[192:207]
  ds_read_b64_tr_b16 a[8:9], v2 offset:55296
  ds_read_b64_tr_b16 a[10:11], v3 offset:29696
  s_add_u32 m0, s40, 24448
  s_waitcnt vmcnt(16) lgkmcnt(8)
  v_mfma_f32_32x32x16_bf16 v[112:127], a[16:19], a[104:107], v[112:127]
  buffer_load_dwordx4 v12, s[20:23], s60 offen offset:128  lds
  ds_read_b64_tr_b16 a[12:13], v2 offset:55808
  ds_read_b64_tr_b16 a[14:15], v3 offset:30208
  v_mfma_f32_32x32x16_bf16 v[128:143], a[20:23], a[104:107], v[128:143]
  ds_read_b64_tr_b16 a[16:17], v1 offset:41984
  ds_read_b64_tr_b16 a[18:19], v2 offset:16384
  s_add_u32 s46, s45, 6144
  buffer_load_dwordx4 a[212:215], v4, s[28:31], s46 offen offset:1024 sc1
  s_waitcnt vmcnt(15)
  v_mfma_f32_32x32x16_bf16 v[112:127], a[24:27], a[108:111], v[112:127]
  ds_read_b64_tr_b16 a[20:21], v1 offset:42496
  ds_read_b64_tr_b16 a[22:23], v2 offset:16896
  s_add_u32 m0, s40, 25344
  s_waitcnt lgkmcnt(8)
  v_mfma_f32_32x32x16_bf16 v[128:143], a[28:31], a[108:111], v[128:143]
  buffer_load_dwordx4 v12, s[20:23], s60 offen offset:256  lds
  ds_read_b64_tr_b16 a[24:25], v2 offset:56320
  ds_read_b64_tr_b16 a[26:27], v3 offset:30720
  v_mfma_f32_32x32x16_bf16 v[144:159], a[0:3], a[104:107], v[144:159]
  ds_read_b64_tr_b16 a[28:29], v2 offset:56832
  ds_read_b64_tr_b16 a[30:31], v3 offset:31232
  v_mfma_f32_32x32x16_bf16 v[160:175], a[4:7], a[104:107], v[160:175]
  ds_read_b64_tr_b16 a[0:1], v1 offset:43008
  ds_read_b64_tr_b16 a[2:3], v2 offset:17408
  s_add_u32 m0, s40, 26624
  s_waitcnt lgkmcnt(8)
  v_mfma_f32_32x32x16_bf16 v[144:159], a[8:11], a[108:111], v[144:159]
  buffer_load_dwordx4 v12, s[20:23], s61 offen  lds
  ds_read_b64_tr_b16 a[4:5], v1 offset:43520
  ds_read_b64_tr_b16 a[6:7], v2 offset:17920
  v_mfma_f32_32x32x16_bf16 v[160:175], a[12:15], a[108:111], v[160:175]
  ds_read_b64_tr_b16 a[8:9], v2 offset:57344
  ds_read_b64_tr_b16 a[10:11], v3 offset:31744
  s_add_u32 s46, s45, 8192
  buffer_load_dwordx4 a[216:219], v4, s[28:31], s46 offen offset:0 sc1
  v_mfma_f32_32x32x16_bf16 v[176:191], a[16:19], a[104:107], v[176:191]
  ds_read_b64_tr_b16 a[12:13], v2 offset:57856
  ds_read_b64_tr_b16 a[14:15], v3 offset:32256
  s_add_u32 m0, s40, 27520
  s_waitcnt lgkmcnt(8)
  v_mfma_f32_32x32x16_bf16 v[192:207], a[20:23], a[104:107], v[192:207]
  buffer_load_dwordx4 v12, s[20:23], s61 offen offset:128  lds
  ds_read_b64_tr_b16 a[16:17], v1 offset:4096
  ds_read_b64_tr_b16 a[18:19], v1 offset:44032
  v_mfma_f32_32x32x16_bf16 v[176:191], a[24:27], a[108:111], v[176:191]
  ds_read_b64_tr_b16 a[20:21], v1 offset:4608
  ds_read_b64_tr_b16 a[22:23], v1 offset:44544
  v_mfma_f32_32x32x16_bf16 v[192:207], a[28:31], a[108:111], v[192:207]
  ds_read_b64_tr_b16 a[24:25], v2 offset:18432
  ds_read_b64_tr_b16 a[26:27], v2 offset:58368
  s_add_u32 m0, s40, 28416
  s_waitcnt vmcnt(17) lgkmcnt(8)
  v_mfma_f32_32x32x16_bf16 v[112:127], a[0:3], a[112:115], v[112:127]
  buffer_load_dwordx4 v12, s[20:23], s61 offen offset:256  lds
  ds_read_b64_tr_b16 a[28:29], v2 offset:18944
  ds_read_b64_tr_b16 a[30:31], v2 offset:58880
  v_mfma_f32_32x32x16_bf16 v[128:143], a[4:7], a[112:115], v[128:143]
  ds_read_b64_tr_b16 a[0:1], v1 offset:5120
  ds_read_b64_tr_b16 a[2:3], v1 offset:45056
  s_add_u32 s46, s45, 8192
  buffer_load_dwordx4 a[220:223], v4, s[28:31], s46 offen offset:1024 sc1
  s_waitcnt vmcnt(18)
  v_mfma_f32_32x32x16_bf16 v[112:127], a[8:11], a[116:119], v[112:127]
  ds_read_b64_tr_b16 a[4:5], v1 offset:5632
  ds_read_b64_tr_b16 a[6:7], v1 offset:45568
  s_add_u32 m0, s40, 29696
  s_waitcnt lgkmcnt(8)
  v_mfma_f32_32x32x16_bf16 v[128:143], a[12:15], a[116:119], v[128:143]
  buffer_load_dwordx4 v11, s[20:23], s60 offen  lds
  ds_read_b64_tr_b16 a[8:9], v2 offset:19456
  ds_read_b64_tr_b16 a[10:11], v2 offset:59392
  v_mfma_f32_32x32x16_bf16 v[144:159], a[16:19], a[112:115], v[144:159]
  ds_read_b64_tr_b16 a[12:13], v2 offset:19968
  ds_read_b64_tr_b16 a[14:15], v2 offset:59904
  v_mfma_f32_32x32x16_bf16 v[160:175], a[20:23], a[112:115], v[160:175]
  ds_read_b64_tr_b16 a[16:17], v1 offset:6144
  ds_read_b64_tr_b16 a[18:19], v1 offset:46080
  s_waitcnt lgkmcnt(8)
  v_mfma_f32_32x32x16_bf16 v[144:159], a[24:27], a[116:119], v[144:159]
  ds_read_b64_tr_b16 a[20:21], v1 offset:6656
  ds_read_b64_tr_b16 a[22:23], v1 offset:46592
  v_mfma_f32_32x32x16_bf16 v[160:175], a[28:31], a[116:119], v[160:175]
  ds_read_b64_tr_b16 a[24:25], v2 offset:20480
  ds_read_b64_tr_b16 a[26:27], v2 offset:60416
  s_add_u32 s46, s86, 18432
  buffer_load_dwordx4 a[224:227], v4, s[28:31], s46 offen offset:0 sc1
  v_mfma_f32_32x32x16_bf16 v[176:191], a[0:3], a[112:115], v[176:191]
  ds_read_b64_tr_b16 a[28:29], v2 offset:20992
  ds_read_b64_tr_b16 a[30:31], v2 offset:60928
  s_waitcnt lgkmcnt(8)
  v_mfma_f32_32x32x16_bf16 v[192:207], a[4:7], a[112:115], v[192:207]
  ds_read_b64_tr_b16 a[0:1], v1 offset:7168
  ds_read_b64_tr_b16 a[2:3], v1 offset:47104
  v_mfma_f32_32x32x16_bf16 v[176:191], a[8:11], a[116:119], v[176:191]
  ds_read_b64_tr_b16 a[4:5], v1 offset:7680
  ds_read_b64_tr_b16 a[6:7], v1 offset:47616
  v_mfma_f32_32x32x16_bf16 v[192:207], a[12:15], a[116:119], v[192:207]
  ds_read_b64_tr_b16 a[8:9], v2 offset:21504
  ds_read_b64_tr_b16 a[10:11], v2 offset:61440
  s_waitcnt vmcnt(18) lgkmcnt(8)
  v_mfma_f32_32x32x16_bf16 v[112:127], a[16:19], a[120:123], v[112:127]
  ds_read_b64_tr_b16 a[12:13], v2 offset:22016
  ds_read_b64_tr_b16 a[14:15], v2 offset:61952
  v_mfma_f32_32x32x16_bf16 v[128:143], a[20:23], a[120:123], v[128:143]
  ds_read_b64_tr_b16 a[16:17], v1 offset:8192
  ds_read_b64_tr_b16 a[18:19], v1 offset:48128
  s_add_u32 s46, s86, 18432
  buffer_load_dwordx4 a[228:231], v4, s[28:31], s46 offen offset:1024 sc1
  s_waitcnt vmcnt(16)
  v_mfma_f32_32x32x16_bf16 v[112:127], a[24:27], a[124:127], v[112:127]
  ds_read_b64_tr_b16 a[20:21], v1 offset:8704
  ds_read_b64_tr_b16 a[22:23], v1 offset:48640
  s_waitcnt lgkmcnt(8)
  v_mfma_f32_32x32x16_bf16 v[128:143], a[28:31], a[124:127], v[128:143]
  ds_read_b64_tr_b16 a[24:25], v2 offset:22528
  ds_read_b64_tr_b16 a[26:27], v2 offset:62464
  v_mfma_f32_32x32x16_bf16 v[144:159], a[0:3], a[120:123], v[144:159]
  ds_read_b64_tr_b16 a[28:29], v2 offset:23040
  ds_read_b64_tr_b16 a[30:31], v2 offset:62976
  v_mfma_f32_32x32x16_bf16 v[160:175], a[4:7], a[120:123], v[160:175]
  s_barrier
  ds_read_b64_tr_b16 a[0:1], v1 offset:9216
  ds_read_b64_tr_b16 a[2:3], v1 offset:49152
  s_add_u32 m0, s40, 30720
  s_waitcnt lgkmcnt(8)
  v_mfma_f32_32x32x16_bf16 v[144:159], a[8:11], a[124:127], v[144:159]
  buffer_load_dwordx4 v11, s[20:23], s61 offen  lds
  ds_read_b64_tr_b16 a[4:5], v1 offset:9728
  ds_read_b64_tr_b16 a[6:7], v1 offset:49664
  v_mfma_f32_32x32x16_bf16 v[160:175], a[12:15], a[124:127], v[160:175]
  ds_read_b64_tr_b16 a[8:9], v2 offset:23552
  ds_read_b64_tr_b16 a[10:11], v2 offset:63488
  s_add_u32 s46, s86, 4096
  buffer_load_dwordx4 a[232:235], v4, s[28:31], s46 offen offset:0 sc1
  v_mfma_f32_32x32x16_bf16 v[176:191], a[16:19], a[120:123], v[176:191]
  ds_read_b64_tr_b16 a[12:13], v2 offset:24064
  ds_read_b64_tr_b16 a[14:15], v2 offset:64000
  s_add_u32 m0, s40, 31744
  s_waitcnt lgkmcnt(8)
  v_mfma_f32_32x32x16_bf16 v[192:207], a[20:23], a[120:123], v[192:207]
  buffer_load_dwordx4 v12, s[20:23], s55 offen  lds
  ds_read_b64_tr_b16 a[16:17], v1 offset:10240
  ds_read_b64_tr_b16 a[18:19], v1 offset:50176
  v_mfma_f32_32x32x16_bf16 v[176:191], a[24:27], a[124:127], v[176:191]
  ds_read_b64_tr_b16 a[20:21], v1 offset:10752
  ds_read_b64_tr_b16 a[22:23], v1 offset:50688
  v_mfma_f32_32x32x16_bf16 v[192:207], a[28:31], a[124:127], v[192:207]
  ds_read_b64_tr_b16 a[24:25], v2 offset:24576
  ds_read_b64_tr_b16 a[26:27], v2 offset:64512
  s_add_u32 m0, s40, 32768
  s_waitcnt vmcnt(16) lgkmcnt(8)
  v_mfma_f32_32x32x16_bf16 v[112:127], a[0:3], a[208:211], v[112:127]
  buffer_load_dwordx4 v12, s[20:23], s56 offen  lds
  ds_read_b64_tr_b16 a[28:29], v2 offset:25088
  ds_read_b64_tr_b16 a[30:31], v2 offset:65024
  v_mfma_f32_32x32x16_bf16 v[128:143], a[4:7], a[208:211], v[128:143]
  ds_read_b64_tr_b16 a[0:1], v1 offset:11264
  ds_read_b64_tr_b16 a[2:3], v1 offset:51200
  s_add_u32 s46, s86, 4096
  buffer_load_dwordx4 a[236:239], v4, s[28:31], s46 offen offset:1024 sc1
  s_waitcnt vmcnt(14)
  v_mfma_f32_32x32x16_bf16 v[112:127], a[8:11], a[212:215], v[112:127]
  ds_read_b64_tr_b16 a[4:5], v1 offset:11776
  ds_read_b64_tr_b16 a[6:7], v1 offset:51712
  s_add_u32 m0, s40, 33792
  s_waitcnt lgkmcnt(8)
  v_mfma_f32_32x32x16_bf16 v[128:143], a[12:15], a[212:215], v[128:143]
  buffer_load_dwordx4 v10, s[24:27], s68 offen  lds
  ds_read_b64_tr_b16 a[8:9], v2 offset:25600
  ds_read_b64_tr_b16 a[10:11], v3 offset:0
  v_mfma_f32_32x32x16_bf16 v[144:159], a[16:19], a[208:211], v[144:159]
  ds_read_b64_tr_b16 a[12:13], v2 offset:26112
  ds_read_b64_tr_b16 a[14:15], v3 offset:512
  v_mfma_f32_32x32x16_bf16 v[160:175], a[20:23], a[208:211], v[160:175]
  ds_read_b64_tr_b16 a[16:17], v1 offset:12288
  ds_read_b64_tr_b16 a[18:19], v1 offset:52224
  s_add_u32 m0, s40, 34816
  s_waitcnt lgkmcnt(8)
  v_mfma_f32_32x32x16_bf16 v[144:159], a[24:27], a[212:215], v[144:159]
  buffer_load_dwordx4 v8, s[24:27], s68 offen  lds
  ds_read_b64_tr_b16 a[20:21], v1 offset:12800
FF_H8:
  s_cbranch_execz FF_H12
  ds_read_b64_tr_b16 a[22:23], v1 offset:52736
  v_cmp_gt_u32 vcc, 3, v13
  s_nop 4
  s_and_b32 s46, vcc_lo, 15
  s_cbranch_scc1 FF_SP3
FF_SP3_B:
  v_mfma_f32_32x32x16_bf16 v[160:175], a[28:31], a[212:215], v[160:175]
  ds_read_b64_tr_b16 a[24:25], v2 offset:26624
  ds_read_b64_tr_b16 a[26:27], v3 offset:1024
  s_add_u32 s46, s45, 10240
  buffer_load_dwordx4 a[128:131], v4, s[28:31], s46 offen offset:0 sc1
  v_mfma_f32_32x32x16_bf16 v[176:191], a[0:3], a[208:211], v[176:191]
  ds_read_b64_tr_b16 a[28:29], v2 offset:27136
  ds_read_b64_tr_b16 a[30:31], v3 offset:1536
  s_add_u32 m0, s40, 35840
  s_waitcnt lgkmcnt(8)
  v_mfma_f32_32x32x16_bf16 v[192:207], a[4:7], a[208:211], v[192:207]
  buffer_load_dwordx4 v8, s[24:27], s69 offen  lds
  ds_read_b64_tr_b16 a[0:1], v1 offset:13312
  ds_read_b64_tr_b16 a[2:3], v1 offset:53248
  v_mfma_f32_32x32x16_bf16 v[176:191], a[8:11], a[212:215], v[176:191]
  ds_read_b64_tr_b16 a[4:5], v1 offset:13824
  ds_read_b64_tr_b16 a[6:7], v1 offset:53760
  v_mfma_f32_32x32x16_bf16 v[192:207], a[12:15], a[212:215], v[192:207]
  ds_read_b64_tr_b16 a[8:9], v2 offset:27648
  ds_read_b64_tr_b16 a[10:11], v3 offset:2048
  s_add_u32 m0, s40, 36864
  s_waitcnt vmcnt(15) lgkmcnt(8)
  v_mfma_f32_32x32x16_bf16 v[112:127], a[16:19], a[216:219], v[112:127]
  buffer_load_dwordx4 v8, s[24:27], s70 offen  lds
  ds_read_b64_tr_b16 a[12:13], v2 offset:28160
  ds_read_b64_tr_b16 a[14:15], v3 offset:2560
  v_mfma_f32_32x32x16_bf16 v[128:143], a[20:23], a[216:219], v[128:143]
  ds_read_b64_tr_b16 a[16:17], v1 offset:14336
  ds_read_b64_tr_b16 a[18:19], v1 offset:54272
  s_add_u32 s46, s45, 10240
  buffer_load_dwordx4 a[132:135], v4, s[28:31], s46 offen offset:1024 sc1
  s_waitcnt vmcnt(14)
  v_mfma_f32_32x32x16_bf16 v[112:127], a[24:27], a[220:223], v[112:127]
  ds_read_b64_tr_b16 a[20:21], v1 offset:14848
  ds_read_b64_tr_b16 a[22:23], v1 offset:54784
  s_add_u32 m0, s40, 37888
  s_waitcnt lgkmcnt(8)
  v_mfma_f32_32x32x16_bf16 v[128:143], a[28:31], a[220:223], v[128:143]
  buffer_load_dwordx4 v8, s[24:27], s71 offen  lds
  ds_read_b64_tr_b16 a[24:25], v2 offset:28672
  ds_read_b64_tr_b16 a[26:27], v3 offset:3072
  v_mfma_f32_32x32x16_bf16 v[144:159], a[0:3], a[216:219], v[144:159]
  ds_read_b64_tr_b16 a[28:29], v2 offset:29184
  ds_read_b64_tr_b16 a[30:31], v3 offset:3584
  v_mfma_f32_32x32x16_bf16 v[160:175], a[4:7], a[216:219], v[160:175]
  ds_read_b64_tr_b16 a[0:1], v1 offset:15360
  ds_read_b64_tr_b16 a[2:3], v1 offset:55296
  s_add_u32 m0, s40, 38784
  s_waitcnt lgkmcnt(8)
  v_mfma_f32_32x32x16_bf16 v[144:159], a[8:11], a[220:223], v[144:159]
  buffer_load_dwordx4 v11, s[20:23], s60 offen offset:128  lds
  ds_read_b64_tr_b16 a[4:5], v1 offset:15872
  ds_read_b64_tr_b16 a[6:7], v1 offset:55808
  v_mfma_f32_32x32x16_bf16 v[160:175], a[12:15], a[220:223], v[160:175]
  ds_read_b64_tr_b16 a[8:9], v2 offset:29696
  ds_read_b64_tr_b16 a[10:11], v3 offset:4096
  s_add_u32 s46, s45, 12288
  buffer_load_dwordx4 a[136:139], v4, s[28:31], s46 offen offset:0 sc1
  v_mfma_f32_32x32x16_bf16 v[176:191], a[16:19], a[216:219], v[176:191]
  ds_read_b64_tr_b16 a[12:13], v2 offset:30208
  ds_read_b64_tr_b16 a[14:15], v3 offset:4608
  s_add_u32 m0, s40, -128
  s_waitcnt lgkmcnt(8)
  v_mfma_f32_32x32x16_bf16 v[192:207], a[20:23], a[216:219], v[192:207]
  buffer_load_dwordx4 v11, s[20:23], s61 offen offset:128  lds
  ds_read_b64_tr_b16 a[16:17], v1 offset:16384
  ds_read_b64_tr_b16 a[18:19], v1 offset:56320
  v_mfma_f32_32x32x16_bf16 v[176:191], a[24:27], a[220:223], v[176:191]
  ds_read_b64_tr_b16 a[20:21], v1 offset:16896
  ds_read_b64_tr_b16 a[22:23], v1 offset:56832
  v_mfma_f32_32x32x16_bf16 v[192:207], a[28:31], a[220:223], v[192:207]
  ds_read_b64_tr_b16 a[24:25], v2 offset:30720
  ds_read_b64_tr_b16 a[26:27], v3 offset:5120
  s_add_u32 m0, s40, 896
  s_waitcnt vmcnt(16) lgkmcnt(8)
  v_mfma_f32_32x32x16_bf16 v[112:127], a[0:3], a[224:227], v[112:127]
  buffer_load_dwordx4 v12, s[20:23], s55 offen offset:128  lds
  ds_read_b64_tr_b16 a[28:29], v2 offset:31232
  ds_read_b64_tr_b16 a[30:31], v3 offset:5632
  v_mfma_f32_32x32x16_bf16 v[128:143], a[4:7], a[224:227], v[128:143]
  ds_read_b64_tr_b16 a[0:1], v1 offset:17408
  ds_read_b64_tr_b16 a[2:3], v1 offset:57344
  s_add_u32 s46, s45, 12288
  buffer_load_dwordx4 a[140:143], v4, s[28:31], s46 offen offset:1024 sc1
  s_waitcnt vmcnt(17)
  v_mfma_f32_32x32x16_bf16 v[112:127], a[8:11], a[228:231], v[112:127]
  ds_read_b64_tr_b16 a[4:5], v1 offset:17920
  ds_read_b64_tr_b16 a[6:7], v1 offset:57856
  s_add_u32 m0, s40, 1920
  s_waitcnt lgkmcnt(8)
  v_mfma_f32_32x32x16_bf16 v[128:143], a[12:15], a[228:231], v[128:143]
  buffer_load_dwordx4 v12, s[20:23], s56 offen offset:128  lds
  ds_read_b64_tr_b16 a[8:9], v2 offset:31744
  ds_read_b64_tr_b16 a[10:11], v3 offset:6144
  v_mfma_f32_32x32x16_bf16 v[144:159], a[16:19], a[224:227], v[144:159]
  ds_read_b64_tr_b16 a[12:13], v2 offset:32256
  ds_read_b64_tr_b16 a[14:15], v3 offset:6656
  v_mfma_f32_32x32x16_bf16 v[160:175], a[20:23], a[224:227], v[160:175]
  ds_read_b64_tr_b16 a[16:17], v1 offset:18432
  ds_read_b64_tr_b16 a[18:19], v1 offset:58368
  s_waitcnt lgkmcnt(8)
  v_mfma_f32_32x32x16_bf16 v[144:159], a[24:27], a[228:231], v[144:159]
  ds_read_b64_tr_b16 a[20:21], v1 offset:18944
  ds_read_b64_tr_b16 a[22:23], v1 offset:58880
  v_mfma_f32_32x32x16_bf16 v[160:175], a[28:31], a[228:231], v[160:175]
  ds_read_b64_tr_b16 a[24:25], v2 offset:32768
  ds_read_b64_tr_b16 a[26:27], v3 offset:7168
  s_add_u32 s46, s86, 20480
  buffer_load_dwordx4 a[144:147], v4, s[28:31], s46 offen offset:0 sc1
  v_mfma_f32_32x32x16_bf16 v[176:191], a[0:3], a[224:227], v[176:191]
  ds_read_b64_tr_b16 a[28:29], v2 offset:33280
  ds_read_b64_tr_b16 a[30:31], v3 offset:7680
  s_waitcnt lgkmcnt(8)
  v_mfma_f32_32x32x16_bf16 v[192:207], a[4:7], a[224:227], v[192:207]
  ds_read_b64_tr_b16 a[0:1], v1 offset:19456
  ds_read_b64_tr_b16 a[2:3], v1 offset:59392
  v_mfma_f32_32x32x16_bf16 v[176:191], a[8:11], a[228:231], v[176:191]
  ds_read_b64_tr_b16 a[4:5], v1 offset:19968
  ds_read_b64_tr_b16 a[6:7], v1 offset:59904
  v_mfma_f32_32x32x16_bf16 v[192:207], a[12:15], a[228:231], v[192:207]
  ds_read_b64_tr_b16 a[8:9], v2 offset:33792
  ds_read_b64_tr_b16 a[10:11], v3 offset:8192
  s_waitcnt vmcnt(17) lgkmcnt(8)
  v_mfma_f32_32x32x16_bf16 v[112:127], a[16:19], a[232:235], v[112:127]
  ds_read_b64_tr_b16 a[12:13], v2 offset:34304
  ds_read_b64_tr_b16 a[14:15], v3 offset:8704
  v_mfma_f32_32x32x16_bf16 v[128:143], a[20:23], a[232:235], v[128:143]
  ds_read_b64_tr_b16 a[16:17], v1 offset:20480
  ds_read_b64_tr_b16 a[18:19], v1 offset:60416
  s_add_u32 s46, s86, 20480
  buffer_load_dwordx4 a[148:151], v4, s[28:31], s46 offen offset:1024 sc1
  s_waitcnt vmcnt(15)
  v_mfma_f32_32x32x16_bf16 v[112:127], a[24:27], a[236:239], v[112:127]
  ds_read_b64_tr_b16 a[20:21], v1 offset:20992
  ds_read_b64_tr_b16 a[22:23], v1 offset:60928
  s_waitcnt lgkmcnt(8)
  v_mfma_f32_32x32x16_bf16 v[128:143], a[28:31], a[236:239], v[128:143]
  ds_read_b64_tr_b16 a[24:25], v2 offset:34816
  ds_read_b64_tr_b16 a[26:27], v3 offset:9216
  v_mfma_f32_32x32x16_bf16 v[144:159], a[0:3], a[232:235], v[144:159]
  ds_read_b64_tr_b16 a[28:29], v2 offset:35328
  ds_read_b64_tr_b16 a[30:31], v3 offset:9728
  v_mfma_f32_32x32x16_bf16 v[160:175], a[4:7], a[232:235], v[160:175]
  s_barrier
  ds_read_b64_tr_b16 a[0:1], v1 offset:21504
  ds_read_b64_tr_b16 a[2:3], v1 offset:61440
  s_add_u32 m0, s40, 2944
  s_waitcnt lgkmcnt(8)
  v_mfma_f32_32x32x16_bf16 v[144:159], a[8:11], a[236:239], v[144:159]
  buffer_load_dwordx4 v8, s[24:27], s68 offen offset:128  lds
  ds_read_b64_tr_b16 a[4:5], v1 offset:22016
  ds_read_b64_tr_b16 a[6:7], v1 offset:61952
  v_mfma_f32_32x32x16_bf16 v[160:175], a[12:15], a[236:239], v[160:175]
  ds_read_b64_tr_b16 a[8:9], v2 offset:35840
  ds_read_b64_tr_b16 a[10:11], v3 offset:10240
  s_add_u32 s46, s86, 22528
  buffer_load_dwordx4 a[152:155], v4, s[28:31], s46 offen offset:0 sc1
  v_mfma_f32_32x32x16_bf16 v[176:191], a[16:19], a[232:235], v[176:191]
  ds_read_b64_tr_b16 a[12:13], v2 offset:36352
  ds_read_b64_tr_b16 a[14:15], v3 offset:10752
  s_add_u32 m0, s40, 3968
  s_waitcnt lgkmcnt(8)
  v_mfma_f32_32x32x16_bf16 v[192:207], a[20:23], a[232:235], v[192:207]
  buffer_load_dwordx4 v8, s[24:27], s69 offen offset:128  lds
  ds_read_b64_tr_b16 a[16:17], v1 offset:22528
  ds_read_b64_tr_b16 a[18:19], v1 offset:62464
  v_mfma_f32_32x32x16_bf16 v[176:191], a[24:27], a[236:239], v[176:191]
  ds_read_b64_tr_b16 a[20:21], v1 offset:23040
  ds_read_b64_tr_b16 a[22:23], v1 offset:62976
  v_mfma_f32_32x32x16_bf16 v[192:207], a[28:31], a[236:239], v[192:207]
  ds_read_b64_tr_b16 a[24:25], v2 offset:36864
  ds_read_b64_tr_b16 a[26:27], v3 offset:11264
  s_add_u32 m0, s40, 4992
  s_waitcnt vmcnt(15) lgkmcnt(8)
  v_mfma_f32_32x32x16_bf16 v[112:127], a[0:3], a[128:131], v[112:127]
  buffer_load_dwordx4 v8, s[24:27], s70 offen offset:128  lds
  ds_read_b64_tr_b16 a[28:29], v2 offset:37376
  ds_read_b64_tr_b16 a[30:31], v3 offset:11776
  v_mfma_f32_32x32x16_bf16 v[128:143], a[4:7], a[128:131], v[128:143]
  ds_read_b64_tr_b16 a[0:1], v1 offset:23552
  ds_read_b64_tr_b16 a[2:3], v1 offset:63488
  s_add_u32 s46, s86, 22528
  buffer_load_dwordx4 a[156:159], v4, s[28:31], s46 offen offset:1024 sc1
  s_waitcnt vmcnt(14)
  v_mfma_f32_32x32x16_bf16 v[112:127], a[8:11], a[132:135], v[112:127]
  ds_read_b64_tr_b16 a[4:5], v1 offset:24064
  ds_read_b64_tr_b16 a[6:7], v1 offset:64000
  buffer_load_dword v16, off, s[28:31], s43 offset:12 sc1
  s_add_u32 m0, s40, 6016
  s_waitcnt lgkmcnt(8)
  v_mfma_f32_32x32x16_bf16 v[128:143], a[12:15], a[132:135], v[128:143]
  buffer_load_dwordx4 v8, s[24:27], s71 offen offset:128  lds
  ds_read_b64_tr_b16 a[8:9], v2 offset:37888
  ds_read_b64_tr_b16 a[10:11], v3 offset:12288
  v_mfma_f32_32x32x16_bf16 v[144:159], a[16:19], a[128:131], v[144:159]
  ds_read_b64_tr_b16 a[12:13], v2 offset:38400
  ds_read_b64_tr_b16 a[14:15], v3 offset:12800
  v_mfma_f32_32x32x16_bf16 v[160:175], a[20:23], a[128:131], v[160:175]
  ds_read_b64_tr_b16 a[16:17], v1 offset:24576
  ds_read_b64_tr_b16 a[18:19], v1 offset:64512
  s_add_u32 m0, s40, 6912
  s_waitcnt lgkmcnt(8)
  v_mfma_f32_32x32x16_bf16 v[144:159], a[24:27], a[132:135], v[144:159]
  buffer_load_dwordx4 v11, s[20:23], s60 offen offset:256  lds
  ds_read_b64_tr_b16 a[20:21], v1 offset:25088
  ds_read_b64_tr_b16 a[22:23], v1 offset:65024
  v_mfma_f32_32x32x16_bf16 v[160:175], a[28:31], a[132:135], v[160:175]
  ds_read_b64_tr_b16 a[24:25], v2 offset:38912
  ds_read_b64_tr_b16 a[26:27], v3 offset:13312
  s_add_u32 s46, s45, 20480
  buffer_load_dwordx4 a[160:163], v4, s[28:31], s46 offen offset:0 sc1
  v_mfma_f32_32x32x16_bf16 v[176:191], a[0:3], a[128:131], v[176:191]
  ds_read_b64_tr_b16 a[28:29], v2 offset:39424
  ds_read_b64_tr_b16 a[30:31], v3 offset:13824
  s_add_u32 m0, s40, 7936
  s_waitcnt lgkmcnt(8)
  v_mfma_f32_32x32x16_bf16 v[192:207], a[4:7], a[128:131], v[192:207]
  buffer_load_dwordx4 v11, s[20:23], s61 offen offset:256  lds
  ds_read_b64_tr_b16 a[0:1], v1 offset:25600
  ds_read_b64_tr_b16 a[2:3], v2 offset:0
  v_mfma_f32_32x32x16_bf16 v[176:191], a[8:11], a[132:135], v[176:191]
  ds_read_b64_tr_b16 a[4:5], v1 offset:26112
  ds_read_b64_tr_b16 a[6:7], v2 offset:512
  v_mfma_f32_32x32x16_bf16 v[192:207], a[12:15], a[132:135], v[192:207]
  ds_read_b64_tr_b16 a[8:9], v2 offset:39936
  ds_read_b64_tr_b16 a[10:11], v3 offset:14336
  s_add_u32 m0, s40, 8960
  s_waitcnt vmcnt(16) lgkmcnt(8)
  v_mfma_f32_32x32x16_bf16 v[112:127], a[16:19], a[136:139], v[112:127]
  buffer_load_dwordx4 v12, s[20:23], s55 offen offset:256  lds
  ds_read_b64_tr_b16 a[12:13], v2 offset:40448
  ds_read_b64_tr_b16 a[14:15], v3 offset:14848
  v_mfma_f32_32x32x16_bf16 v[128:143], a[20:23], a[136:139], v[128:143]
  ds_read_b64_tr_b16 a[16:17], v1 offset:26624
  ds_read_b64_tr_b16 a[18:19], v2 offset:1024
  s_add_u32 s46, s45, 20480
  buffer_load_dwordx4 a[164:167], v4, s[28:31], s46 offen offset:1024 sc1
  s_waitcnt vmcnt(15)
  v_mfma_f32_32x32x16_bf16 v[112:127], a[24:27], a[140:143], v[112:127]
  ds_read_b64_tr_b16 a[20:21], v1 offset:27136
  ds_read_b64_tr_b16 a[22:23], v2 offset:1536
  s_add_u32 m0, s40, 9984
  s_waitcnt lgkmcnt(8)
  v_mfma_f32_32x32x16_bf16 v[128:143], a[28:31], a[140:143], v[128:143]
  buffer_load_dwordx4 v12, s[20:23], s56 offen offset:256  lds
  ds_read_b64_tr_b16 a[24:25], v2 offset:40960
  ds_read_b64_tr_b16 a[26:27], v3 offset:15360
  v_mfma_f32_32x32x16_bf16 v[144:159], a[0:3], a[136:139], v[144:159]
  ds_read_b64_tr_b16 a[28:29], v2 offset:41472
  ds_read_b64_tr_b16 a[30:31], v3 offset:15872
  v_mfma_f32_32x32x16_bf16 v[160:175], a[4:7], a[136:139], v[160:175]
  ds_read_b64_tr_b16 a[0:1], v1 offset:27648
  ds_read_b64_tr_b16 a[2:3], v2 offset:2048
  s_add_u32 m0, s40, 11008
  s_waitcnt lgkmcnt(8)
  v_mfma_f32_32x32x16_bf16 v[144:159], a[8:11], a[140:143], v[144:159]
  buffer_load_dwordx4 v10, s[24:27], s68 offen offset:256  lds
  ds_read_b64_tr_b16 a[4:5], v1 offset:28160
  ds_read_b64_tr_b16 a[6:7], v2 offset:2560
  v_mfma_f32_32x32x16_bf16 v[160:175], a[12:15], a[140:143], v[160:175]
  ds_read_b64_tr_b16 a[8:9], v2 offset:41984
  ds_read_b64_tr_b16 a[10:11], v3 offset:16384
  s_add_u32 s46, s45, 22528
  buffer_load_dwordx4 a[168:171], v4, s[28:31], s46 offen offset:0 sc1
  v_mfma_f32_32x32x16_bf16 v[176:191], a[16:19], a[136:139], v[176:191]
  ds_read_b64_tr_b16 a[12:13], v2 offset:42496
  ds_read_b64_tr_b16 a[14:15], v3 offset:16896
  s_add_u32 m0, s40, 12032
  s_waitcnt lgkmcnt(8)
  v_mfma_f32_32x32x16_bf16 v[192:207], a[20:23], a[136:139], v[192:207]
  buffer_load_dwordx4 v8, s[24:27], s68 offen offset:256  lds
  ds_read_b64_tr_b16 a[16:17], v1 offset:28672
  ds_read_b64_tr_b16 a[18:19], v2 offset:3072
  v_mfma_f32_32x32x16_bf16 v[176:191], a[24:27], a[140:143], v[176:191]
  ds_read_b64_tr_b16 a[20:21], v1 offset:29184
  ds_read_b64_tr_b16 a[22:23], v2 offset:3584
  v_mfma_f32_32x32x16_bf16 v[192:207], a[28:31], a[140:143], v[192:207]
  ds_read_b64_tr_b16 a[24:25], v2 offset:43008
  ds_read_b64_tr_b16 a[26:27], v3 offset:17408
  s_add_u32 m0, s40, 13056
  s_waitcnt vmcnt(17) lgkmcnt(8)
  v_mfma_f32_32x32x16_bf16 v[112:127], a[0:3], a[144:147], v[112:127]
  buffer_load_dwordx4 v8, s[24:27], s69 offen offset:256  lds
  ds_read_b64_tr_b16 a[28:29], v2 offset:43520
  ds_read_b64_tr_b16 a[30:31], v3 offset:17920
  v_mfma_f32_32x32x16_bf16 v[128:143], a[4:7], a[144:147], v[128:143]
  ds_read_b64_tr_b16 a[0:1], v1 offset:29696
  ds_read_b64_tr_b16 a[2:3], v2 offset:4096
  s_add_u32 s46, s45, 22528
  buffer_load_dwordx4 a[172:175], v4, s[28:31], s46 offen offset:1024 sc1
  s_waitcnt vmcnt(18)
  v_mfma_f32_32x32x16_bf16 v[112:127], a[8:11], a[148:151], v[112:127]
  ds_read_b64_tr_b16 a[4:5], v1 offset:30208
  ds_read_b64_tr_b16 a[6:7], v2 offset:4608
  s_add_u32 m0, s40, 14080
  s_waitcnt lgkmcnt(8)
  v_mfma_f32_32x32x16_bf16 v[128:143], a[12:15], a[148:151], v[128:143]
  buffer_load_dwordx4 v8, s[24:27], s70 offen offset:256  lds
  ds_read_b64_tr_b16 a[8:9], v2 offset:44032
  ds_read_b64_tr_b16 a[10:11], v3 offset:18432
  v_mfma_f32_32x32x16_bf16 v[144:159], a[16:19], a[144:147], v[144:159]
  ds_read_b64_tr_b16 a[12:13], v2 offset:44544
  ds_read_b64_tr_b16 a[14:15], v3 offset:18944
  v_mfma_f32_32x32x16_bf16 v[160:175], a[20:23], a[144:147], v[160:175]
  ds_read_b64_tr_b16 a[16:17], v1 offset:30720
  ds_read_b64_tr_b16 a[18:19], v2 offset:5120
  s_waitcnt lgkmcnt(8)
  v_mfma_f32_32x32x16_bf16 v[144:159], a[24:27], a[148:151], v[144:159]
  ds_read_b64_tr_b16 a[20:21], v1 offset:31232
  ds_read_b64_tr_b16 a[22:23], v2 offset:5632
  v_mfma_f32_32x32x16_bf16 v[160:175], a[28:31], a[148:151], v[160:175]
  ds_read_b64_tr_b16 a[24:25], v2 offset:45056
  ds_read_b64_tr_b16 a[26:27], v3 offset:19456
  s_add_u32 s46, s86, 10240
  buffer_load_dwordx4 a[176:179], v4, s[28:31], s46 offen offset:0 sc1
  v_mfma_f32_32x32x16_bf16 v[176:191], a[0:3], a[144:147], v[176:191]
  ds_read_b64_tr_b16 a[28:29], v2 offset:45568
  ds_read_b64_tr_b16 a[30:31], v3 offset:19968
  s_waitcnt lgkmcnt(8)
  v_mfma_f32_32x32x16_bf16 v[192:207], a[4:7], a[144:147], v[192:207]
  ds_read_b64_tr_b16 a[0:1], v1 offset:31744
  ds_read_b64_tr_b16 a[2:3], v2 offset:6144
  v_mfma_f32_32x32x16_bf16 v[176:191], a[8:11], a[148:151], v[176:191]
  ds_read_b64_tr_b16 a[4:5], v1 offset:32256
  ds_read_b64_tr_b16 a[6:7], v2 offset:6656
  v_mfma_f32_32x32x16_bf16 v[192:207], a[12:15], a[148:151], v[192:207]
  ds_read_b64_tr_b16 a[8:9], v2 offset:46080
  ds_read_b64_tr_b16 a[10:11], v3 offset:20480
  s_add_u32 s46, s86, 10240
  buffer_load_dwordx4 a[180:183], v4, s[28:31], s46 offen offset:1024 sc1
  s_waitcnt vmcnt(19) lgkmcnt(8)
  v_mfma_f32_32x32x16_bf16 v[112:127], a[16:19], a[152:155], v[112:127]
  ds_read_b64_tr_b16 a[12:13], v2 offset:46592
  ds_read_b64_tr_b16 a[14:15], v3 offset:20992
  s_add_u32 s46, s86, 12288
  buffer_load_dwordx4 a[184:187], v4, s[28:31], s46 offen offset:0 sc1
  v_mfma_f32_32x32x16_bf16 v[128:143], a[20:23], a[152:155], v[128:143]
  ds_read_b64_tr_b16 a[16:17], v1 offset:32768
  ds_read_b64_tr_b16 a[18:19], v2 offset:7168
  s_waitcnt vmcnt(17)
  v_mfma_f32_32x32x16_bf16 v[112:127], a[24:27], a[156:159], v[112:127]
  ds_read_b64_tr_b16 a[20:21], v1 offset:33280
  ds_read_b64_tr_b16 a[22:23], v2 offset:7680
  s_waitcnt vmcnt(16)
  v_cmp_gt_u32 vcc, 1, v16
  s_nop 4
  s_cmp_lg_u64 vcc, 0
  s_cbranch_scc1 FF_SP4
FF_SP4_B:
  s_waitcnt lgkmcnt(8)
  v_mfma_f32_32x32x16_bf16 v[128:143], a[28:31], a[156:159], v[128:143]
  ds_read_b64_tr_b16 a[24:25], v2 offset:47104
  ds_read_b64_tr_b16 a[26:27], v3 offset:21504
  s_and_b32 s46, s4, 3
  s_sub_u32 s46, 3, s46
  s_mul_i32 s46, s46, 98304
  s_add_u32 s73, s46, s44
  s_add_u32 s46, s86, 12288
  buffer_load_dwordx4 a[188:191], v4, s[28:31], s46 offen offset:1024 sc1
  v_mfma_f32_32x32x16_bf16 v[144:159], a[0:3], a[152:155], v[144:159]
  ds_read_b64_tr_b16 a[28:29], v2 offset:47616
  ds_read_b64_tr_b16 a[30:31], v3 offset:22016
  s_add_u32 s46, s73, 0
  buffer_load_dwordx4 a[40:43], v4, s[28:31], s46 offen offset:0 sc1
  v_mfma_f32_32x32x16_bf16 v[160:175], a[4:7], a[152:155], v[160:175]
  s_barrier
  ds_read_b64_tr_b16 a[0:1], v1 offset:33792
  ds_read_b64_tr_b16 a[2:3], v2 offset:8192
  s_add_u32 m0, s40, 15104
  s_waitcnt lgkmcnt(8)
  v_mfma_f32_32x32x16_bf16 v[144:159], a[8:11], a[156:159], v[144:159]
  buffer_load_dwordx4 v8, s[24:27], s71 offen offset:256  lds
  ds_read_b64_tr_b16 a[4:5], v1 offset:34304
  ds_read_b64_tr_b16 a[6:7], v2 offset:8704
  s_add_u32 s46, s73, 0
  buffer_load_dwordx4 a[44:47], v4, s[28:31], s46 offen offset:1024 sc1
  v_mfma_f32_32x32x16_bf16 v[160:175], a[12:15], a[156:159], v[160:175]
  ds_read_b64_tr_b16 a[8:9], v2 offset:48128
  ds_read_b64_tr_b16 a[10:11], v3 offset:22528
  s_add_u32 s46, s73, 0
  buffer_load_dwordx4 a[48:51], v4, s[28:31], s46 offen offset:2048 sc1
  v_mfma_f32_32x32x16_bf16 v[176:191], a[16:19], a[152:155], v[176:191]
  ds_read_b64_tr_b16 a[12:13], v2 offset:48640
  ds_read_b64_tr_b16 a[14:15], v3 offset:23040
  s_add_u32 s46, s73, 0
  buffer_load_dwordx4 a[52:55], v4, s[28:31], s46 offen offset:3072 sc1
  s_waitcnt lgkmcnt(8)
  v_mfma_f32_32x32x16_bf16 v[192:207], a[20:23], a[152:155], v[192:207]
  ds_read_b64_tr_b16 a[16:17], v1 offset:34816
  ds_read_b64_tr_b16 a[18:19], v2 offset:9216
  s_add_u32 s46, s73, 4096
  buffer_load_dwordx4 a[56:59], v4, s[28:31], s46 offen offset:0 sc1
  v_mfma_f32_32x32x16_bf16 v[176:191], a[24:27], a[156:159], v[176:191]
  ds_read_b64_tr_b16 a[20:21], v1 offset:35328
  ds_read_b64_tr_b16 a[22:23], v2 offset:9728
  s_add_u32 s46, s73, 4096
  buffer_load_dwordx4 a[60:63], v4, s[28:31], s46 offen offset:1024 sc1
  v_mfma_f32_32x32x16_bf16 v[192:207], a[28:31], a[156:159], v[192:207]
  ds_read_b64_tr_b16 a[24:25], v2 offset:49152
  ds_read_b64_tr_b16 a[26:27], v3 offset:23552
  s_add_u32 s46, s73, 4096
  buffer_load_dwordx4 a[64:67], v4, s[28:31], s46 offen offset:2048 sc1
  s_waitcnt vmcnt(22) lgkmcnt(8)
  v_mfma_f32_32x32x16_bf16 v[112:127], a[0:3], a[160:163], v[112:127]
  ds_read_b64_tr_b16 a[28:29], v2 offset:49664
  ds_read_b64_tr_b16 a[30:31], v3 offset:24064
  s_add_u32 s46, s73, 4096
  buffer_load_dwordx4 a[68:71], v4, s[28:31], s46 offen offset:3072 sc1
  v_mfma_f32_32x32x16_bf16 v[128:143], a[4:7], a[160:163], v[128:143]
  ds_read_b64_tr_b16 a[0:1], v1 offset:35840
  ds_read_b64_tr_b16 a[2:3], v2 offset:10240
  s_add_u32 s46, s73, 8192
  buffer_load_dwordx4 a[72:75], v4, s[28:31], s46 offen offset:0 sc1
  s_waitcnt vmcnt(21)
  v_mfma_f32_32x32x16_bf16 v[112:127], a[8:11], a[164:167], v[112:127]
  ds_read_b64_tr_b16 a[4:5], v1 offset:36352
  ds_read_b64_tr_b16 a[6:7], v2 offset:10752
  buffer_load_dwordx2 v[32:33], v19, s[8:11], 0 offen offset:0
  s_waitcnt lgkmcnt(8)
  v_mfma_f32_32x32x16_bf16 v[128:143], a[12:15], a[164:167], v[128:143]
  ds_read_b64_tr_b16 a[8:9], v2 offset:50176
  ds_read_b64_tr_b16 a[10:11], v3 offset:24576
  buffer_load_dwordx2 v[34:35], v22, s[32:35], 0 offen offset:0
  s_waitcnt vmcnt(20)
  v_mfma_f32_32x32x16_bf16 v[112:127], a[16:19], a[168:171], v[112:127]
  ds_read_b64_tr_b16 a[12:13], v2 offset:50688
  ds_read_b64_tr_b16 a[14:15], v3 offset:25088
  buffer_load_dwordx2 v[36:37], v19, s[8:11], 0 offen offset:256
  v_mfma_f32_32x32x16_bf16 v[128:143], a[20:23], a[168:171], v[128:143]
  ds_read_b64_tr_b16 a[16:17], v1 offset:36864
  ds_read_b64_tr_b16 a[18:19], v2 offset:11264
  buffer_load_dwordx2 v[38:39], v22, s[32:35], 0 offen offset:256
  s_waitcnt vmcnt(19) lgkmcnt(8)
  v_mfma_f32_32x32x16_bf16 v[112:127], a[24:27], a[172:175], v[112:127]
  ds_read_b64_tr_b16 a[20:21], v1 offset:37376
  ds_read_b64_tr_b16 a[22:23], v2 offset:11776
  buffer_load_dwordx2 v[40:41], v19, s[8:11], 0 offen offset:512
  v_mfma_f32_32x32x16_bf16 v[128:143], a[28:31], a[172:175], v[128:143]
  ds_read_b64_tr_b16 a[24:25], v2 offset:51200
  ds_read_b64_tr_b16 a[26:27], v3 offset:25600
  buffer_load_dwordx2 v[42:43], v22, s[32:35], 0 offen offset:512
  s_waitcnt vmcnt(19)
  v_mfma_f32_32x32x16_bf16 v[112:127], a[0:3], a[176:179], v[112:127]
  ds_read_b64_tr_b16 a[28:29], v2 offset:51712
  ds_read_b64_tr_b16 a[30:31], v3 offset:26112
  buffer_load_dwordx2 v[44:45], v19, s[8:11], 0 offen offset:768
  s_waitcnt lgkmcnt(8)
  v_mfma_f32_32x32x16_bf16 v[128:143], a[4:7], a[176:179], v[128:143]
  ds_read_b64_tr_b16 a[0:1], v1 offset:38912
  ds_read_b64_tr_b16 a[2:3], v2 offset:13312
  buffer_load_dwordx2 v[46:47], v22, s[32:35], 0 offen offset:768
  s_waitcnt vmcnt(20)
  v_mfma_f32_32x32x16_bf16 v[112:127], a[8:11], a[180:183], v[112:127]
  ds_read_b64_tr_b16 a[4:5], v1 offset:39424
  ds_read_b64_tr_b16 a[6:7], v2 offset:13824
  buffer_load_dwordx2 v[48:49], v19, s[8:11], 0 offen offset:1024
  v_mfma_f32_32x32x16_bf16 v[128:143], a[12:15], a[180:183], v[128:143]
  ds_read_b64_tr_b16 a[8:9], v2 offset:53248
  ds_read_b64_tr_b16 a[10:11], v3 offset:27648
  buffer_load_dwordx2 v[50:51], v22, s[32:35], 0 offen offset:1024
  s_waitcnt vmcnt(21) lgkmcnt(8)
  v_mfma_f32_32x32x16_bf16 v[112:127], a[16:19], a[184:187], v[112:127]
  ds_read_b64_tr_b16 a[12:13], v2 offset:53760
  ds_read_b64_tr_b16 a[14:15], v3 offset:28160
  v_mfma_f32_32x32x16_bf16 v[128:143], a[20:23], a[184:187], v[128:143]
  ds_read_b64_tr_b16 a[16:17], v1 offset:39936
  ds_read_b64_tr_b16 a[18:19], v2 offset:14336
  s_waitcnt vmcnt(20)
  v_mfma_f32_32x32x16_bf16 v[112:127], a[24:27], a[188:191], v[112:127]
  ds_read_b64_tr_b16 a[20:21], v1 offset:40448
  ds_read_b64_tr_b16 a[22:23], v2 offset:14848
  s_waitcnt lgkmcnt(8)
  v_mfma_f32_32x32x16_bf16 v[128:143], a[28:31], a[188:191], v[128:143]
  ds_read_b64_tr_b16 a[24:25], v2 offset:54272
  ds_read_b64_tr_b16 a[26:27], v3 offset:28672
  s_waitcnt vmcnt(19)
  v_mfma_f32_32x32x16_bf16 v[112:127], a[0:3], a[40:43], v[112:127]
  ds_read_b64_tr_b16 a[28:29], v2 offset:54784
  ds_read_b64_tr_b16 a[30:31], v3 offset:29184
  v_mfma_f32_32x32x16_bf16 v[128:143], a[4:7], a[40:43], v[128:143]
  ds_read_b64_tr_b16 a[0:1], v1 offset:40960
  ds_read_b64_tr_b16 a[2:3], v2 offset:15360
  s_waitcnt vmcnt(17) lgkmcnt(8)
  v_mfma_f32_32x32x16_bf16 v[112:127], a[8:11], a[44:47], v[112:127]
  ds_read_b64_tr_b16 a[4:5], v1 offset:41472
  ds_read_b64_tr_b16 a[6:7], v2 offset:15872
  v_mfma_f32_32x32x16_bf16 v[128:143], a[12:15], a[44:47], v[128:143]
  ds_read_b64_tr_b16 a[8:9], v2 offset:55296
  ds_read_b64_tr_b16 a[10:11], v3 offset:29696
  s_waitcnt vmcnt(16)
  v_mfma_f32_32x32x16_bf16 v[112:127], a[16:19], a[48:51], v[112:127]
  ds_read_b64_tr_b16 a[12:13], v2 offset:55808
  ds_read_b64_tr_b16 a[14:15], v3 offset:30208
  s_waitcnt lgkmcnt(8)
  v_mfma_f32_32x32x16_bf16 v[128:143], a[20:23], a[48:51], v[128:143]
  ds_read_b64_tr_b16 a[16:17], v1 offset:41984
  ds_read_b64_tr_b16 a[18:19], v2 offset:16384
  s_waitcnt vmcnt(15)
  v_mfma_f32_32x32x16_bf16 v[112:127], a[24:27], a[52:55], v[112:127]
  ds_read_b64_tr_b16 a[20:21], v1 offset:42496
  ds_read_b64_tr_b16 a[22:23], v2 offset:16896
  v_mfma_f32_32x32x16_bf16 v[128:143], a[28:31], a[52:55], v[128:143]
  ds_read_b64_tr_b16 a[24:25], v2 offset:56320
  ds_read_b64_tr_b16 a[26:27], v3 offset:30720
  s_waitcnt vmcnt(14) lgkmcnt(8)
  v_mfma_f32_32x32x16_bf16 v[112:127], a[0:3], a[56:59], v[112:127]
  ds_read_b64_tr_b16 a[28:29], v2 offset:56832
  ds_read_b64_tr_b16 a[30:31], v3 offset:31232
  v_mfma_f32_32x32x16_bf16 v[128:143], a[4:7], a[56:59], v[128:143]
  ds_read_b64_tr_b16 a[0:1], v1 offset:37888
  ds_read_b64_tr_b16 a[2:3], v2 offset:12288
  s_waitcnt vmcnt(13)
  v_mfma_f32_32x32x16_bf16 v[112:127], a[8:11], a[60:63], v[112:127]
  ds_read_b64_tr_b16 a[4:5], v1 offset:38400
  ds_read_b64_tr_b16 a[6:7], v2 offset:12800
  s_waitcnt lgkmcnt(8)
  v_mfma_f32_32x32x16_bf16 v[128:143], a[12:15], a[60:63], v[128:143]
  ds_read_b64_tr_b16 a[8:9], v1 offset:43008
  ds_read_b64_tr_b16 a[10:11], v2 offset:17408
  s_waitcnt vmcnt(12)
  v_mfma_f32_32x32x16_bf16 v[112:127], a[16:19], a[64:67], v[112:127]
  ds_read_b64_tr_b16 a[12:13], v1 offset:43520
  ds_read_b64_tr_b16 a[14:15], v2 offset:17920
  v_mfma_f32_32x32x16_bf16 v[128:143], a[20:23], a[64:67], v[128:143]
  ds_read_b64_tr_b16 a[16:17], v2 offset:57344
  ds_read_b64_tr_b16 a[18:19], v3 offset:31744
  s_waitcnt vmcnt(11) lgkmcnt(8)
  v_mfma_f32_32x32x16_bf16 v[112:127], a[24:27], a[68:71], v[112:127]
  ds_read_b64_tr_b16 a[20:21], v2 offset:57856
  ds_read_b64_tr_b16 a[22:23], v3 offset:32256
  v_mfma_f32_32x32x16_bf16 v[128:143], a[28:31], a[68:71], v[128:143]
  ds_read_b64_tr_b16 a[24:25], v1 offset:4096
  ds_read_b64_tr_b16 a[26:27], v1 offset:44032
  s_waitcnt vmcnt(10)
  v_mfma_f32_32x32x16_bf16 v[112:127], a[0:3], a[72:75], v[112:127]
  ds_read_b64_tr_b16 a[28:29], v1 offset:4608
  ds_read_b64_tr_b16 a[30:31], v1 offset:44544
  s_waitcnt lgkmcnt(8)
  v_mfma_f32_32x32x16_bf16 v[128:143], a[4:7], a[72:75], v[128:143]
  ds_read_b64_tr_b16 a[0:1], v2 offset:18432
  ds_read_b64_tr_b16 a[2:3], v2 offset:58368
  v_mfma_f32_32x32x16_bf16 v[144:159], a[8:11], a[160:163], v[144:159]
  ds_read_b64_tr_b16 a[4:5], v2 offset:18944
  ds_read_b64_tr_b16 a[6:7], v2 offset:58880
  v_mfma_f32_32x32x16_bf16 v[160:175], a[12:15], a[160:163], v[160:175]
  ds_read_b64_tr_b16 a[8:9], v1 offset:5120
FF_H9:
  s_cbranch_execz FF_H13
  ds_read_b64_tr_b16 a[10:11], v1 offset:45056
  s_waitcnt lgkmcnt(8)
  v_mfma_f32_32x32x16_bf16 v[144:159], a[16:19], a[164:167], v[144:159]
  ds_read_b64_tr_b16 a[12:13], v1 offset:5632
  ds_read_b64_tr_b16 a[14:15], v1 offset:45568
  s_add_u32 s99, s90, 0
  v_cvt_pk_bf16_f32 v112, v112, v113
  v_cvt_pk_bf16_f32 v113, v114, v115
  v_mfma_f32_32x32x16_bf16 v[160:175], a[20:23], a[164:167], v[160:175]
  ds_read_b64_tr_b16 a[16:17], v2 offset:19456
  ds_read_b64_tr_b16 a[18:19], v2 offset:59392
  v_cvt_pk_bf16_f32 v114, v116, v117
  v_cvt_pk_bf16_f32 v115, v118, v119
  v_mfma_f32_32x32x16_bf16 v[144:159], a[24:27], a[168:171], v[144:159]
  ds_read_b64_tr_b16 a[20:21], v2 offset:19968
  ds_read_b64_tr_b16 a[22:23], v2 offset:59904
  s_waitcnt lgkmcnt(8)
  v_mfma_f32_32x32x16_bf16 v[160:175], a[28:31], a[168:171], v[160:175]
  s_barrier
  ds_read_b64_tr_b16 a[24:25], v1 offset:6144
  ds_read_b64_tr_b16 a[26:27], v1 offset:46080
  v_mfma_f32_32x32x16_bf16 v[144:159], a[0:3], a[172:175], v[144:159]
  ds_read_b64_tr_b16 a[28:29], v1 offset:6656
  ds_read_b64_tr_b16 a[30:31], v1 offset:46592
  buffer_store_dwordx4 v[112:115], v7, s[28:31], s99 offen offset:0 sc1
  v_mfma_f32_32x32x16_bf16 v[160:175], a[4:7], a[172:175], v[160:175]
  ds_read_b64_tr_b16 a[0:1], v2 offset:20480
  ds_read_b64_tr_b16 a[2:3], v2 offset:60416
  s_waitcnt lgkmcnt(8)
  v_mfma_f32_32x32x16_bf16 v[144:159], a[8:11], a[176:179], v[144:159]
  ds_read_b64_tr_b16 a[4:5], v2 offset:20992
  ds_read_b64_tr_b16 a[6:7], v2 offset:60928
  v_cvt_pk_bf16_f32 v116, v120, v121
  v_cvt_pk_bf16_f32 v117, v122, v123
  v_cvt_pk_bf16_f32 v118, v124, v125
  v_mfma_f32_32x32x16_bf16 v[160:175], a[12:15], a[176:179], v[160:175]
  ds_read_b64_tr_b16 a[8:9], v1 offset:7168
  ds_read_b64_tr_b16 a[10:11], v1 offset:47104
  v_cvt_pk_bf16_f32 v119, v126, v127
  v_mfma_f32_32x32x16_bf16 v[144:159], a[16:19], a[180:183], v[144:159]
  ds_read_b64_tr_b16 a[12:13], v1 offset:7680
  ds_read_b64_tr_b16 a[14:15], v1 offset:47616
  s_waitcnt lgkmcnt(8)
  v_mfma_f32_32x32x16_bf16 v[160:175], a[20:23], a[180:183], v[160:175]
  ds_read_b64_tr_b16 a[16:17], v2 offset:21504
  ds_read_b64_tr_b16 a[18:19], v2 offset:61440
  buffer_store_dwordx4 v[116:119], v7, s[28:31], s99 offen offset:256 sc1
  v_mfma_f32_32x32x16_bf16 v[144:159], a[24:27], a[184:187], v[144:159]
  ds_read_b64_tr_b16 a[20:21], v2 offset:22016
  ds_read_b64_tr_b16 a[22:23], v2 offset:61952
  v_mfma_f32_32x32x16_bf16 v[160:175], a[28:31], a[184:187], v[160:175]
  ds_read_b64_tr_b16 a[24:25], v1 offset:8192
  ds_read_b64_tr_b16 a[26:27], v1 offset:48128
  v_cvt_pk_bf16_f32 v128, v128, v129
  v_cvt_pk_bf16_f32 v129, v130, v131
  s_waitcnt lgkmcnt(8)
  v_mfma_f32_32x32x16_bf16 v[144:159], a[0:3], a[188:191], v[144:159]
  ds_read_b64_tr_b16 a[28:29], v1 offset:8704
  ds_read_b64_tr_b16 a[30:31], v1 offset:48640
  v_cvt_pk_bf16_f32 v130, v132, v133
  v_cvt_pk_bf16_f32 v131, v134, v135
  v_mfma_f32_32x32x16_bf16 v[160:175], a[4:7], a[188:191], v[160:175]
  ds_read_b64_tr_b16 a[0:1], v2 offset:22528
  ds_read_b64_tr_b16 a[2:3], v2 offset:62464
  buffer_store_dwordx4 v[128:131], v7, s[28:31], s99 offen offset:512 sc1
  v_mfma_f32_32x32x16_bf16 v[144:159], a[8:11], a[40:43], v[144:159]
  ds_read_b64_tr_b16 a[4:5], v2 offset:23040
  ds_read_b64_tr_b16 a[6:7], v2 offset:62976
  s_waitcnt lgkmcnt(8)
  v_mfma_f32_32x32x16_bf16 v[160:175], a[12:15], a[40:43], v[160:175]
  ds_read_b64_tr_b16 a[8:9], v1 offset:9216
  ds_read_b64_tr_b16 a[10:11], v1 offset:49152
  v_cvt_pk_bf16_f32 v132, v136, v137
  v_cvt_pk_bf16_f32 v133, v138, v139
  v_cvt_pk_bf16_f32 v134, v140, v141
  v_mfma_f32_32x32x16_bf16 v[144:159], a[16:19], a[44:47], v[144:159]
  ds_read_b64_tr_b16 a[12:13], v1 offset:9728
  ds_read_b64_tr_b16 a[14:15], v1 offset:49664
  v_cvt_pk_bf16_f32 v135, v142, v143
  v_mfma_f32_32x32x16_bf16 v[160:175], a[20:23], a[44:47], v[160:175]
  ds_read_b64_tr_b16 a[16:17], v2 offset:23552
  ds_read_b64_tr_b16 a[18:19], v2 offset:63488
  s_waitcnt lgkmcnt(8)
  v_mfma_f32_32x32x16_bf16 v[144:159], a[24:27], a[48:51], v[144:159]
  ds_read_b64_tr_b16 a[20:21], v2 offset:24064
  ds_read_b64_tr_b16 a[22:23], v2 offset:64000
  buffer_store_dwordx4 v[132:135], v7, s[28:31], s99 offen offset:768 sc1
  v_mfma_f32_32x32x16_bf16 v[160:175], a[28:31], a[48:51], v[160:175]
  ds_read_b64_tr_b16 a[24:25], v1 offset:10240
  ds_read_b64_tr_b16 a[26:27], v1 offset:50176
  v_mfma_f32_32x32x16_bf16 v[144:159], a[0:3], a[52:55], v[144:159]
  ds_read_b64_tr_b16 a[28:29], v1 offset:10752
  ds_read_b64_tr_b16 a[30:31], v1 offset:50688
  s_waitcnt lgkmcnt(8)
  v_mfma_f32_32x32x16_bf16 v[160:175], a[4:7], a[52:55], v[160:175]
  ds_read_b64_tr_b16 a[0:1], v2 offset:24576
  ds_read_b64_tr_b16 a[2:3], v2 offset:64512
  s_waitcnt vmcnt(13)
  v_lshlrev_b32 v64, 16, v32
  v_and_b32 v65, s41, v32
  v_lshlrev_b32 v66, 16, v33
  v_and_b32 v67, s41, v33
  v_mfma_f32_32x32x16_bf16 v[144:159], a[8:11], a[56:59], v[144:159]
  ds_read_b64_tr_b16 a[4:5], v2 offset:25088
  ds_read_b64_tr_b16 a[6:7], v2 offset:65024
  s_waitcnt vmcnt(12)
  v_lshlrev_b32 v32, 16, v34
  v_and_b32 v33, s41, v34
  v_lshlrev_b32 v34, 16, v35
  v_and_b32 v35, s41, v35
  v_mfma_f32_32x32x16_bf16 v[160:175], a[12:15], a[56:59], v[160:175]
  ds_read_b64_tr_b16 a[8:9], v2 offset:52224
  ds_read_b64_tr_b16 a[10:11], v3 offset:26624
  v_add_f32 v64, v64, v32
  v_add_f32 v65, v65, v33
  v_add_f32 v66, v66, v34
  s_waitcnt lgkmcnt(8)
  v_mfma_f32_32x32x16_bf16 v[144:159], a[16:19], a[60:63], v[144:159]
  ds_read_b64_tr_b16 a[12:13], v2 offset:52736
  ds_read_b64_tr_b16 a[14:15], v3 offset:27136
  v_add_f32 v67, v67, v35
  s_waitcnt vmcnt(11)
  v_lshlrev_b32 v68, 16, v36
  v_and_b32 v69, s41, v36
  v_lshlrev_b32 v70, 16, v37
  v_mfma_f32_32x32x16_bf16 v[160:175], a[20:23], a[60:63], v[160:175]
  ds_read_b64_tr_b16 a[16:17], v1 offset:11264
  ds_read_b64_tr_b16 a[18:19], v1 offset:51200
  v_and_b32 v71, s41, v37
  s_waitcnt vmcnt(10)
  v_lshlrev_b32 v36, 16, v38
  v_and_b32 v37, s41, v38
  v_lshlrev_b32 v38, 16, v39
  v_mfma_f32_32x32x16_bf16 v[144:159], a[24:27], a[64:67], v[144:159]
  ds_read_b64_tr_b16 a[20:21], v1 offset:11776
  ds_read_b64_tr_b16 a[22:23], v1 offset:51712
  v_and_b32 v39, s41, v39
  v_add_f32 v68, v68, v36
  v_add_f32 v69, v69, v37
  s_waitcnt lgkmcnt(8)
  v_mfma_f32_32x32x16_bf16 v[160:175], a[28:31], a[64:67], v[160:175]
  ds_read_b64_tr_b16 a[24:25], v2 offset:25600
  ds_read_b64_tr_b16 a[26:27], v3 offset:0
  v_add_f32 v70, v70, v38
  v_add_f32 v71, v71, v39
  s_waitcnt vmcnt(9)
  v_lshlrev_b32 v72, 16, v40
  v_and_b32 v73, s41, v40
  v_mfma_f32_32x32x16_bf16 v[144:159], a[0:3], a[68:71], v[144:159]
  ds_read_b64_tr_b16 a[28:29], v2 offset:26112
  ds_read_b64_tr_b16 a[30:31], v3 offset:512
  v_lshlrev_b32 v74, 16, v41
  v_and_b32 v75, s41, v41
  s_waitcnt vmcnt(8)
  v_lshlrev_b32 v40, 16, v42
  v_and_b32 v41, s41, v42
  v_mfma_f32_32x32x16_bf16 v[160:175], a[4:7], a[68:71], v[160:175]
  ds_read_b64_tr_b16 a[0:1], v1 offset:12288
  ds_read_b64_tr_b16 a[2:3], v1 offset:52224
  v_lshlrev_b32 v42, 16, v43
  v_and_b32 v43, s41, v43
  v_add_f32 v72, v72, v40
  s_waitcnt lgkmcnt(8)
  v_mfma_f32_32x32x16_bf16 v[144:159], a[8:11], a[72:75], v[144:159]
  ds_read_b64_tr_b16 a[4:5], v1 offset:12800
  ds_read_b64_tr_b16 a[6:7], v1 offset:52736
  v_add_f32 v73, v73, v41
  v_add_f32 v74, v74, v42
  v_add_f32 v75, v75, v43
  s_waitcnt vmcnt(7)
  v_lshlrev_b32 v76, 16, v44
  v_mfma_f32_32x32x16_bf16 v[160:175], a[12:15], a[72:75], v[160:175]
  ds_read_b64_tr_b16 a[8:9], v2 offset:26624
  ds_read_b64_tr_b16 a[10:11], v3 offset:1024
  v_and_b32 v77, s41, v44
  v_lshlrev_b32 v78, 16, v45
  v_and_b32 v79, s41, v45
  s_waitcnt vmcnt(6)
  v_lshlrev_b32 v44, 16, v46
  v_mfma_f32_32x32x16_bf16 v[176:191], a[16:19], a[160:163], v[176:191]
  ds_read_b64_tr_b16 a[12:13], v2 offset:27136
  ds_read_b64_tr_b16 a[14:15], v3 offset:1536
  v_and_b32 v45, s41, v46
  v_lshlrev_b32 v46, 16, v47
  v_and_b32 v47, s41, v47
  s_waitcnt lgkmcnt(8)
  v_mfma_f32_32x32x16_bf16 v[192:207], a[20:23], a[160:163], v[192:207]
  ds_read_b64_tr_b16 a[16:17], v1 offset:13312
  ds_read_b64_tr_b16 a[18:19], v1 offset:53248
  v_add_f32 v76, v76, v44
  v_add_f32 v77, v77, v45
  v_add_f32 v78, v78, v46
  v_add_f32 v79, v79, v47
  v_mfma_f32_32x32x16_bf16 v[176:191], a[24:27], a[164:167], v[176:191]
  ds_read_b64_tr_b16 a[20:21], v1 offset:13824
  ds_read_b64_tr_b16 a[22:23], v1 offset:53760
  s_add_u32 s99, s90, 65536
  v_cvt_pk_bf16_f32 v144, v144, v145
  v_cvt_pk_bf16_f32 v145, v146, v147
  v_mfma_f32_32x32x16_bf16 v[192:207], a[28:31], a[164:167], v[192:207]
  ds_read_b64_tr_b16 a[24:25], v2 offset:27648
  ds_read_b64_tr_b16 a[26:27], v3 offset:2048
  v_cvt_pk_bf16_f32 v146, v148, v149
  v_cvt_pk_bf16_f32 v147, v150, v151
  s_waitcnt lgkmcnt(8)
  v_mfma_f32_32x32x16_bf16 v[176:191], a[0:3], a[168:171], v[176:191]
  ds_read_b64_tr_b16 a[28:29], v2 offset:28160
  ds_read_b64_tr_b16 a[30:31], v3 offset:2560
  buffer_store_dwordx4 v[144:147], v7, s[28:31], s99 offen offset:0 sc1
  v_mfma_f32_32x32x16_bf16 v[192:207], a[4:7], a[168:171], v[192:207]
  ds_read_b64_tr_b16 a[0:1], v1 offset:14336
  ds_read_b64_tr_b16 a[2:3], v1 offset:54272
  s_waitcnt vmcnt(6)
  v_lshlrev_b32 v80, 16, v48
  v_and_b32 v81, s41, v48
  v_lshlrev_b32 v82, 16, v49
  v_and_b32 v83, s41, v49
  v_mfma_f32_32x32x16_bf16 v[176:191], a[8:11], a[172:175], v[176:191]
  ds_read_b64_tr_b16 a[4:5], v1 offset:14848
  ds_read_b64_tr_b16 a[6:7], v1 offset:54784
  v_cvt_pk_bf16_f32 v148, v152, v153
  v_cvt_pk_bf16_f32 v149, v154, v155
  s_waitcnt lgkmcnt(8)
  v_mfma_f32_32x32x16_bf16 v[192:207], a[12:15], a[172:175], v[192:207]
  ds_read_b64_tr_b16 a[8:9], v2 offset:28672
  ds_read_b64_tr_b16 a[10:11], v3 offset:3072
  v_cvt_pk_bf16_f32 v150, v156, v157
  v_cvt_pk_bf16_f32 v151, v158, v159
  s_waitcnt vmcnt(5)
  v_lshlrev_b32 v48, 16, v50
  v_mfma_f32_32x32x16_bf16 v[176:191], a[16:19], a[176:179], v[176:191]
  ds_read_b64_tr_b16 a[12:13], v2 offset:29184
  ds_read_b64_tr_b16 a[14:15], v3 offset:3584
  buffer_store_dwordx4 v[148:151], v7, s[28:31], s99 offen offset:256 sc1
  v_mfma_f32_32x32x16_bf16 v[192:207], a[20:23], a[176:179], v[192:207]
  ds_read_b64_tr_b16 a[16:17], v1 offset:16384
  ds_read_b64_tr_b16 a[18:19], v1 offset:56320
  v_and_b32 v49, s41, v50
  v_lshlrev_b32 v50, 16, v51
  v_and_b32 v51, s41, v51
  s_waitcnt lgkmcnt(8)
  v_mfma_f32_32x32x16_bf16 v[176:191], a[24:27], a[180:183], v[176:191]
  ds_read_b64_tr_b16 a[20:21], v1 offset:16896
  ds_read_b64_tr_b16 a[22:23], v1 offset:56832
  v_cvt_pk_bf16_f32 v160, v160, v161
  v_cvt_pk_bf16_f32 v161, v162, v163
  v_cvt_pk_bf16_f32 v162, v164, v165
  v_mfma_f32_32x32x16_bf16 v[192:207], a[28:31], a[180:183], v[192:207]
  ds_read_b64_tr_b16 a[24:25], v2 offset:30720
  ds_read_b64_tr_b16 a[26:27], v3 offset:5120
  v_cvt_pk_bf16_f32 v163, v166, v167
  v_add_f32 v80, v80, v48
  v_add_f32 v81, v81, v49
  v_add_f32 v82, v82, v50
  v_mfma_f32_32x32x16_bf16 v[176:191], a[0:3], a[184:187], v[176:191]
  ds_read_b64_tr_b16 a[28:29], v2 offset:31232
  ds_read_b64_tr_b16 a[30:31], v3 offset:5632
  s_waitcnt vmcnt(2)
  v_mov_b32 v14, 4
  buffer_store_dword v14, off, s[28:31], s42 offset:2048 sc1
  s_waitcnt lgkmcnt(8)
  v_mfma_f32_32x32x16_bf16 v[192:207], a[4:7], a[184:187], v[192:207]
  ds_read_b64_tr_b16 a[0:1], v1 offset:17408
  ds_read_b64_tr_b16 a[2:3], v1 offset:57344
  v_add_f32 v83, v83, v51
  v_mfma_f32_32x32x16_bf16 v[176:191], a[8:11], a[188:191], v[176:191]
  ds_read_b64_tr_b16 a[4:5], v1 offset:17920
  ds_read_b64_tr_b16 a[6:7], v1 offset:57856
  buffer_store_dwordx4 v[160:163], v7, s[28:31], s99 offen offset:512 sc1
  v_mfma_f32_32x32x16_bf16 v[192:207], a[12:15], a[188:191], v[192:207]
  ds_read_b64_tr_b16 a[8:9], v2 offset:31744
  ds_read_b64_tr_b16 a[10:11], v3 offset:6144
  s_waitcnt lgkmcnt(8)
  v_mfma_f32_32x32x16_bf16 v[176:191], a[16:19], a[40:43], v[176:191]
  ds_read_b64_tr_b16 a[12:13], v2 offset:32256
  ds_read_b64_tr_b16 a[14:15], v3 offset:6656
  v_cvt_pk_bf16_f32 v164, v168, v169
  v_cvt_pk_bf16_f32 v165, v170, v171
  v_cvt_pk_bf16_f32 v166, v172, v173
  v_mfma_f32_32x32x16_bf16 v[192:207], a[20:23], a[40:43], v[192:207]
  s_barrier
  ds_read_b64_tr_b16 a[16:17], v1 offset:18432
  ds_read_b64_tr_b16 a[18:19], v1 offset:58368
  v_cvt_pk_bf16_f32 v167, v174, v175
  v_mfma_f32_32x32x16_bf16 v[176:191], a[24:27], a[44:47], v[176:191]
  ds_read_b64_tr_b16 a[20:21], v1 offset:18944
  ds_read_b64_tr_b16 a[22:23], v1 offset:58880
  s_waitcnt lgkmcnt(8)
  v_mfma_f32_32x32x16_bf16 v[192:207], a[28:31], a[44:47], v[192:207]
  ds_read_b64_tr_b16 a[24:25], v2 offset:32768
  ds_read_b64_tr_b16 a[26:27], v3 offset:7168
  buffer_store_dwordx4 v[164:167], v7, s[28:31], s99 offen offset:768 sc1
  v_mfma_f32_32x32x16_bf16 v[176:191], a[0:3], a[48:51], v[176:191]
  ds_read_b64_tr_b16 a[28:29], v2 offset:33280
  ds_read_b64_tr_b16 a[30:31], v3 offset:7680
  v_mfma_f32_32x32x16_bf16 v[192:207], a[4:7], a[48:51], v[192:207]
  ds_read_b64_tr_b16 a[0:1], v1 offset:19456
  ds_read_b64_tr_b16 a[2:3], v1 offset:59392
  s_waitcnt lgkmcnt(8)
  v_mfma_f32_32x32x16_bf16 v[176:191], a[8:11], a[52:55], v[176:191]
  ds_read_b64_tr_b16 a[4:5], v1 offset:19968
  ds_read_b64_tr_b16 a[6:7], v1 offset:59904
  v_mfma_f32_32x32x16_bf16 v[192:207], a[12:15], a[52:55], v[192:207]
  ds_read_b64_tr_b16 a[8:9], v2 offset:33792
  ds_read_b64_tr_b16 a[10:11], v3 offset:8192
  v_mfma_f32_32x32x16_bf16 v[176:191], a[16:19], a[56:59], v[176:191]
  ds_read_b64_tr_b16 a[12:13], v2 offset:34304
  ds_read_b64_tr_b16 a[14:15], v3 offset:8704
  buffer_load_dword v21, v20, s[28:31], s88 offen sc1
  s_waitcnt lgkmcnt(8)
  v_mfma_f32_32x32x16_bf16 v[192:207], a[20:23], a[56:59], v[192:207]
  ds_read_b64_tr_b16 a[16:17], v1 offset:15360
  ds_read_b64_tr_b16 a[18:19], v1 offset:55296
  v_mfma_f32_32x32x16_bf16 v[176:191], a[24:27], a[60:63], v[176:191]
  ds_read_b64_tr_b16 a[20:21], v1 offset:15872
  ds_read_b64_tr_b16 a[22:23], v1 offset:55808
  v_mfma_f32_32x32x16_bf16 v[192:207], a[28:31], a[60:63], v[192:207]
  s_waitcnt lgkmcnt(6)
  v_mfma_f32_32x32x16_bf16 v[176:191], a[0:3], a[64:67], v[176:191]
  v_mfma_f32_32x32x16_bf16 v[192:207], a[4:7], a[64:67], v[192:207]
  v_mfma_f32_32x32x16_bf16 v[176:191], a[8:11], a[68:71], v[176:191]
  s_waitcnt lgkmcnt(0)
  v_mfma_f32_32x32x16_bf16 v[192:207], a[12:15], a[68:71], v[192:207]
  v_mfma_f32_32x32x16_bf16 v[176:191], a[16:19], a[72:75], v[176:191]
  v_mfma_f32_32x32x16_bf16 v[192:207], a[20:23], a[72:75], v[192:207]
  s_add_u32 s99, s90, 131072
  s_nop 9
  v_cvt_pk_bf16_f32 v176, v176, v177
  v_cvt_pk_bf16_f32 v177, v178, v179
  v_cvt_pk_bf16_f32 v178, v180, v181
  v_cvt_pk_bf16_f32 v179, v182, v183
  buffer_store_dwordx4 v[176:179], v7, s[28:31], s99 offen offset:0 sc1
  v_cvt_pk_bf16_f32 v180, v184, v185
  v_cvt_pk_bf16_f32 v181, v186, v187
  v_cvt_pk_bf16_f32 v182, v188, v189
  v_cvt_pk_bf16_f32 v183, v190, v191
  buffer_store_dwordx4 v[180:183], v7, s[28:31], s99 offen offset:256 sc1
  v_cvt_pk_bf16_f32 v192, v192, v193
  v_cvt_pk_bf16_f32 v193, v194, v195
  v_cvt_pk_bf16_f32 v194, v196, v197
  v_cvt_pk_bf16_f32 v195, v198, v199
  buffer_store_dwordx4 v[192:195], v7, s[28:31], s99 offen offset:512 sc1
  v_cvt_pk_bf16_f32 v196, v200, v201
  v_cvt_pk_bf16_f32 v197, v202, v203
  v_cvt_pk_bf16_f32 v198, v204, v205
  v_cvt_pk_bf16_f32 v199, v206, v207
  buffer_store_dwordx4 v[196:199], v7, s[28:31], s99 offen offset:768 sc1
  s_waitcnt vmcnt(0)
  v_mov_b32 v14, 6
  buffer_store_dword v14, off, s[28:31], s42 offset:2048 sc1
  s_mov_b32 s92, 7
  s_mov_b32 s93, 0
  s_mov_b32 s101, 0
  v_lshrrev_b32 v84, 6, v0
  v_lshlrev_b32 v84, 3, v84
  s_branch FF_TIN
FF_TLOOP:
  s_waitcnt vmcnt(0)
  s_bitcmp1_b32 s93, 0
  s_cbranch_scc0 FF_TSa_0
  v_mfma_f32_16x16x32_bf16 v[64:67], a[32:35], a[76:79], v[64:67]
  v_mfma_f32_16x16x32_bf16 v[68:71], a[36:39], a[80:83], v[68:71]
  v_mfma_f32_16x16x32_bf16 v[76:79], a[32:35], a[84:87], v[76:79]
FF_TSa_0:
  s_bitcmp1_b32 s93, 1
  s_cbranch_scc0 FF_TSa_1
  v_mfma_f32_16x16x32_bf16 v[64:67], a[36:39], a[88:91], v[64:67]
  v_mfma_f32_16x16x32_bf16 v[72:75], a[32:35], a[92:95], v[72:75]
  v_mfma_f32_16x16x32_bf16 v[76:79], a[36:39], a[96:99], v[76:79]
FF_TSa_1:
  s_bitcmp1_b32 s93, 2
  s_cbranch_scc0 FF_TSa_2
  v_mfma_f32_16x16x32_bf16 v[68:71], a[32:35], a[100:103], v[68:71]
  v_mfma_f32_16x16x32_bf16 v[72:75], a[36:39], a[104:107], v[72:75]
  v_mfma_f32_16x16x32_bf16 v[80:83], a[32:35], a[108:111], v[80:83]
FF_TSa_2:
  s_mov_b32 s93, 0
FF_TIN:
  v_cmp_gt_u32 vcc, 4, v21
  v_cmp_gt_u32 s[46:47], 5, v21
  v_cmp_gt_u32 s[48:49], 6, v21
  s_mov_b32 s72, 6
  s_nop 2
  s_nop 0
  s_and_b32 s48, s48, s74
  s_cselect_b32 s72, 5, s72
  s_and_b32 s46, s46, s74
  s_cselect_b32 s72, 4, s72
  s_and_b32 s46, vcc_lo, s74
  s_cselect_b32 s72, 3, s72
  v_xor_b32 v84, 4, v84
  v_mov_b32 v85, s72
  ds_write_b32 v84, v85 offset:3584
  s_waitcnt lgkmcnt(0)
  s_barrier
  v_and_b32 v85, 4, v84
  ds_read_b32 v85, v85 offset:3584
  s_waitcnt lgkmcnt(0)
  v_readfirstlane_b32 s72, v85
  s_nop 4
  s_bitcmp1_b32 s92, 0
  s_cbranch_scc0 FF_TIa_0
  s_cmp_lt_u32 s72, 4
  s_cbranch_scc1 FF_TIa_0
  s_add_u32 s91, s89, 0
  buffer_load_dwordx4 a[76:79], v18, s[28:31], s91 offen offset:0 sc1
  s_add_u32 s91, s89, 196608
  buffer_load_dwordx4 a[80:83], v18, s[28:31], s91 offen offset:0 sc1
  s_add_u32 s91, s89, 393216
  buffer_load_dwordx4 a[84:87], v18, s[28:31], s91 offen offset:0 sc1
  s_bitset0_b32 s92, 0
  s_bitset1_b32 s93, 0
FF_TIa_0:
  s_bitcmp1_b32 s92, 1
  s_cbranch_scc0 FF_TIa_1
  s_cmp_lt_u32 s72, 5
  s_cbranch_scc1 FF_TIa_1
  s_add_u32 s91, s89, 65536
  buffer_load_dwordx4 a[88:91], v18, s[28:31], s91 offen offset:0 sc1
  s_add_u32 s91, s89, 262144
  buffer_load_dwordx4 a[92:95], v18, s[28:31], s91 offen offset:0 sc1
  s_add_u32 s91, s89, 458752
  buffer_load_dwordx4 a[96:99], v18, s[28:31], s91 offen offset:0 sc1
  s_bitset0_b32 s92, 1
  s_bitset1_b32 s93, 1
FF_TIa_1:
  s_bitcmp1_b32 s92, 2
  s_cbranch_scc0 FF_TIa_2
  s_cmp_lt_u32 s72, 6
  s_cbranch_scc1 FF_TIa_2
  s_add_u32 s91, s89, 131072
  buffer_load_dwordx4 a[100:103], v18, s[28:31], s91 offen offset:0 sc1
  s_add_u32 s91, s89, 327680
  buffer_load_dwordx4 a[104:107], v18, s[28:31], s91 offen offset:0 sc1
  s_add_u32 s91, s89, 524288
  buffer_load_dwordx4 a[108:111], v18, s[28:31], s91 offen offset:0 sc1
  s_bitset0_b32 s92, 2
  s_bitset1_b32 s93, 2
FF_TIa_2:
  s_cmp_eq_u32 s92, 0
  s_cbranch_scc1 FF_TDONE
  s_cmp_lg_u32 s93, 0
  s_cbranch_scc1 FF_TNS
FF_TNS:
  buffer_load_dword v21, v20, s[28:31], s88 offen sc1
  s_add_u32 s101, s101, 1
  s_cmp_lt_u32 s101, 30000
  s_cbranch_scc1 FF_TLOOP
FF_TDONE:
  s_waitcnt vmcnt(0)
  s_bitcmp1_b32 s93, 0
  s_cbranch_scc0 FF_TSb_0
  v_mfma_f32_16x16x32_bf16 v[64:67], a[32:35], a[76:79], v[64:67]
  v_mfma_f32_16x16x32_bf16 v[68:71], a[36:39], a[80:83], v[68:71]
  v_mfma_f32_16x16x32_bf16 v[76:79], a[32:35], a[84:87], v[76:79]
FF_TSb_0:
  s_bitcmp1_b32 s93, 1
  s_cbranch_scc0 FF_TSb_1
  v_mfma_f32_16x16x32_bf16 v[64:67], a[36:39], a[88:91], v[64:67]
  v_mfma_f32_16x16x32_bf16 v[72:75], a[32:35], a[92:95], v[72:75]
  v_mfma_f32_16x16x32_bf16 v[76:79], a[36:39], a[96:99], v[76:79]
FF_TSb_1:
  s_bitcmp1_b32 s93, 2
  s_cbranch_scc0 FF_TSb_2
  v_mfma_f32_16x16x32_bf16 v[68:71], a[32:35], a[100:103], v[68:71]
  v_mfma_f32_16x16x32_bf16 v[72:75], a[36:39], a[104:107], v[72:75]
  v_mfma_f32_16x16x32_bf16 v[80:83], a[32:35], a[108:111], v[80:83]
FF_TSb_2:
  s_mov_b32 s93, 0
  s_nop 7
  v_cvt_pk_bf16_f32 v64, v64, v65
  v_cvt_pk_bf16_f32 v65, v66, v67
  buffer_store_dwordx2 v[64:65], v19, s[64:67], 0 offen offset:0
  v_cvt_pk_bf16_f32 v68, v68, v69
  v_cvt_pk_bf16_f32 v69, v70, v71
  buffer_store_dwordx2 v[68:69], v19, s[64:67], 0 offen offset:256
  v_cvt_pk_bf16_f32 v72, v72, v73
  v_cvt_pk_bf16_f32 v73, v74, v75
  buffer_store_dwordx2 v[72:73], v19, s[64:67], 0 offen offset:512
  v_cvt_pk_bf16_f32 v76, v76, v77
  v_cvt_pk_bf16_f32 v77, v78, v79
  buffer_store_dwordx2 v[76:77], v19, s[64:67], 0 offen offset:768
  v_and_b32 v14, 32, v0
  v_lshl_add_u32 v19, v14, 24, v19
  v_cvt_pk_bf16_f32 v80, v80, v81
  v_cvt_pk_bf16_f32 v81, v82, v83
  buffer_store_dwordx2 v[80:81], v19, s[64:67], 0 offen offset:1024
FF_END:
  s_endpgm
FF_SP0:
  s_mov_b32 s101, 0
FF_SP0_L:
  s_sleep 48
  v_and_b32 v29, 0xc1, v0
  v_lshlrev_b32 v29, 7, v29
  buffer_load_dword v29, v29, s[36:39], 0 offen sc1
  s_waitcnt vmcnt(0)
  s_add_u32 s101, s101, 1
  s_cmp_eq_u32 s6, 0
  s_cselect_b32 s100, 128, 0
  v_cmp_gt_u32 vcc, s100, v29
  s_nop 4
  s_cmp_lg_u64 vcc, 0
  s_cbranch_scc0 FF_SP0_B
  s_cmp_lt_u32 s101, 30000
  s_cbranch_scc1 FF_SP0_L
  s_branch FF_SP0_B
FF_SP1:
  s_mov_b32 s101, 0
FF_SP1_L:
  s_sleep 2
  buffer_load_dword v16, v15, s[28:31], s43 offen sc1
  s_waitcnt vmcnt(0)
  s_add_u32 s101, s101, 1
  v_cmp_gt_u32 vcc, 1, v16
  s_nop 4
  s_and_b32 s46, vcc_lo, 7
  s_cbranch_scc0 FF_SP1_B
  s_cmp_lt_u32 s101, 30000
  s_cbranch_scc1 FF_SP1_L
  s_branch FF_SP1_B
FF_SP2:
  s_mov_b32 s101, 0
FF_SP2_L:
  s_sleep 2
  buffer_load_dword v17, v15, s[28:31], s43 offen sc1
  s_waitcnt vmcnt(0)
  s_add_u32 s101, s101, 1
  v_cmp_gt_u32 vcc, 2, v17
  s_nop 4
  s_and_b32 s46, vcc_lo, 7
  s_cbranch_scc0 FF_SP2_B
  s_cmp_lt_u32 s101, 30000
  s_cbranch_scc1 FF_SP2_L
  s_branch FF_SP2_B
FF_SP3:
  s_mov_b32 s101, 0
FF_SP3_L:
  s_sleep 2
  buffer_load_dword v13, v15, s[28:31], s43 offen sc1
  s_waitcnt vmcnt(0)
  s_add_u32 s101, s101, 1
  v_cmp_gt_u32 vcc, 3, v13
  s_nop 4
  s_and_b32 s46, vcc_lo, 15
  s_cbranch_scc0 FF_SP3_B
  s_cmp_lt_u32 s101, 30000
  s_cbranch_scc1 FF_SP3_L
  s_branch FF_SP3_B
FF_SP4:
  s_mov_b32 s101, 0
FF_SP4_L:
  s_sleep 2
  buffer_load_dword v16, off, s[28:31], s43 offset:12 sc1
  s_waitcnt vmcnt(0)
  s_add_u32 s101, s101, 1
  v_cmp_gt_u32 vcc, 1, v16
  s_nop 4
  s_cmp_lg_u64 vcc, 0
  s_cbranch_scc0 FF_SP4_B
  s_cmp_lt_u32 s101, 30000
  s_cbranch_scc1 FF_SP4_L
  s_branch FF_SP4_B
FF_LAST:
  s_endpgm
.p2align 12
AT_START:
  s_load_dwordx2 s[36:37], s[0:1], 72
  s_load_dwordx2 s[16:17], s[0:1], 64
  s_load_dwordx2 s[20:21], s[0:1], 56
  s_lshl_b32 s99, s7, 7
  s_add_u32 s51, s99, s98
  s_mul_i32 s50, s7, 221184
  s_add_u32 s7, s7, 1
  s_cmp_eq_u32 s7, 9
  s_cselect_b32 s7, 0, s7
  s_lshl_b32 s99, s7, 7
  s_add_u32 s53, s99, s98
  s_mul_i32 s52, s7, 221184
  s_add_u32 s51, s50, 13824
  s_add_u32 s53, s52, 13824
  v_lshrrev_b32 v50, 5, v32
  v_bfe_u32 v51, v32, 4, 1
  v_bfe_u32 v52, v32, 2, 2
  v_and_b32 v53, 3, v32
  v_lshl_add_u32 v55, v33, 1, v51
  v_lshl_add_u32 v55, v55, 3, v52
  v_lshlrev_b32 v57, 4, v53
  v_lshl_add_u32 v56, v50, 6, v57
  s_mul_i32 s47, s3, 288
  v_mul_u32_u24 v34, 3456, v55
  v_add_u32 v34, s47, v34
  v_mul_u32_u24 v35, 72, v50
  v_add3_u32 v8, v34, v35, v57
  v_mul_u32_u24 v35, 72, v53
  v_add_u32 v34, v34, v35
  v_mul_u32_u24 v35, 1160, v50
  v_sub_u32 v9, v34, v35
  v_add_u32 v9, 2368, v9
  v_mul_u32_u24 v35, 13824, v50
  v_add3_u32 v10, v34, v35, 64
  s_mov_b32 s14, 1990656
  s_mov_b32 s15, 0x20000
  s_add_u32 m0, s40, 19328
  s_nop 0
  buffer_load_dwordx4 v8, s[12:15], s50 offen offset:1152  lds
  s_add_u32 m0, s40, 20208
  s_nop 0
  buffer_load_dwordx4 v8, s[12:15], s50 offen offset:1296  lds
  s_getpc_b64 s[46:47]
AT_PC0:
  s_lshr_b32 s48, s2, 5
  s_lshl_b32 s48, s48, 2
  s_add_u32 s48, s48, s6
  s_mul_i32 s48, s48, 1536
  v_and_b32 v58, 63, v0
  v_min_u32 v58, 11, v58
  v_lshl_add_u32 v58, v58, 7, s48
  v_min_u32 v58, AT_LAST-AT_PC0, v58
  v_mov_b32 v59, s47
  v_add_co_u32 v58, vcc, s46, v58
  v_addc_co_u32 v59, vcc, 0, v59, vcc
  global_load_dword a40, v[58:59], off
  v_and_b32 v54, 31, v32
  v_lshlrev_b32 v4, 4, v32
  v_bfe_u32 v34, v54, 1, 3
  v_xor_b32 v34, v34, v50
  v_lshl_add_u32 v35, v54, 7, s40
  v_xor_b32 v36, 0, v34
  v_lshl_add_u32 v44, v36, 4, v35
  v_xor_b32 v36, 2, v34
  v_lshl_add_u32 v45, v36, 4, v35
  v_xor_b32 v36, 4, v34
  v_lshl_add_u32 v46, v36, 4, v35
  v_xor_b32 v36, 6, v34
  v_lshl_add_u32 v47, v36, 4, v35
  s_mov_b32 s41, 0xffff0000
  s_mov_b32 s30, 83886080
  s_mov_b32 s31, 0x20000
  v_lshlrev_b32 v1, 8, v50
  v_lshl_add_u32 v1, v52, 6, v1
  v_lshl_add_u32 v1, v51, 5, v1
  v_lshl_add_u32 v1, v53, 3, v1
  v_add_u32 v2, 0x10000, v1
  v_add_u32 v3, 0x20000, v1
  v_mov_b32 v100, 0
  v_mov_b32 v101, 0
  v_mov_b32 v102, 0
  v_mov_b32 v103, 0
  v_mov_b32 v104, 0
  v_mov_b32 v105, 0
  v_mov_b32 v106, 0
  v_mov_b32 v107, 0
  s_mov_b32 s101, 0x3f803f80
  s_add_u32 s7, s7, 1
  s_cmp_eq_u32 s7, 9
  s_cselect_b32 s7, 0, s7
  s_lshl_b32 s99, s7, 7
  s_add_u32 s55, s99, s98
  s_mul_i32 s54, s7, 221184
  s_add_u32 s7, s7, 1
  s_cmp_eq_u32 s7, 9
  s_cselect_b32 s7, 0, s7
  s_lshl_b32 s99, s7, 7
  s_add_u32 s57, s99, s98
  s_mul_i32 s56, s7, 221184
  s_add_u32 s7, s7, 1
  s_cmp_eq_u32 s7, 9
  s_cselect_b32 s7, 0, s7
  s_lshl_b32 s99, s7, 7
  s_add_u32 s59, s99, s98
  s_mul_i32 s58, s7, 221184
  s_add_u32 s7, s7, 1
  s_cmp_eq_u32 s7, 9
  s_cselect_b32 s7, 0, s7
  s_lshl_b32 s99, s7, 7
  s_add_u32 s61, s99, s98
  s_mul_i32 s60, s7, 221184
  s_add_u32 s7, s7, 1
  s_cmp_eq_u32 s7, 9
  s_cselect_b32 s7, 0, s7
  s_lshl_b32 s99, s7, 7
  s_add_u32 s63, s99, s98
  s_mul_i32 s62, s7, 221184
  s_add_u32 s7, s7, 1
  s_cmp_eq_u32 s7, 9
  s_cselect_b32 s7, 0, s7
  s_lshl_b32 s99, s7, 7
  s_add_u32 s65, s99, s98
  s_mul_i32 s64, s7, 221184
  s_add_u32 s7, s7, 1
  s_cmp_eq_u32 s7, 9
  s_cselect_b32 s7, 0, s7
  s_lshl_b32 s99, s7, 7
  s_add_u32 s67, s99, s98
  s_mul_i32 s66, s7, 221184
  s_mov_b32 s38, 256
  s_mov_b32 s39, 0x20000
  s_mov_b32 s42, 0x3f317218
  s_mov_b32 s43, 0x35c1a2a0
  v_lshlrev_b32 v36, 8, v50
  v_lshl_add_u32 v36, v52, 6, v36
  v_add_u32 v36, v36, v57
  v_mul_u32_u24 v37, 520, v51
  v_add_u32 v13, v36, v37
  v_add_u32 v14, 0x10000, v13
  v_add_u32 v15, 0x20000, v13
  v_add_u32 v16, s40, v4
  v_mov_b32 v17, 0x3f803f80
  s_lshl_b32 s49, s5, 4
  s_add_u32 s49, s49, s4
  s_lshl_b32 s49, s49, 2
  s_add_u32 s49, s49, s6
  s_mul_i32 s49, s49, 24576
  s_add_u32 s68, s49, 50331648
  s_mul_i32 s46, s3, 147456
  s_add_u32 s46, s46, 41943040
  s_lshl_b32 s47, s6, 13
  s_add_u32 s91, s46, s47
  s_lshl_b32 s48, s5, 8
  s_add_u32 s88, s91, s48
  s_add_u32 s89, s88, 131072
  s_cmp_lt_u32 s6, 2
  s_cselect_b32 s89, s89, 1879048192
  s_lshl_b32 s47, s6, 12
  s_add_u32 s92, s46, s47
  s_add_u32 s92, s92, 131072
  v_and_b32 v34, 15, v32
  v_and_b32 v35, 1, v34
  v_lshlrev_b32 v35, 4, v35
  v_mov_b32 v36, 0x3f80
  v_lshlrev_b32 v35, v35, v36
  v_lshrrev_b32 v34, 1, v34
  v_cmp_eq_u32 vcc, 0, v34
  v_cmp_eq_u32 s[46:47], 1, v34
  v_cmp_eq_u32 s[48:49], 2, v34
  v_cmp_eq_u32 s[72:73], 3, v34
  v_cndmask_b32 v96, 0, v35, vcc
  v_cndmask_b32 v97, 0, v35, s[46:47]
  v_cndmask_b32 v98, 0, v35, s[48:49]
  v_cndmask_b32 v99, 0, v35, s[72:73]
  v_accvgpr_write_b32 a32, v96
  v_accvgpr_write_b32 a33, v97
  v_accvgpr_write_b32 a34, v98
  v_accvgpr_write_b32 a35, v99
  v_cmp_eq_u32 vcc, 4, v34
  v_cmp_eq_u32 s[46:47], 5, v34
  v_cmp_eq_u32 s[48:49], 6, v34
  v_cmp_eq_u32 s[72:73], 7, v34
  v_cndmask_b32 v96, 0, v35, vcc
  v_cndmask_b32 v97, 0, v35, s[46:47]
  v_cndmask_b32 v98, 0, v35, s[48:49]
  v_cndmask_b32 v99, 0, v35, s[72:73]
  v_accvgpr_write_b32 a36, v96
  v_accvgpr_write_b32 a37, v97
  v_accvgpr_write_b32 a38, v98
  v_accvgpr_write_b32 a39, v99
  s_mov_b32 s44, 0x3ffff
  s_mov_b32 s45, 0x3ffff
  s_mov_b32 s72, 0x3ffff
  s_mov_b32 s73, 0xfffc0000
  s_mov_b32 s74, 0xfffc0000
  s_mov_b32 s75, 0x0
  s_mov_b32 s76, 0x3ffff
  s_mov_b32 s77, 0x0
  s_mov_b32 s78, 0x0
  s_mov_b32 s79, 0xfffc0000
  s_mov_b32 s80, 0x0
  s_mov_b32 s81, 0x3ffff
  s_mov_b32 s82, 0xffff
  s_mov_b32 s83, 0xffff
  s_mov_b32 s84, 0x0
  s_mov_b32 s85, 0xffffffff
  s_mov_b32 s18, 2359296
  s_mov_b32 s19, 0x20000
  s_mov_b32 s22, 1152
  s_mov_b32 s23, 0x20000
  s_add_u32 m0, s40, 22528
  s_nop 0
  buffer_load_dwordx4 v9, s[12:15], s50 offen  lds
  s_add_u32 m0, s40, 21248
  s_nop 0
  buffer_load_dwordx4 v8, s[12:15], s50 offen offset:2304  lds
  s_waitcnt vmcnt(9)
  s_add_u32 m0, s40, 8192
  s_nop 0
  buffer_load_dwordx4 v40, s[8:11], s55 offen offset:0  lds
  buffer_load_dwordx4 v41, s[8:11], s55 offen offset:1024  lds
  buffer_load_dwordx4 v42, s[8:11], s55 offen offset:2048  lds
  buffer_load_dwordx4 v43, s[8:11], s55 offen offset:3072  lds
  s_add_u32 s55, s54, 13824
  s_add_u32 m0, s40, 12288
  s_nop 0
  buffer_load_dwordx4 v40, s[8:11], s57 offen offset:0  lds
  buffer_load_dwordx4 v41, s[8:11], s57 offen offset:1024  lds
  buffer_load_dwordx4 v42, s[8:11], s57 offen offset:2048  lds
  buffer_load_dwordx4 v43, s[8:11], s57 offen offset:3072  lds
  s_add_u32 s57, s56, 13824
  ds_read_b128 v[112:115], v44 offset:0
  ds_read_b128 v[116:119], v45 offset:0
  ds_read_b128 v[120:123], v46 offset:0
  ds_read_b128 v[124:127], v47 offset:0
  s_mov_b64 exec, 0
  s_cmp_eq_u32 s6, 0
  s_cbranch_scc1 AT_H0
  s_cmp_eq_u32 s6, 1
  s_cbranch_scc1 AT_H1
  s_cmp_eq_u32 s6, 2
  s_cbranch_scc1 AT_H2
  s_branch AT_H3
AT_H8:
AT_H9:
AT_H10:
AT_H11:
AT_HB:
  s_mov_b64 exec, -1
  s_waitcnt vmcnt(13)
  s_add_u32 m0, s40, 16384
  s_nop 0
  buffer_load_dwordx4 v40, s[8:11], s59 offen offset:0  lds
  buffer_load_dwordx4 v41, s[8:11], s59 offen offset:1024  lds
  buffer_load_dwordx4 v42, s[8:11], s59 offen offset:2048  lds
  buffer_load_dwordx4 v43, s[8:11], s59 offen offset:3072  lds
  s_add_u32 s59, s58, 13824
  ds_read_b128 v[128:131], v44 offset:4096
  ds_read_b128 v[132:135], v45 offset:4096
  ds_read_b128 v[136:139], v46 offset:4096
  ds_read_b128 v[140:143], v47 offset:4096
  s_waitcnt lgkmcnt(7)
  v_dot2c_f32_bf16 v100, s101, v112
  v_dot2c_f32_bf16 v101, s101, v113
  v_dot2c_f32_bf16 v102, s101, v114
  v_dot2c_f32_bf16 v103, s101, v115
  v_dot2c_f32_bf16 v104, v112, v112
  v_dot2c_f32_bf16 v105, v113, v113
  v_dot2c_f32_bf16 v106, v114, v114
  v_dot2c_f32_bf16 v107, v115, v115
  s_waitcnt lgkmcnt(6)
  v_dot2c_f32_bf16 v100, s101, v116
  v_dot2c_f32_bf16 v101, s101, v117
  v_dot2c_f32_bf16 v102, s101, v118
  v_dot2c_f32_bf16 v103, s101, v119
  v_dot2c_f32_bf16 v104, v116, v116
  v_dot2c_f32_bf16 v105, v117, v117
  v_dot2c_f32_bf16 v106, v118, v118
  v_dot2c_f32_bf16 v107, v119, v119
  s_waitcnt lgkmcnt(5)
  v_dot2c_f32_bf16 v100, s101, v120
  v_dot2c_f32_bf16 v101, s101, v121
  v_dot2c_f32_bf16 v102, s101, v122
  v_dot2c_f32_bf16 v103, s101, v123
  v_dot2c_f32_bf16 v104, v120, v120
  v_dot2c_f32_bf16 v105, v121, v121
  v_dot2c_f32_bf16 v106, v122, v122
  v_dot2c_f32_bf16 v107, v123, v123
  s_waitcnt lgkmcnt(4)
  v_dot2c_f32_bf16 v100, s101, v124
  v_dot2c_f32_bf16 v101, s101, v125
  v_dot2c_f32_bf16 v102, s101, v126
  v_dot2c_f32_bf16 v103, s101, v127
  v_dot2c_f32_bf16 v104, v124, v124
  v_dot2c_f32_bf16 v105, v125, v125
  v_dot2c_f32_bf16 v106, v126, v126
  v_dot2c_f32_bf16 v107, v127, v127
  s_waitcnt vmcnt(8)
  s_add_u32 m0, s40, 0
  s_nop 0
  buffer_load_dwordx4 v40, s[8:11], s61 offen offset:0  lds
  buffer_load_dwordx4 v41, s[8:11], s61 offen offset:1024  lds
  buffer_load_dwordx4 v42, s[8:11], s61 offen offset:2048  lds
  buffer_load_dwordx4 v43, s[8:11], s61 offen offset:3072  lds
  s_add_u32 s61, s60, 13824
  ds_read_b128 v[144:147], v44 offset:8192
  ds_read_b128 v[148:151], v45 offset:8192
  ds_read_b128 v[152:155], v46 offset:8192
  ds_read_b128 v[156:159], v47 offset:8192
  s_waitcnt lgkmcnt(7)
  v_dot2c_f32_bf16 v100, s101, v128
  v_dot2c_f32_bf16 v101, s101, v129
  v_dot2c_f32_bf16 v102, s101, v130
  v_dot2c_f32_bf16 v103, s101, v131
  v_dot2c_f32_bf16 v104, v128, v128
  v_dot2c_f32_bf16 v105, v129, v129
  v_dot2c_f32_bf16 v106, v130, v130
  v_dot2c_f32_bf16 v107, v131, v131
  s_waitcnt lgkmcnt(6)
  v_dot2c_f32_bf16 v100, s101, v132
  v_dot2c_f32_bf16 v101, s101, v133
  v_dot2c_f32_bf16 v102, s101, v134
  v_dot2c_f32_bf16 v103, s101, v135
  v_dot2c_f32_bf16 v104, v132, v132
  v_dot2c_f32_bf16 v105, v133, v133
  v_dot2c_f32_bf16 v106, v134, v134
  v_dot2c_f32_bf16 v107, v135, v135
  s_waitcnt lgkmcnt(5)
  v_dot2c_f32_bf16 v100, s101, v136
  v_dot2c_f32_bf16 v101, s101, v137
  v_dot2c_f32_bf16 v102, s101, v138
  v_dot2c_f32_bf16 v103, s101, v139
  v_dot2c_f32_bf16 v104, v136, v136
  v_dot2c_f32_bf16 v105, v137, v137
  v_dot2c_f32_bf16 v106, v138, v138
  v_dot2c_f32_bf16 v107, v139, v139
  s_waitcnt lgkmcnt(4)
  v_dot2c_f32_bf16 v100, s101, v140
  v_dot2c_f32_bf16 v101, s101, v141
  v_dot2c_f32_bf16 v102, s101, v142
  v_dot2c_f32_bf16 v103, s101, v143
  v_dot2c_f32_bf16 v104, v140, v140
  v_dot2c_f32_bf16 v105, v141, v141
  v_dot2c_f32_bf16 v106, v142, v142
  v_dot2c_f32_bf16 v107, v143, v143
  s_waitcnt vmcnt(8)
  s_add_u32 m0, s40, 4096
  s_nop 0
  buffer_load_dwordx4 v40, s[8:11], s63 offen offset:0  lds
  buffer_load_dwordx4 v41, s[8:11], s63 offen offset:1024  lds
  buffer_load_dwordx4 v42, s[8:11], s63 offen offset:2048  lds
  buffer_load_dwordx4 v43, s[8:11], s63 offen offset:3072  lds
  s_add_u32 s63, s62, 13824
  ds_read_b128 v[160:163], v44 offset:12288
  ds_read_b128 v[164:167], v45 offset:12288
  ds_read_b128 v[168:171], v46 offset:12288
  ds_read_b128 v[172:175], v47 offset:12288
  s_waitcnt lgkmcnt(7)
  v_dot2c_f32_bf16 v100, s101, v144
  v_dot2c_f32_bf16 v101, s101, v145
  v_dot2c_f32_bf16 v102, s101, v146
  v_dot2c_f32_bf16 v103, s101, v147
  v_dot2c_f32_bf16 v104, v144, v144
  v_dot2c_f32_bf16 v105, v145, v145
  v_dot2c_f32_bf16 v106, v146, v146
  v_dot2c_f32_bf16 v107, v147, v147
  s_waitcnt lgkmcnt(6)
  v_dot2c_f32_bf16 v100, s101, v148
  v_dot2c_f32_bf16 v101, s101, v149
  v_dot2c_f32_bf16 v102, s101, v150
  v_dot2c_f32_bf16 v103, s101, v151
  v_dot2c_f32_bf16 v104, v148, v148
  v_dot2c_f32_bf16 v105, v149, v149
  v_dot2c_f32_bf16 v106, v150, v150
  v_dot2c_f32_bf16 v107, v151, v151
  s_waitcnt lgkmcnt(5)
  v_dot2c_f32_bf16 v100, s101, v152
  v_dot2c_f32_bf16 v101, s101, v153
  v_dot2c_f32_bf16 v102, s101, v154
  v_dot2c_f32_bf16 v103, s101, v155
  v_dot2c_f32_bf16 v104, v152, v152
  v_dot2c_f32_bf16 v105, v153, v153
  v_dot2c_f32_bf16 v106, v154, v154
  v_dot2c_f32_bf16 v107, v155, v155
  s_waitcnt lgkmcnt(4)
  v_dot2c_f32_bf16 v100, s101, v156
  v_dot2c_f32_bf16 v101, s101, v157
  v_dot2c_f32_bf16 v102, s101, v158
  v_dot2c_f32_bf16 v103, s101, v159
  v_dot2c_f32_bf16 v104, v156, v156
  v_dot2c_f32_bf16 v105, v157, v157
  v_dot2c_f32_bf16 v106, v158, v158
  v_dot2c_f32_bf16 v107, v159, v159
  s_waitcnt vmcnt(8)
  s_add_u32 m0, s40, 8192
  s_nop 0
  buffer_load_dwordx4 v40, s[8:11], s65 offen offset:0  lds
  buffer_load_dwordx4 v41, s[8:11], s65 offen offset:1024  lds
  buffer_load_dwordx4 v42, s[8:11], s65 offen offset:2048  lds
  buffer_load_dwordx4 v43, s[8:11], s65 offen offset:3072  lds
  s_add_u32 s65, s64, 13824
  ds_read_b128 v[176:179], v44 offset:16384
  ds_read_b128 v[180:183], v45 offset:16384
  ds_read_b128 v[184:187], v46 offset:16384
  ds_read_b128 v[188:191], v47 offset:16384
  s_waitcnt lgkmcnt(7)
  v_dot2c_f32_bf16 v100, s101, v160
  v_dot2c_f32_bf16 v101, s101, v161
  v_dot2c_f32_bf16 v102, s101, v162
  v_dot2c_f32_bf16 v103, s101, v163
  v_dot2c_f32_bf16 v104, v160, v160
  v_dot2c_f32_bf16 v105, v161, v161
  v_dot2c_f32_bf16 v106, v162, v162
  v_dot2c_f32_bf16 v107, v163, v163
  s_waitcnt lgkmcnt(6)
  v_dot2c_f32_bf16 v100, s101, v164
  v_dot2c_f32_bf16 v101, s101, v165
  v_dot2c_f32_bf16 v102, s101, v166
  v_dot2c_f32_bf16 v103, s101, v167
  v_dot2c_f32_bf16 v104, v164, v164
  v_dot2c_f32_bf16 v105, v165, v165
  v_dot2c_f32_bf16 v106, v166, v166
  v_dot2c_f32_bf16 v107, v167, v167
  s_waitcnt lgkmcnt(5)
  v_dot2c_f32_bf16 v100, s101, v168
  v_dot2c_f32_bf16 v101, s101, v169
  v_dot2c_f32_bf16 v102, s101, v170
  v_dot2c_f32_bf16 v103, s101, v171
  v_dot2c_f32_bf16 v104, v168, v168
  v_dot2c_f32_bf16 v105, v169, v169
  v_dot2c_f32_bf16 v106, v170, v170
  v_dot2c_f32_bf16 v107, v171, v171
  s_waitcnt lgkmcnt(4)
  v_dot2c_f32_bf16 v100, s101, v172
  v_dot2c_f32_bf16 v101, s101, v173
  v_dot2c_f32_bf16 v102, s101, v174
  v_dot2c_f32_bf16 v103, s101, v175
  v_dot2c_f32_bf16 v104, v172, v172
  v_dot2c_f32_bf16 v105, v173, v173
  v_dot2c_f32_bf16 v106, v174, v174
  v_dot2c_f32_bf16 v107, v175, v175
  s_waitcnt vmcnt(8)
  s_add_u32 m0, s40, 12288
  s_nop 0
  buffer_load_dwordx4 v40, s[8:11], s67 offen offset:0  lds
  buffer_load_dwordx4 v41, s[8:11], s67 offen offset:1024  lds
  buffer_load_dwordx4 v42, s[8:11], s67 offen offset:2048  lds
  buffer_load_dwordx4 v43, s[8:11], s67 offen offset:3072  lds
  s_add_u32 s67, s66, 13824
  ds_read_b128 v[192:195], v44 offset:0
  ds_read_b128 v[196:199], v45 offset:0
  ds_read_b128 v[200:203], v46 offset:0
  ds_read_b128 v[204:207], v47 offset:0
  s_waitcnt lgkmcnt(7)
  v_dot2c_f32_bf16 v100, s101, v176
  v_dot2c_f32_bf16 v101, s101, v177
  v_dot2c_f32_bf16 v102, s101, v178
  v_dot2c_f32_bf16 v103, s101, v179
  v_dot2c_f32_bf16 v104, v176, v176
  v_dot2c_f32_bf16 v105, v177, v177
  v_dot2c_f32_bf16 v106, v178, v178
  v_dot2c_f32_bf16 v107, v179, v179
  s_waitcnt lgkmcnt(6)
  v_dot2c_f32_bf16 v100, s101, v180
  v_dot2c_f32_bf16 v101, s101, v181
  v_dot2c_f32_bf16 v102, s101, v182
  v_dot2c_f32_bf16 v103, s101, v183
  v_dot2c_f32_bf16 v104, v180, v180
  v_dot2c_f32_bf16 v105, v181, v181
  v_dot2c_f32_bf16 v106, v182, v182
  v_dot2c_f32_bf16 v107, v183, v183
  s_waitcnt lgkmcnt(5)
  v_dot2c_f32_bf16 v100, s101, v184
  v_dot2c_f32_bf16 v101, s101, v185
  v_dot2c_f32_bf16 v102, s101, v186
  v_dot2c_f32_bf16 v103, s101, v187
  v_dot2c_f32_bf16 v104, v184, v184
  v_dot2c_f32_bf16 v105, v185, v185
  v_dot2c_f32_bf16 v106, v186, v186
  v_dot2c_f32_bf16 v107, v187, v187
  s_waitcnt lgkmcnt(4)
  v_dot2c_f32_bf16 v100, s101, v188
  v_dot2c_f32_bf16 v101, s101, v189
  v_dot2c_f32_bf16 v102, s101, v190
  v_dot2c_f32_bf16 v103, s101, v191
  v_dot2c_f32_bf16 v104, v188, v188
  v_dot2c_f32_bf16 v105, v189, v189
  v_dot2c_f32_bf16 v106, v190, v190
  v_dot2c_f32_bf16 v107, v191, v191
  s_waitcnt vmcnt(8)
  s_add_u32 m0, s40, 22128
  s_nop 0
  buffer_load_dwordx4 v8, s[12:15], s50 offen offset:2448  lds
  s_add_u32 m0, s40, 24448
  s_nop 0
  buffer_load_dwordx4 v8, s[12:15], s51 offen offset:1152  lds
  s_add_u32 m0, s40, 25328
  s_nop 0
  buffer_load_dwordx4 v8, s[12:15], s51 offen offset:1296  lds
  s_add_u32 m0, s40, 27648
  s_nop 0
  buffer_load_dwordx4 v9, s[12:15], s51 offen  lds
  ds_read_b128 v[208:211], v44 offset:4096
  ds_read_b128 v[212:215], v45 offset:4096
  ds_read_b128 v[216:219], v46 offset:4096
  ds_read_b128 v[220:223], v47 offset:4096
  s_waitcnt lgkmcnt(7)
  v_dot2c_f32_bf16 v100, s101, v192
  v_dot2c_f32_bf16 v101, s101, v193
  v_dot2c_f32_bf16 v102, s101, v194
  v_dot2c_f32_bf16 v103, s101, v195
  v_dot2c_f32_bf16 v104, v192, v192
  v_dot2c_f32_bf16 v105, v193, v193
  v_dot2c_f32_bf16 v106, v194, v194
  v_dot2c_f32_bf16 v107, v195, v195
  s_waitcnt lgkmcnt(6)
  v_dot2c_f32_bf16 v100, s101, v196
  v_dot2c_f32_bf16 v101, s101, v197
  v_dot2c_f32_bf16 v102, s101, v198
  v_dot2c_f32_bf16 v103, s101, v199
  v_dot2c_f32_bf16 v104, v196, v196
  v_dot2c_f32_bf16 v105, v197, v197
  v_dot2c_f32_bf16 v106, v198, v198
  v_dot2c_f32_bf16 v107, v199, v199
  s_waitcnt lgkmcnt(5)
  v_dot2c_f32_bf16 v100, s101, v200
  v_dot2c_f32_bf16 v101, s101, v201
  v_dot2c_f32_bf16 v102, s101, v202
  v_dot2c_f32_bf16 v103, s101, v203
  v_dot2c_f32_bf16 v104, v200, v200
  v_dot2c_f32_bf16 v105, v201, v201
  v_dot2c_f32_bf16 v106, v202, v202
  v_dot2c_f32_bf16 v107, v203, v203
  s_waitcnt lgkmcnt(4)
  v_dot2c_f32_bf16 v100, s101, v204
  v_dot2c_f32_bf16 v101, s101, v205
  v_dot2c_f32_bf16 v102, s101, v206
  v_dot2c_f32_bf16 v103, s101, v207
  v_dot2c_f32_bf16 v104, v204, v204
  v_dot2c_f32_bf16 v105, v205, v205
  v_dot2c_f32_bf16 v106, v206, v206
  v_dot2c_f32_bf16 v107, v207, v207
  s_waitcnt vmcnt(8)
  s_add_u32 m0, s40, 26368
  s_nop 0
  buffer_load_dwordx4 v8, s[12:15], s51 offen offset:2304  lds
  s_add_u32 m0, s40, 27248
  s_nop 0
  buffer_load_dwordx4 v8, s[12:15], s51 offen offset:2448  lds
  s_add_u32 m0, s40, 29568
  s_nop 0
  buffer_load_dwordx4 v8, s[12:15], s52 offen offset:1152  lds
  s_add_u32 m0, s40, 30448
  s_nop 0
  buffer_load_dwordx4 v8, s[12:15], s52 offen offset:1296  lds
  ds_read_b128 v[224:227], v44 offset:8192
  ds_read_b128 v[228:231], v45 offset:8192
  ds_read_b128 v[232:235], v46 offset:8192
  ds_read_b128 v[236:239], v47 offset:8192
  s_waitcnt lgkmcnt(7)
  v_dot2c_f32_bf16 v100, s101, v208
  v_dot2c_f32_bf16 v101, s101, v209
  v_dot2c_f32_bf16 v102, s101, v210
  v_dot2c_f32_bf16 v103, s101, v211
  v_dot2c_f32_bf16 v104, v208, v208
  v_dot2c_f32_bf16 v105, v209, v209
  v_dot2c_f32_bf16 v106, v210, v210
  v_dot2c_f32_bf16 v107, v211, v211
  s_waitcnt lgkmcnt(6)
  v_dot2c_f32_bf16 v100, s101, v212
  v_dot2c_f32_bf16 v101, s101, v213
  v_dot2c_f32_bf16 v102, s101, v214
  v_dot2c_f32_bf16 v103, s101, v215
  v_dot2c_f32_bf16 v104, v212, v212
  v_dot2c_f32_bf16 v105, v213, v213
  v_dot2c_f32_bf16 v106, v214, v214
  v_dot2c_f32_bf16 v107, v215, v215
  s_waitcnt lgkmcnt(5)
  v_dot2c_f32_bf16 v100, s101, v216
  v_dot2c_f32_bf16 v101, s101, v217
  v_dot2c_f32_bf16 v102, s101, v218
  v_dot2c_f32_bf16 v103, s101, v219
  v_dot2c_f32_bf16 v104, v216, v216
  v_dot2c_f32_bf16 v105, v217, v217
  v_dot2c_f32_bf16 v106, v218, v218
  v_dot2c_f32_bf16 v107, v219, v219
  s_waitcnt lgkmcnt(4)
  v_dot2c_f32_bf16 v100, s101, v220
  v_dot2c_f32_bf16 v101, s101, v221
  v_dot2c_f32_bf16 v102, s101, v222
  v_dot2c_f32_bf16 v103, s101, v223
  v_dot2c_f32_bf16 v104, v220, v220
  v_dot2c_f32_bf16 v105, v221, v221
  v_dot2c_f32_bf16 v106, v222, v222
  v_dot2c_f32_bf16 v107, v223, v223
  s_waitcnt vmcnt(8)
  s_add_u32 m0, s40, 32768
  s_nop 0
  buffer_load_dwordx4 v9, s[12:15], s52 offen  lds
  s_add_u32 m0, s40, 31488
  s_nop 0
  buffer_load_dwordx4 v8, s[12:15], s52 offen offset:2304  lds
  s_add_u32 m0, s40, 32368
  s_nop 0
  buffer_load_dwordx4 v8, s[12:15], s52 offen offset:2448  lds
  s_add_u32 m0, s40, 34688
  s_nop 0
  buffer_load_dwordx4 v8, s[12:15], s53 offen offset:1152  lds
  ds_read_b128 v[240:243], v44 offset:12288
  ds_read_b128 v[244:247], v45 offset:12288
  ds_read_b128 v[248:251], v46 offset:12288
  ds_read_b128 v[252:255], v47 offset:12288
  s_waitcnt lgkmcnt(7)
  v_dot2c_f32_bf16 v100, s101, v224
  v_dot2c_f32_bf16 v101, s101, v225
  v_dot2c_f32_bf16 v102, s101, v226
  v_dot2c_f32_bf16 v103, s101, v227
  v_dot2c_f32_bf16 v104, v224, v224
  v_dot2c_f32_bf16 v105, v225, v225
  v_dot2c_f32_bf16 v106, v226, v226
  v_dot2c_f32_bf16 v107, v227, v227
  s_waitcnt lgkmcnt(6)
  v_dot2c_f32_bf16 v100, s101, v228
  v_dot2c_f32_bf16 v101, s101, v229
  v_dot2c_f32_bf16 v102, s101, v230
  v_dot2c_f32_bf16 v103, s101, v231
  v_dot2c_f32_bf16 v104, v228, v228
  v_dot2c_f32_bf16 v105, v229, v229
  v_dot2c_f32_bf16 v106, v230, v230
  v_dot2c_f32_bf16 v107, v231, v231
  s_waitcnt lgkmcnt(5)
  v_dot2c_f32_bf16 v100, s101, v232
  v_dot2c_f32_bf16 v101, s101, v233
  v_dot2c_f32_bf16 v102, s101, v234
  v_dot2c_f32_bf16 v103, s101, v235
  v_dot2c_f32_bf16 v104, v232, v232
  v_dot2c_f32_bf16 v105, v233, v233
  v_dot2c_f32_bf16 v106, v234, v234
  v_dot2c_f32_bf16 v107, v235, v235
  s_waitcnt lgkmcnt(4)
  v_dot2c_f32_bf16 v100, s101, v236
  v_dot2c_f32_bf16 v101, s101, v237
  v_dot2c_f32_bf16 v102, s101, v238
  v_dot2c_f32_bf16 v103, s101, v239
  v_dot2c_f32_bf16 v104, v236, v236
  v_dot2c_f32_bf16 v105, v237, v237
  v_dot2c_f32_bf16 v106, v238, v238
  v_dot2c_f32_bf16 v107, v239, v239
  s_waitcnt vmcnt(6) lgkmcnt(0)
  s_barrier
  ds_read_b64_tr_b16 a[0:1], v1 offset:24576
  ds_read_b64_tr_b16 a[2:3], v1 offset:29696
  ds_read_b64_tr_b16 a[4:5], v13 offset:26624
  ds_read_b64_tr_b16 a[6:7], v13 offset:31744
  v_dot2c_f32_bf16 v100, s101, v240
  v_dot2c_f32_bf16 v101, s101, v241
  v_dot2c_f32_bf16 v102, s101, v242
  v_dot2c_f32_bf16 v103, s101, v243
  v_dot2c_f32_bf16 v104, v240, v240
  v_dot2c_f32_bf16 v105, v241, v241
  v_dot2c_f32_bf16 v106, v242, v242
  v_dot2c_f32_bf16 v107, v243, v243
  v_dot2c_f32_bf16 v100, s101, v244
  v_dot2c_f32_bf16 v101, s101, v245
  v_dot2c_f32_bf16 v102, s101, v246
  v_dot2c_f32_bf16 v103, s101, v247
  v_dot2c_f32_bf16 v104, v244, v244
  v_dot2c_f32_bf16 v105, v245, v245
  v_dot2c_f32_bf16 v106, v246, v246
  v_dot2c_f32_bf16 v107, v247, v247
  v_dot2c_f32_bf16 v100, s101, v248
  v_dot2c_f32_bf16 v101, s101, v249
  v_dot2c_f32_bf16 v102, s101, v250
  v_dot2c_f32_bf16 v103, s101, v251
  v_dot2c_f32_bf16 v104, v248, v248
  v_dot2c_f32_bf16 v105, v249, v249
  v_dot2c_f32_bf16 v106, v250, v250
  v_dot2c_f32_bf16 v107, v251, v251
  v_dot2c_f32_bf16 v100, s101, v252
  v_dot2c_f32_bf16 v101, s101, v253
  v_dot2c_f32_bf16 v102, s101, v254
  v_dot2c_f32_bf16 v103, s101, v255
  v_dot2c_f32_bf16 v104, v252, v252
  v_dot2c_f32_bf16 v105, v253, v253
  v_dot2c_f32_bf16 v106, v254, v254
  v_dot2c_f32_bf16 v107, v255, v255
  v_add_f32 v100, v100, v102
  v_add_f32 v101, v101, v103
  v_add_f32 v104, v104, v106
  v_add_f32 v105, v105, v107
  v_add_f32 v26, v100, v101
  v_add_f32 v27, v104, v105
  v_add_f32 v5, v100, v101
  v_add_f32 v6, v104, v105
  s_nop 0
  v_permlane32_swap_b32 v26, v5
  v_permlane32_swap_b32 v27, v6
  v_add_f32 v26, v26, v5
  v_add_f32 v27, v27, v6
  v_mul_f32 v26, 0x3ae38e39, v26
  v_mul_f32 v27, 0x3ae38e39, v27
  v_fma_f32 v27, -v26, v26, v27
  v_max_f32 v27, 0, v27
  v_cvt_pk_bf16_f32 v26, v27, v26
  ds_read_b64_tr_b16 a[8:9], v1 offset:25088
  ds_read_b64_tr_b16 a[10:11], v1 offset:30208
  v_lshlrev_b32 v27, 16, v26
  v_and_b32 v26, s41, v26
  v_add_f32 v27, 0x3727c5ac, v27
  v_cvt_pk_bf16_f32 v27, v27, v27
  v_lshlrev_b32 v27, 16, v27
  v_sqrt_f32 v27, v27
  ds_read_b64_tr_b16 a[12:13], v1 offset:27648
  ds_read_b64_tr_b16 a[14:15], v1 offset:32768
  v_cvt_pk_bf16_f32 v27, v27, v27
  v_lshlrev_b32 v27, 16, v27
  v_mul_f32 v6, 0x3f317218, v27
  v_rcp_f32 v5, v6
  ds_read_b64_tr_b16 a[16:17], v1 offset:25600
  ds_read_b64_tr_b16 a[18:19], v1 offset:30720
  v_mul_f32 v6, -v26, v5
  v_lshlrev_b32 v18, 16, v112
  v_and_b32 v19, s41, v112
  v_lshlrev_b32 v20, 16, v113
  v_and_b32 v21, s41, v113
  v_fma_f32 v18, v18, v5, v6
  v_fma_f32 v19, v19, v5, v6
  v_fma_f32 v20, v20, v5, v6
  v_fma_f32 v21, v21, v5, v6
  v_cvt_pk_bf16_f32 v112, v18, v19
  v_cvt_pk_bf16_f32 v113, v20, v21
  v_lshlrev_b32 v22, 16, v114
  v_and_b32 v23, s41, v114
  v_lshlrev_b32 v24, 16, v115
  v_and_b32 v25, s41, v115
  v_fma_f32 v22, v22, v5, v6
  v_fma_f32 v23, v23, v5, v6
  v_fma_f32 v24, v24, v5, v6
  v_fma_f32 v25, v25, v5, v6
  v_cvt_pk_bf16_f32 v114, v22, v23
  v_cvt_pk_bf16_f32 v115, v24, v25
  ds_read_b64_tr_b16 a[20:21], v1 offset:26112
  ds_read_b64_tr_b16 a[22:23], v1 offset:31232
  ds_read_b64_tr_b16 a[24:25], v1 offset:28160
  ds_read_b64_tr_b16 a[26:27], v1 offset:33280
  s_add_u32 m0, s40, 35568
  s_waitcnt lgkmcnt(8)
  v_mfma_f32_32x32x16_bf16 v[32:47], v[112:115], a[0:3], 0
  buffer_load_dwordx4 v8, s[12:15], s53 offen offset:1296  lds
  ds_read_b64_tr_b16 a[28:29], v1 offset:28672
  ds_read_b64_tr_b16 a[30:31], v1 offset:33792
  v_lshlrev_b32 v18, 16, v116
  v_and_b32 v19, s41, v116
  v_lshlrev_b32 v20, 16, v117
  v_mfma_f32_32x32x16_bf16 v[96:111], v[112:115], a[4:7], 0
  ds_read_b64_tr_b16 a[0:1], v1 offset:29184
  ds_read_b64_tr_b16 a[2:3], v1 offset:34304
  v_and_b32 v21, s41, v117
  v_fma_f32 v18, v18, v5, v6
  v_fma_f32 v19, v19, v5, v6
  v_mfma_f32_32x32x16_bf16 v[48:63], v[112:115], a[8:11], 0
  ds_read_b64_tr_b16 a[4:5], v1 offset:64512
  ds_read_b64_tr_b16 a[6:7], v2 offset:4096
  v_fma_f32 v20, v20, v5, v6
  s_add_u32 m0, s40, 37888
  s_waitcnt lgkmcnt(8)
  v_mfma_f32_32x32x16_bf16 a[128:143], v[112:115], a[12:15], 0
  buffer_load_dwordx4 v9, s[12:15], s53 offen  lds
  ds_read_b64_tr_b16 a[8:9], v14 offset:1024
AT_H0:
  s_cbranch_execz AT_H4
  ds_read_b64_tr_b16 a[10:11], v14 offset:6144
  v_fma_f32 v21, v21, v5, v6
  v_cvt_pk_bf16_f32 v116, v18, v19
  v_mfma_f32_32x32x16_bf16 v[64:79], v[112:115], a[16:19], 0
  ds_read_b64_tr_b16 a[12:13], v1 offset:65024
  ds_read_b64_tr_b16 a[14:15], v2 offset:4608
  v_cvt_pk_bf16_f32 v117, v20, v21
  v_lshlrev_b32 v22, 16, v118
  v_and_b32 v23, s41, v118
  v_lshlrev_b32 v24, 16, v119
  v_mfma_f32_32x32x16_bf16 v[80:95], v[112:115], a[20:23], 0
  ds_read_b64_tr_b16 a[16:17], v2 offset:2048
  ds_read_b64_tr_b16 a[18:19], v2 offset:7168
  v_and_b32 v25, s41, v119
  s_add_u32 m0, s40, 36608
  s_waitcnt lgkmcnt(8)
  v_mfma_f32_32x32x16_bf16 a[144:159], v[112:115], a[24:27], 0
  buffer_load_dwordx4 v8, s[12:15], s53 offen offset:2304  lds
  ds_read_b64_tr_b16 a[20:21], v2 offset:0
  ds_read_b64_tr_b16 a[22:23], v2 offset:5120
  v_fma_f32 v22, v22, v5, v6
  v_fma_f32 v23, v23, v5, v6
  v_mfma_f32_32x32x16_bf16 a[160:175], v[112:115], a[28:31], 0
  ds_read_b64_tr_b16 a[24:25], v2 offset:512
  ds_read_b64_tr_b16 a[26:27], v2 offset:5632
  v_fma_f32 v24, v24, v5, v6
  v_fma_f32 v25, v25, v5, v6
  v_cvt_pk_bf16_f32 v118, v22, v23
  v_cvt_pk_bf16_f32 v119, v24, v25
  v_mfma_f32_32x32x16_bf16 a[176:191], v[112:115], a[0:3], 0
  ds_read_b64_tr_b16 a[28:29], v2 offset:2560
  ds_read_b64_tr_b16 a[30:31], v2 offset:7680
  v_lshlrev_b32 v18, 16, v120
  v_and_b32 v19, s41, v120
  s_add_u32 m0, s40, 3696
  s_waitcnt lgkmcnt(8)
  v_mfma_f32_32x32x16_bf16 v[32:47], v[116:119], a[4:7], v[32:47]
  buffer_load_dwordx4 v8, s[12:15], s53 offen offset:2448  lds
  ds_read_b64_tr_b16 a[0:1], v2 offset:3072
  ds_read_b64_tr_b16 a[2:3], v2 offset:8192
  v_lshlrev_b32 v20, 16, v121
  v_and_b32 v21, s41, v121
  v_mfma_f32_32x32x16_bf16 v[96:111], v[116:119], a[8:11], v[96:111]
  ds_read_b64_tr_b16 a[4:5], v2 offset:3584
  ds_read_b64_tr_b16 a[6:7], v2 offset:8704
  v_fma_f32 v18, v18, v5, v6
  v_fma_f32 v19, v19, v5, v6
  v_fma_f32 v20, v20, v5, v6
  v_mfma_f32_32x32x16_bf16 v[48:63], v[116:119], a[12:15], v[48:63]
  ds_read_b64_tr_b16 a[8:9], v2 offset:38912
  ds_read_b64_tr_b16 a[10:11], v2 offset:44032
  v_fma_f32 v21, v21, v5, v6
  s_add_u32 m0, s40, 6016
  s_waitcnt lgkmcnt(8)
  v_mfma_f32_32x32x16_bf16 a[128:143], v[116:119], a[16:19], a[128:143]
  buffer_load_dwordx4 v8, s[12:15], s54 offen offset:1152  lds
  ds_read_b64_tr_b16 a[12:13], v14 offset:40960
  ds_read_b64_tr_b16 a[14:15], v14 offset:46080
  v_cvt_pk_bf16_f32 v120, v18, v19
  v_cvt_pk_bf16_f32 v121, v20, v21
  v_mfma_f32_32x32x16_bf16 v[64:79], v[116:119], a[20:23], v[64:79]
  ds_read_b64_tr_b16 a[16:17], v2 offset:39424
  ds_read_b64_tr_b16 a[18:19], v2 offset:44544
  v_lshlrev_b32 v22, 16, v122
  v_and_b32 v23, s41, v122
  v_lshlrev_b32 v24, 16, v123
  v_and_b32 v25, s41, v123
  v_mfma_f32_32x32x16_bf16 v[80:95], v[116:119], a[24:27], v[80:95]
  ds_read_b64_tr_b16 a[20:21], v2 offset:41984
  ds_read_b64_tr_b16 a[22:23], v2 offset:47104
  v_fma_f32 v22, v22, v5, v6
  s_add_u32 m0, s40, 6896
  s_waitcnt lgkmcnt(8)
  v_mfma_f32_32x32x16_bf16 a[144:159], v[116:119], a[28:31], a[144:159]
  buffer_load_dwordx4 v8, s[12:15], s54 offen offset:1296  lds
  ds_read_b64_tr_b16 a[24:25], v2 offset:39936
  ds_read_b64_tr_b16 a[26:27], v2 offset:45056
  v_fma_f32 v23, v23, v5, v6
  v_fma_f32 v24, v24, v5, v6
  v_mfma_f32_32x32x16_bf16 a[160:175], v[116:119], a[0:3], a[160:175]
  ds_read_b64_tr_b16 a[28:29], v2 offset:40448
  ds_read_b64_tr_b16 a[30:31], v2 offset:45568
  v_fma_f32 v25, v25, v5, v6
  v_cvt_pk_bf16_f32 v122, v22, v23
  v_cvt_pk_bf16_f32 v123, v24, v25
  v_mfma_f32_32x32x16_bf16 a[176:191], v[116:119], a[4:7], a[176:191]
  ds_read_b64_tr_b16 a[0:1], v2 offset:42496
  ds_read_b64_tr_b16 a[2:3], v2 offset:47616
  v_lshlrev_b32 v18, 16, v124
  v_and_b32 v19, s41, v124
  s_add_u32 m0, s40, 9216
  s_waitcnt lgkmcnt(8)
  v_mfma_f32_32x32x16_bf16 v[32:47], v[120:123], a[8:11], v[32:47]
  buffer_load_dwordx4 v9, s[12:15], s54 offen  lds
  ds_read_b64_tr_b16 a[4:5], v2 offset:43008
  ds_read_b64_tr_b16 a[6:7], v2 offset:48128
  v_lshlrev_b32 v20, 16, v125
  v_and_b32 v21, s41, v125
  v_mfma_f32_32x32x16_bf16 v[96:111], v[120:123], a[12:15], v[96:111]
  ds_read_b64_tr_b16 a[8:9], v2 offset:43520
  ds_read_b64_tr_b16 a[10:11], v2 offset:48640
  v_fma_f32 v18, v18, v5, v6
  v_fma_f32 v19, v19, v5, v6
  v_fma_f32 v20, v20, v5, v6
  v_mfma_f32_32x32x16_bf16 v[48:63], v[120:123], a[16:19], v[48:63]
  ds_read_b64_tr_b16 a[12:13], v3 offset:13312
  ds_read_b64_tr_b16 a[14:15], v3 offset:18432
  v_and_b32 v30, 31, v0
  v_lshlrev_b32 v30, 3, v30
  v_and_b32 v28, 32, v0
  v_lshl_add_u32 v30, v28, 7, v30
  s_add_u32 m0, s40, 7936
  s_waitcnt lgkmcnt(8)
  v_mfma_f32_32x32x16_bf16 a[128:143], v[120:123], a[20:23], a[128:143]
  buffer_load_dwordx4 v8, s[12:15], s54 offen offset:2304  lds
  ds_read_b64_tr_b16 a[16:17], v15 offset:15360
  ds_read_b64_tr_b16 a[18:19], v15 offset:20480
  v_mfma_f32_32x32x16_bf16 v[64:79], v[120:123], a[24:27], v[64:79]
  ds_read_b64_tr_b16 a[20:21], v3 offset:13824
  ds_read_b64_tr_b16 a[22:23], v3 offset:18944
  v_accvgpr_write_b32 a240, -1
  v_accvgpr_write_b32 a241, -1
  v_accvgpr_write_b32 a242, -1
  v_accvgpr_write_b32 a243, -1
  v_mfma_f32_32x32x16_bf16 v[80:95], v[120:123], a[28:31], v[80:95]
  ds_read_b64_tr_b16 a[24:25], v3 offset:16384
  ds_read_b64_tr_b16 a[26:27], v3 offset:21504
  v_and_b32 v28, 48, v0
  v_lshlrev_b32 v28, 8, v28
  v_and_b32 v29, 15, v0
  v_lshl_add_u32 v28, v29, 4, v28
  s_add_u32 m0, s40, 8816
  s_waitcnt lgkmcnt(8)
  v_mfma_f32_32x32x16_bf16 a[144:159], v[120:123], a[0:3], a[144:159]
  buffer_load_dwordx4 v8, s[12:15], s54 offen offset:2448  lds
  ds_read_b64_tr_b16 a[28:29], v3 offset:14336
  ds_read_b64_tr_b16 a[30:31], v3 offset:19456
  v_mfma_f32_32x32x16_bf16 a[160:175], v[120:123], a[4:7], a[160:175]
  ds_read_b64_tr_b16 a[0:1], v3 offset:14848
  ds_read_b64_tr_b16 a[2:3], v3 offset:19968
  s_add_u32 s46, s88, 0
  s_cmp_eq_u32 s6, 0
  s_cselect_b32 s46, s46, 1879048192
  buffer_store_dwordx4 a[240:243], v28, s[28:31], s46 offen sc1
  v_fma_f32 v21, v21, v5, v6
  v_cvt_pk_bf16_f32 v124, v18, v19
  v_cvt_pk_bf16_f32 v125, v20, v21
  v_lshlrev_b32 v22, 16, v126
  v_and_b32 v23, s41, v126
  v_lshlrev_b32 v24, 16, v127
  v_and_b32 v25, s41, v127
  v_fma_f32 v22, v22, v5, v6
  v_fma_f32 v23, v23, v5, v6
  v_fma_f32 v24, v24, v5, v6
  v_fma_f32 v25, v25, v5, v6
  v_cvt_pk_bf16_f32 v126, v22, v23
  v_cvt_pk_bf16_f32 v127, v24, v25
  v_mfma_f32_32x32x16_bf16 a[176:191], v[120:123], a[8:11], a[176:191]
  ds_read_b64_tr_b16 a[4:5], v3 offset:16896
  ds_read_b64_tr_b16 a[6:7], v3 offset:22016
  s_add_u32 m0, s40, 11136
  s_waitcnt lgkmcnt(8)
  v_mfma_f32_32x32x16_bf16 v[32:47], v[124:127], a[12:15], v[32:47]
  buffer_load_dwordx4 v8, s[12:15], s55 offen offset:1152  lds
  ds_read_b64_tr_b16 a[8:9], v3 offset:17408
  ds_read_b64_tr_b16 a[10:11], v3 offset:22528
  v_lshlrev_b32 v18, 16, v128
  v_and_b32 v19, s41, v128
  v_mfma_f32_32x32x16_bf16 v[96:111], v[124:127], a[16:19], v[96:111]
  ds_read_b64_tr_b16 a[12:13], v3 offset:17920
  ds_read_b64_tr_b16 a[14:15], v3 offset:23040
  s_add_u32 s46, s88, 16384
  s_cmp_eq_u32 s6, 0
  s_cselect_b32 s46, s46, 1879048192
  buffer_store_dwordx4 a[240:243], v28, s[28:31], s46 offen sc1
  v_mfma_f32_32x32x16_bf16 v[48:63], v[124:127], a[20:23], v[48:63]
  s_waitcnt vmcnt(8)
  s_barrier
  ds_read_b64_tr_b16 a[16:17], v1 offset:34816
  ds_read_b64_tr_b16 a[18:19], v1 offset:39936
  s_add_u32 m0, s40, 12016
  s_waitcnt lgkmcnt(8)
  v_mfma_f32_32x32x16_bf16 a[128:143], v[124:127], a[24:27], a[128:143]
  buffer_load_dwordx4 v8, s[12:15], s55 offen offset:1296  lds
  ds_read_b64_tr_b16 a[20:21], v13 offset:36864
  ds_read_b64_tr_b16 a[22:23], v13 offset:41984
  v_mfma_f32_32x32x16_bf16 v[64:79], v[124:127], a[28:31], v[64:79]
  ds_read_b64_tr_b16 a[24:25], v1 offset:35328
  ds_read_b64_tr_b16 a[26:27], v1 offset:40448
  s_add_u32 s46, s88, 32768
  s_cmp_eq_u32 s6, 0
  s_cselect_b32 s46, s46, 1879048192
  buffer_store_dwordx4 a[240:243], v28, s[28:31], s46 offen sc1
  v_mfma_f32_32x32x16_bf16 v[80:95], v[124:127], a[0:3], v[80:95]
  ds_read_b64_tr_b16 a[28:29], v1 offset:37888
  ds_read_b64_tr_b16 a[30:31], v1 offset:43008
  s_add_u32 m0, s40, 14336
  s_waitcnt lgkmcnt(8)
  v_mfma_f32_32x32x16_bf16 a[144:159], v[124:127], a[4:7], a[144:159]
  buffer_load_dwordx4 v9, s[12:15], s55 offen  lds
  ds_read_b64_tr_b16 a[0:1], v1 offset:35840
  ds_read_b64_tr_b16 a[2:3], v1 offset:40960
  v_lshlrev_b32 v20, 16, v129
  v_and_b32 v21, s41, v129
  v_mfma_f32_32x32x16_bf16 a[160:175], v[124:127], a[8:11], a[160:175]
  ds_read_b64_tr_b16 a[4:5], v1 offset:36352
  ds_read_b64_tr_b16 a[6:7], v1 offset:41472
  s_add_u32 s46, s88, 49152
  s_cmp_eq_u32 s6, 0
  s_cselect_b32 s46, s46, 1879048192
  buffer_store_dwordx4 a[240:243], v28, s[28:31], s46 offen sc1
  v_fma_f32 v18, v18, v5, v6
  v_fma_f32 v19, v19, v5, v6
  v_fma_f32 v20, v20, v5, v6
  v_fma_f32 v21, v21, v5, v6
  v_cvt_pk_bf16_f32 v128, v18, v19
  v_cvt_pk_bf16_f32 v129, v20, v21
  v_lshlrev_b32 v22, 16, v130
  v_and_b32 v23, s41, v130
  v_lshlrev_b32 v24, 16, v131
  v_and_b32 v25, s41, v131
  v_fma_f32 v22, v22, v5, v6
  v_fma_f32 v23, v23, v5, v6
  v_fma_f32 v24, v24, v5, v6
  v_fma_f32 v25, v25, v5, v6
  v_cvt_pk_bf16_f32 v130, v22, v23
  v_cvt_pk_bf16_f32 v131, v24, v25
  v_mfma_f32_32x32x16_bf16 a[176:191], v[124:127], a[12:15], a[176:191]
  ds_read_b64_tr_b16 a[8:9], v1 offset:38400
  ds_read_b64_tr_b16 a[10:11], v1 offset:43520
  s_add_u32 m0, s40, 13056
  s_waitcnt lgkmcnt(8)
  v_mfma_f32_32x32x16_bf16 v[32:47], v[128:131], a[16:19], v[32:47]
  buffer_load_dwordx4 v8, s[12:15], s55 offen offset:2304  lds
  ds_read_b64_tr_b16 a[12:13], v1 offset:38912
  ds_read_b64_tr_b16 a[14:15], v1 offset:10240
  v_lshlrev_b32 v18, 16, v132
  v_and_b32 v19, s41, v132
  v_mfma_f32_32x32x16_bf16 v[96:111], v[128:131], a[20:23], v[96:111]
  ds_read_b64_tr_b16 a[16:17], v1 offset:39424
  ds_read_b64_tr_b16 a[18:19], v1 offset:10752
  s_add_u32 s46, s88, 65536
  s_cmp_eq_u32 s6, 0
  s_cselect_b32 s46, s46, 1879048192
  buffer_store_dwordx4 a[240:243], v28, s[28:31], s46 offen sc1
  v_mfma_f32_32x32x16_bf16 v[48:63], v[128:131], a[24:27], v[48:63]
  ds_read_b64_tr_b16 a[20:21], v2 offset:9216
  ds_read_b64_tr_b16 a[22:23], v2 offset:14336
  s_add_u32 m0, s40, 13936
  s_waitcnt lgkmcnt(8)
  v_mfma_f32_32x32x16_bf16 a[128:143], v[128:131], a[28:31], a[128:143]
  buffer_load_dwordx4 v8, s[12:15], s55 offen offset:2448  lds
  ds_read_b64_tr_b16 a[24:25], v14 offset:11264
  ds_read_b64_tr_b16 a[26:27], v14 offset:16384
  v_lshlrev_b32 v20, 16, v133
  v_and_b32 v21, s41, v133
  v_mfma_f32_32x32x16_bf16 v[64:79], v[128:131], a[0:3], v[64:79]
  ds_read_b64_tr_b16 a[28:29], v2 offset:9728
  ds_read_b64_tr_b16 a[30:31], v2 offset:14848
  s_add_u32 s46, s88, 81920
  s_cmp_eq_u32 s6, 0
  s_cselect_b32 s46, s46, 1879048192
  buffer_store_dwordx4 a[240:243], v28, s[28:31], s46 offen sc1
  v_mfma_f32_32x32x16_bf16 v[80:95], v[128:131], a[4:7], v[80:95]
  ds_read_b64_tr_b16 a[0:1], v2 offset:12288
  ds_read_b64_tr_b16 a[2:3], v2 offset:17408
  s_add_u32 m0, s40, 16256
  s_waitcnt lgkmcnt(8)
  v_mfma_f32_32x32x16_bf16 a[144:159], v[128:131], a[8:11], a[144:159]
  buffer_load_dwordx4 v8, s[12:15], s56 offen offset:1152  lds
  ds_read_b64_tr_b16 a[4:5], v2 offset:10240
  ds_read_b64_tr_b16 a[6:7], v2 offset:15360
  v_fma_f32 v18, v18, v5, v6
  v_fma_f32 v19, v19, v5, v6
  v_mfma_f32_32x32x16_bf16 a[160:175], v[128:131], a[12:15], a[160:175]
  ds_read_b64_tr_b16 a[8:9], v2 offset:10752
  ds_read_b64_tr_b16 a[10:11], v2 offset:15872
  s_add_u32 s46, s88, 98304
  s_cmp_eq_u32 s6, 0
  s_cselect_b32 s46, s46, 1879048192
  buffer_store_dwordx4 a[240:243], v28, s[28:31], s46 offen sc1
  v_fma_f32 v20, v20, v5, v6
  v_fma_f32 v21, v21, v5, v6
  v_cvt_pk_bf16_f32 v132, v18, v19
  v_cvt_pk_bf16_f32 v133, v20, v21
  v_lshlrev_b32 v22, 16, v134
  v_and_b32 v23, s41, v134
  v_lshlrev_b32 v24, 16, v135
  v_and_b32 v25, s41, v135
  v_fma_f32 v22, v22, v5, v6
  v_fma_f32 v23, v23, v5, v6
  v_fma_f32 v24, v24, v5, v6
  v_fma_f32 v25, v25, v5, v6
  v_cvt_pk_bf16_f32 v134, v22, v23
  v_cvt_pk_bf16_f32 v135, v24, v25
  v_mfma_f32_32x32x16_bf16 a[176:191], v[128:131], a[16:19], a[176:191]
  ds_read_b64_tr_b16 a[12:13], v2 offset:12800
  ds_read_b64_tr_b16 a[14:15], v2 offset:17920
  s_add_u32 m0, s40, 17136
  s_waitcnt lgkmcnt(8)
  v_mfma_f32_32x32x16_bf16 v[32:47], v[132:135], a[20:23], v[32:47]
  buffer_load_dwordx4 v8, s[12:15], s56 offen offset:1296  lds
  ds_read_b64_tr_b16 a[16:17], v2 offset:13312
  ds_read_b64_tr_b16 a[18:19], v1 offset:50176
  v_lshlrev_b32 v18, 16, v136
  v_and_b32 v19, s41, v136
  v_mfma_f32_32x32x16_bf16 v[96:111], v[132:135], a[24:27], v[96:111]
  ds_read_b64_tr_b16 a[20:21], v2 offset:13824
  ds_read_b64_tr_b16 a[22:23], v1 offset:50688
  s_add_u32 s46, s88, 114688
  s_cmp_eq_u32 s6, 0
  s_cselect_b32 s46, s46, 1879048192
  buffer_store_dwordx4 a[240:243], v28, s[28:31], s46 offen sc1
  v_mfma_f32_32x32x16_bf16 v[48:63], v[132:135], a[28:31], v[48:63]
  ds_read_b64_tr_b16 a[24:25], v2 offset:49152
  ds_read_b64_tr_b16 a[26:27], v2 offset:54272
  s_add_u32 m0, s40, 19456
  s_waitcnt lgkmcnt(8)
  v_mfma_f32_32x32x16_bf16 a[128:143], v[132:135], a[0:3], a[128:143]
  buffer_load_dwordx4 v9, s[12:15], s56 offen  lds
  ds_read_b64_tr_b16 a[28:29], v14 offset:51200
  ds_read_b64_tr_b16 a[30:31], v14 offset:56320
  v_lshlrev_b32 v20, 16, v137
  v_and_b32 v21, s41, v137
  v_mfma_f32_32x32x16_bf16 v[64:79], v[132:135], a[4:7], v[64:79]
  ds_read_b64_tr_b16 a[0:1], v2 offset:49664
  ds_read_b64_tr_b16 a[2:3], v2 offset:54784
  s_add_u32 s46, s88, 131072
  s_cmp_eq_u32 s6, 0
  s_cselect_b32 s46, s46, 1879048192
  buffer_store_dwordx4 a[240:243], v28, s[28:31], s46 offen sc1
  v_mfma_f32_32x32x16_bf16 v[80:95], v[132:135], a[8:11], v[80:95]
  ds_read_b64_tr_b16 a[4:5], v2 offset:52224
  ds_read_b64_tr_b16 a[6:7], v2 offset:57344
  s_add_u32 m0, s40, 18176
  s_waitcnt lgkmcnt(8)
  v_mfma_f32_32x32x16_bf16 a[144:159], v[132:135], a[12:15], a[144:159]
  buffer_load_dwordx4 v8, s[12:15], s56 offen offset:2304  lds
  ds_read_b64_tr_b16 a[8:9], v2 offset:50176
  ds_read_b64_tr_b16 a[10:11], v2 offset:55296
  v_fma_f32 v18, v18, v5, v6
  v_fma_f32 v19, v19, v5, v6
  v_mfma_f32_32x32x16_bf16 a[160:175], v[132:135], a[16:19], a[160:175]
  ds_read_b64_tr_b16 a[12:13], v2 offset:50688
  ds_read_b64_tr_b16 a[14:15], v2 offset:55808
  s_lshl_b32 s32, s5, 4
  s_andn2_b32 s47, s4, 3
  s_add_u32 s32, s32, s47
  s_add_u32 s32, s32, s6
  s_mul_i32 s32, s32, 4352
  s_and_b32 s47, s4, 3
  s_lshl_b32 s47, s47, 2
  s_add_u32 s32, s32, s47
  s_add_u32 s32, s32, 46137344
  v_mov_b32 v26, 0
  v_fma_f32 v20, v20, v5, v6
  v_fma_f32 v21, v21, v5, v6
  v_cvt_pk_bf16_f32 v136, v18, v19
  v_cvt_pk_bf16_f32 v137, v20, v21
  v_lshlrev_b32 v22, 16, v138
  v_and_b32 v23, s41, v138
  v_lshlrev_b32 v24, 16, v139
  v_and_b32 v25, s41, v139
  v_fma_f32 v22, v22, v5, v6
  v_fma_f32 v23, v23, v5, v6
  v_fma_f32 v24, v24, v5, v6
  v_fma_f32 v25, v25, v5, v6
  v_cvt_pk_bf16_f32 v138, v22, v23
  v_cvt_pk_bf16_f32 v139, v24, v25
  v_mfma_f32_32x32x16_bf16 a[176:191], v[132:135], a[20:23], a[176:191]
  ds_read_b64_tr_b16 a[16:17], v2 offset:52736
  ds_read_b64_tr_b16 a[18:19], v2 offset:57856
  s_waitcnt lgkmcnt(8)
  v_mfma_f32_32x32x16_bf16 v[32:47], v[136:139], a[24:27], v[32:47]
  ds_read_b64_tr_b16 a[20:21], v2 offset:53248
  ds_read_b64_tr_b16 a[22:23], v2 offset:24576
  v_and_b32 v29, 3, v0
  v_mul_u32_u24 v29, 4352, v29
  s_add_u32 s46, s32, 0
  s_cmp_eq_u32 s6, 0
  s_cselect_b32 s46, s46, 1879048192
  buffer_store_dword v26, v29, s[28:31], s46 offen sc1
  v_mfma_f32_32x32x16_bf16 v[96:111], v[136:139], a[28:31], v[96:111]
  ds_read_b64_tr_b16 a[24:25], v2 offset:53760
  ds_read_b64_tr_b16 a[26:27], v2 offset:25088
  v_lshlrev_b32 v18, 16, v140
  v_mfma_f32_32x32x16_bf16 v[48:63], v[136:139], a[0:3], v[48:63]
  ds_read_b64_tr_b16 a[28:29], v3 offset:23552
  ds_read_b64_tr_b16 a[30:31], v3 offset:28672
  v_and_b32 v19, s41, v140
  v_lshlrev_b32 v20, 16, v141
  v_and_b32 v21, s41, v141
  s_waitcnt lgkmcnt(8)
  v_mfma_f32_32x32x16_bf16 a[128:143], v[136:139], a[4:7], a[128:143]
  ds_read_b64_tr_b16 a[0:1], v15 offset:25600
  ds_read_b64_tr_b16 a[2:3], v15 offset:30720
  v_fma_f32 v18, v18, v5, v6
  v_fma_f32 v19, v19, v5, v6
  v_fma_f32 v20, v20, v5, v6
  v_mfma_f32_32x32x16_bf16 v[64:79], v[136:139], a[8:11], v[64:79]
  ds_read_b64_tr_b16 a[4:5], v3 offset:24064
  ds_read_b64_tr_b16 a[6:7], v3 offset:29184
  v_fma_f32 v21, v21, v5, v6
  v_cvt_pk_bf16_f32 v140, v18, v19
  v_cvt_pk_bf16_f32 v141, v20, v21
  v_mfma_f32_32x32x16_bf16 v[80:95], v[136:139], a[12:15], v[80:95]
  ds_read_b64_tr_b16 a[8:9], v3 offset:26624
  ds_read_b64_tr_b16 a[10:11], v3 offset:31744
  v_lshlrev_b32 v22, 16, v142
  v_and_b32 v23, s41, v142
  v_lshlrev_b32 v24, 16, v143
  s_waitcnt lgkmcnt(8)
  v_mfma_f32_32x32x16_bf16 a[144:159], v[136:139], a[16:19], a[144:159]
  ds_read_b64_tr_b16 a[12:13], v3 offset:24576
  ds_read_b64_tr_b16 a[14:15], v3 offset:29696
  v_and_b32 v25, s41, v143
  v_fma_f32 v22, v22, v5, v6
  v_fma_f32 v23, v23, v5, v6
  v_mfma_f32_32x32x16_bf16 a[160:175], v[136:139], a[20:23], a[160:175]
  ds_read_b64_tr_b16 a[16:17], v3 offset:25088
  ds_read_b64_tr_b16 a[18:19], v3 offset:30208
  v_fma_f32 v24, v24, v5, v6
  v_fma_f32 v25, v25, v5, v6
  v_cvt_pk_bf16_f32 v142, v22, v23
  v_cvt_pk_bf16_f32 v143, v24, v25
  v_mfma_f32_32x32x16_bf16 a[176:191], v[136:139], a[24:27], a[176:191]
  ds_read_b64_tr_b16 a[20:21], v3 offset:27136
  ds_read_b64_tr_b16 a[22:23], v3 offset:32256
  v_lshlrev_b32 v18, 16, v144
  v_and_b32 v19, s41, v144
  v_lshlrev_b32 v20, 16, v145
  s_waitcnt lgkmcnt(8)
  v_mfma_f32_32x32x16_bf16 v[32:47], v[140:143], a[28:31], v[32:47]
  ds_read_b64_tr_b16 a[24:25], v3 offset:27648
  ds_read_b64_tr_b16 a[26:27], v2 offset:64512
  v_and_b32 v21, s41, v145
  v_fma_f32 v18, v18, v5, v6
  v_fma_f32 v19, v19, v5, v6
  v_mfma_f32_32x32x16_bf16 v[96:111], v[140:143], a[0:3], v[96:111]
  ds_read_b64_tr_b16 a[28:29], v3 offset:28160
  ds_read_b64_tr_b16 a[30:31], v2 offset:65024
  v_fma_f32 v20, v20, v5, v6
  v_fma_f32 v21, v21, v5, v6
  v_cvt_pk_bf16_f32 v144, v18, v19
  v_mfma_f32_32x32x16_bf16 v[48:63], v[140:143], a[4:7], v[48:63]
  s_waitcnt vmcnt(9)
  s_barrier
  ds_read_b64_tr_b16 a[0:1], v1 offset:11264
  ds_read_b64_tr_b16 a[2:3], v1 offset:16384
  s_add_u32 m0, s40, 19056
  s_waitcnt lgkmcnt(8)
  v_mfma_f32_32x32x16_bf16 a[128:143], v[140:143], a[8:11], a[128:143]
  buffer_load_dwordx4 v8, s[12:15], s56 offen offset:2448  lds
  ds_read_b64_tr_b16 a[4:5], v13 offset:13312
  ds_read_b64_tr_b16 a[6:7], v13 offset:18432
  v_cvt_pk_bf16_f32 v145, v20, v21
  v_lshlrev_b32 v22, 16, v146
  v_mfma_f32_32x32x16_bf16 v[64:79], v[140:143], a[12:15], v[64:79]
  ds_read_b64_tr_b16 a[8:9], v1 offset:11776
  ds_read_b64_tr_b16 a[10:11], v1 offset:16896
  v_and_b32 v23, s41, v146
  v_lshlrev_b32 v24, 16, v147
  v_and_b32 v25, s41, v147
  v_fma_f32 v22, v22, v5, v6
  v_mfma_f32_32x32x16_bf16 v[80:95], v[140:143], a[16:19], v[80:95]
  ds_read_b64_tr_b16 a[12:13], v1 offset:14336
  ds_read_b64_tr_b16 a[14:15], v1 offset:19456
  v_fma_f32 v23, v23, v5, v6
  s_add_u32 m0, s40, 21376
  s_waitcnt lgkmcnt(8)
  v_mfma_f32_32x32x16_bf16 a[144:159], v[140:143], a[20:23], a[144:159]
  buffer_load_dwordx4 v8, s[12:15], s57 offen offset:1152  lds
  ds_read_b64_tr_b16 a[16:17], v1 offset:12288
  ds_read_b64_tr_b16 a[18:19], v1 offset:17408
  v_fma_f32 v24, v24, v5, v6
  v_fma_f32 v25, v25, v5, v6
  v_mfma_f32_32x32x16_bf16 a[160:175], v[140:143], a[24:27], a[160:175]
  ds_read_b64_tr_b16 a[20:21], v1 offset:12800
  ds_read_b64_tr_b16 a[22:23], v1 offset:17920
  v_cvt_pk_bf16_f32 v146, v22, v23
  v_cvt_pk_bf16_f32 v147, v24, v25
  v_lshlrev_b32 v18, 16, v148
  v_mfma_f32_32x32x16_bf16 a[176:191], v[140:143], a[28:31], a[176:191]
  ds_read_b64_tr_b16 a[24:25], v1 offset:14848
  ds_read_b64_tr_b16 a[26:27], v1 offset:19968
  v_and_b32 v19, s41, v148
  v_lshlrev_b32 v20, 16, v149
  s_add_u32 m0, s40, 22256
  s_waitcnt lgkmcnt(8)
  v_mfma_f32_32x32x16_bf16 v[32:47], v[144:147], a[0:3], v[32:47]
  buffer_load_dwordx4 v8, s[12:15], s57 offen offset:1296  lds
  ds_read_b64_tr_b16 a[28:29], v1 offset:15360
  ds_read_b64_tr_b16 a[30:31], v1 offset:20480
  v_and_b32 v21, s41, v149
  v_fma_f32 v18, v18, v5, v6
  v_mfma_f32_32x32x16_bf16 v[96:111], v[144:147], a[4:7], v[96:111]
  ds_read_b64_tr_b16 a[0:1], v1 offset:15872
  ds_read_b64_tr_b16 a[2:3], v1 offset:20992
  v_fma_f32 v19, v19, v5, v6
  v_fma_f32 v20, v20, v5, v6
  v_fma_f32 v21, v21, v5, v6
  v_mfma_f32_32x32x16_bf16 v[48:63], v[144:147], a[8:11], v[48:63]
  ds_read_b64_tr_b16 a[4:5], v1 offset:51200
  ds_read_b64_tr_b16 a[6:7], v1 offset:56320
  v_cvt_pk_bf16_f32 v148, v18, v19
  s_add_u32 m0, s40, 24576
  s_waitcnt lgkmcnt(8)
  v_mfma_f32_32x32x16_bf16 a[128:143], v[144:147], a[12:15], a[128:143]
  buffer_load_dwordx4 v9, s[12:15], s57 offen  lds
  ds_read_b64_tr_b16 a[8:9], v13 offset:53248
  ds_read_b64_tr_b16 a[10:11], v13 offset:58368
  v_cvt_pk_bf16_f32 v149, v20, v21
  v_lshlrev_b32 v22, 16, v150
  v_mfma_f32_32x32x16_bf16 v[64:79], v[144:147], a[16:19], v[64:79]
  ds_read_b64_tr_b16 a[12:13], v1 offset:51712
  ds_read_b64_tr_b16 a[14:15], v1 offset:56832
  v_and_b32 v23, s41, v150
  v_lshlrev_b32 v24, 16, v151
  v_and_b32 v25, s41, v151
  v_fma_f32 v22, v22, v5, v6
  v_mfma_f32_32x32x16_bf16 v[80:95], v[144:147], a[20:23], v[80:95]
  ds_read_b64_tr_b16 a[16:17], v1 offset:54272
  ds_read_b64_tr_b16 a[18:19], v1 offset:59392
  v_fma_f32 v23, v23, v5, v6
  s_add_u32 m0, s40, 23296
  s_waitcnt lgkmcnt(8)
  v_mfma_f32_32x32x16_bf16 a[144:159], v[144:147], a[24:27], a[144:159]
  buffer_load_dwordx4 v8, s[12:15], s57 offen offset:2304  lds
  ds_read_b64_tr_b16 a[20:21], v1 offset:52224
  ds_read_b64_tr_b16 a[22:23], v1 offset:57344
  v_fma_f32 v24, v24, v5, v6
  v_fma_f32 v25, v25, v5, v6
  v_mfma_f32_32x32x16_bf16 a[160:175], v[144:147], a[28:31], a[160:175]
  ds_read_b64_tr_b16 a[24:25], v1 offset:52736
  ds_read_b64_tr_b16 a[26:27], v1 offset:57856
  v_cvt_pk_bf16_f32 v150, v22, v23
  v_cvt_pk_bf16_f32 v151, v24, v25
  v_lshlrev_b32 v18, 16, v152
  v_mfma_f32_32x32x16_bf16 a[176:191], v[144:147], a[0:3], a[176:191]
  ds_read_b64_tr_b16 a[28:29], v1 offset:54784
  ds_read_b64_tr_b16 a[30:31], v1 offset:59904
  v_and_b32 v19, s41, v152
  v_lshlrev_b32 v20, 16, v153
  s_add_u32 m0, s40, 24176
  s_waitcnt lgkmcnt(8)
  v_mfma_f32_32x32x16_bf16 v[32:47], v[148:151], a[4:7], v[32:47]
  buffer_load_dwordx4 v8, s[12:15], s57 offen offset:2448  lds
  ds_read_b64_tr_b16 a[0:1], v1 offset:55296
  ds_read_b64_tr_b16 a[2:3], v1 offset:60416
  v_and_b32 v21, s41, v153
  v_fma_f32 v18, v18, v5, v6
  v_mfma_f32_32x32x16_bf16 v[96:111], v[148:151], a[8:11], v[96:111]
  ds_read_b64_tr_b16 a[4:5], v1 offset:55808
  ds_read_b64_tr_b16 a[6:7], v1 offset:60928
  v_fma_f32 v19, v19, v5, v6
  v_fma_f32 v20, v20, v5, v6
  v_fma_f32 v21, v21, v5, v6
  v_mfma_f32_32x32x16_bf16 v[48:63], v[148:151], a[12:15], v[48:63]
  ds_read_b64_tr_b16 a[8:9], v2 offset:25600
  ds_read_b64_tr_b16 a[10:11], v2 offset:30720
  v_cvt_pk_bf16_f32 v152, v18, v19
  s_add_u32 m0, s40, 26496
  s_waitcnt lgkmcnt(8)
  v_mfma_f32_32x32x16_bf16 a[128:143], v[148:151], a[16:19], a[128:143]
  buffer_load_dwordx4 v8, s[12:15], s58 offen offset:1152  lds
  ds_read_b64_tr_b16 a[12:13], v14 offset:27648
  ds_read_b64_tr_b16 a[14:15], v14 offset:32768
  v_cvt_pk_bf16_f32 v153, v20, v21
  v_lshlrev_b32 v22, 16, v154
  v_mfma_f32_32x32x16_bf16 v[64:79], v[148:151], a[20:23], v[64:79]
  ds_read_b64_tr_b16 a[16:17], v2 offset:26112
  ds_read_b64_tr_b16 a[18:19], v2 offset:31232
  v_and_b32 v23, s41, v154
  v_lshlrev_b32 v24, 16, v155
  v_and_b32 v25, s41, v155
  v_fma_f32 v22, v22, v5, v6
  v_mfma_f32_32x32x16_bf16 v[80:95], v[148:151], a[24:27], v[80:95]
  ds_read_b64_tr_b16 a[20:21], v2 offset:28672
AT_H1:
  s_cbranch_execz AT_H5
  ds_read_b64_tr_b16 a[22:23], v2 offset:33792
  v_fma_f32 v23, v23, v5, v6
  s_add_u32 m0, s40, 27376
  s_waitcnt lgkmcnt(8)
  v_mfma_f32_32x32x16_bf16 a[144:159], v[148:151], a[28:31], a[144:159]
  buffer_load_dwordx4 v8, s[12:15], s58 offen offset:1296  lds
  ds_read_b64_tr_b16 a[24:25], v2 offset:26624
  ds_read_b64_tr_b16 a[26:27], v2 offset:31744
  v_fma_f32 v24, v24, v5, v6
  v_fma_f32 v25, v25, v5, v6
  v_mfma_f32_32x32x16_bf16 a[160:175], v[148:151], a[0:3], a[160:175]
  ds_read_b64_tr_b16 a[28:29], v2 offset:27136
  ds_read_b64_tr_b16 a[30:31], v2 offset:32256
  v_cvt_pk_bf16_f32 v154, v22, v23
  v_cvt_pk_bf16_f32 v155, v24, v25
  v_lshlrev_b32 v18, 16, v156
  v_mfma_f32_32x32x16_bf16 a[176:191], v[148:151], a[4:7], a[176:191]
  ds_read_b64_tr_b16 a[0:1], v2 offset:29184
  ds_read_b64_tr_b16 a[2:3], v2 offset:34304
  v_and_b32 v19, s41, v156
  v_lshlrev_b32 v20, 16, v157
  s_add_u32 m0, s40, 29696
  s_waitcnt lgkmcnt(8)
  v_mfma_f32_32x32x16_bf16 v[32:47], v[152:155], a[8:11], v[32:47]
  buffer_load_dwordx4 v9, s[12:15], s58 offen  lds
  ds_read_b64_tr_b16 a[4:5], v2 offset:29696
  ds_read_b64_tr_b16 a[6:7], v2 offset:34816
  v_and_b32 v21, s41, v157
  v_fma_f32 v18, v18, v5, v6
  v_mfma_f32_32x32x16_bf16 v[96:111], v[152:155], a[12:15], v[96:111]
  ds_read_b64_tr_b16 a[8:9], v2 offset:30208
  ds_read_b64_tr_b16 a[10:11], v2 offset:35328
  v_fma_f32 v19, v19, v5, v6
  v_fma_f32 v20, v20, v5, v6
  v_fma_f32 v21, v21, v5, v6
  v_mfma_f32_32x32x16_bf16 v[48:63], v[152:155], a[16:19], v[48:63]
  ds_read_b64_tr_b16 a[12:13], v3 offset:0
  ds_read_b64_tr_b16 a[14:15], v3 offset:5120
  v_cvt_pk_bf16_f32 v156, v18, v19
  s_add_u32 m0, s40, 28416
  s_waitcnt lgkmcnt(8)
  v_mfma_f32_32x32x16_bf16 a[128:143], v[152:155], a[20:23], a[128:143]
  buffer_load_dwordx4 v8, s[12:15], s58 offen offset:2304  lds
  ds_read_b64_tr_b16 a[16:17], v15 offset:2048
  ds_read_b64_tr_b16 a[18:19], v15 offset:7168
  v_cvt_pk_bf16_f32 v157, v20, v21
  v_lshlrev_b32 v22, 16, v158
  v_mfma_f32_32x32x16_bf16 v[64:79], v[152:155], a[24:27], v[64:79]
  ds_read_b64_tr_b16 a[20:21], v3 offset:512
  ds_read_b64_tr_b16 a[22:23], v3 offset:5632
  v_and_b32 v23, s41, v158
  v_lshlrev_b32 v24, 16, v159
  v_and_b32 v25, s41, v159
  v_fma_f32 v22, v22, v5, v6
  v_mfma_f32_32x32x16_bf16 v[80:95], v[152:155], a[28:31], v[80:95]
  ds_read_b64_tr_b16 a[24:25], v3 offset:3072
  ds_read_b64_tr_b16 a[26:27], v3 offset:8192
  v_fma_f32 v23, v23, v5, v6
  v_fma_f32 v24, v24, v5, v6
  s_waitcnt lgkmcnt(8)
  v_mfma_f32_32x32x16_bf16 a[144:159], v[152:155], a[0:3], a[144:159]
  ds_read_b64_tr_b16 a[28:29], v3 offset:1024
  ds_read_b64_tr_b16 a[30:31], v3 offset:6144
  v_fma_f32 v25, v25, v5, v6
  v_cvt_pk_bf16_f32 v158, v22, v23
  v_cvt_pk_bf16_f32 v159, v24, v25
  v_mfma_f32_32x32x16_bf16 a[160:175], v[152:155], a[4:7], a[160:175]
  ds_read_b64_tr_b16 a[0:1], v3 offset:1536
  ds_read_b64_tr_b16 a[2:3], v3 offset:6656
  v_lshlrev_b32 v18, 16, v160
  v_and_b32 v19, s41, v160
  v_lshlrev_b32 v20, 16, v161
  v_and_b32 v21, s41, v161
  v_mfma_f32_32x32x16_bf16 a[176:191], v[152:155], a[8:11], a[176:191]
  ds_read_b64_tr_b16 a[4:5], v3 offset:3584
  ds_read_b64_tr_b16 a[6:7], v3 offset:8704
  v_fma_f32 v18, v18, v5, v6
  v_fma_f32 v19, v19, v5, v6
  s_waitcnt lgkmcnt(8)
  v_mfma_f32_32x32x16_bf16 v[32:47], v[156:159], a[12:15], v[32:47]
  ds_read_b64_tr_b16 a[8:9], v3 offset:4096
  ds_read_b64_tr_b16 a[10:11], v3 offset:9216
  v_fma_f32 v20, v20, v5, v6
  v_fma_f32 v21, v21, v5, v6
  v_cvt_pk_bf16_f32 v160, v18, v19
  v_mfma_f32_32x32x16_bf16 v[96:111], v[156:159], a[16:19], v[96:111]
  ds_read_b64_tr_b16 a[12:13], v3 offset:4608
  ds_read_b64_tr_b16 a[14:15], v3 offset:9728
  v_cvt_pk_bf16_f32 v161, v20, v21
  v_lshlrev_b32 v22, 16, v162
  v_and_b32 v23, s41, v162
  v_lshlrev_b32 v24, 16, v163
  v_mfma_f32_32x32x16_bf16 v[48:63], v[156:159], a[20:23], v[48:63]
  s_waitcnt vmcnt(4)
  s_barrier
  ds_read_b64_tr_b16 a[16:17], v1 offset:21504
  ds_read_b64_tr_b16 a[18:19], v1 offset:26624
  s_add_u32 m0, s40, 29296
  s_waitcnt lgkmcnt(8)
  v_mfma_f32_32x32x16_bf16 a[128:143], v[156:159], a[24:27], a[128:143]
  buffer_load_dwordx4 v8, s[12:15], s58 offen offset:2448  lds
  ds_read_b64_tr_b16 a[20:21], v13 offset:23552
  ds_read_b64_tr_b16 a[22:23], v13 offset:28672
  v_and_b32 v25, s41, v163
  v_fma_f32 v22, v22, v5, v6
  v_mfma_f32_32x32x16_bf16 v[64:79], v[156:159], a[28:31], v[64:79]
  ds_read_b64_tr_b16 a[24:25], v1 offset:22016
  ds_read_b64_tr_b16 a[26:27], v1 offset:27136
  v_fma_f32 v23, v23, v5, v6
  v_fma_f32 v24, v24, v5, v6
  v_fma_f32 v25, v25, v5, v6
  v_mfma_f32_32x32x16_bf16 v[80:95], v[156:159], a[0:3], v[80:95]
  ds_read_b64_tr_b16 a[28:29], v1 offset:24576
  ds_read_b64_tr_b16 a[30:31], v1 offset:29696
  s_add_u32 m0, s40, 31616
  s_waitcnt lgkmcnt(8)
  v_mfma_f32_32x32x16_bf16 a[144:159], v[156:159], a[4:7], a[144:159]
  buffer_load_dwordx4 v8, s[12:15], s59 offen offset:1152  lds
  ds_read_b64_tr_b16 a[0:1], v1 offset:22528
  ds_read_b64_tr_b16 a[2:3], v1 offset:27648
  v_lshlrev_b32 v26, 12, v0
  v_mov_b32 v27, 1
  s_and_b32 s47, s2, 1
  s_lshl_b32 s47, s47, 7
  buffer_atomic_add v27, v26, s[36:39], s47 offen sc1
  v_mfma_f32_32x32x16_bf16 a[160:175], v[156:159], a[8:11], a[160:175]
  ds_read_b64_tr_b16 a[4:5], v1 offset:23040
  ds_read_b64_tr_b16 a[6:7], v1 offset:28160
  v_cvt_pk_bf16_f32 v162, v22, v23
  v_cvt_pk_bf16_f32 v163, v24, v25
  v_mfma_f32_32x32x16_bf16 a[176:191], v[156:159], a[12:15], a[176:191]
  ds_read_b64_tr_b16 a[8:9], v1 offset:25088
  ds_read_b64_tr_b16 a[10:11], v1 offset:30208
  v_lshlrev_b32 v18, 16, v164
  v_and_b32 v19, s41, v164
  s_add_u32 m0, s40, 32496
  s_waitcnt lgkmcnt(8)
  v_mfma_f32_32x32x16_bf16 v[32:47], v[160:163], a[16:19], v[32:47]
  buffer_load_dwordx4 v8, s[12:15], s59 offen offset:1296  lds
  ds_read_b64_tr_b16 a[12:13], v1 offset:25600
  ds_read_b64_tr_b16 a[14:15], v1 offset:30720
  v_lshlrev_b32 v20, 16, v165
  v_and_b32 v21, s41, v165
  v_mfma_f32_32x32x16_bf16 v[96:111], v[160:163], a[20:23], v[96:111]
  ds_read_b64_tr_b16 a[16:17], v1 offset:26112
  ds_read_b64_tr_b16 a[18:19], v1 offset:31232
  v_fma_f32 v18, v18, v5, v6
  v_fma_f32 v19, v19, v5, v6
  v_fma_f32 v20, v20, v5, v6
  v_mfma_f32_32x32x16_bf16 v[48:63], v[160:163], a[24:27], v[48:63]
  ds_read_b64_tr_b16 a[20:21], v1 offset:61440
  ds_read_b64_tr_b16 a[22:23], v2 offset:1024
  v_fma_f32 v21, v21, v5, v6
  s_add_u32 m0, s40, 34816
  s_waitcnt lgkmcnt(8)
  v_mfma_f32_32x32x16_bf16 a[128:143], v[160:163], a[28:31], a[128:143]
  buffer_load_dwordx4 v9, s[12:15], s59 offen  lds
  ds_read_b64_tr_b16 a[24:25], v13 offset:63488
  ds_read_b64_tr_b16 a[26:27], v14 offset:3072
  v_cvt_pk_bf16_f32 v164, v18, v19
  v_cvt_pk_bf16_f32 v165, v20, v21
  v_mfma_f32_32x32x16_bf16 v[64:79], v[160:163], a[0:3], v[64:79]
  ds_read_b64_tr_b16 a[28:29], v1 offset:61952
  ds_read_b64_tr_b16 a[30:31], v2 offset:1536
  v_lshlrev_b32 v22, 16, v166
  v_and_b32 v23, s41, v166
  v_lshlrev_b32 v24, 16, v167
  v_and_b32 v25, s41, v167
  v_mfma_f32_32x32x16_bf16 v[80:95], v[160:163], a[4:7], v[80:95]
  ds_read_b64_tr_b16 a[0:1], v1 offset:64512
  ds_read_b64_tr_b16 a[2:3], v2 offset:4096
  v_fma_f32 v22, v22, v5, v6
  s_add_u32 m0, s40, 33536
  s_waitcnt lgkmcnt(8)
  v_mfma_f32_32x32x16_bf16 a[144:159], v[160:163], a[8:11], a[144:159]
  buffer_load_dwordx4 v8, s[12:15], s59 offen offset:2304  lds
  ds_read_b64_tr_b16 a[4:5], v1 offset:62464
  ds_read_b64_tr_b16 a[6:7], v2 offset:2048
  v_fma_f32 v23, v23, v5, v6
  v_fma_f32 v24, v24, v5, v6
  v_mfma_f32_32x32x16_bf16 a[160:175], v[160:163], a[12:15], a[160:175]
  ds_read_b64_tr_b16 a[8:9], v1 offset:62976
  ds_read_b64_tr_b16 a[10:11], v2 offset:2560
  s_getpc_b64 s[46:47]
AT_PC1:
  s_lshr_b32 s48, s2, 5
  s_lshl_b32 s48, s48, 2
  s_add_u32 s48, s48, s6
  s_mul_i32 s48, s48, 1536
  v_and_b32 v26, 63, v0
  v_min_u32 v26, 11, v26
  v_lshl_add_u32 v26, v26, 7, s48
  v_min_u32 v26, AT_LAST-AT_PC1, v26
  v_mov_b32 v27, s47
  v_add_co_u32 v26, vcc, s46, v26
  v_addc_co_u32 v27, vcc, 0, v27, vcc
  global_load_dword a41, v[26:27], off
  v_fma_f32 v25, v25, v5, v6
  v_cvt_pk_bf16_f32 v166, v22, v23
  v_cvt_pk_bf16_f32 v167, v24, v25
  v_mfma_f32_32x32x16_bf16 a[176:191], v[160:163], a[16:19], a[176:191]
  ds_read_b64_tr_b16 a[12:13], v1 offset:65024
  ds_read_b64_tr_b16 a[14:15], v2 offset:4608
  s_add_u32 m0, s40, 34416
  s_waitcnt lgkmcnt(8)
  v_mfma_f32_32x32x16_bf16 v[32:47], v[164:167], a[20:23], v[32:47]
  buffer_load_dwordx4 v8, s[12:15], s59 offen offset:2448  lds
  ds_read_b64_tr_b16 a[16:17], v2 offset:0
  ds_read_b64_tr_b16 a[18:19], v2 offset:5120
  v_lshlrev_b32 v18, 16, v168
  v_and_b32 v19, s41, v168
  v_mfma_f32_32x32x16_bf16 v[96:111], v[164:167], a[24:27], v[96:111]
  ds_read_b64_tr_b16 a[20:21], v2 offset:512
  ds_read_b64_tr_b16 a[22:23], v2 offset:5632
  v_lshlrev_b32 v20, 16, v169
  v_and_b32 v21, s41, v169
  v_fma_f32 v18, v18, v5, v6
  v_mfma_f32_32x32x16_bf16 v[48:63], v[164:167], a[28:31], v[48:63]
  ds_read_b64_tr_b16 a[24:25], v2 offset:35840
  ds_read_b64_tr_b16 a[26:27], v2 offset:40960
  v_and_b32 v28, 32, v0
  v_lshl_add_u32 v26, v28, 13, v16
  v_xor_b32 v28, 32, v28
  v_lshl_add_u32 v27, v28, 13, v16
  s_add_u32 m0, s40, 36736
  s_waitcnt lgkmcnt(8)
  v_mfma_f32_32x32x16_bf16 a[128:143], v[164:167], a[0:3], a[128:143]
  buffer_load_dwordx4 v8, s[12:15], s60 offen offset:1152  lds
  ds_read_b64_tr_b16 a[28:29], v14 offset:37888
  ds_read_b64_tr_b16 a[30:31], v14 offset:43008
  v_mfma_f32_32x32x16_bf16 v[64:79], v[164:167], a[4:7], v[64:79]
  ds_read_b64_tr_b16 a[0:1], v2 offset:36352
  ds_read_b64_tr_b16 a[2:3], v2 offset:41472
  s_lshl_b32 s46, s6, 10
  v_add_u32 v28, s46, v4
  v_add_u32 v29, 79872, v28
  v_mfma_f32_32x32x16_bf16 v[80:95], v[164:167], a[8:11], v[80:95]
  ds_read_b64_tr_b16 a[4:5], v2 offset:38912
  ds_read_b64_tr_b16 a[6:7], v2 offset:44032
  v_fma_f32 v19, v19, v5, v6
  s_add_u32 m0, s40, 37616
  s_waitcnt lgkmcnt(8)
  v_mfma_f32_32x32x16_bf16 a[144:159], v[164:167], a[12:15], a[144:159]
  buffer_load_dwordx4 v8, s[12:15], s60 offen offset:1296  lds
  ds_read_b64_tr_b16 a[8:9], v2 offset:36864
  ds_read_b64_tr_b16 a[10:11], v2 offset:41984
  v_fma_f32 v20, v20, v5, v6
  v_fma_f32 v21, v21, v5, v6
  v_mfma_f32_32x32x16_bf16 a[160:175], v[164:167], a[16:19], a[160:175]
  ds_read_b64_tr_b16 a[12:13], v2 offset:37376
  ds_read_b64_tr_b16 a[14:15], v2 offset:42496
  v_cvt_pk_bf16_f32 v168, v18, v19
  v_cvt_pk_bf16_f32 v169, v20, v21
  v_lshlrev_b32 v22, 16, v170
  v_and_b32 v23, s41, v170
  v_lshlrev_b32 v24, 16, v171
  v_and_b32 v25, s41, v171
  v_fma_f32 v22, v22, v5, v6
  v_fma_f32 v23, v23, v5, v6
  v_fma_f32 v24, v24, v5, v6
  v_fma_f32 v25, v25, v5, v6
  v_cvt_pk_bf16_f32 v170, v22, v23
  v_cvt_pk_bf16_f32 v171, v24, v25
  v_mfma_f32_32x32x16_bf16 a[176:191], v[164:167], a[20:23], a[176:191]
  ds_read_b64_tr_b16 a[16:17], v2 offset:39424
  ds_read_b64_tr_b16 a[18:19], v2 offset:44544
  v_lshlrev_b32 v18, 16, v172
  v_and_b32 v19, s41, v172
  s_add_u32 m0, s40, 6144
  s_waitcnt lgkmcnt(8)
  v_mfma_f32_32x32x16_bf16 v[32:47], v[168:171], a[24:27], v[32:47]
  buffer_load_dwordx4 v9, s[12:15], s60 offen  lds
  ds_read_b64_tr_b16 a[20:21], v2 offset:39936
  ds_read_b64_tr_b16 a[22:23], v2 offset:45056
  v_lshlrev_b32 v20, 16, v173
  v_and_b32 v21, s41, v173
  v_mfma_f32_32x32x16_bf16 v[96:111], v[168:171], a[28:31], v[96:111]
  ds_read_b64_tr_b16 a[24:25], v2 offset:40448
  ds_read_b64_tr_b16 a[26:27], v2 offset:45568
  v_fma_f32 v18, v18, v5, v6
  v_fma_f32 v19, v19, v5, v6
  v_fma_f32 v20, v20, v5, v6
  v_mfma_f32_32x32x16_bf16 v[48:63], v[168:171], a[0:3], v[48:63]
  ds_read_b64_tr_b16 a[28:29], v3 offset:10240
  ds_read_b64_tr_b16 a[30:31], v3 offset:15360
  v_fma_f32 v21, v21, v5, v6
  s_add_u32 m0, s40, 4864
  s_waitcnt lgkmcnt(8)
  v_mfma_f32_32x32x16_bf16 a[128:143], v[168:171], a[4:7], a[128:143]
  buffer_load_dwordx4 v8, s[12:15], s60 offen offset:2304  lds
  ds_read_b64_tr_b16 a[0:1], v15 offset:12288
  ds_read_b64_tr_b16 a[2:3], v15 offset:17408
  v_cvt_pk_bf16_f32 v172, v18, v19
  v_cvt_pk_bf16_f32 v173, v20, v21
  v_mfma_f32_32x32x16_bf16 v[64:79], v[168:171], a[8:11], v[64:79]
  ds_read_b64_tr_b16 a[4:5], v3 offset:10752
  ds_read_b64_tr_b16 a[6:7], v3 offset:15872
  v_lshlrev_b32 v22, 16, v174
  v_and_b32 v23, s41, v174
  v_lshlrev_b32 v24, 16, v175
  v_and_b32 v25, s41, v175
  v_mfma_f32_32x32x16_bf16 v[80:95], v[168:171], a[12:15], v[80:95]
  ds_read_b64_tr_b16 a[8:9], v3 offset:13312
  ds_read_b64_tr_b16 a[10:11], v3 offset:18432
  v_fma_f32 v22, v22, v5, v6
  v_fma_f32 v23, v23, v5, v6
  s_waitcnt lgkmcnt(8)
  v_mfma_f32_32x32x16_bf16 a[144:159], v[168:171], a[16:19], a[144:159]
  ds_read_b64_tr_b16 a[12:13], v3 offset:11264
  ds_read_b64_tr_b16 a[14:15], v3 offset:16384
  v_fma_f32 v24, v24, v5, v6
  v_fma_f32 v25, v25, v5, v6
  v_cvt_pk_bf16_f32 v174, v22, v23
  v_mfma_f32_32x32x16_bf16 a[160:175], v[168:171], a[20:23], a[160:175]
  ds_read_b64_tr_b16 a[16:17], v3 offset:11776
  ds_read_b64_tr_b16 a[18:19], v3 offset:16896
  v_cvt_pk_bf16_f32 v175, v24, v25
  v_lshlrev_b32 v18, 16, v176
  v_and_b32 v19, s41, v176
  v_lshlrev_b32 v20, 16, v177
  v_mfma_f32_32x32x16_bf16 a[176:191], v[168:171], a[24:27], a[176:191]
  ds_read_b64_tr_b16 a[20:21], v3 offset:13824
  ds_read_b64_tr_b16 a[22:23], v3 offset:18944
  v_and_b32 v21, s41, v177
  v_fma_f32 v18, v18, v5, v6
  s_waitcnt lgkmcnt(8)
  v_mfma_f32_32x32x16_bf16 v[32:47], v[172:175], a[28:31], v[32:47]
  ds_read_b64_tr_b16 a[24:25], v3 offset:14336
  ds_read_b64_tr_b16 a[26:27], v3 offset:19456
  v_fma_f32 v19, v19, v5, v6
  v_fma_f32 v20, v20, v5, v6
  v_fma_f32 v21, v21, v5, v6
  v_mfma_f32_32x32x16_bf16 v[96:111], v[172:175], a[0:3], v[96:111]
  ds_read_b64_tr_b16 a[28:29], v3 offset:14848
  ds_read_b64_tr_b16 a[30:31], v3 offset:19968
  v_cvt_pk_bf16_f32 v176, v18, v19
  v_cvt_pk_bf16_f32 v177, v20, v21
  v_lshlrev_b32 v22, 16, v178
  v_mfma_f32_32x32x16_bf16 v[48:63], v[172:175], a[4:7], v[48:63]
  s_waitcnt vmcnt(4)
  s_barrier
  ds_read_b64_tr_b16 a[0:1], v1 offset:31744
  ds_read_b64_tr_b16 a[2:3], v1 offset:36864
  s_add_u32 m0, s40, 5744
  s_waitcnt lgkmcnt(8)
  v_mfma_f32_32x32x16_bf16 a[128:143], v[172:175], a[8:11], a[128:143]
  buffer_load_dwordx4 v8, s[12:15], s60 offen offset:2448  lds
  ds_read_b64_tr_b16 a[4:5], v13 offset:33792
  ds_read_b64_tr_b16 a[6:7], v13 offset:38912
  v_and_b32 v23, s41, v178
  v_lshlrev_b32 v24, 16, v179
  v_and_b32 v25, s41, v179
  v_mfma_f32_32x32x16_bf16 v[64:79], v[172:175], a[12:15], v[64:79]
  ds_read_b64_tr_b16 a[8:9], v1 offset:32256
  ds_read_b64_tr_b16 a[10:11], v1 offset:37376
  v_fma_f32 v22, v22, v5, v6
  v_fma_f32 v23, v23, v5, v6
  v_fma_f32 v24, v24, v5, v6
  v_mfma_f32_32x32x16_bf16 v[80:95], v[172:175], a[16:19], v[80:95]
  ds_read_b64_tr_b16 a[12:13], v1 offset:34816
  ds_read_b64_tr_b16 a[14:15], v1 offset:39936
  v_fma_f32 v25, v25, v5, v6
  s_add_u32 m0, s40, 8064
  s_waitcnt lgkmcnt(8)
  v_mfma_f32_32x32x16_bf16 a[144:159], v[172:175], a[20:23], a[144:159]
  buffer_load_dwordx4 v8, s[12:15], s61 offen offset:1152  lds
  ds_read_b64_tr_b16 a[16:17], v1 offset:32768
  ds_read_b64_tr_b16 a[18:19], v1 offset:37888
  v_cvt_pk_bf16_f32 v178, v22, v23
  v_cvt_pk_bf16_f32 v179, v24, v25
  v_mfma_f32_32x32x16_bf16 a[160:175], v[172:175], a[24:27], a[160:175]
  ds_read_b64_tr_b16 a[20:21], v1 offset:33280
  ds_read_b64_tr_b16 a[22:23], v1 offset:38400
  v_lshlrev_b32 v18, 16, v180
  v_and_b32 v19, s41, v180
  v_lshlrev_b32 v20, 16, v181
  v_and_b32 v21, s41, v181
  v_mfma_f32_32x32x16_bf16 a[176:191], v[172:175], a[28:31], a[176:191]
  ds_read_b64_tr_b16 a[24:25], v1 offset:35328
  ds_read_b64_tr_b16 a[26:27], v1 offset:40448
  v_fma_f32 v18, v18, v5, v6
  s_add_u32 m0, s40, 8944
  s_waitcnt lgkmcnt(8)
  v_mfma_f32_32x32x16_bf16 v[32:47], v[176:179], a[0:3], v[32:47]
  buffer_load_dwordx4 v8, s[12:15], s61 offen offset:1296  lds
  ds_read_b64_tr_b16 a[28:29], v1 offset:35840
  ds_read_b64_tr_b16 a[30:31], v1 offset:40960
  v_fma_f32 v19, v19, v5, v6
  v_fma_f32 v20, v20, v5, v6
  v_mfma_f32_32x32x16_bf16 v[96:111], v[176:179], a[4:7], v[96:111]
  ds_read_b64_tr_b16 a[0:1], v1 offset:36352
  ds_read_b64_tr_b16 a[2:3], v1 offset:41472
  v_fma_f32 v21, v21, v5, v6
  v_cvt_pk_bf16_f32 v180, v18, v19
  v_cvt_pk_bf16_f32 v181, v20, v21
  v_mfma_f32_32x32x16_bf16 v[48:63], v[176:179], a[8:11], v[48:63]
  ds_read_b64_tr_b16 a[4:5], v2 offset:6144
  ds_read_b64_tr_b16 a[6:7], v2 offset:11264
  v_lshlrev_b32 v22, 16, v182
  v_and_b32 v23, s41, v182
  s_add_u32 m0, s40, 11264
  s_waitcnt lgkmcnt(8)
  v_mfma_f32_32x32x16_bf16 a[128:143], v[176:179], a[12:15], a[128:143]
  buffer_load_dwordx4 v9, s[12:15], s61 offen  lds
  ds_read_b64_tr_b16 a[8:9], v14 offset:8192
  ds_read_b64_tr_b16 a[10:11], v14 offset:13312
  v_lshlrev_b32 v24, 16, v183
  v_and_b32 v25, s41, v183
  v_mfma_f32_32x32x16_bf16 v[64:79], v[176:179], a[16:19], v[64:79]
  ds_read_b64_tr_b16 a[12:13], v2 offset:6656
  ds_read_b64_tr_b16 a[14:15], v2 offset:11776
  v_fma_f32 v22, v22, v5, v6
  v_fma_f32 v23, v23, v5, v6
  v_fma_f32 v24, v24, v5, v6
  v_mfma_f32_32x32x16_bf16 v[80:95], v[176:179], a[20:23], v[80:95]
  ds_read_b64_tr_b16 a[16:17], v2 offset:9216
  ds_read_b64_tr_b16 a[18:19], v2 offset:14336
  v_fma_f32 v25, v25, v5, v6
  s_add_u32 m0, s40, 9984
  s_waitcnt lgkmcnt(8)
  v_mfma_f32_32x32x16_bf16 a[144:159], v[176:179], a[24:27], a[144:159]
  buffer_load_dwordx4 v8, s[12:15], s61 offen offset:2304  lds
  ds_read_b64_tr_b16 a[20:21], v2 offset:7168
  ds_read_b64_tr_b16 a[22:23], v2 offset:12288
  v_cvt_pk_bf16_f32 v182, v22, v23
  v_cvt_pk_bf16_f32 v183, v24, v25
  v_mfma_f32_32x32x16_bf16 a[160:175], v[176:179], a[28:31], a[160:175]
  ds_read_b64_tr_b16 a[24:25], v2 offset:7680
  ds_read_b64_tr_b16 a[26:27], v2 offset:12800
  v_lshlrev_b32 v18, 16, v184
  v_and_b32 v19, s41, v184
  v_lshlrev_b32 v20, 16, v185
  v_and_b32 v21, s41, v185
  v_mfma_f32_32x32x16_bf16 a[176:191], v[176:179], a[0:3], a[176:191]
  ds_read_b64_tr_b16 a[28:29], v2 offset:9728
  ds_read_b64_tr_b16 a[30:31], v2 offset:14848
  v_fma_f32 v18, v18, v5, v6
  s_add_u32 m0, s40, 10864
  s_waitcnt lgkmcnt(8)
  v_mfma_f32_32x32x16_bf16 v[32:47], v[180:183], a[4:7], v[32:47]
  buffer_load_dwordx4 v8, s[12:15], s61 offen offset:2448  lds
  ds_read_b64_tr_b16 a[0:1], v2 offset:10240
  ds_read_b64_tr_b16 a[2:3], v2 offset:15360
  v_fma_f32 v19, v19, v5, v6
  v_fma_f32 v20, v20, v5, v6
  v_mfma_f32_32x32x16_bf16 v[96:111], v[180:183], a[8:11], v[96:111]
  ds_read_b64_tr_b16 a[4:5], v2 offset:10752
  ds_read_b64_tr_b16 a[6:7], v2 offset:15872
  v_fma_f32 v21, v21, v5, v6
  v_cvt_pk_bf16_f32 v184, v18, v19
  v_cvt_pk_bf16_f32 v185, v20, v21
  v_mfma_f32_32x32x16_bf16 v[48:63], v[180:183], a[12:15], v[48:63]
  ds_read_b64_tr_b16 a[8:9], v2 offset:46080
  ds_read_b64_tr_b16 a[10:11], v2 offset:51200
  v_lshlrev_b32 v22, 16, v186
  v_and_b32 v23, s41, v186
  s_add_u32 m0, s40, 13184
  s_waitcnt lgkmcnt(8)
  v_mfma_f32_32x32x16_bf16 a[128:143], v[180:183], a[16:19], a[128:143]
  buffer_load_dwordx4 v8, s[12:15], s62 offen offset:1152  lds
  ds_read_b64_tr_b16 a[12:13], v14 offset:48128
  ds_read_b64_tr_b16 a[14:15], v14 offset:53248
  v_lshlrev_b32 v24, 16, v187
  v_and_b32 v25, s41, v187
  v_mfma_f32_32x32x16_bf16 v[64:79], v[180:183], a[20:23], v[64:79]
  ds_read_b64_tr_b16 a[16:17], v2 offset:46592
  ds_read_b64_tr_b16 a[18:19], v2 offset:51712
  v_fma_f32 v22, v22, v5, v6
  v_fma_f32 v23, v23, v5, v6
  v_fma_f32 v24, v24, v5, v6
  v_mfma_f32_32x32x16_bf16 v[80:95], v[180:183], a[24:27], v[80:95]
  ds_read_b64_tr_b16 a[20:21], v2 offset:49152
  ds_read_b64_tr_b16 a[22:23], v2 offset:54272
  v_fma_f32 v25, v25, v5, v6
  s_add_u32 m0, s40, 14064
  s_waitcnt lgkmcnt(8)
  v_mfma_f32_32x32x16_bf16 a[144:159], v[180:183], a[28:31], a[144:159]
  buffer_load_dwordx4 v8, s[12:15], s62 offen offset:1296  lds
  ds_read_b64_tr_b16 a[24:25], v2 offset:47104
  ds_read_b64_tr_b16 a[26:27], v2 offset:52224
  v_cvt_pk_bf16_f32 v186, v22, v23
  v_cvt_pk_bf16_f32 v187, v24, v25
  v_mfma_f32_32x32x16_bf16 a[160:175], v[180:183], a[0:3], a[160:175]
  ds_read_b64_tr_b16 a[28:29], v2 offset:47616
  ds_read_b64_tr_b16 a[30:31], v2 offset:52736
  v_lshlrev_b32 v18, 16, v188
  v_and_b32 v19, s41, v188
  v_lshlrev_b32 v20, 16, v189
  v_and_b32 v21, s41, v189
  v_mfma_f32_32x32x16_bf16 a[176:191], v[180:183], a[4:7], a[176:191]
  ds_read_b64_tr_b16 a[0:1], v2 offset:49664
  ds_read_b64_tr_b16 a[2:3], v2 offset:54784
  v_fma_f32 v18, v18, v5, v6
  s_add_u32 m0, s40, 16384
  s_waitcnt lgkmcnt(8)
  v_mfma_f32_32x32x16_bf16 v[32:47], v[184:187], a[8:11], v[32:47]
  buffer_load_dwordx4 v9, s[12:15], s62 offen  lds
  ds_read_b64_tr_b16 a[4:5], v2 offset:50176
  ds_read_b64_tr_b16 a[6:7], v2 offset:55296
  v_fma_f32 v19, v19, v5, v6
  v_fma_f32 v20, v20, v5, v6
  v_mfma_f32_32x32x16_bf16 v[96:111], v[184:187], a[12:15], v[96:111]
  ds_read_b64_tr_b16 a[8:9], v2 offset:50688
  ds_read_b64_tr_b16 a[10:11], v2 offset:55808
  v_fma_f32 v21, v21, v5, v6
  v_cvt_pk_bf16_f32 v188, v18, v19
  v_cvt_pk_bf16_f32 v189, v20, v21
  v_mfma_f32_32x32x16_bf16 v[48:63], v[184:187], a[16:19], v[48:63]
  ds_read_b64_tr_b16 a[12:13], v3 offset:20480
  ds_read_b64_tr_b16 a[14:15], v3 offset:25600
  v_lshlrev_b32 v22, 16, v190
  v_and_b32 v23, s41, v190
  s_add_u32 m0, s40, 15104
  s_waitcnt lgkmcnt(8)
  v_mfma_f32_32x32x16_bf16 a[128:143], v[184:187], a[20:23], a[128:143]
  buffer_load_dwordx4 v8, s[12:15], s62 offen offset:2304  lds
  ds_read_b64_tr_b16 a[16:17], v15 offset:22528
  ds_read_b64_tr_b16 a[18:19], v15 offset:27648
  v_lshlrev_b32 v24, 16, v191
  v_and_b32 v25, s41, v191
  v_mfma_f32_32x32x16_bf16 v[64:79], v[184:187], a[24:27], v[64:79]
  ds_read_b64_tr_b16 a[20:21], v3 offset:20992
  ds_read_b64_tr_b16 a[22:23], v3 offset:26112
  v_fma_f32 v22, v22, v5, v6
  v_fma_f32 v23, v23, v5, v6
  v_fma_f32 v24, v24, v5, v6
  v_mfma_f32_32x32x16_bf16 v[80:95], v[184:187], a[28:31], v[80:95]
  ds_read_b64_tr_b16 a[24:25], v3 offset:23552
  ds_read_b64_tr_b16 a[26:27], v3 offset:28672
  v_fma_f32 v25, v25, v5, v6
  v_cvt_pk_bf16_f32 v190, v22, v23
  s_waitcnt lgkmcnt(8)
  v_mfma_f32_32x32x16_bf16 a[144:159], v[184:187], a[0:3], a[144:159]
  ds_read_b64_tr_b16 a[28:29], v3 offset:21504
  ds_read_b64_tr_b16 a[30:31], v3 offset:26624
  v_cvt_pk_bf16_f32 v191, v24, v25
  v_lshlrev_b32 v18, 16, v192
  v_and_b32 v19, s41, v192
  v_lshlrev_b32 v20, 16, v193
  v_mfma_f32_32x32x16_bf16 a[160:175], v[184:187], a[4:7], a[160:175]
  ds_read_b64_tr_b16 a[0:1], v3 offset:22016
  ds_read_b64_tr_b16 a[2:3], v3 offset:27136
  v_and_b32 v21, s41, v193
  v_fma_f32 v18, v18, v5, v6
  v_fma_f32 v19, v19, v5, v6
  v_mfma_f32_32x32x16_bf16 a[176:191], v[184:187], a[8:11], a[176:191]
  ds_read_b64_tr_b16 a[4:5], v3 offset:24064
  ds_read_b64_tr_b16 a[6:7], v3 offset:29184
  v_fma_f32 v20, v20, v5, v6
  v_fma_f32 v21, v21, v5, v6
  s_waitcnt lgkmcnt(8)
  v_mfma_f32_32x32x16_bf16 v[32:47], v[188:191], a[12:15], v[32:47]
  ds_read_b64_tr_b16 a[8:9], v3 offset:24576
  ds_read_b64_tr_b16 a[10:11], v3 offset:29696
  v_cvt_pk_bf16_f32 v192, v18, v19
  v_cvt_pk_bf16_f32 v193, v20, v21
  v_lshlrev_b32 v22, 16, v194
  v_mfma_f32_32x32x16_bf16 v[96:111], v[188:191], a[16:19], v[96:111]
  ds_read_b64_tr_b16 a[12:13], v3 offset:25088
  ds_read_b64_tr_b16 a[14:15], v3 offset:30208
  v_and_b32 v23, s41, v194
  v_lshlrev_b32 v24, 16, v195
  v_and_b32 v25, s41, v195
  v_fma_f32 v22, v22, v5, v6
  v_mfma_f32_32x32x16_bf16 v[48:63], v[188:191], a[20:23], v[48:63]
  s_waitcnt vmcnt(4)
  s_barrier
  ds_read_b64_tr_b16 a[16:17], v1 offset:41984
  ds_read_b64_tr_b16 a[18:19], v1 offset:13312
  s_add_u32 m0, s40, 15984
  s_waitcnt lgkmcnt(8)
  v_mfma_f32_32x32x16_bf16 a[128:143], v[188:191], a[24:27], a[128:143]
  buffer_load_dwordx4 v8, s[12:15], s62 offen offset:2448  lds
  ds_read_b64_tr_b16 a[20:21], v13 offset:10240
  ds_read_b64_tr_b16 a[22:23], v13 offset:15360
  v_fma_f32 v23, v23, v5, v6
  v_fma_f32 v24, v24, v5, v6
  v_mfma_f32_32x32x16_bf16 v[64:79], v[188:191], a[28:31], v[64:79]
  ds_read_b64_tr_b16 a[24:25], v1 offset:42496
AT_H2:
  s_cbranch_execz AT_H6
  ds_read_b64_tr_b16 a[26:27], v1 offset:13824
  v_fma_f32 v25, v25, v5, v6
  v_cvt_pk_bf16_f32 v194, v22, v23
  v_cvt_pk_bf16_f32 v195, v24, v25
  v_mfma_f32_32x32x16_bf16 v[80:95], v[188:191], a[0:3], v[80:95]
  ds_read_b64_tr_b16 a[28:29], v1 offset:11264
  ds_read_b64_tr_b16 a[30:31], v1 offset:16384
  v_lshlrev_b32 v18, 16, v196
  v_and_b32 v19, s41, v196
  s_add_u32 m0, s40, 18304
  s_waitcnt lgkmcnt(8)
  v_mfma_f32_32x32x16_bf16 a[144:159], v[188:191], a[4:7], a[144:159]
  buffer_load_dwordx4 v8, s[12:15], s63 offen offset:1152  lds
  ds_read_b64_tr_b16 a[0:1], v1 offset:43008
  ds_read_b64_tr_b16 a[2:3], v1 offset:14336
  v_lshlrev_b32 v20, 16, v197
  v_and_b32 v21, s41, v197
  v_mfma_f32_32x32x16_bf16 a[160:175], v[188:191], a[8:11], a[160:175]
  ds_read_b64_tr_b16 a[4:5], v1 offset:43520
  ds_read_b64_tr_b16 a[6:7], v1 offset:14848
  v_fma_f32 v18, v18, v5, v6
  v_fma_f32 v19, v19, v5, v6
  v_fma_f32 v20, v20, v5, v6
  v_mfma_f32_32x32x16_bf16 a[176:191], v[188:191], a[12:15], a[176:191]
  ds_read_b64_tr_b16 a[8:9], v1 offset:11776
  ds_read_b64_tr_b16 a[10:11], v1 offset:16896
  v_fma_f32 v21, v21, v5, v6
  s_add_u32 m0, s40, 19184
  s_waitcnt lgkmcnt(8)
  v_mfma_f32_32x32x16_bf16 v[32:47], v[192:195], a[16:19], v[32:47]
  buffer_load_dwordx4 v8, s[12:15], s63 offen offset:1296  lds
  ds_read_b64_tr_b16 a[12:13], v1 offset:12288
  ds_read_b64_tr_b16 a[14:15], v1 offset:17408
  v_cvt_pk_bf16_f32 v196, v18, v19
  v_cvt_pk_bf16_f32 v197, v20, v21
  v_mfma_f32_32x32x16_bf16 v[96:111], v[192:195], a[20:23], v[96:111]
  ds_read_b64_tr_b16 a[16:17], v1 offset:12800
  ds_read_b64_tr_b16 a[18:19], v1 offset:17920
  v_lshlrev_b32 v22, 16, v198
  v_and_b32 v23, s41, v198
  v_lshlrev_b32 v24, 16, v199
  v_and_b32 v25, s41, v199
  v_mfma_f32_32x32x16_bf16 v[48:63], v[192:195], a[24:27], v[48:63]
  ds_read_b64_tr_b16 a[20:21], v2 offset:16384
  ds_read_b64_tr_b16 a[22:23], v1 offset:53248
  v_fma_f32 v22, v22, v5, v6
  s_add_u32 m0, s40, 21504
  s_waitcnt lgkmcnt(8)
  v_mfma_f32_32x32x16_bf16 a[128:143], v[192:195], a[28:31], a[128:143]
  buffer_load_dwordx4 v9, s[12:15], s63 offen  lds
  ds_read_b64_tr_b16 a[24:25], v13 offset:50176
  ds_read_b64_tr_b16 a[26:27], v13 offset:55296
  v_fma_f32 v23, v23, v5, v6
  v_fma_f32 v24, v24, v5, v6
  v_mfma_f32_32x32x16_bf16 v[64:79], v[192:195], a[0:3], v[64:79]
  ds_read_b64_tr_b16 a[28:29], v2 offset:16896
  ds_read_b64_tr_b16 a[30:31], v1 offset:53760
  v_fma_f32 v25, v25, v5, v6
  v_cvt_pk_bf16_f32 v198, v22, v23
  v_cvt_pk_bf16_f32 v199, v24, v25
  v_mfma_f32_32x32x16_bf16 v[80:95], v[192:195], a[4:7], v[80:95]
  ds_read_b64_tr_b16 a[0:1], v1 offset:51200
  ds_read_b64_tr_b16 a[2:3], v1 offset:56320
  v_lshlrev_b32 v18, 16, v200
  v_and_b32 v19, s41, v200
  s_add_u32 m0, s40, 20224
  s_waitcnt lgkmcnt(8)
  v_mfma_f32_32x32x16_bf16 a[144:159], v[192:195], a[8:11], a[144:159]
  buffer_load_dwordx4 v8, s[12:15], s63 offen offset:2304  lds
  ds_read_b64_tr_b16 a[4:5], v2 offset:17408
  ds_read_b64_tr_b16 a[6:7], v1 offset:54272
  v_lshlrev_b32 v20, 16, v201
  v_and_b32 v21, s41, v201
  v_mfma_f32_32x32x16_bf16 a[160:175], v[192:195], a[12:15], a[160:175]
  ds_read_b64_tr_b16 a[8:9], v2 offset:17920
  ds_read_b64_tr_b16 a[10:11], v1 offset:54784
  v_fma_f32 v18, v18, v5, v6
  v_fma_f32 v19, v19, v5, v6
  v_fma_f32 v20, v20, v5, v6
  v_mfma_f32_32x32x16_bf16 a[176:191], v[192:195], a[16:19], a[176:191]
  ds_read_b64_tr_b16 a[12:13], v1 offset:51712
  ds_read_b64_tr_b16 a[14:15], v1 offset:56832
  v_fma_f32 v21, v21, v5, v6
  s_add_u32 m0, s40, 21104
  s_waitcnt lgkmcnt(8)
  v_mfma_f32_32x32x16_bf16 v[32:47], v[196:199], a[20:23], v[32:47]
  buffer_load_dwordx4 v8, s[12:15], s63 offen offset:2448  lds
  ds_read_b64_tr_b16 a[16:17], v1 offset:52224
  ds_read_b64_tr_b16 a[18:19], v1 offset:57344
  v_cvt_pk_bf16_f32 v200, v18, v19
  v_cvt_pk_bf16_f32 v201, v20, v21
  v_mfma_f32_32x32x16_bf16 v[96:111], v[196:199], a[24:27], v[96:111]
  ds_read_b64_tr_b16 a[20:21], v1 offset:52736
  ds_read_b64_tr_b16 a[22:23], v1 offset:57856
  v_lshlrev_b32 v22, 16, v202
  v_and_b32 v23, s41, v202
  v_lshlrev_b32 v24, 16, v203
  v_and_b32 v25, s41, v203
  v_mfma_f32_32x32x16_bf16 v[48:63], v[196:199], a[28:31], v[48:63]
  ds_read_b64_tr_b16 a[24:25], v2 offset:56320
  ds_read_b64_tr_b16 a[26:27], v2 offset:27648
  v_fma_f32 v22, v22, v5, v6
  s_add_u32 m0, s40, 23424
  s_waitcnt lgkmcnt(8)
  v_mfma_f32_32x32x16_bf16 a[128:143], v[196:199], a[0:3], a[128:143]
  buffer_load_dwordx4 v8, s[12:15], s64 offen offset:1152  lds
  ds_read_b64_tr_b16 a[28:29], v14 offset:24576
  ds_read_b64_tr_b16 a[30:31], v14 offset:29696
  v_fma_f32 v23, v23, v5, v6
  v_fma_f32 v24, v24, v5, v6
  v_mfma_f32_32x32x16_bf16 v[64:79], v[196:199], a[4:7], v[64:79]
  ds_read_b64_tr_b16 a[0:1], v2 offset:56832
  ds_read_b64_tr_b16 a[2:3], v2 offset:28160
  v_fma_f32 v25, v25, v5, v6
  v_cvt_pk_bf16_f32 v202, v22, v23
  v_cvt_pk_bf16_f32 v203, v24, v25
  v_mfma_f32_32x32x16_bf16 v[80:95], v[196:199], a[8:11], v[80:95]
  ds_read_b64_tr_b16 a[4:5], v2 offset:25600
  ds_read_b64_tr_b16 a[6:7], v2 offset:30720
  v_lshlrev_b32 v18, 16, v204
  v_and_b32 v19, s41, v204
  s_add_u32 m0, s40, 24304
  s_waitcnt lgkmcnt(8)
  v_mfma_f32_32x32x16_bf16 a[144:159], v[196:199], a[12:15], a[144:159]
  buffer_load_dwordx4 v8, s[12:15], s64 offen offset:1296  lds
  ds_read_b64_tr_b16 a[8:9], v2 offset:57344
  ds_read_b64_tr_b16 a[10:11], v2 offset:28672
  v_lshlrev_b32 v20, 16, v205
  v_and_b32 v21, s41, v205
  v_mfma_f32_32x32x16_bf16 a[160:175], v[196:199], a[16:19], a[160:175]
  ds_read_b64_tr_b16 a[12:13], v2 offset:57856
  ds_read_b64_tr_b16 a[14:15], v2 offset:29184
  v_fma_f32 v18, v18, v5, v6
  v_fma_f32 v19, v19, v5, v6
  v_fma_f32 v20, v20, v5, v6
  v_mfma_f32_32x32x16_bf16 a[176:191], v[196:199], a[20:23], a[176:191]
  ds_read_b64_tr_b16 a[16:17], v2 offset:26112
  ds_read_b64_tr_b16 a[18:19], v2 offset:31232
  v_fma_f32 v21, v21, v5, v6
  s_add_u32 m0, s40, 26624
  s_waitcnt lgkmcnt(8)
  v_mfma_f32_32x32x16_bf16 v[32:47], v[200:203], a[24:27], v[32:47]
  buffer_load_dwordx4 v9, s[12:15], s64 offen  lds
  ds_read_b64_tr_b16 a[20:21], v2 offset:26624
  ds_read_b64_tr_b16 a[22:23], v2 offset:31744
  v_cvt_pk_bf16_f32 v204, v18, v19
  v_cvt_pk_bf16_f32 v205, v20, v21
  v_mfma_f32_32x32x16_bf16 v[96:111], v[200:203], a[28:31], v[96:111]
  ds_read_b64_tr_b16 a[24:25], v2 offset:27136
  ds_read_b64_tr_b16 a[26:27], v2 offset:32256
  v_lshlrev_b32 v22, 16, v206
  v_and_b32 v23, s41, v206
  v_lshlrev_b32 v24, 16, v207
  v_and_b32 v25, s41, v207
  v_mfma_f32_32x32x16_bf16 v[48:63], v[200:203], a[0:3], v[48:63]
  ds_read_b64_tr_b16 a[28:29], v3 offset:30720
  ds_read_b64_tr_b16 a[30:31], v3 offset:2048
  v_fma_f32 v22, v22, v5, v6
  s_add_u32 m0, s40, 25344
  s_waitcnt lgkmcnt(8)
  v_mfma_f32_32x32x16_bf16 a[128:143], v[200:203], a[4:7], a[128:143]
  buffer_load_dwordx4 v8, s[12:15], s64 offen offset:2304  lds
  ds_read_b64_tr_b16 a[0:1], v14 offset:64512
  ds_read_b64_tr_b16 a[2:3], v15 offset:4096
  v_fma_f32 v23, v23, v5, v6
  v_fma_f32 v24, v24, v5, v6
  v_mfma_f32_32x32x16_bf16 v[64:79], v[200:203], a[8:11], v[64:79]
  ds_read_b64_tr_b16 a[4:5], v3 offset:31232
  ds_read_b64_tr_b16 a[6:7], v3 offset:2560
  v_fma_f32 v25, v25, v5, v6
  v_cvt_pk_bf16_f32 v206, v22, v23
  v_cvt_pk_bf16_f32 v207, v24, v25
  v_mfma_f32_32x32x16_bf16 v[80:95], v[200:203], a[12:15], v[80:95]
  ds_read_b64_tr_b16 a[8:9], v3 offset:0
  ds_read_b64_tr_b16 a[10:11], v3 offset:5120
  v_lshlrev_b32 v18, 16, v208
  v_and_b32 v19, s41, v208
  v_lshlrev_b32 v20, 16, v209
  s_waitcnt lgkmcnt(8)
  v_mfma_f32_32x32x16_bf16 a[144:159], v[200:203], a[16:19], a[144:159]
  ds_read_b64_tr_b16 a[12:13], v3 offset:31744
  ds_read_b64_tr_b16 a[14:15], v3 offset:3072
  v_and_b32 v21, s41, v209
  v_fma_f32 v18, v18, v5, v6
  v_fma_f32 v19, v19, v5, v6
  v_mfma_f32_32x32x16_bf16 a[160:175], v[200:203], a[20:23], a[160:175]
  ds_read_b64_tr_b16 a[16:17], v3 offset:32256
  ds_read_b64_tr_b16 a[18:19], v3 offset:3584
  v_fma_f32 v20, v20, v5, v6
  v_fma_f32 v21, v21, v5, v6
  v_cvt_pk_bf16_f32 v208, v18, v19
  v_mfma_f32_32x32x16_bf16 a[176:191], v[200:203], a[24:27], a[176:191]
  ds_read_b64_tr_b16 a[20:21], v3 offset:512
  ds_read_b64_tr_b16 a[22:23], v3 offset:5632
  v_cvt_pk_bf16_f32 v209, v20, v21
  v_lshlrev_b32 v22, 16, v210
  v_and_b32 v23, s41, v210
  s_waitcnt lgkmcnt(8)
  v_mfma_f32_32x32x16_bf16 v[32:47], v[204:207], a[28:31], v[32:47]
  ds_read_b64_tr_b16 a[24:25], v3 offset:1024
  ds_read_b64_tr_b16 a[26:27], v3 offset:6144
  v_lshlrev_b32 v24, 16, v211
  v_and_b32 v25, s41, v211
  v_fma_f32 v22, v22, v5, v6
  v_mfma_f32_32x32x16_bf16 v[96:111], v[204:207], a[0:3], v[96:111]
  ds_read_b64_tr_b16 a[28:29], v3 offset:1536
  ds_read_b64_tr_b16 a[30:31], v3 offset:6656
  v_fma_f32 v23, v23, v5, v6
  v_fma_f32 v24, v24, v5, v6
  v_fma_f32 v25, v25, v5, v6
  v_mfma_f32_32x32x16_bf16 v[48:63], v[204:207], a[4:7], v[48:63]
  s_waitcnt vmcnt(4)
  s_barrier
  ds_read_b64_tr_b16 a[0:1], v1 offset:18432
  ds_read_b64_tr_b16 a[2:3], v1 offset:23552
  s_add_u32 m0, s40, 26224
  s_waitcnt lgkmcnt(8)
  v_mfma_f32_32x32x16_bf16 a[128:143], v[204:207], a[8:11], a[128:143]
  buffer_load_dwordx4 v8, s[12:15], s64 offen offset:2448  lds
  ds_read_b64_tr_b16 a[4:5], v13 offset:20480
  ds_read_b64_tr_b16 a[6:7], v13 offset:25600
  v_cvt_pk_bf16_f32 v210, v22, v23
  v_cvt_pk_bf16_f32 v211, v24, v25
  v_mfma_f32_32x32x16_bf16 v[64:79], v[204:207], a[12:15], v[64:79]
  ds_read_b64_tr_b16 a[8:9], v1 offset:18944
  ds_read_b64_tr_b16 a[10:11], v1 offset:24064
  v_lshlrev_b32 v18, 16, v212
  v_and_b32 v19, s41, v212
  v_lshlrev_b32 v20, 16, v213
  v_and_b32 v21, s41, v213
  v_mfma_f32_32x32x16_bf16 v[80:95], v[204:207], a[16:19], v[80:95]
  ds_read_b64_tr_b16 a[12:13], v1 offset:21504
  ds_read_b64_tr_b16 a[14:15], v1 offset:26624
  v_fma_f32 v18, v18, v5, v6
  s_add_u32 m0, s40, 28544
  s_waitcnt lgkmcnt(8)
  v_mfma_f32_32x32x16_bf16 a[144:159], v[204:207], a[20:23], a[144:159]
  buffer_load_dwordx4 v8, s[12:15], s65 offen offset:1152  lds
  ds_read_b64_tr_b16 a[16:17], v1 offset:19456
  ds_read_b64_tr_b16 a[18:19], v1 offset:24576
  v_fma_f32 v19, v19, v5, v6
  v_fma_f32 v20, v20, v5, v6
  v_mfma_f32_32x32x16_bf16 a[160:175], v[204:207], a[24:27], a[160:175]
  ds_read_b64_tr_b16 a[20:21], v1 offset:19968
  ds_read_b64_tr_b16 a[22:23], v1 offset:25088
  v_fma_f32 v21, v21, v5, v6
  v_cvt_pk_bf16_f32 v212, v18, v19
  v_cvt_pk_bf16_f32 v213, v20, v21
  v_mfma_f32_32x32x16_bf16 a[176:191], v[204:207], a[28:31], a[176:191]
  ds_read_b64_tr_b16 a[24:25], v1 offset:22016
  ds_read_b64_tr_b16 a[26:27], v1 offset:27136
  v_lshlrev_b32 v22, 16, v214
  v_and_b32 v23, s41, v214
  s_add_u32 m0, s40, 29424
  s_waitcnt lgkmcnt(8)
  v_mfma_f32_32x32x16_bf16 v[32:47], v[208:211], a[0:3], v[32:47]
  buffer_load_dwordx4 v8, s[12:15], s65 offen offset:1296  lds
  ds_read_b64_tr_b16 a[28:29], v1 offset:22528
  ds_read_b64_tr_b16 a[30:31], v1 offset:27648
  v_lshlrev_b32 v24, 16, v215
  v_and_b32 v25, s41, v215
  v_mfma_f32_32x32x16_bf16 v[96:111], v[208:211], a[4:7], v[96:111]
  ds_read_b64_tr_b16 a[0:1], v1 offset:23040
  ds_read_b64_tr_b16 a[2:3], v1 offset:28160
  v_fma_f32 v22, v22, v5, v6
  v_fma_f32 v23, v23, v5, v6
  v_fma_f32 v24, v24, v5, v6
  v_mfma_f32_32x32x16_bf16 v[48:63], v[208:211], a[8:11], v[48:63]
  ds_read_b64_tr_b16 a[4:5], v1 offset:58368
  ds_read_b64_tr_b16 a[6:7], v1 offset:63488
  v_fma_f32 v25, v25, v5, v6
  s_add_u32 m0, s40, 31744
  s_waitcnt lgkmcnt(8)
  v_mfma_f32_32x32x16_bf16 a[128:143], v[208:211], a[12:15], a[128:143]
  buffer_load_dwordx4 v9, s[12:15], s65 offen  lds
  ds_read_b64_tr_b16 a[8:9], v13 offset:60416
  ds_read_b64_tr_b16 a[10:11], v14 offset:0
  v_cvt_pk_bf16_f32 v214, v22, v23
  v_cvt_pk_bf16_f32 v215, v24, v25
  v_mfma_f32_32x32x16_bf16 v[64:79], v[208:211], a[16:19], v[64:79]
  ds_read_b64_tr_b16 a[12:13], v1 offset:58880
  ds_read_b64_tr_b16 a[14:15], v1 offset:64000
  v_lshlrev_b32 v18, 16, v216
  v_and_b32 v19, s41, v216
  v_lshlrev_b32 v20, 16, v217
  v_and_b32 v21, s41, v217
  v_mfma_f32_32x32x16_bf16 v[80:95], v[208:211], a[20:23], v[80:95]
  ds_read_b64_tr_b16 a[16:17], v1 offset:61440
  ds_read_b64_tr_b16 a[18:19], v2 offset:1024
  v_fma_f32 v18, v18, v5, v6
  s_add_u32 m0, s40, 30464
  s_waitcnt lgkmcnt(8)
  v_mfma_f32_32x32x16_bf16 a[144:159], v[208:211], a[24:27], a[144:159]
  buffer_load_dwordx4 v8, s[12:15], s65 offen offset:2304  lds
  ds_read_b64_tr_b16 a[20:21], v1 offset:59392
  ds_read_b64_tr_b16 a[22:23], v1 offset:64512
  v_fma_f32 v19, v19, v5, v6
  v_fma_f32 v20, v20, v5, v6
  v_mfma_f32_32x32x16_bf16 a[160:175], v[208:211], a[28:31], a[160:175]
  ds_read_b64_tr_b16 a[24:25], v1 offset:59904
  ds_read_b64_tr_b16 a[26:27], v1 offset:65024
  v_fma_f32 v21, v21, v5, v6
  v_cvt_pk_bf16_f32 v216, v18, v19
  v_cvt_pk_bf16_f32 v217, v20, v21
  v_mfma_f32_32x32x16_bf16 a[176:191], v[208:211], a[0:3], a[176:191]
  ds_read_b64_tr_b16 a[28:29], v1 offset:61952
  ds_read_b64_tr_b16 a[30:31], v2 offset:1536
  v_lshlrev_b32 v22, 16, v218
  v_and_b32 v23, s41, v218
  s_add_u32 m0, s40, 31344
  s_waitcnt lgkmcnt(8)
  v_mfma_f32_32x32x16_bf16 v[32:47], v[212:215], a[4:7], v[32:47]
  buffer_load_dwordx4 v8, s[12:15], s65 offen offset:2448  lds
  ds_read_b64_tr_b16 a[0:1], v1 offset:62464
  ds_read_b64_tr_b16 a[2:3], v2 offset:2048
  v_lshlrev_b32 v24, 16, v219
  v_and_b32 v25, s41, v219
  v_mfma_f32_32x32x16_bf16 v[96:111], v[212:215], a[8:11], v[96:111]
  ds_read_b64_tr_b16 a[4:5], v1 offset:62976
  ds_read_b64_tr_b16 a[6:7], v2 offset:2560
  v_fma_f32 v22, v22, v5, v6
  v_fma_f32 v23, v23, v5, v6
  v_fma_f32 v24, v24, v5, v6
  v_mfma_f32_32x32x16_bf16 v[48:63], v[212:215], a[12:15], v[48:63]
  ds_read_b64_tr_b16 a[8:9], v2 offset:32768
  ds_read_b64_tr_b16 a[10:11], v2 offset:37888
  v_fma_f32 v25, v25, v5, v6
  s_add_u32 m0, s40, 33664
  s_waitcnt lgkmcnt(8)
  v_mfma_f32_32x32x16_bf16 a[128:143], v[212:215], a[16:19], a[128:143]
  buffer_load_dwordx4 v8, s[12:15], s66 offen offset:1152  lds
  ds_read_b64_tr_b16 a[12:13], v14 offset:34816
  ds_read_b64_tr_b16 a[14:15], v14 offset:39936
  v_cvt_pk_bf16_f32 v218, v22, v23
  v_cvt_pk_bf16_f32 v219, v24, v25
  v_mfma_f32_32x32x16_bf16 v[64:79], v[212:215], a[20:23], v[64:79]
  ds_read_b64_tr_b16 a[16:17], v2 offset:33280
  ds_read_b64_tr_b16 a[18:19], v2 offset:38400
  v_lshlrev_b32 v18, 16, v220
  v_and_b32 v19, s41, v220
  v_lshlrev_b32 v20, 16, v221
  v_and_b32 v21, s41, v221
  v_mfma_f32_32x32x16_bf16 v[80:95], v[212:215], a[24:27], v[80:95]
  ds_read_b64_tr_b16 a[20:21], v2 offset:35840
  ds_read_b64_tr_b16 a[22:23], v2 offset:40960
  v_fma_f32 v18, v18, v5, v6
  s_add_u32 m0, s40, 34544
  s_waitcnt lgkmcnt(8)
  v_mfma_f32_32x32x16_bf16 a[144:159], v[212:215], a[28:31], a[144:159]
  buffer_load_dwordx4 v8, s[12:15], s66 offen offset:1296  lds
  ds_read_b64_tr_b16 a[24:25], v2 offset:33792
  ds_read_b64_tr_b16 a[26:27], v2 offset:38912
  v_fma_f32 v19, v19, v5, v6
  v_fma_f32 v20, v20, v5, v6
  v_mfma_f32_32x32x16_bf16 a[160:175], v[212:215], a[0:3], a[160:175]
  ds_read_b64_tr_b16 a[28:29], v2 offset:34304
  ds_read_b64_tr_b16 a[30:31], v2 offset:39424
  v_fma_f32 v21, v21, v5, v6
  v_cvt_pk_bf16_f32 v220, v18, v19
  v_cvt_pk_bf16_f32 v221, v20, v21
  v_mfma_f32_32x32x16_bf16 a[176:191], v[212:215], a[4:7], a[176:191]
  ds_read_b64_tr_b16 a[0:1], v2 offset:36352
  ds_read_b64_tr_b16 a[2:3], v2 offset:41472
  v_lshlrev_b32 v22, 16, v222
  v_and_b32 v23, s41, v222
  s_add_u32 m0, s40, 36864
  s_waitcnt lgkmcnt(8)
  v_mfma_f32_32x32x16_bf16 v[32:47], v[216:219], a[8:11], v[32:47]
  buffer_load_dwordx4 v9, s[12:15], s66 offen  lds
  ds_read_b64_tr_b16 a[4:5], v2 offset:36864
  ds_read_b64_tr_b16 a[6:7], v2 offset:41984
  v_lshlrev_b32 v24, 16, v223
  v_and_b32 v25, s41, v223
  v_mfma_f32_32x32x16_bf16 v[96:111], v[216:219], a[12:15], v[96:111]
  ds_read_b64_tr_b16 a[8:9], v2 offset:37376
  ds_read_b64_tr_b16 a[10:11], v2 offset:42496
  v_fma_f32 v22, v22, v5, v6
  v_fma_f32 v23, v23, v5, v6
  v_fma_f32 v24, v24, v5, v6
  v_mfma_f32_32x32x16_bf16 v[48:63], v[216:219], a[16:19], v[48:63]
  ds_read_b64_tr_b16 a[12:13], v3 offset:7168
  ds_read_b64_tr_b16 a[14:15], v3 offset:12288
  v_fma_f32 v25, v25, v5, v6
  s_add_u32 m0, s40, 35584
  s_waitcnt lgkmcnt(8)
  v_mfma_f32_32x32x16_bf16 a[128:143], v[216:219], a[20:23], a[128:143]
  buffer_load_dwordx4 v8, s[12:15], s66 offen offset:2304  lds
  ds_read_b64_tr_b16 a[16:17], v15 offset:9216
  ds_read_b64_tr_b16 a[18:19], v15 offset:14336
  v_cvt_pk_bf16_f32 v222, v22, v23
  v_cvt_pk_bf16_f32 v223, v24, v25
  v_mfma_f32_32x32x16_bf16 v[64:79], v[216:219], a[24:27], v[64:79]
  ds_read_b64_tr_b16 a[20:21], v3 offset:7680
  ds_read_b64_tr_b16 a[22:23], v3 offset:12800
  v_lshlrev_b32 v18, 16, v224
  v_and_b32 v19, s41, v224
  v_lshlrev_b32 v20, 16, v225
  v_and_b32 v21, s41, v225
  v_mfma_f32_32x32x16_bf16 v[80:95], v[216:219], a[28:31], v[80:95]
  ds_read_b64_tr_b16 a[24:25], v3 offset:10240
  ds_read_b64_tr_b16 a[26:27], v3 offset:15360
  v_fma_f32 v18, v18, v5, v6
  v_fma_f32 v19, v19, v5, v6
  s_waitcnt lgkmcnt(8)
  v_mfma_f32_32x32x16_bf16 a[144:159], v[216:219], a[0:3], a[144:159]
  ds_read_b64_tr_b16 a[28:29], v3 offset:8192
  ds_read_b64_tr_b16 a[30:31], v3 offset:13312
  v_fma_f32 v20, v20, v5, v6
  v_fma_f32 v21, v21, v5, v6
  v_cvt_pk_bf16_f32 v224, v18, v19
  v_mfma_f32_32x32x16_bf16 a[160:175], v[216:219], a[4:7], a[160:175]
  ds_read_b64_tr_b16 a[0:1], v3 offset:8704
  ds_read_b64_tr_b16 a[2:3], v3 offset:13824
  v_cvt_pk_bf16_f32 v225, v20, v21
  v_lshlrev_b32 v22, 16, v226
  v_and_b32 v23, s41, v226
  v_lshlrev_b32 v24, 16, v227
  v_mfma_f32_32x32x16_bf16 a[176:191], v[216:219], a[8:11], a[176:191]
  ds_read_b64_tr_b16 a[4:5], v3 offset:10752
  ds_read_b64_tr_b16 a[6:7], v3 offset:15872
  v_and_b32 v25, s41, v227
  v_fma_f32 v22, v22, v5, v6
  s_waitcnt lgkmcnt(8)
  v_mfma_f32_32x32x16_bf16 v[32:47], v[220:223], a[12:15], v[32:47]
  ds_read_b64_tr_b16 a[8:9], v3 offset:11264
  ds_read_b64_tr_b16 a[10:11], v3 offset:16384
  v_fma_f32 v23, v23, v5, v6
  v_fma_f32 v24, v24, v5, v6
  v_fma_f32 v25, v25, v5, v6
  v_mfma_f32_32x32x16_bf16 v[96:111], v[220:223], a[16:19], v[96:111]
  ds_read_b64_tr_b16 a[12:13], v3 offset:11776
  ds_read_b64_tr_b16 a[14:15], v3 offset:16896
  v_cvt_pk_bf16_f32 v226, v22, v23
  v_cvt_pk_bf16_f32 v227, v24, v25
  v_lshlrev_b32 v18, 16, v228
  v_mfma_f32_32x32x16_bf16 v[48:63], v[220:223], a[20:23], v[48:63]
  s_waitcnt vmcnt(4)
  s_barrier
  ds_read_b64_tr_b16 a[16:17], v1 offset:28672
  ds_read_b64_tr_b16 a[18:19], v1 offset:33792
  s_add_u32 m0, s40, 36464
  s_waitcnt lgkmcnt(8)
  v_mfma_f32_32x32x16_bf16 a[128:143], v[220:223], a[24:27], a[128:143]
  buffer_load_dwordx4 v8, s[12:15], s66 offen offset:2448  lds
  ds_read_b64_tr_b16 a[20:21], v13 offset:30720
  ds_read_b64_tr_b16 a[22:23], v13 offset:35840
  v_and_b32 v19, s41, v228
  v_lshlrev_b32 v20, 16, v229
  v_and_b32 v21, s41, v229
  v_mfma_f32_32x32x16_bf16 v[64:79], v[220:223], a[28:31], v[64:79]
  ds_read_b64_tr_b16 a[24:25], v1 offset:29184
  ds_read_b64_tr_b16 a[26:27], v1 offset:34304
  v_fma_f32 v18, v18, v5, v6
  v_fma_f32 v19, v19, v5, v6
  v_fma_f32 v20, v20, v5, v6
  v_mfma_f32_32x32x16_bf16 v[80:95], v[220:223], a[0:3], v[80:95]
  ds_read_b64_tr_b16 a[28:29], v1 offset:31744
  ds_read_b64_tr_b16 a[30:31], v1 offset:36864
  v_fma_f32 v21, v21, v5, v6
  s_add_u32 m0, s40, 4992
  s_waitcnt lgkmcnt(8)
  v_mfma_f32_32x32x16_bf16 a[144:159], v[220:223], a[4:7], a[144:159]
  buffer_load_dwordx4 v8, s[12:15], s67 offen offset:1152  lds
  ds_read_b64_tr_b16 a[0:1], v1 offset:29696
  ds_read_b64_tr_b16 a[2:3], v1 offset:34816
  v_cvt_pk_bf16_f32 v228, v18, v19
  v_cvt_pk_bf16_f32 v229, v20, v21
  v_mfma_f32_32x32x16_bf16 a[160:175], v[220:223], a[8:11], a[160:175]
  ds_read_b64_tr_b16 a[4:5], v1 offset:30208
  ds_read_b64_tr_b16 a[6:7], v1 offset:35328
  v_lshlrev_b32 v22, 16, v230
  v_and_b32 v23, s41, v230
  v_lshlrev_b32 v24, 16, v231
  v_and_b32 v25, s41, v231
  v_mfma_f32_32x32x16_bf16 a[176:191], v[220:223], a[12:15], a[176:191]
  ds_read_b64_tr_b16 a[8:9], v1 offset:32256
  ds_read_b64_tr_b16 a[10:11], v1 offset:37376
  v_fma_f32 v22, v22, v5, v6
  s_add_u32 m0, s40, 5872
  s_waitcnt lgkmcnt(8)
  v_mfma_f32_32x32x16_bf16 v[32:47], v[224:227], a[16:19], v[32:47]
  buffer_load_dwordx4 v8, s[12:15], s67 offen offset:1296  lds
  ds_read_b64_tr_b16 a[12:13], v1 offset:32768
  ds_read_b64_tr_b16 a[14:15], v1 offset:37888
  v_fma_f32 v23, v23, v5, v6
  v_fma_f32 v24, v24, v5, v6
  v_mfma_f32_32x32x16_bf16 v[96:111], v[224:227], a[20:23], v[96:111]
  ds_read_b64_tr_b16 a[16:17], v1 offset:33280
  ds_read_b64_tr_b16 a[18:19], v1 offset:38400
  v_fma_f32 v25, v25, v5, v6
  v_cvt_pk_bf16_f32 v230, v22, v23
  v_cvt_pk_bf16_f32 v231, v24, v25
  v_mfma_f32_32x32x16_bf16 v[48:63], v[224:227], a[24:27], v[48:63]
  ds_read_b64_tr_b16 a[20:21], v2 offset:3072
  ds_read_b64_tr_b16 a[22:23], v2 offset:8192
  v_lshlrev_b32 v18, 16, v232
  v_and_b32 v19, s41, v232
  s_add_u32 m0, s40, 8192
  s_waitcnt lgkmcnt(8)
  v_mfma_f32_32x32x16_bf16 a[128:143], v[224:227], a[28:31], a[128:143]
  buffer_load_dwordx4 v9, s[12:15], s67 offen  lds
  ds_read_b64_tr_b16 a[24:25], v14 offset:5120
  ds_read_b64_tr_b16 a[26:27], v14 offset:10240
  v_lshlrev_b32 v20, 16, v233
  v_and_b32 v21, s41, v233
  v_mfma_f32_32x32x16_bf16 v[64:79], v[224:227], a[0:3], v[64:79]
  ds_read_b64_tr_b16 a[28:29], v2 offset:3584
  ds_read_b64_tr_b16 a[30:31], v2 offset:8704
  v_fma_f32 v18, v18, v5, v6
  v_fma_f32 v19, v19, v5, v6
  v_fma_f32 v20, v20, v5, v6
  v_mfma_f32_32x32x16_bf16 v[80:95], v[224:227], a[4:7], v[80:95]
  ds_read_b64_tr_b16 a[0:1], v2 offset:6144
  ds_read_b64_tr_b16 a[2:3], v2 offset:11264
  v_fma_f32 v21, v21, v5, v6
  s_add_u32 m0, s40, 6912
  s_waitcnt lgkmcnt(8)
  v_mfma_f32_32x32x16_bf16 a[144:159], v[224:227], a[8:11], a[144:159]
  buffer_load_dwordx4 v8, s[12:15], s67 offen offset:2304  lds
  ds_read_b64_tr_b16 a[4:5], v2 offset:4096
  ds_read_b64_tr_b16 a[6:7], v2 offset:9216
  v_cvt_pk_bf16_f32 v232, v18, v19
  v_cvt_pk_bf16_f32 v233, v20, v21
  v_mfma_f32_32x32x16_bf16 a[160:175], v[224:227], a[12:15], a[160:175]
  ds_read_b64_tr_b16 a[8:9], v2 offset:4608
  ds_read_b64_tr_b16 a[10:11], v2 offset:9728
  v_lshlrev_b32 v22, 16, v234
  v_and_b32 v23, s41, v234
  v_lshlrev_b32 v24, 16, v235
  v_and_b32 v25, s41, v235
  v_mfma_f32_32x32x16_bf16 a[176:191], v[224:227], a[16:19], a[176:191]
  ds_read_b64_tr_b16 a[12:13], v2 offset:6656
  ds_read_b64_tr_b16 a[14:15], v2 offset:11776
  v_fma_f32 v22, v22, v5, v6
  s_add_u32 m0, s40, 7792
  s_waitcnt lgkmcnt(8)
  v_mfma_f32_32x32x16_bf16 v[32:47], v[228:231], a[20:23], v[32:47]
  buffer_load_dwordx4 v8, s[12:15], s67 offen offset:2448  lds
  ds_read_b64_tr_b16 a[16:17], v2 offset:7168
  ds_read_b64_tr_b16 a[18:19], v2 offset:12288
  v_fma_f32 v23, v23, v5, v6
  v_fma_f32 v24, v24, v5, v6
  v_mfma_f32_32x32x16_bf16 v[96:111], v[228:231], a[24:27], v[96:111]
  ds_read_b64_tr_b16 a[20:21], v2 offset:7680
  ds_read_b64_tr_b16 a[22:23], v2 offset:12800
  v_fma_f32 v25, v25, v5, v6
  v_cvt_pk_bf16_f32 v234, v22, v23
  v_cvt_pk_bf16_f32 v235, v24, v25
  v_mfma_f32_32x32x16_bf16 v[48:63], v[228:231], a[28:31], v[48:63]
  ds_read_b64_tr_b16 a[24:25], v2 offset:43008
  ds_read_b64_tr_b16 a[26:27], v2 offset:48128
  v_lshlrev_b32 v18, 16, v236
  v_and_b32 v19, s41, v236
  v_lshlrev_b32 v20, 16, v237
  s_waitcnt lgkmcnt(8)
  v_mfma_f32_32x32x16_bf16 a[128:143], v[228:231], a[0:3], a[128:143]
  ds_read_b64_tr_b16 a[28:29], v14 offset:45056
  ds_read_b64_tr_b16 a[30:31], v14 offset:50176
  v_and_b32 v21, s41, v237
  v_fma_f32 v18, v18, v5, v6
  v_fma_f32 v19, v19, v5, v6
  v_mfma_f32_32x32x16_bf16 v[64:79], v[228:231], a[4:7], v[64:79]
  ds_read_b64_tr_b16 a[0:1], v2 offset:43520
  ds_read_b64_tr_b16 a[2:3], v2 offset:48640
  v_fma_f32 v20, v20, v5, v6
  v_fma_f32 v21, v21, v5, v6
  v_cvt_pk_bf16_f32 v236, v18, v19
  v_mfma_f32_32x32x16_bf16 v[80:95], v[228:231], a[8:11], v[80:95]
  ds_read_b64_tr_b16 a[4:5], v2 offset:46080
  ds_read_b64_tr_b16 a[6:7], v2 offset:51200
  v_cvt_pk_bf16_f32 v237, v20, v21
AT_H3:
  s_cbranch_execz AT_H7
  v_lshlrev_b32 v22, 16, v238
  v_and_b32 v23, s41, v238
  s_waitcnt lgkmcnt(8)
  v_mfma_f32_32x32x16_bf16 a[144:159], v[228:231], a[12:15], a[144:159]
  ds_read_b64_tr_b16 a[8:9], v2 offset:44032
  ds_read_b64_tr_b16 a[10:11], v2 offset:49152
  v_lshlrev_b32 v24, 16, v239
  v_and_b32 v25, s41, v239
  v_fma_f32 v22, v22, v5, v6
  v_mfma_f32_32x32x16_bf16 a[160:175], v[228:231], a[16:19], a[160:175]
  ds_read_b64_tr_b16 a[12:13], v2 offset:44544
  ds_read_b64_tr_b16 a[14:15], v2 offset:49664
  v_fma_f32 v23, v23, v5, v6
  v_fma_f32 v24, v24, v5, v6
  v_fma_f32 v25, v25, v5, v6
  v_mfma_f32_32x32x16_bf16 a[176:191], v[228:231], a[20:23], a[176:191]
  ds_read_b64_tr_b16 a[16:17], v2 offset:46592
  ds_read_b64_tr_b16 a[18:19], v2 offset:51712
  v_cvt_pk_bf16_f32 v238, v22, v23
  v_cvt_pk_bf16_f32 v239, v24, v25
  s_waitcnt lgkmcnt(8)
  v_mfma_f32_32x32x16_bf16 v[32:47], v[232:235], a[24:27], v[32:47]
  ds_read_b64_tr_b16 a[20:21], v2 offset:47104
  ds_read_b64_tr_b16 a[22:23], v2 offset:52224
  v_lshlrev_b32 v18, 16, v240
  v_and_b32 v19, s41, v240
  v_lshlrev_b32 v20, 16, v241
  v_and_b32 v21, s41, v241
  v_mfma_f32_32x32x16_bf16 v[96:111], v[232:235], a[28:31], v[96:111]
  ds_read_b64_tr_b16 a[24:25], v2 offset:47616
  ds_read_b64_tr_b16 a[26:27], v2 offset:52736
  v_fma_f32 v18, v18, v5, v6
  v_fma_f32 v19, v19, v5, v6
  v_fma_f32 v20, v20, v5, v6
  v_mfma_f32_32x32x16_bf16 v[48:63], v[232:235], a[0:3], v[48:63]
  ds_read_b64_tr_b16 a[28:29], v3 offset:17408
  ds_read_b64_tr_b16 a[30:31], v3 offset:22528
  v_fma_f32 v21, v21, v5, v6
  v_cvt_pk_bf16_f32 v240, v18, v19
  s_waitcnt lgkmcnt(8)
  v_mfma_f32_32x32x16_bf16 a[128:143], v[232:235], a[4:7], a[128:143]
  ds_read_b64_tr_b16 a[0:1], v15 offset:19456
  ds_read_b64_tr_b16 a[2:3], v15 offset:24576
  v_cvt_pk_bf16_f32 v241, v20, v21
  v_lshlrev_b32 v22, 16, v242
  v_and_b32 v23, s41, v242
  v_lshlrev_b32 v24, 16, v243
  v_mfma_f32_32x32x16_bf16 v[64:79], v[232:235], a[8:11], v[64:79]
  ds_read_b64_tr_b16 a[4:5], v3 offset:17920
  ds_read_b64_tr_b16 a[6:7], v3 offset:23040
  v_and_b32 v25, s41, v243
  v_fma_f32 v22, v22, v5, v6
  v_fma_f32 v23, v23, v5, v6
  v_mfma_f32_32x32x16_bf16 v[80:95], v[232:235], a[12:15], v[80:95]
  ds_read_b64_tr_b16 a[8:9], v3 offset:20480
  ds_read_b64_tr_b16 a[10:11], v3 offset:25600
  v_fma_f32 v24, v24, v5, v6
  v_fma_f32 v25, v25, v5, v6
  s_waitcnt lgkmcnt(8)
  v_mfma_f32_32x32x16_bf16 a[144:159], v[232:235], a[16:19], a[144:159]
  ds_read_b64_tr_b16 a[12:13], v3 offset:18432
  ds_read_b64_tr_b16 a[14:15], v3 offset:23552
  v_cvt_pk_bf16_f32 v242, v22, v23
  v_cvt_pk_bf16_f32 v243, v24, v25
  v_lshlrev_b32 v18, 16, v244
  v_mfma_f32_32x32x16_bf16 a[160:175], v[232:235], a[20:23], a[160:175]
  ds_read_b64_tr_b16 a[16:17], v3 offset:18944
  ds_read_b64_tr_b16 a[18:19], v3 offset:24064
  v_and_b32 v19, s41, v244
  v_lshlrev_b32 v20, 16, v245
  v_and_b32 v21, s41, v245
  v_fma_f32 v18, v18, v5, v6
  v_mfma_f32_32x32x16_bf16 a[176:191], v[232:235], a[24:27], a[176:191]
  ds_read_b64_tr_b16 a[20:21], v3 offset:20992
  ds_read_b64_tr_b16 a[22:23], v3 offset:26112
  v_fma_f32 v19, v19, v5, v6
  v_fma_f32 v20, v20, v5, v6
  s_waitcnt lgkmcnt(8)
  v_mfma_f32_32x32x16_bf16 v[32:47], v[236:239], a[28:31], v[32:47]
  ds_read_b64_tr_b16 a[24:25], v3 offset:21504
  ds_read_b64_tr_b16 a[26:27], v3 offset:26624
  v_fma_f32 v21, v21, v5, v6
  v_cvt_pk_bf16_f32 v244, v18, v19
  v_cvt_pk_bf16_f32 v245, v20, v21
  v_mfma_f32_32x32x16_bf16 v[96:111], v[236:239], a[0:3], v[96:111]
  ds_read_b64_tr_b16 a[28:29], v3 offset:22016
  ds_read_b64_tr_b16 a[30:31], v3 offset:27136
  v_lshlrev_b32 v22, 16, v246
  v_and_b32 v23, s41, v246
  v_lshlrev_b32 v24, 16, v247
  v_and_b32 v25, s41, v247
  v_mfma_f32_32x32x16_bf16 v[48:63], v[236:239], a[4:7], v[48:63]
  s_waitcnt vmcnt(0)
  s_barrier
  ds_read_b64_tr_b16 a[0:1], v1 offset:38912
  ds_read_b64_tr_b16 a[2:3], v1 offset:10240
  s_add_u32 m0, s40, 18432
  s_waitcnt lgkmcnt(8)
  v_mfma_f32_32x32x16_bf16 a[128:143], v[236:239], a[8:11], a[128:143]
  buffer_load_dwordx4 v8, s[12:15], s50 offen  lds
  ds_read_b64_tr_b16 a[4:5], v2 offset:13312
  ds_read_b64_tr_b16 a[6:7], v1 offset:50176
  v_fma_f32 v22, v22, v5, v6
  v_fma_f32 v23, v23, v5, v6
  v_mfma_f32_32x32x16_bf16 v[64:79], v[236:239], a[12:15], v[64:79]
  ds_read_b64_tr_b16 a[8:9], v2 offset:53248
  ds_read_b64_tr_b16 a[10:11], v2 offset:24576
  v_fma_f32 v24, v24, v5, v6
  v_fma_f32 v25, v25, v5, v6
  v_cvt_pk_bf16_f32 v246, v22, v23
  v_mfma_f32_32x32x16_bf16 v[80:95], v[236:239], a[16:19], v[80:95]
  ds_read_b64_tr_b16 a[12:13], v3 offset:27648
  ds_read_b64_tr_b16 a[14:15], v2 offset:64512
  v_cvt_pk_bf16_f32 v247, v24, v25
  s_add_u32 m0, s40, 19456
  s_waitcnt lgkmcnt(8)
  v_mfma_f32_32x32x16_bf16 a[144:159], v[236:239], a[20:23], a[144:159]
  buffer_load_dwordx4 v8, s[12:15], s51 offen  lds
  ds_read_b64_tr_b16 a[16:17], v13 offset:40960
  ds_read_b64_tr_b16 a[18:19], v13 offset:12288
  v_lshlrev_b32 v18, 16, v248
  v_and_b32 v19, s41, v248
  v_lshlrev_b32 v20, 16, v249
  v_mfma_f32_32x32x16_bf16 a[160:175], v[236:239], a[24:27], a[160:175]
  ds_read_b64_tr_b16 a[20:21], v14 offset:15360
  ds_read_b64_tr_b16 a[22:23], v13 offset:52224
  v_and_b32 v21, s41, v249
  v_fma_f32 v18, v18, v5, v6
  v_fma_f32 v19, v19, v5, v6
  v_mfma_f32_32x32x16_bf16 a[176:191], v[236:239], a[28:31], a[176:191]
  ds_read_b64_tr_b16 a[24:25], v14 offset:55296
  ds_read_b64_tr_b16 a[26:27], v14 offset:26624
  v_fma_f32 v20, v20, v5, v6
  s_add_u32 m0, s40, 20480
  s_waitcnt lgkmcnt(8)
  v_mfma_f32_32x32x16_bf16 v[32:47], v[240:243], a[0:3], v[32:47]
  buffer_load_dwordx4 v8, s[12:15], s52 offen  lds
  ds_read_b64_tr_b16 a[28:29], v15 offset:29696
  ds_read_b64_tr_b16 a[30:31], v15 offset:1024
  v_fma_f32 v21, v21, v5, v6
  v_cvt_pk_bf16_f32 v248, v18, v19
  v_cvt_pk_bf16_f32 v249, v20, v21
  v_lshlrev_b32 v22, 16, v250
  v_and_b32 v23, s41, v250
  v_lshlrev_b32 v24, 16, v251
  v_and_b32 v25, s41, v251
  v_fma_f32 v22, v22, v5, v6
  v_fma_f32 v23, v23, v5, v6
  v_fma_f32 v24, v24, v5, v6
  v_fma_f32 v25, v25, v5, v6
  v_cvt_pk_bf16_f32 v250, v22, v23
  v_cvt_pk_bf16_f32 v251, v24, v25
  v_mfma_f32_32x32x16_bf16 v[32:47], v[244:247], a[4:7], v[32:47]
  ds_read_b64_tr_b16 a[0:1], v1 offset:39424
  ds_read_b64_tr_b16 a[2:3], v1 offset:10752
  v_lshlrev_b32 v18, 16, v252
  v_and_b32 v19, s41, v252
  v_lshlrev_b32 v20, 16, v253
  v_and_b32 v21, s41, v253
  v_fma_f32 v18, v18, v5, v6
  v_fma_f32 v19, v19, v5, v6
  v_fma_f32 v20, v20, v5, v6
  v_fma_f32 v21, v21, v5, v6
  v_cvt_pk_bf16_f32 v252, v18, v19
  v_cvt_pk_bf16_f32 v253, v20, v21
  v_lshlrev_b32 v22, 16, v254
  v_and_b32 v23, s41, v254
  v_lshlrev_b32 v24, 16, v255
  v_and_b32 v25, s41, v255
  v_fma_f32 v22, v22, v5, v6
  v_fma_f32 v23, v23, v5, v6
  v_fma_f32 v24, v24, v5, v6
  v_fma_f32 v25, v25, v5, v6
  v_cvt_pk_bf16_f32 v254, v22, v23
  v_cvt_pk_bf16_f32 v255, v24, v25
  v_mfma_f32_32x32x16_bf16 v[32:47], v[248:251], a[8:11], v[32:47]
  ds_read_b64_tr_b16 a[4:5], v2 offset:13824
  ds_read_b64_tr_b16 a[6:7], v1 offset:50688
  v_and_b32 v11, 0xc1, v0
  v_lshlrev_b32 v11, 7, v11
  buffer_load_dword v11, v11, s[36:39], 0 offen sc1
  s_add_u32 m0, s40, 21504
  s_waitcnt lgkmcnt(8)
  v_mfma_f32_32x32x16_bf16 v[32:47], v[252:255], a[12:15], v[32:47]
  buffer_load_dwordx4 v8, s[12:15], s53 offen  lds
  ds_read_b64_tr_b16 a[8:9], v2 offset:53760
  ds_read_b64_tr_b16 a[10:11], v2 offset:25088
  v_mfma_f32_32x32x16_bf16 v[96:111], v[240:243], a[16:19], v[96:111]
  ds_read_b64_tr_b16 a[12:13], v3 offset:28160
  ds_read_b64_tr_b16 a[14:15], v2 offset:65024
  v_mfma_f32_32x32x16_bf16 v[96:111], v[244:247], a[20:23], v[96:111]
  ds_read_b64_tr_b16 a[16:17], v1 offset:41984
  ds_read_b64_tr_b16 a[18:19], v1 offset:13312
  s_add_u32 m0, s40, 22528
  s_waitcnt lgkmcnt(8)
  v_mfma_f32_32x32x16_bf16 v[96:111], v[248:251], a[24:27], v[96:111]
  buffer_load_dwordx4 v8, s[12:15], s54 offen  lds
  ds_read_b64_tr_b16 a[20:21], v2 offset:16384
  ds_read_b64_tr_b16 a[22:23], v1 offset:53248
  v_exp_f32 v18, v32 clamp
  v_exp_f32 v19, v33 clamp
  v_max_f32 v32, s43, v32
  v_max_f32 v33, s43, v33
  v_mfma_f32_32x32x16_bf16 v[96:111], v[252:255], a[28:31], v[96:111]
  ds_read_b64_tr_b16 a[24:25], v2 offset:56320
  ds_read_b64_tr_b16 a[26:27], v2 offset:27648
  v_fmac_f32 v18, s42, v32
  v_fmac_f32 v19, s42, v33
  v_cvt_pk_bf16_f32 v32, v18, v19
  v_exp_f32 v20, v34 clamp
  v_exp_f32 v21, v35 clamp
  v_mfma_f32_32x32x16_bf16 v[48:63], v[240:243], a[0:3], v[48:63]
  ds_read_b64_tr_b16 a[28:29], v3 offset:30720
  ds_read_b64_tr_b16 a[30:31], v3 offset:2048
  v_max_f32 v34, s43, v34
  v_max_f32 v35, s43, v35
  v_fmac_f32 v20, s42, v34
  v_fmac_f32 v21, s42, v35
  s_add_u32 m0, s40, 23552
  s_waitcnt lgkmcnt(8)
  v_mfma_f32_32x32x16_bf16 v[48:63], v[244:247], a[4:7], v[48:63]
  buffer_load_dwordx4 v8, s[12:15], s55 offen  lds
  ds_read_b64_tr_b16 a[0:1], v1 offset:39936
  ds_read_b64_tr_b16 a[2:3], v1 offset:11264
  v_cvt_pk_bf16_f32 v33, v20, v21
  v_exp_f32 v18, v36 clamp
  v_exp_f32 v19, v37 clamp
  v_mfma_f32_32x32x16_bf16 v[48:63], v[248:251], a[8:11], v[48:63]
  ds_read_b64_tr_b16 a[4:5], v2 offset:14336
  ds_read_b64_tr_b16 a[6:7], v1 offset:51200
  v_max_f32 v36, s43, v36
  v_max_f32 v37, s43, v37
  v_fmac_f32 v18, s42, v36
  v_fmac_f32 v19, s42, v37
  v_cvt_pk_bf16_f32 v34, v18, v19
  v_exp_f32 v20, v38 clamp
  v_mfma_f32_32x32x16_bf16 v[48:63], v[252:255], a[12:15], v[48:63]
  ds_read_b64_tr_b16 a[8:9], v2 offset:54272
  ds_read_b64_tr_b16 a[10:11], v2 offset:25600
  v_exp_f32 v21, v39 clamp
  v_max_f32 v38, s43, v38
  v_max_f32 v39, s43, v39
  v_fmac_f32 v20, s42, v38
  s_add_u32 m0, s40, 24576
  s_waitcnt lgkmcnt(8)
  v_mfma_f32_32x32x16_bf16 a[128:143], v[240:243], a[16:19], a[128:143]
  buffer_load_dwordx4 v8, s[12:15], s56 offen  lds
  ds_read_b64_tr_b16 a[12:13], v3 offset:28672
  ds_read_b64_tr_b16 a[14:15], v3 offset:0
  v_fmac_f32 v21, s42, v39
  v_cvt_pk_bf16_f32 v35, v20, v21
  v_exp_f32 v18, v40 clamp
  v_mfma_f32_32x32x16_bf16 a[128:143], v[244:247], a[20:23], a[128:143]
  ds_read_b64_tr_b16 a[16:17], v1 offset:40448
  ds_read_b64_tr_b16 a[18:19], v1 offset:11776
  v_exp_f32 v19, v41 clamp
  v_max_f32 v40, s43, v40
  v_max_f32 v41, s43, v41
  v_fmac_f32 v18, s42, v40
  v_fmac_f32 v19, s42, v41
  v_cvt_pk_bf16_f32 v36, v18, v19
  v_mfma_f32_32x32x16_bf16 a[128:143], v[248:251], a[24:27], a[128:143]
  ds_read_b64_tr_b16 a[20:21], v2 offset:14848
  ds_read_b64_tr_b16 a[22:23], v1 offset:51712
  v_exp_f32 v20, v42 clamp
  v_exp_f32 v21, v43 clamp
  v_max_f32 v42, s43, v42
  v_max_f32 v43, s43, v43
  s_waitcnt lgkmcnt(8)
  v_mfma_f32_32x32x16_bf16 a[128:143], v[252:255], a[28:31], a[128:143]
  ds_read_b64_tr_b16 a[24:25], v2 offset:54784
  ds_read_b64_tr_b16 a[26:27], v2 offset:26112
  v_fmac_f32 v20, s42, v42
  v_fmac_f32 v21, s42, v43
  v_cvt_pk_bf16_f32 v37, v20, v21
  v_exp_f32 v18, v44 clamp
  v_exp_f32 v19, v45 clamp
  v_mfma_f32_32x32x16_bf16 v[64:79], v[240:243], a[0:3], v[64:79]
  ds_read_b64_tr_b16 a[28:29], v3 offset:29184
  ds_read_b64_tr_b16 a[30:31], v3 offset:512
  v_max_f32 v44, s43, v44
  v_max_f32 v45, s43, v45
  v_fmac_f32 v18, s42, v44
  v_fmac_f32 v19, s42, v45
  v_cvt_pk_bf16_f32 v38, v18, v19
  v_exp_f32 v20, v46 clamp
  v_mfma_f32_32x32x16_bf16 v[64:79], v[244:247], a[4:7], v[64:79]
  ds_read_b64_tr_b16 a[0:1], v1 offset:42496
  ds_read_b64_tr_b16 a[2:3], v1 offset:13824
  v_exp_f32 v21, v47 clamp
  v_max_f32 v46, s43, v46
  v_max_f32 v47, s43, v47
  v_fmac_f32 v20, s42, v46
  v_fmac_f32 v21, s42, v47
  s_waitcnt lgkmcnt(8)
  v_mfma_f32_32x32x16_bf16 v[64:79], v[248:251], a[8:11], v[64:79]
  ds_read_b64_tr_b16 a[4:5], v2 offset:16896
  ds_read_b64_tr_b16 a[6:7], v1 offset:53760
  v_cvt_pk_bf16_f32 v39, v20, v21
  v_cvt_pk_bf16_f32 v40, v96, v97
  v_exp_f32 v18, v96 clamp
  v_exp_f32 v19, v97 clamp
  v_mfma_f32_32x32x16_bf16 v[64:79], v[252:255], a[12:15], v[64:79]
  ds_read_b64_tr_b16 a[8:9], v2 offset:56832
  ds_read_b64_tr_b16 a[10:11], v2 offset:28160
  v_max_f32 v96, s43, v96
  v_max_f32 v97, s43, v97
  v_fmac_f32 v18, s42, v96
  v_fmac_f32 v19, s42, v97
  v_cvt_pk_bf16_f32 v96, v18, v19
  v_cndmask_b32 v40, v17, v40, s[82:83]
  v_mfma_f32_32x32x16_bf16 v[80:95], v[240:243], a[16:19], v[80:95]
  ds_read_b64_tr_b16 a[12:13], v3 offset:31232
  ds_read_b64_tr_b16 a[14:15], v3 offset:2560
  v_cvt_pk_bf16_f32 v41, v98, v99
  v_exp_f32 v20, v98 clamp
  v_exp_f32 v21, v99 clamp
  v_max_f32 v98, s43, v98
  s_waitcnt lgkmcnt(8)
  v_mfma_f32_32x32x16_bf16 v[80:95], v[244:247], a[20:23], v[80:95]
  ds_read_b64_tr_b16 a[16:17], v1 offset:43008
  ds_read_b64_tr_b16 a[18:19], v1 offset:14336
  v_max_f32 v99, s43, v99
  v_fmac_f32 v20, s42, v98
  v_fmac_f32 v21, s42, v99
  v_cvt_pk_bf16_f32 v97, v20, v21
  v_cndmask_b32 v41, v17, v41, s[82:83]
  v_cvt_pk_bf16_f32 v42, v100, v101
  v_mfma_f32_32x32x16_bf16 v[80:95], v[248:251], a[24:27], v[80:95]
  ds_read_b64_tr_b16 a[20:21], v2 offset:17408
  ds_read_b64_tr_b16 a[22:23], v1 offset:54272
  v_exp_f32 v18, v100 clamp
  v_exp_f32 v19, v101 clamp
  v_max_f32 v100, s43, v100
  v_max_f32 v101, s43, v101
  v_fmac_f32 v18, s42, v100
  v_mfma_f32_32x32x16_bf16 v[80:95], v[252:255], a[28:31], v[80:95]
  ds_read_b64_tr_b16 a[24:25], v2 offset:57344
  ds_read_b64_tr_b16 a[26:27], v2 offset:28672
  v_fmac_f32 v19, s42, v101
  v_cvt_pk_bf16_f32 v98, v18, v19
  v_cndmask_b32 v42, v17, v42, s[82:83]
  v_cvt_pk_bf16_f32 v43, v102, v103
  s_waitcnt lgkmcnt(8)
  v_mfma_f32_32x32x16_bf16 a[144:159], v[240:243], a[0:3], a[144:159]
  ds_read_b64_tr_b16 a[28:29], v3 offset:31744
  ds_read_b64_tr_b16 a[30:31], v3 offset:3072
  v_exp_f32 v20, v102 clamp
  v_exp_f32 v21, v103 clamp
  v_max_f32 v102, s43, v102
  v_max_f32 v103, s43, v103
  v_fmac_f32 v20, s42, v102
  v_mfma_f32_32x32x16_bf16 a[144:159], v[244:247], a[4:7], a[144:159]
  ds_read_b64_tr_b16 a[0:1], v1 offset:43520
  ds_read_b64_tr_b16 a[2:3], v1 offset:14848
  v_fmac_f32 v21, s42, v103
  v_cvt_pk_bf16_f32 v99, v20, v21
  v_cndmask_b32 v43, v17, v43, s[82:83]
  v_cvt_pk_bf16_f32 v44, v104, v105
  v_exp_f32 v18, v104 clamp
  v_mfma_f32_32x32x16_bf16 a[144:159], v[248:251], a[8:11], a[144:159]
  ds_read_b64_tr_b16 a[4:5], v2 offset:17920
  ds_read_b64_tr_b16 a[6:7], v1 offset:54784
  v_exp_f32 v19, v105 clamp
  v_max_f32 v104, s43, v104
  v_max_f32 v105, s43, v105
  v_fmac_f32 v18, s42, v104
  v_fmac_f32 v19, s42, v105
  s_waitcnt lgkmcnt(8)
  v_mfma_f32_32x32x16_bf16 a[144:159], v[252:255], a[12:15], a[144:159]
  ds_read_b64_tr_b16 a[8:9], v2 offset:57856
  ds_read_b64_tr_b16 a[10:11], v2 offset:29184
  v_cvt_pk_bf16_f32 v100, v18, v19
  v_cndmask_b32 v44, v17, v44, s[82:83]
  v_cvt_pk_bf16_f32 v45, v106, v107
  v_exp_f32 v20, v106 clamp
  v_mfma_f32_32x32x16_bf16 a[160:175], v[240:243], a[16:19], a[160:175]
  ds_read_b64_tr_b16 a[12:13], v3 offset:32256
  ds_read_b64_tr_b16 a[14:15], v3 offset:3584
  v_exp_f32 v21, v107 clamp
  v_max_f32 v106, s43, v106
  v_max_f32 v107, s43, v107
  v_fmac_f32 v20, s42, v106
  v_fmac_f32 v21, s42, v107
  v_cvt_pk_bf16_f32 v101, v20, v21
  v_mfma_f32_32x32x16_bf16 a[160:175], v[244:247], a[20:23], a[160:175]
  s_waitcnt vmcnt(1)
  s_barrier
  ds_read_b64_tr_b16 a[16:17], v1 offset:22528
  ds_read_b64_tr_b16 a[18:19], v1 offset:23552
  v_cndmask_b32 v45, v17, v45, s[82:83]
  v_cvt_pk_bf16_f32 v46, v108, v109
  s_add_u32 m0, s40, 25600
  s_waitcnt lgkmcnt(8)
  v_mfma_f32_32x32x16_bf16 a[160:175], v[248:251], a[24:27], a[160:175]
  buffer_load_dwordx4 v8, s[12:15], s57 offen  lds
  ds_read_b64_tr_b16 a[20:21], v1 offset:23040
  ds_read_b64_tr_b16 a[22:23], v1 offset:24064
  v_exp_f32 v18, v108 clamp
  v_exp_f32 v19, v109 clamp
  v_max_f32 v108, s43, v108
  v_max_f32 v109, s43, v109
  v_mfma_f32_32x32x16_bf16 a[160:175], v[252:255], a[28:31], a[160:175]
  ds_read_b64_tr_b16 a[24:25], v1 offset:62464
  ds_read_b64_tr_b16 a[26:27], v1 offset:63488
  v_fmac_f32 v18, s42, v108
  v_fmac_f32 v19, s42, v109
  v_cvt_pk_bf16_f32 v102, v18, v19
  v_cndmask_b32 v46, v17, v46, s[82:83]
  v_cvt_pk_bf16_f32 v47, v110, v111
  v_mfma_f32_32x32x16_bf16 a[176:191], v[240:243], a[0:3], a[176:191]
  ds_read_b64_tr_b16 a[28:29], v1 offset:62976
  ds_read_b64_tr_b16 a[30:31], v1 offset:64000
  v_exp_f32 v20, v110 clamp
  v_exp_f32 v21, v111 clamp
  v_max_f32 v110, s43, v110
  s_add_u32 m0, s40, 26624
  s_waitcnt lgkmcnt(8)
  v_mfma_f32_32x32x16_bf16 a[176:191], v[244:247], a[4:7], a[176:191]
  buffer_load_dwordx4 v8, s[12:15], s58 offen  lds
  ds_read_b64_tr_b16 a[0:1], v2 offset:36864
  ds_read_b64_tr_b16 a[2:3], v2 offset:37888
  v_max_f32 v111, s43, v111
  v_fmac_f32 v20, s42, v110
  v_fmac_f32 v21, s42, v111
  v_cvt_pk_bf16_f32 v103, v20, v21
  v_cndmask_b32 v47, v17, v47, s[82:83]
  v_mfma_f32_32x32x16_bf16 a[176:191], v[248:251], a[8:11], a[176:191]
  ds_read_b64_tr_b16 a[4:5], v2 offset:37376
  ds_read_b64_tr_b16 a[6:7], v2 offset:38400
  v_exp_f32 v18, v48 clamp
  v_exp_f32 v19, v49 clamp
  v_max_f32 v48, s43, v48
  v_max_f32 v49, s43, v49
  v_fmac_f32 v18, s42, v48
  v_mfma_f32_32x32x16_bf16 a[176:191], v[252:255], a[12:15], a[176:191]
  ds_read_b64_tr_b16 a[8:9], v3 offset:11264
  ds_read_b64_tr_b16 a[10:11], v3 offset:12288
  v_fmac_f32 v19, s42, v49
  v_cvt_pk_bf16_f32 v48, v18, v19
  v_exp_f32 v20, v50 clamp
  s_add_u32 m0, s40, 27648
  s_waitcnt lgkmcnt(8)
  v_mfma_f32_32x32x16_bf16 a[48:63], a[16:19], v[112:115], 0
  buffer_load_dwordx4 v8, s[12:15], s59 offen  lds
  ds_read_b64_tr_b16 a[12:13], v3 offset:11776
  ds_read_b64_tr_b16 a[14:15], v3 offset:12800
  v_and_b32 v9, 16, v0
  v_lshlrev_b32 v9, 5, v9
  v_sub_u32 v13, v13, v9
  v_sub_u32 v14, v14, v9
  v_sub_u32 v15, v15, v9
  v_mfma_f32_32x32x16_bf16 a[64:79], a[20:23], v[112:115], 0
  ds_read_b64_tr_b16 a[16:17], v1 offset:24576
  ds_read_b64_tr_b16 a[18:19], v1 offset:25600
  v_exp_f32 v21, v51 clamp
  v_max_f32 v50, s43, v50
  v_max_f32 v51, s43, v51
  v_fmac_f32 v20, s42, v50
  v_fmac_f32 v21, s42, v51
  v_cvt_pk_bf16_f32 v49, v20, v21
  v_mfma_f32_32x32x16_bf16 a[48:63], a[24:27], v[116:119], a[48:63]
  ds_read_b64_tr_b16 a[20:21], v1 offset:25088
  ds_read_b64_tr_b16 a[22:23], v1 offset:26112
  v_exp_f32 v18, v52 clamp
  v_exp_f32 v19, v53 clamp
  v_max_f32 v52, s43, v52
  s_add_u32 m0, s40, 28672
  s_waitcnt lgkmcnt(8)
  v_mfma_f32_32x32x16_bf16 a[64:79], a[28:31], v[116:119], a[64:79]
  buffer_load_dwordx4 v8, s[12:15], s60 offen  lds
  ds_read_b64_tr_b16 a[24:25], v1 offset:64512
  ds_read_b64_tr_b16 a[26:27], v2 offset:0
  v_max_f32 v53, s43, v53
  v_fmac_f32 v18, s42, v52
  v_fmac_f32 v19, s42, v53
  v_cvt_pk_bf16_f32 v50, v18, v19
  v_mfma_f32_32x32x16_bf16 a[48:63], a[0:3], v[120:123], a[48:63]
  ds_read_b64_tr_b16 a[28:29], v1 offset:65024
  ds_read_b64_tr_b16 a[30:31], v2 offset:512
  v_exp_f32 v20, v54 clamp
  v_exp_f32 v21, v55 clamp
  v_max_f32 v54, s43, v54
  v_max_f32 v55, s43, v55
  v_fmac_f32 v20, s42, v54
  v_mfma_f32_32x32x16_bf16 a[64:79], a[4:7], v[120:123], a[64:79]
  ds_read_b64_tr_b16 a[0:1], v2 offset:38912
  ds_read_b64_tr_b16 a[2:3], v2 offset:39936
  v_fmac_f32 v21, s42, v55
  v_cvt_pk_bf16_f32 v51, v20, v21
  v_exp_f32 v18, v56 clamp
  s_add_u32 m0, s40, 29696
  s_waitcnt lgkmcnt(8)
  v_mfma_f32_32x32x16_bf16 a[48:63], a[8:11], v[124:127], a[48:63]
  buffer_load_dwordx4 v8, s[12:15], s61 offen  lds
  ds_read_b64_tr_b16 a[4:5], v2 offset:39424
  ds_read_b64_tr_b16 a[6:7], v2 offset:40448
  v_exp_f32 v19, v57 clamp
  v_max_f32 v56, s43, v56
  v_max_f32 v57, s43, v57
  v_fmac_f32 v18, s42, v56
  v_fmac_f32 v19, s42, v57
  v_mfma_f32_32x32x16_bf16 a[64:79], a[12:15], v[124:127], a[64:79]
  ds_read_b64_tr_b16 a[8:9], v3 offset:13312
  ds_read_b64_tr_b16 a[10:11], v3 offset:14336
  v_cvt_pk_bf16_f32 v52, v18, v19
  v_exp_f32 v20, v58 clamp
  v_exp_f32 v21, v59 clamp
  v_max_f32 v58, s43, v58
  v_max_f32 v59, s43, v59
  v_mfma_f32_32x32x16_bf16 a[48:63], a[16:19], v[128:131], a[48:63]
  ds_read_b64_tr_b16 a[12:13], v3 offset:13824
  ds_read_b64_tr_b16 a[14:15], v3 offset:14848
  v_fmac_f32 v20, s42, v58
  v_fmac_f32 v21, s42, v59
  v_cvt_pk_bf16_f32 v53, v20, v21
  s_add_u32 m0, s40, 30720
  s_waitcnt lgkmcnt(8)
  v_mfma_f32_32x32x16_bf16 a[64:79], a[20:23], v[128:131], a[64:79]
  buffer_load_dwordx4 v8, s[12:15], s62 offen  lds
  ds_read_b64_tr_b16 a[16:17], v1 offset:26624
  ds_read_b64_tr_b16 a[18:19], v1 offset:27648
  v_exp_f32 v18, v60 clamp
  v_exp_f32 v19, v61 clamp
  v_max_f32 v60, s43, v60
  v_max_f32 v61, s43, v61
  v_mfma_f32_32x32x16_bf16 a[48:63], a[24:27], v[132:135], a[48:63]
  ds_read_b64_tr_b16 a[20:21], v1 offset:27136
  ds_read_b64_tr_b16 a[22:23], v1 offset:28160
  v_fmac_f32 v18, s42, v60
  v_fmac_f32 v19, s42, v61
  v_cvt_pk_bf16_f32 v54, v18, v19
  v_exp_f32 v20, v62 clamp
  v_exp_f32 v21, v63 clamp
  v_mfma_f32_32x32x16_bf16 a[64:79], a[28:31], v[132:135], a[64:79]
  ds_read_b64_tr_b16 a[24:25], v2 offset:1024
  ds_read_b64_tr_b16 a[26:27], v2 offset:2048
  v_max_f32 v62, s43, v62
  v_max_f32 v63, s43, v63
  v_fmac_f32 v20, s42, v62
  v_fmac_f32 v21, s42, v63
  s_add_u32 m0, s40, 31744
  s_waitcnt lgkmcnt(8)
  v_mfma_f32_32x32x16_bf16 a[48:63], a[0:3], v[136:139], a[48:63]
  buffer_load_dwordx4 v8, s[12:15], s63 offen  lds
  ds_read_b64_tr_b16 a[28:29], v2 offset:1536
  ds_read_b64_tr_b16 a[30:31], v2 offset:2560
  v_cvt_pk_bf16_f32 v55, v20, v21
  v_accvgpr_read_b32 v22, a128
  v_accvgpr_read_b32 v23, a129
  v_cvt_pk_bf16_f32 v22, v22, v23
  v_mfma_f32_32x32x16_bf16 a[64:79], a[4:7], v[136:139], a[64:79]
  ds_read_b64_tr_b16 a[0:1], v2 offset:40960
  ds_read_b64_tr_b16 a[2:3], v2 offset:41984
  v_cndmask_b32 v104, v17, v22, s[44:45]
  v_cndmask_b32 v56, v22, v40, s[44:45]
  v_accvgpr_read_b32 v24, a130
  v_accvgpr_read_b32 v25, a131
  v_cvt_pk_bf16_f32 v24, v24, v25
  v_mfma_f32_32x32x16_bf16 a[48:63], a[8:11], v[140:143], a[48:63]
  ds_read_b64_tr_b16 a[4:5], v2 offset:41472
  ds_read_b64_tr_b16 a[6:7], v2 offset:42496
  v_cndmask_b32 v105, v17, v24, s[44:45]
  v_cndmask_b32 v57, v24, v41, s[44:45]
  v_accvgpr_read_b32 v22, a132
  v_accvgpr_read_b32 v23, a133
  s_add_u32 m0, s40, 32768
  s_waitcnt lgkmcnt(8)
  v_mfma_f32_32x32x16_bf16 a[64:79], a[12:15], v[140:143], a[64:79]
  buffer_load_dwordx4 v8, s[12:15], s64 offen  lds
  ds_read_b64_tr_b16 a[8:9], v3 offset:15360
  ds_read_b64_tr_b16 a[10:11], v3 offset:16384
  v_cvt_pk_bf16_f32 v22, v22, v23
  v_cndmask_b32 v106, v17, v22, s[44:45]
  v_cndmask_b32 v58, v22, v42, s[44:45]
  v_accvgpr_read_b32 v24, a134
  v_mfma_f32_32x32x16_bf16 a[48:63], a[16:19], v[144:147], a[48:63]
  ds_read_b64_tr_b16 a[12:13], v3 offset:15872
  ds_read_b64_tr_b16 a[14:15], v3 offset:16896
  s_cmp_eq_u32 s6, 0
  s_cselect_b32 s100, 128, 0
  v_cmp_gt_u32 vcc, s100, v11
  s_nop 4
  s_cmp_lg_u64 vcc, 0
  s_cbranch_scc1 AT_SP0
AT_SP0_B:
  v_accvgpr_read_b32 v25, a135
  v_cvt_pk_bf16_f32 v24, v24, v25
  v_cndmask_b32 v107, v17, v24, s[44:45]
  v_cndmask_b32 v59, v24, v43, s[44:45]
  v_accvgpr_read_b32 v22, a136
  v_accvgpr_read_b32 v23, a137
  v_cvt_pk_bf16_f32 v22, v22, v23
  v_cndmask_b32 v108, v17, v22, s[44:45]
  v_cndmask_b32 v60, v22, v44, s[44:45]
  v_accvgpr_read_b32 v24, a138
  v_accvgpr_read_b32 v25, a139
  v_cvt_pk_bf16_f32 v24, v24, v25
AT_H4:
  s_cbranch_execz AT_H8
  v_cndmask_b32 v109, v17, v24, s[44:45]
  v_cndmask_b32 v61, v24, v45, s[44:45]
  v_accvgpr_read_b32 v22, a140
  v_accvgpr_read_b32 v23, a141
  v_cvt_pk_bf16_f32 v22, v22, v23
  v_cndmask_b32 v110, v17, v22, s[44:45]
  v_cndmask_b32 v62, v22, v46, s[44:45]
  v_accvgpr_read_b32 v24, a142
  v_accvgpr_read_b32 v25, a143
  v_cvt_pk_bf16_f32 v24, v24, v25
  v_cndmask_b32 v111, v17, v24, s[44:45]
  v_cndmask_b32 v63, v24, v47, s[44:45]
  v_mfma_f32_32x32x16_bf16 a[64:79], a[20:23], v[144:147], a[64:79]
  s_waitcnt vmcnt(3)
  s_barrier
  ds_read_b64_tr_b16 a[16:17], v1 offset:28672
  ds_read_b64_tr_b16 a[18:19], v1 offset:29696
  v_exp_f32 v18, v64 clamp
  v_exp_f32 v19, v65 clamp
  s_add_u32 m0, s40, 33792
  v_mfma_f32_32x32x16_bf16 a[192:207], v[32:35], v[104:107], 0
  buffer_load_dwordx4 v8, s[12:15], s65 offen  lds
  v_max_f32 v64, s43, v64
  v_max_f32 v65, s43, v65
  v_fmac_f32 v18, s42, v64
  v_fmac_f32 v19, s42, v65
  v_cvt_pk_bf16_f32 v64, v18, v19
  v_exp_f32 v20, v66 clamp
  v_mfma_f32_32x32x16_bf16 a[192:207], v[36:39], v[108:111], a[192:207]
  v_exp_f32 v21, v67 clamp
  v_max_f32 v66, s43, v66
  v_max_f32 v67, s43, v67
  v_fmac_f32 v20, s42, v66
  v_fmac_f32 v21, s42, v67
  v_cvt_pk_bf16_f32 v65, v20, v21
  v_exp_f32 v18, v68 clamp
  v_mfma_f32_32x32x16_bf16 a[208:223], v[32:35], v[56:59], 0
  v_exp_f32 v19, v69 clamp
  v_max_f32 v68, s43, v68
  v_max_f32 v69, s43, v69
  v_fmac_f32 v18, s42, v68
  v_fmac_f32 v19, s42, v69
  v_cvt_pk_bf16_f32 v66, v18, v19
  s_add_u32 m0, s40, 34816
  v_mfma_f32_32x32x16_bf16 a[208:223], v[36:39], v[60:63], a[208:223]
  buffer_load_dwordx4 v8, s[12:15], s66 offen  lds
  v_exp_f32 v20, v70 clamp
  v_exp_f32 v21, v71 clamp
  v_max_f32 v70, s43, v70
  v_max_f32 v71, s43, v71
  v_fmac_f32 v20, s42, v70
  v_fmac_f32 v21, s42, v71
  v_mfma_f32_32x32x16_bf16 a[224:239], v[96:99], v[56:59], 0
  ds_write_b128 v16, a[192:195] offset:2048
  v_cvt_pk_bf16_f32 v67, v20, v21
  v_exp_f32 v18, v72 clamp
  v_exp_f32 v19, v73 clamp
  v_max_f32 v72, s43, v72
  v_max_f32 v73, s43, v73
  v_fmac_f32 v18, s42, v72
  v_mfma_f32_32x32x16_bf16 a[224:239], v[100:103], v[60:63], a[224:239]
  v_accvgpr_read_b32 v22, a144
  v_accvgpr_read_b32 v23, a145
  v_cvt_pk_bf16_f32 v22, v22, v23
  v_cndmask_b32 v104, v17, v22, s[44:45]
  v_cndmask_b32 v56, v22, v40, s[44:45]
  v_accvgpr_read_b32 v24, a146
  s_add_u32 m0, s40, 35840
  s_waitcnt lgkmcnt(9)
  v_mfma_f32_32x32x16_bf16 a[48:63], a[24:27], v[148:151], a[48:63]
  buffer_load_dwordx4 v8, s[12:15], s67 offen  lds
  ds_read_b64_tr_b16 a[20:21], v1 offset:29184
  ds_read_b64_tr_b16 a[22:23], v1 offset:30208
  ds_write_b128 v16, a[196:199] offset:3072
  v_accvgpr_read_b32 v25, a147
  v_cvt_pk_bf16_f32 v24, v24, v25
  v_cndmask_b32 v105, v17, v24, s[44:45]
  v_fmac_f32 v19, s42, v73
  v_mfma_f32_32x32x16_bf16 a[64:79], a[28:31], v[148:151], a[64:79]
  ds_read_b64_tr_b16 a[24:25], v2 offset:3072
  ds_read_b64_tr_b16 a[26:27], v2 offset:4096
  v_cndmask_b32 v57, v24, v41, s[44:45]
  v_accvgpr_read_b32 v22, a148
  v_accvgpr_read_b32 v23, a149
  v_cvt_pk_bf16_f32 v22, v22, v23
  v_cndmask_b32 v106, v17, v22, s[44:45]
  v_mfma_f32_32x32x16_bf16 a[48:63], a[0:3], v[152:155], a[48:63]
  ds_read_b64_tr_b16 a[28:29], v2 offset:3584
  ds_read_b64_tr_b16 a[30:31], v2 offset:4608
  ds_write_b128 v16, a[216:219] offset:4096
  v_cndmask_b32 v58, v22, v42, s[44:45]
  v_accvgpr_read_b32 v24, a150
  v_accvgpr_read_b32 v25, a151
  s_add_u32 m0, s40, 36720
  s_waitcnt lgkmcnt(11)
  v_mfma_f32_32x32x16_bf16 a[64:79], a[4:7], v[152:155], a[64:79]
  buffer_load_dwordx4 v8, s[12:15], s50 offen offset:144  lds
  ds_read_b64_tr_b16 a[0:1], v2 offset:43008
  ds_read_b64_tr_b16 a[2:3], v2 offset:44032
  v_cvt_pk_bf16_f32 v24, v24, v25
  v_cndmask_b32 v107, v17, v24, s[44:45]
  v_cndmask_b32 v59, v24, v43, s[44:45]
  v_accvgpr_read_b32 v22, a152
  v_mfma_f32_32x32x16_bf16 a[48:63], a[8:11], v[156:159], a[48:63]
  ds_read_b64_tr_b16 a[4:5], v2 offset:43520
  ds_read_b64_tr_b16 a[6:7], v2 offset:44544
  ds_write_b128 v16, a[220:223] offset:5120
  v_accvgpr_read_b32 v23, a153
  v_cvt_pk_bf16_f32 v22, v22, v23
  v_cndmask_b32 v108, v17, v22, s[44:45]
  v_cndmask_b32 v60, v22, v44, s[44:45]
  v_mfma_f32_32x32x16_bf16 a[64:79], a[12:15], v[156:159], a[64:79]
  ds_read_b64_tr_b16 a[8:9], v3 offset:17408
  ds_read_b64_tr_b16 a[10:11], v3 offset:18432
  v_accvgpr_read_b32 v24, a154
  v_accvgpr_read_b32 v25, a155
  v_cvt_pk_bf16_f32 v24, v24, v25
  v_cndmask_b32 v109, v17, v24, s[44:45]
  s_add_u32 m0, s40, 37888
  s_waitcnt lgkmcnt(10)
  v_mfma_f32_32x32x16_bf16 a[48:63], a[16:19], v[160:163], a[48:63]
  buffer_load_dwordx4 v10, s[12:15], s50 offen  lds
  ds_read_b64_tr_b16 a[12:13], v3 offset:17920
  ds_read_b64_tr_b16 a[14:15], v3 offset:18944
  ds_write_b64 v26, a[200:201] offset:4096
  ds_write_b128 v26, a[232:235] offset:0
  v_cndmask_b32 v61, v24, v45, s[44:45]
  v_accvgpr_read_b32 v22, a156
  v_mfma_f32_32x32x16_bf16 a[64:79], a[20:23], v[160:163], a[64:79]
  ds_read_b64_tr_b16 a[16:17], v1 offset:30720
  ds_read_b64_tr_b16 a[18:19], v1 offset:31744
  v_accvgpr_read_b32 v23, a157
  v_cvt_pk_bf16_f32 v22, v22, v23
  v_cndmask_b32 v110, v17, v22, s[44:45]
  v_cndmask_b32 v62, v22, v46, s[44:45]
  v_accvgpr_read_b32 v24, a158
  v_mfma_f32_32x32x16_bf16 a[48:63], a[24:27], v[164:167], a[48:63]
  ds_read_b64_tr_b16 a[20:21], v1 offset:31232
  ds_read_b64_tr_b16 a[22:23], v1 offset:32256
  v_accvgpr_read_b32 v25, a159
  v_cvt_pk_bf16_f32 v24, v24, v25
  v_cndmask_b32 v111, v17, v24, s[44:45]
  v_cndmask_b32 v63, v24, v47, s[44:45]
  s_add_u32 m0, s40, 38768
  s_waitcnt lgkmcnt(11)
  v_mfma_f32_32x32x16_bf16 a[64:79], a[28:31], v[164:167], a[64:79]
  buffer_load_dwordx4 v8, s[12:15], s51 offen offset:144  lds
  ds_read_b64_tr_b16 a[24:25], v2 offset:5120
  ds_read_b64_tr_b16 a[26:27], v2 offset:6144
  v_cvt_pk_bf16_f32 v68, v18, v19
  v_exp_f32 v20, v74 clamp
  v_exp_f32 v21, v75 clamp
  v_mfma_f32_32x32x16_bf16 a[80:95], v[48:51], v[104:107], 0
  v_max_f32 v74, s43, v74
  v_max_f32 v75, s43, v75
  v_fmac_f32 v20, s42, v74
  v_fmac_f32 v21, s42, v75
  v_cvt_pk_bf16_f32 v69, v20, v21
  v_exp_f32 v18, v76 clamp
  v_exp_f32 v19, v77 clamp
  v_mfma_f32_32x32x16_bf16 a[80:95], v[52:55], v[108:111], a[80:95]
  v_max_f32 v76, s43, v76
  v_max_f32 v77, s43, v77
  v_fmac_f32 v18, s42, v76
  v_fmac_f32 v19, s42, v77
  v_cvt_pk_bf16_f32 v70, v18, v19
  v_exp_f32 v20, v78 clamp
  s_add_u32 m0, s40, 18288
  v_mfma_f32_32x32x16_bf16 a[96:111], v[48:51], v[56:59], 0
  buffer_load_dwordx4 v8, s[12:15], s52 offen offset:144  lds
  v_exp_f32 v21, v79 clamp
  v_max_f32 v78, s43, v78
  v_max_f32 v79, s43, v79
  v_fmac_f32 v20, s42, v78
  v_fmac_f32 v21, s42, v79
  v_cvt_pk_bf16_f32 v71, v20, v21
  v_mfma_f32_32x32x16_bf16 a[96:111], v[52:55], v[60:63], a[96:111]
  v_exp_f32 v18, v80 clamp
  v_exp_f32 v19, v81 clamp
  v_max_f32 v80, s43, v80
  v_max_f32 v81, s43, v81
  v_fmac_f32 v18, s42, v80
  v_fmac_f32 v19, s42, v81
  v_cvt_pk_bf16_f32 v80, v18, v19
  v_mfma_f32_32x32x16_bf16 a[112:127], v[96:99], v[56:59], 0
  ds_write_b128 v16, a[80:83] offset:6144
  v_exp_f32 v20, v82 clamp
  v_exp_f32 v21, v83 clamp
  v_max_f32 v82, s43, v82
  v_max_f32 v83, s43, v83
  v_fmac_f32 v20, s42, v82
  s_add_u32 m0, s40, 19456
  v_mfma_f32_32x32x16_bf16 a[112:127], v[100:103], v[60:63], a[112:127]
  buffer_load_dwordx4 v10, s[12:15], s52 offen  lds
  v_accvgpr_read_b32 v22, a160
  v_accvgpr_read_b32 v23, a161
  v_cvt_pk_bf16_f32 v22, v22, v23
  v_cndmask_b32 v104, v17, v22, s[44:45]
  v_cndmask_b32 v56, v22, v40, s[44:45]
  v_accvgpr_read_b32 v24, a162
  v_fmac_f32 v21, s42, v83
  v_mfma_f32_32x32x16_bf16 a[48:63], a[0:3], v[168:171], a[48:63]
  ds_read_b64_tr_b16 a[28:29], v2 offset:5632
  ds_read_b64_tr_b16 a[30:31], v2 offset:6656
  ds_write_b128 v16, a[84:87] offset:7168
  v_accvgpr_read_b32 v25, a163
  v_cvt_pk_bf16_f32 v24, v24, v25
  v_cndmask_b32 v105, v17, v24, s[44:45]
  v_cndmask_b32 v57, v24, v41, s[44:45]
  v_mfma_f32_32x32x16_bf16 a[64:79], a[4:7], v[168:171], a[64:79]
  ds_read_b64_tr_b16 a[0:1], v2 offset:45056
  ds_read_b64_tr_b16 a[2:3], v2 offset:46080
  v_accvgpr_read_b32 v22, a164
  v_accvgpr_read_b32 v23, a165
  v_cvt_pk_bf16_f32 v22, v22, v23
  v_cndmask_b32 v106, v17, v22, s[44:45]
  s_add_u32 m0, s40, 20336
  s_waitcnt lgkmcnt(10)
  v_mfma_f32_32x32x16_bf16 a[48:63], a[8:11], v[172:175], a[48:63]
  buffer_load_dwordx4 v8, s[12:15], s53 offen offset:144  lds
  ds_read_b64_tr_b16 a[4:5], v2 offset:45568
  ds_read_b64_tr_b16 a[6:7], v2 offset:46592
  ds_write_b128 v16, a[104:107] offset:8192
  v_cndmask_b32 v58, v22, v42, s[44:45]
  v_accvgpr_read_b32 v24, a166
  v_accvgpr_read_b32 v25, a167
  v_mfma_f32_32x32x16_bf16 a[64:79], a[12:15], v[172:175], a[64:79]
  ds_read_b64_tr_b16 a[8:9], v3 offset:19456
  ds_read_b64_tr_b16 a[10:11], v3 offset:20480
  v_cvt_pk_bf16_f32 v24, v24, v25
  v_cndmask_b32 v107, v17, v24, s[44:45]
  v_cndmask_b32 v59, v24, v43, s[44:45]
  v_accvgpr_read_b32 v22, a168
  v_accvgpr_read_b32 v23, a169
  v_mfma_f32_32x32x16_bf16 a[48:63], a[16:19], v[176:179], a[48:63]
  ds_read_b64_tr_b16 a[12:13], v3 offset:19968
  ds_read_b64_tr_b16 a[14:15], v3 offset:20992
  ds_write_b128 v16, a[108:111] offset:9216
  v_cvt_pk_bf16_f32 v22, v22, v23
  v_cndmask_b32 v108, v17, v22, s[44:45]
  v_cndmask_b32 v60, v22, v44, s[44:45]
  s_add_u32 m0, s40, 21360
  s_waitcnt lgkmcnt(11)
  v_mfma_f32_32x32x16_bf16 a[64:79], a[20:23], v[176:179], a[64:79]
  buffer_load_dwordx4 v8, s[12:15], s54 offen offset:144  lds
  ds_read_b64_tr_b16 a[16:17], v1 offset:32768
  ds_read_b64_tr_b16 a[18:19], v1 offset:33792
  v_accvgpr_read_b32 v24, a170
  v_accvgpr_read_b32 v25, a171
  v_cvt_pk_bf16_f32 v24, v24, v25
  v_cndmask_b32 v109, v17, v24, s[44:45]
  v_mfma_f32_32x32x16_bf16 a[48:63], a[24:27], v[180:183], a[48:63]
  ds_read_b64_tr_b16 a[20:21], v1 offset:33280
  ds_read_b64_tr_b16 a[22:23], v1 offset:34304
  ds_write_b64 v26, a[88:89] offset:8192
  ds_write_b128 v27, a[120:123] offset:0
  v_cndmask_b32 v61, v24, v45, s[44:45]
  v_accvgpr_read_b32 v22, a172
  v_accvgpr_read_b32 v23, a173
  v_mfma_f32_32x32x16_bf16 a[64:79], a[28:31], v[180:183], a[64:79]
  ds_read_b64_tr_b16 a[24:25], v2 offset:7168
  ds_read_b64_tr_b16 a[26:27], v2 offset:8192
  v_cvt_pk_bf16_f32 v22, v22, v23
  v_cndmask_b32 v110, v17, v22, s[44:45]
  v_cndmask_b32 v62, v22, v46, s[44:45]
  v_accvgpr_read_b32 v24, a174
  v_accvgpr_read_b32 v25, a175
  s_waitcnt lgkmcnt(11)
  v_mfma_f32_32x32x16_bf16 a[48:63], a[0:3], v[184:187], a[48:63]
  ds_read_b64_tr_b16 a[28:29], v2 offset:7680
  ds_read_b64_tr_b16 a[30:31], v2 offset:8704
  v_cvt_pk_bf16_f32 v24, v24, v25
  v_cndmask_b32 v111, v17, v24, s[44:45]
  v_cndmask_b32 v63, v24, v47, s[44:45]
  v_cvt_pk_bf16_f32 v81, v20, v21
  v_exp_f32 v18, v84 clamp
  v_mfma_f32_32x32x16_bf16 a[64:79], a[4:7], v[184:187], a[64:79]
  ds_read_b64_tr_b16 a[0:1], v2 offset:47104
  ds_read_b64_tr_b16 a[2:3], v2 offset:48128
  v_exp_f32 v19, v85 clamp
  v_max_f32 v84, s43, v84
  v_max_f32 v85, s43, v85
  v_fmac_f32 v18, s42, v84
  v_fmac_f32 v19, s42, v85
  v_cvt_pk_bf16_f32 v82, v18, v19
  v_mfma_f32_32x32x16_bf16 a[48:63], a[8:11], v[188:191], a[48:63]
  ds_read_b64_tr_b16 a[4:5], v2 offset:47616
  ds_read_b64_tr_b16 a[6:7], v2 offset:48640
  v_exp_f32 v20, v86 clamp
  v_exp_f32 v21, v87 clamp
  v_max_f32 v86, s43, v86
  v_max_f32 v87, s43, v87
  s_waitcnt lgkmcnt(10)
  v_mfma_f32_32x32x16_bf16 a[64:79], a[12:15], v[188:191], a[64:79]
  ds_read_b64_tr_b16 a[8:9], v3 offset:21504
  ds_read_b64_tr_b16 a[10:11], v3 offset:22528
  v_fmac_f32 v20, s42, v86
  v_fmac_f32 v21, s42, v87
  v_cvt_pk_bf16_f32 v83, v20, v21
  v_exp_f32 v18, v88 clamp
  v_exp_f32 v19, v89 clamp
  v_mfma_f32_32x32x16_bf16 a[192:207], v[64:67], v[104:107], 0
  v_max_f32 v88, s43, v88
  v_max_f32 v89, s43, v89
  v_fmac_f32 v18, s42, v88
  v_fmac_f32 v19, s42, v89
  v_cvt_pk_bf16_f32 v84, v18, v19
  v_exp_f32 v20, v90 clamp
  v_exp_f32 v21, v91 clamp
  v_mfma_f32_32x32x16_bf16 a[192:207], v[68:71], v[108:111], a[192:207]
  v_max_f32 v90, s43, v90
  v_max_f32 v91, s43, v91
  v_fmac_f32 v20, s42, v90
  v_fmac_f32 v21, s42, v91
  v_cvt_pk_bf16_f32 v85, v20, v21
  v_exp_f32 v18, v92 clamp
  v_exp_f32 v19, v93 clamp
  v_mfma_f32_32x32x16_bf16 a[208:223], v[64:67], v[56:59], 0
  v_max_f32 v92, s43, v92
  v_max_f32 v93, s43, v93
  v_fmac_f32 v18, s42, v92
  v_fmac_f32 v19, s42, v93
  v_cvt_pk_bf16_f32 v86, v18, v19
  v_exp_f32 v20, v94 clamp
  v_exp_f32 v21, v95 clamp
  v_mfma_f32_32x32x16_bf16 a[208:223], v[68:71], v[60:63], a[208:223]
  v_max_f32 v94, s43, v94
  v_max_f32 v95, s43, v95
  v_fmac_f32 v20, s42, v94
  v_fmac_f32 v21, s42, v95
  v_cvt_pk_bf16_f32 v87, v20, v21
  v_mfma_f32_32x32x16_bf16 a[224:239], v[96:99], v[56:59], 0
  ds_write_b128 v16, a[192:195] offset:10240
  v_mfma_f32_32x32x16_bf16 a[224:239], v[100:103], v[60:63], a[224:239]
  v_accvgpr_read_b32 v22, a176
  v_accvgpr_read_b32 v23, a177
  v_cvt_pk_bf16_f32 v22, v22, v23
  v_cndmask_b32 v104, v17, v22, s[44:45]
  v_cndmask_b32 v56, v22, v40, s[44:45]
  v_accvgpr_read_b32 v24, a178
  v_accvgpr_read_b32 v25, a179
  v_mfma_f32_32x32x16_bf16 a[48:63], a[16:19], v[192:195], a[48:63]
  ds_read_b64_tr_b16 a[12:13], v3 offset:22016
  ds_read_b64_tr_b16 a[14:15], v3 offset:23040
  ds_write_b128 v16, a[196:199] offset:11264
  v_cvt_pk_bf16_f32 v24, v24, v25
  v_cndmask_b32 v105, v17, v24, s[44:45]
  v_cndmask_b32 v57, v24, v41, s[44:45]
  v_accvgpr_read_b32 v22, a180
  v_mfma_f32_32x32x16_bf16 a[64:79], a[20:23], v[192:195], a[64:79]
  s_waitcnt vmcnt(7)
  s_barrier
  ds_read_b64_tr_b16 a[16:17], v1 offset:34816
  ds_read_b64_tr_b16 a[18:19], v1 offset:35840
  v_accvgpr_read_b32 v23, a181
  v_cvt_pk_bf16_f32 v22, v22, v23
  s_add_u32 m0, s40, 22528
  s_waitcnt lgkmcnt(10)
  v_mfma_f32_32x32x16_bf16 a[48:63], a[24:27], v[196:199], a[48:63]
  buffer_load_dwordx4 v10, s[12:15], s54 offen  lds
  ds_read_b64_tr_b16 a[20:21], v1 offset:35328
  ds_read_b64_tr_b16 a[22:23], v1 offset:36352
  ds_write_b128 v16, a[216:219] offset:12288
  v_cndmask_b32 v106, v17, v22, s[44:45]
  v_cndmask_b32 v58, v22, v42, s[44:45]
  v_accvgpr_read_b32 v24, a182
  v_mfma_f32_32x32x16_bf16 a[64:79], a[28:31], v[196:199], a[64:79]
  ds_read_b64_tr_b16 a[24:25], v2 offset:9216
  ds_read_b64_tr_b16 a[26:27], v2 offset:10240
  v_accvgpr_read_b32 v25, a183
  v_cvt_pk_bf16_f32 v24, v24, v25
  v_cndmask_b32 v107, v17, v24, s[44:45]
  v_cndmask_b32 v59, v24, v43, s[44:45]
  v_accvgpr_read_b32 v22, a184
  v_mfma_f32_32x32x16_bf16 a[48:63], a[0:3], v[200:203], a[48:63]
  ds_read_b64_tr_b16 a[28:29], v2 offset:9728
  ds_read_b64_tr_b16 a[30:31], v2 offset:10752
  ds_write_b128 v16, a[220:223] offset:13312
  v_accvgpr_read_b32 v23, a185
  v_cvt_pk_bf16_f32 v22, v22, v23
  v_cndmask_b32 v108, v17, v22, s[44:45]
  s_add_u32 m0, s40, 23408
  s_waitcnt lgkmcnt(11)
  v_mfma_f32_32x32x16_bf16 a[64:79], a[4:7], v[200:203], a[64:79]
  buffer_load_dwordx4 v8, s[12:15], s55 offen offset:144  lds
  ds_read_b64_tr_b16 a[0:1], v2 offset:49152
  ds_read_b64_tr_b16 a[2:3], v2 offset:50176
  v_cndmask_b32 v60, v22, v44, s[44:45]
  v_accvgpr_read_b32 v24, a186
  v_accvgpr_read_b32 v25, a187
  v_cvt_pk_bf16_f32 v24, v24, v25
  v_mfma_f32_32x32x16_bf16 a[48:63], a[8:11], v[204:207], a[48:63]
  ds_read_b64_tr_b16 a[4:5], v2 offset:49664
  ds_read_b64_tr_b16 a[6:7], v2 offset:50688
  ds_write_b64 v26, a[200:201] offset:12288
  ds_write_b128 v26, a[236:239] offset:1024
  v_cndmask_b32 v109, v17, v24, s[44:45]
  v_cndmask_b32 v61, v24, v45, s[44:45]
  v_accvgpr_read_b32 v22, a188
  v_mfma_f32_32x32x16_bf16 a[64:79], a[12:15], v[204:207], a[64:79]
  ds_read_b64_tr_b16 a[8:9], v3 offset:23552
  ds_read_b64_tr_b16 a[10:11], v3 offset:24576
  v_accvgpr_read_b32 v23, a189
  v_cvt_pk_bf16_f32 v22, v22, v23
  v_cndmask_b32 v110, v17, v22, s[44:45]
  v_cndmask_b32 v62, v22, v46, s[44:45]
  s_add_u32 m0, s40, 24432
  s_waitcnt lgkmcnt(11)
  v_mfma_f32_32x32x16_bf16 a[48:63], a[16:19], v[208:211], a[48:63]
  buffer_load_dwordx4 v8, s[12:15], s56 offen offset:144  lds
  ds_read_b64_tr_b16 a[12:13], v3 offset:24064
  ds_read_b64_tr_b16 a[14:15], v3 offset:25088
  v_accvgpr_read_b32 v24, a190
  v_accvgpr_read_b32 v25, a191
  v_cvt_pk_bf16_f32 v24, v24, v25
  v_cndmask_b32 v111, v17, v24, s[44:45]
  v_cndmask_b32 v63, v24, v47, s[44:45]
  v_mfma_f32_32x32x16_bf16 a[64:79], a[20:23], v[208:211], a[64:79]
  ds_read_b64_tr_b16 a[16:17], v1 offset:36864
  ds_read_b64_tr_b16 a[18:19], v1 offset:37888
  v_mov_b32 v17, 0x3fb8aa3b
  v_mov_b32 v5, s43
  v_mfma_f32_32x32x16_bf16 a[80:95], v[80:83], v[104:107], 0
  s_add_u32 m0, s40, 25600
  v_mfma_f32_32x32x16_bf16 a[80:95], v[84:87], v[108:111], a[80:95]
  buffer_load_dwordx4 v10, s[12:15], s56 offen  lds
  v_mfma_f32_32x32x16_bf16 a[96:111], v[80:83], v[56:59], 0
  v_mfma_f32_32x32x16_bf16 a[96:111], v[84:87], v[60:63], a[96:111]
  s_add_u32 m0, s40, 26480
  v_mfma_f32_32x32x16_bf16 a[112:127], v[96:99], v[56:59], 0
  buffer_load_dwordx4 v8, s[12:15], s57 offen offset:144  lds
  s_nop 5
  ds_write_b128 v16, a[80:83] offset:14336
  v_mfma_f32_32x32x16_bf16 a[112:127], v[100:103], v[60:63], a[112:127]
  v_mfma_f32_32x32x16_bf16 a[48:63], a[24:27], v[212:215], a[48:63]
  ds_read_b64_tr_b16 a[20:21], v1 offset:37376
  ds_read_b64_tr_b16 a[22:23], v1 offset:38400
  ds_write_b128 v16, a[84:87] offset:15360
  s_add_u32 m0, s40, 27504
  s_waitcnt lgkmcnt(12)
  v_mfma_f32_32x32x16_bf16 a[64:79], a[28:31], v[212:215], a[64:79]
  buffer_load_dwordx4 v8, s[12:15], s58 offen offset:144  lds
  ds_read_b64_tr_b16 a[24:25], v2 offset:11264
  ds_read_b64_tr_b16 a[26:27], v2 offset:12288
  v_mfma_f32_32x32x16_bf16 a[48:63], a[0:3], v[216:219], a[48:63]
  ds_read_b64_tr_b16 a[28:29], v2 offset:11776
  ds_read_b64_tr_b16 a[30:31], v2 offset:12800
  ds_write_b128 v16, a[104:107] offset:16384
  v_mfma_f32_32x32x16_bf16 a[64:79], a[4:7], v[216:219], a[64:79]
  ds_read_b64_tr_b16 a[0:1], v2 offset:51200
  ds_read_b64_tr_b16 a[2:3], v2 offset:52224
  s_waitcnt lgkmcnt(11)
  v_mfma_f32_32x32x16_bf16 a[48:63], a[8:11], v[220:223], a[48:63]
  ds_read_b64_tr_b16 a[4:5], v2 offset:51712
  ds_read_b64_tr_b16 a[6:7], v2 offset:52736
  ds_write_b128 v16, a[108:111] offset:17408
  v_mfma_f32_32x32x16_bf16 a[64:79], a[12:15], v[220:223], a[64:79]
  ds_read_b64_tr_b16 a[8:9], v3 offset:25600
  ds_read_b64_tr_b16 a[10:11], v3 offset:26624
  v_mfma_f32_32x32x16_bf16 a[48:63], a[16:19], v[224:227], a[48:63]
  ds_read_b64_tr_b16 a[12:13], v3 offset:26112
  ds_read_b64_tr_b16 a[14:15], v3 offset:27136
  ds_write_b64 v26, a[88:89] offset:16384
  ds_write_b128 v27, a[124:127] offset:1024
  s_waitcnt lgkmcnt(12)
  v_mfma_f32_32x32x16_bf16 a[64:79], a[20:23], v[224:227], a[64:79]
  ds_read_b64_tr_b16 a[16:17], v1 offset:38912
  ds_read_b64_tr_b16 a[18:19], v1 offset:39936
  v_mfma_f32_32x32x16_bf16 a[48:63], a[24:27], v[228:231], a[48:63]
  ds_read_b64_tr_b16 a[20:21], v1 offset:39424
  ds_read_b64_tr_b16 a[22:23], v1 offset:40448
  v_mfma_f32_32x32x16_bf16 a[64:79], a[28:31], v[228:231], a[64:79]
  ds_read_b64_tr_b16 a[24:25], v2 offset:13312
  ds_read_b64_tr_b16 a[26:27], v2 offset:14336
  s_waitcnt lgkmcnt(6)
  s_barrier
  ds_read_b128 v[72:75], v28 offset:6144
  ds_read_b128 v[76:79], v28 offset:46080
  ds_read_b128 v[88:91], v29 offset:6144
  s_add_u32 m0, s40, 28672
  v_mfma_f32_32x32x16_bf16 a[48:63], a[0:3], v[232:235], a[48:63]
  buffer_load_dwordx4 v10, s[12:15], s58 offen  lds
  ds_read_b64_tr_b16 a[28:29], v2 offset:13824
  ds_read_b64_tr_b16 a[30:31], v2 offset:14848
  ds_read_b128 v[92:95], v29 offset:46080
  ds_read_b128 v[64:67], v28 offset:10240
  ds_read_b128 v[68:71], v28 offset:50176
  ds_read_b128 v[80:83], v29 offset:10240
  v_mfma_f32_32x32x16_bf16 a[64:79], a[4:7], v[232:235], a[64:79]
  ds_read_b64_tr_b16 a[0:1], v2 offset:53248
  ds_read_b64_tr_b16 a[2:3], v2 offset:54272
  ds_read_b128 v[84:87], v29 offset:50176
  s_and_b32 s46, s6, 1
  s_lshl_b32 s46, s46, 10
  v_add_u32 v26, s46, v4
  v_add_u32 v27, 79872, v26
  v_mfma_f32_32x32x16_bf16 a[48:63], a[8:11], v[236:239], a[48:63]
  ds_read_b64_tr_b16 a[4:5], v2 offset:53760
  ds_read_b64_tr_b16 a[6:7], v2 offset:54784
  s_add_u32 m0, s40, 29552
  v_mfma_f32_32x32x16_bf16 a[64:79], a[12:15], v[236:239], a[64:79]
  buffer_load_dwordx4 v8, s[12:15], s59 offen offset:144  lds
  ds_read_b64_tr_b16 a[8:9], v3 offset:27648
  ds_read_b64_tr_b16 a[10:11], v3 offset:28672
  s_waitcnt lgkmcnt(14)
  v_add_f32 v72, v72, v76
  v_add_f32 v73, v73, v77
  v_add_f32 v74, v74, v78
  v_add_f32 v75, v75, v79
  s_waitcnt lgkmcnt(10)
  v_add_f32 v88, v88, v92
  v_mfma_f32_32x32x16_bf16 a[48:63], a[16:19], v[240:243], a[48:63]
  ds_read_b64_tr_b16 a[12:13], v3 offset:28160
  ds_read_b64_tr_b16 a[14:15], v3 offset:29184
  v_add_f32 v89, v89, v93
  v_add_f32 v90, v90, v94
  v_add_f32 v91, v91, v95
  v_add_f32 v72, v72, v88
  v_add_f32 v73, v73, v89
  v_add_f32 v74, v74, v90
  v_add_f32 v75, v75, v91
  v_mfma_f32_32x32x16_bf16 a[64:79], a[20:23], v[240:243], a[64:79]
  s_waitcnt vmcnt(9)
  s_barrier
  ds_read_b64_tr_b16 a[16:17], v1 offset:40960
  ds_read_b64_tr_b16 a[18:19], v1 offset:43008
  v_cvt_pk_bf16_f32 v76, v72, v73
  v_cvt_pk_bf16_f32 v77, v74, v75
  s_add_u32 m0, s40, 30576
  v_mfma_f32_32x32x16_bf16 a[48:63], a[24:27], v[244:247], a[48:63]
  buffer_load_dwordx4 v8, s[12:15], s60 offen offset:144  lds
  ds_read_b64_tr_b16 a[20:21], v1 offset:41472
  ds_read_b64_tr_b16 a[22:23], v1 offset:43520
  s_add_u32 s46, s88, 0
  buffer_store_dwordx2 v[76:77], v30, s[28:31], s46 offen sc1
  v_mfma_f32_32x32x16_bf16 a[64:79], a[28:31], v[244:247], a[64:79]
  ds_read_b64_tr_b16 a[24:25], v13 offset:41984
  ds_read_b64_tr_b16 a[26:27], v13 offset:42496
  ds_read_b128 v[72:75], v28 offset:14336
  ds_read_b128 v[76:79], v28 offset:54272
  ds_read_b128 v[88:91], v29 offset:14336
  ds_read_b128 v[92:95], v29 offset:54272
  s_waitcnt lgkmcnt(15)
  v_add_f32 v64, v64, v68
  v_mfma_f32_32x32x16_bf16 a[48:63], a[0:3], v[248:251], a[48:63]
  ds_read_b64_tr_b16 a[28:29], v2 offset:15360
  ds_read_b64_tr_b16 a[30:31], v2 offset:17408
  v_add_f32 v65, v65, v69
  v_add_f32 v66, v66, v70
  v_add_f32 v67, v67, v71
  v_add_f32 v80, v80, v84
  v_add_f32 v81, v81, v85
  s_add_u32 m0, s40, 31744
  s_waitcnt lgkmcnt(12)
  v_mfma_f32_32x32x16_bf16 a[64:79], a[4:7], v[248:251], a[64:79]
  buffer_load_dwordx4 v10, s[12:15], s60 offen  lds
  ds_read_b64_tr_b16 a[0:1], v2 offset:15872
  ds_read_b64_tr_b16 a[2:3], v2 offset:17920
  v_add_f32 v82, v82, v86
  v_add_f32 v83, v83, v87
  v_add_f32 v64, v64, v80
  v_add_f32 v65, v65, v81
  v_add_f32 v66, v66, v82
  v_add_f32 v67, v67, v83
  v_mfma_f32_32x32x16_bf16 a[48:63], a[8:11], v[252:255], a[48:63]
  ds_read_b64_tr_b16 a[4:5], v14 offset:16384
  ds_read_b64_tr_b16 a[6:7], v14 offset:16896
  v_cvt_pk_bf16_f32 v68, v64, v65
  v_cvt_pk_bf16_f32 v69, v66, v67
  s_add_u32 s46, s88, 32768
  buffer_store_dwordx2 v[68:69], v30, s[28:31], s46 offen sc1
  v_mfma_f32_32x32x16_bf16 a[64:79], a[12:15], v[252:255], a[64:79]
AT_H5:
  s_cbranch_execz AT_H9
  ds_read_b64_tr_b16 a[8:9], v2 offset:55296
  ds_read_b64_tr_b16 a[10:11], v2 offset:57344
  ds_read_b128 v[64:67], v28 offset:18432
  ds_read_b128 v[68:71], v28 offset:58368
  ds_read_b128 v[80:83], v29 offset:18432
  s_add_u32 m0, s40, 32624
  s_waitcnt lgkmcnt(15)
  v_mfma_f32_32x32x16_bf16 v[32:47], a[16:19], v[112:115], 0
  buffer_load_dwordx4 v8, s[12:15], s61 offen offset:144  lds
  ds_read_b64_tr_b16 a[12:13], v2 offset:55808
  ds_read_b64_tr_b16 a[14:15], v2 offset:57856
  ds_read_b128 v[84:87], v29 offset:58368
  s_waitcnt lgkmcnt(15)
  v_add_f32 v72, v72, v76
  v_add_f32 v73, v73, v77
  v_add_f32 v74, v74, v78
  v_add_f32 v75, v75, v79
  v_mfma_f32_32x32x16_bf16 v[48:63], a[20:23], v[112:115], 0
  ds_read_b64_tr_b16 a[16:17], v14 offset:56320
  ds_read_b64_tr_b16 a[18:19], v14 offset:56832
  s_waitcnt lgkmcnt(15)
  v_add_f32 v88, v88, v92
  v_add_f32 v89, v89, v93
  v_add_f32 v90, v90, v94
  v_add_f32 v91, v91, v95
  v_add_f32 v72, v72, v88
  v_add_f32 v73, v73, v89
  v_add_f32 v74, v74, v90
  v_mfma_f32_32x32x16_bf16 v[96:111], a[24:27], v[112:115], 0
  ds_read_b64_tr_b16 a[20:21], v3 offset:29696
  ds_read_b64_tr_b16 a[22:23], v3 offset:31744
  v_add_f32 v75, v75, v91
  s_add_u32 m0, s40, 33648
  s_waitcnt lgkmcnt(12)
  v_mfma_f32_32x32x16_bf16 v[32:47], a[28:31], v[116:119], v[32:47]
  buffer_load_dwordx4 v8, s[12:15], s62 offen offset:144  lds
  ds_read_b64_tr_b16 a[24:25], v3 offset:30208
  ds_read_b64_tr_b16 a[26:27], v3 offset:32256
  v_cvt_pk_bf16_f32 v76, v72, v73
  v_cvt_pk_bf16_f32 v77, v74, v75
  v_mfma_f32_32x32x16_bf16 v[48:63], a[0:3], v[116:119], v[48:63]
  ds_read_b64_tr_b16 a[28:29], v15 offset:30720
  ds_read_b64_tr_b16 a[30:31], v15 offset:31232
  s_add_u32 s46, s88, 65536
  buffer_store_dwordx2 v[76:77], v30, s[28:31], s46 offen sc1
  v_mfma_f32_32x32x16_bf16 v[96:111], a[4:7], v[116:119], v[96:111]
  ds_read_b64_tr_b16 a[0:1], v1 offset:22528
  ds_read_b64_tr_b16 a[2:3], v1 offset:24576
  ds_read_b128 v[72:75], v26 offset:4096
  s_waitcnt lgkmcnt(9)
  v_mfma_f32_32x32x16_bf16 v[32:47], a[8:11], v[120:123], v[32:47]
  ds_read_b64_tr_b16 a[4:5], v1 offset:23040
  ds_read_b64_tr_b16 a[6:7], v1 offset:25088
  ds_read_b128 v[76:79], v26 offset:44032
  ds_read_b128 v[88:91], v27 offset:4096
  ds_read_b128 v[92:95], v27 offset:44032
  v_mfma_f32_32x32x16_bf16 v[48:63], a[12:15], v[120:123], v[48:63]
  ds_read_b64_tr_b16 a[8:9], v13 offset:23552
  ds_read_b64_tr_b16 a[10:11], v13 offset:24064
  v_add_f32 v64, v64, v68
  v_add_f32 v65, v65, v69
  v_add_f32 v66, v66, v70
  v_add_f32 v67, v67, v71
  v_mfma_f32_32x32x16_bf16 v[96:111], a[16:19], v[120:123], v[96:111]
  ds_read_b64_tr_b16 a[12:13], v1 offset:62464
  ds_read_b64_tr_b16 a[14:15], v1 offset:64512
  v_add_f32 v80, v80, v84
  v_add_f32 v81, v81, v85
  v_add_f32 v82, v82, v86
  s_waitcnt lgkmcnt(12)
  v_mfma_f32_32x32x16_bf16 v[32:47], a[20:23], v[124:127], v[32:47]
  ds_read_b64_tr_b16 a[16:17], v1 offset:62976
  ds_read_b64_tr_b16 a[18:19], v1 offset:65024
  v_add_f32 v83, v83, v87
  v_add_f32 v64, v64, v80
  v_add_f32 v65, v65, v81
  v_add_f32 v66, v66, v82
  v_mfma_f32_32x32x16_bf16 v[48:63], a[24:27], v[124:127], v[48:63]
  ds_read_b64_tr_b16 a[20:21], v13 offset:63488
  ds_read_b64_tr_b16 a[22:23], v13 offset:64000
  v_add_f32 v67, v67, v83
  v_cvt_pk_bf16_f32 v68, v64, v65
  v_cvt_pk_bf16_f32 v69, v66, v67
  v_mfma_f32_32x32x16_bf16 v[96:111], a[28:31], v[124:127], v[96:111]
  ds_read_b64_tr_b16 a[24:25], v2 offset:36864
  ds_read_b64_tr_b16 a[26:27], v2 offset:38912
  s_waitcnt lgkmcnt(8)
  v_mfma_f32_32x32x16_bf16 v[32:47], a[0:3], v[128:131], v[32:47]
  ds_read_b64_tr_b16 a[28:29], v2 offset:37376
  ds_read_b64_tr_b16 a[30:31], v2 offset:39424
  s_add_u32 s46, s88, 98304
  buffer_store_dwordx2 v[68:69], v30, s[28:31], s46 offen sc1
  v_mfma_f32_32x32x16_bf16 v[48:63], a[4:7], v[128:131], v[48:63]
  ds_read_b64_tr_b16 a[0:1], v14 offset:37888
  ds_read_b64_tr_b16 a[2:3], v14 offset:38400
  v_add_f32 v72, v72, v76
  v_add_f32 v73, v73, v77
  v_add_f32 v74, v74, v78
  v_mfma_f32_32x32x16_bf16 v[96:111], a[8:11], v[128:131], v[96:111]
  ds_read_b64_tr_b16 a[4:5], v3 offset:11264
  ds_read_b64_tr_b16 a[6:7], v3 offset:13312
  v_add_f32 v75, v75, v79
  v_add_f32 v88, v88, v92
  v_add_f32 v89, v89, v93
  s_waitcnt lgkmcnt(8)
  v_mfma_f32_32x32x16_bf16 v[32:47], a[12:15], v[132:135], v[32:47]
  ds_read_b64_tr_b16 a[8:9], v3 offset:11776
  ds_read_b64_tr_b16 a[10:11], v3 offset:13824
  v_add_f32 v90, v90, v94
  v_add_f32 v91, v91, v95
  v_add_f32 v72, v72, v88
  v_add_f32 v73, v73, v89
  v_mfma_f32_32x32x16_bf16 v[48:63], a[16:19], v[132:135], v[48:63]
  ds_read_b64_tr_b16 a[12:13], v15 offset:12288
  ds_read_b64_tr_b16 a[14:15], v15 offset:12800
  v_add_f32 v74, v74, v90
  v_add_f32 v75, v75, v91
  v_cvt_pk_bf16_f32 v76, v72, v73
  v_mfma_f32_32x32x16_bf16 v[96:111], a[20:23], v[132:135], v[96:111]
  s_waitcnt vmcnt(11)
  s_barrier
  ds_read_b64_tr_b16 a[16:17], v1 offset:25600
  ds_read_b64_tr_b16 a[18:19], v1 offset:27648
  s_add_u32 m0, s40, 34816
  s_waitcnt lgkmcnt(8)
  v_mfma_f32_32x32x16_bf16 v[32:47], a[24:27], v[136:139], v[32:47]
  buffer_load_dwordx4 v10, s[12:15], s62 offen  lds
  ds_read_b64_tr_b16 a[20:21], v1 offset:26112
  ds_read_b64_tr_b16 a[22:23], v1 offset:28160
  v_cvt_pk_bf16_f32 v77, v74, v75
  v_mfma_f32_32x32x16_bf16 v[48:63], a[28:31], v[136:139], v[48:63]
  ds_read_b64_tr_b16 a[24:25], v13 offset:26624
  ds_read_b64_tr_b16 a[26:27], v13 offset:27136
  buffer_store_dwordx2 v[76:77], v30, s[28:31], s89 offen sc1
  v_mfma_f32_32x32x16_bf16 v[96:111], a[0:3], v[136:139], v[96:111]
  ds_read_b64_tr_b16 a[28:29], v2 offset:0
  ds_read_b64_tr_b16 a[30:31], v2 offset:2048
  v_accvgpr_read_b32 v22, a48
  s_add_u32 m0, s40, 35696
  s_waitcnt lgkmcnt(8)
  v_mfma_f32_32x32x16_bf16 v[32:47], a[4:7], v[140:143], v[32:47]
  buffer_load_dwordx4 v8, s[12:15], s63 offen offset:144  lds
  ds_read_b64_tr_b16 a[0:1], v2 offset:512
  ds_read_b64_tr_b16 a[2:3], v2 offset:2560
  v_accvgpr_read_b32 v23, a49
  v_mfma_f32_32x32x16_bf16 v[48:63], a[8:11], v[140:143], v[48:63]
  ds_read_b64_tr_b16 a[4:5], v14 offset:1024
  ds_read_b64_tr_b16 a[6:7], v14 offset:1536
  v_exp_f32 v18, v22 clamp
  v_exp_f32 v19, v23 clamp
  v_mfma_f32_32x32x16_bf16 v[96:111], a[12:15], v[140:143], v[96:111]
  ds_read_b64_tr_b16 a[8:9], v2 offset:39936
  ds_read_b64_tr_b16 a[10:11], v2 offset:41984
  v_max_f32 v22, s43, v22
  v_max_f32 v23, s43, v23
  s_add_u32 m0, s40, 36720
  s_waitcnt lgkmcnt(8)
  v_mfma_f32_32x32x16_bf16 v[32:47], a[16:19], v[144:147], v[32:47]
  buffer_load_dwordx4 v8, s[12:15], s64 offen offset:144  lds
  ds_read_b64_tr_b16 a[12:13], v2 offset:40448
  ds_read_b64_tr_b16 a[14:15], v2 offset:42496
  v_fmac_f32 v18, s42, v22
  v_fmac_f32 v19, s42, v23
  v_mfma_f32_32x32x16_bf16 v[48:63], a[20:23], v[144:147], v[48:63]
  ds_read_b64_tr_b16 a[16:17], v14 offset:40960
  ds_read_b64_tr_b16 a[18:19], v14 offset:41472
  v_cvt_pk_bf16_f32 v64, v18, v19
  v_accvgpr_read_b32 v24, a50
  v_accvgpr_read_b32 v25, a51
  v_mfma_f32_32x32x16_bf16 v[96:111], a[24:27], v[144:147], v[96:111]
  ds_read_b64_tr_b16 a[20:21], v3 offset:14336
  ds_read_b64_tr_b16 a[22:23], v3 offset:16384
  v_exp_f32 v20, v24 clamp
  s_add_u32 m0, s40, 37888
  s_waitcnt lgkmcnt(8)
  v_mfma_f32_32x32x16_bf16 v[32:47], a[28:31], v[148:151], v[32:47]
  buffer_load_dwordx4 v10, s[12:15], s64 offen  lds
  ds_read_b64_tr_b16 a[24:25], v3 offset:14848
  ds_read_b64_tr_b16 a[26:27], v3 offset:16896
  v_exp_f32 v21, v25 clamp
  v_max_f32 v24, s43, v24
  v_mfma_f32_32x32x16_bf16 v[48:63], a[0:3], v[148:151], v[48:63]
  ds_read_b64_tr_b16 a[28:29], v15 offset:15360
  ds_read_b64_tr_b16 a[30:31], v15 offset:15872
  v_max_f32 v25, s43, v25
  v_fmac_f32 v20, s42, v24
  v_fmac_f32 v21, s42, v25
  v_cvt_pk_bf16_f32 v65, v20, v21
  v_mfma_f32_32x32x16_bf16 v[96:111], a[4:7], v[148:151], v[96:111]
  ds_read_b64_tr_b16 a[0:1], v1 offset:28672
  ds_read_b64_tr_b16 a[2:3], v1 offset:30720
  v_accvgpr_read_b32 v22, a52
  s_add_u32 m0, s40, 38768
  s_waitcnt lgkmcnt(8)
  v_mfma_f32_32x32x16_bf16 v[32:47], a[8:11], v[152:155], v[32:47]
  buffer_load_dwordx4 v8, s[12:15], s65 offen offset:144  lds
  ds_read_b64_tr_b16 a[4:5], v1 offset:29184
  ds_read_b64_tr_b16 a[6:7], v1 offset:31232
  v_accvgpr_read_b32 v23, a53
  v_mfma_f32_32x32x16_bf16 v[48:63], a[12:15], v[152:155], v[48:63]
  ds_read_b64_tr_b16 a[8:9], v13 offset:29696
  ds_read_b64_tr_b16 a[10:11], v13 offset:30208
  v_exp_f32 v18, v22 clamp
  v_exp_f32 v19, v23 clamp
  v_mfma_f32_32x32x16_bf16 v[96:111], a[16:19], v[152:155], v[96:111]
  ds_read_b64_tr_b16 a[12:13], v2 offset:3072
  ds_read_b64_tr_b16 a[14:15], v2 offset:5120
  v_max_f32 v22, s43, v22
  v_max_f32 v23, s43, v23
  v_fmac_f32 v18, s42, v22
  s_waitcnt lgkmcnt(8)
  v_mfma_f32_32x32x16_bf16 v[32:47], a[20:23], v[156:159], v[32:47]
  ds_read_b64_tr_b16 a[16:17], v2 offset:3584
  ds_read_b64_tr_b16 a[18:19], v2 offset:5632
  v_fmac_f32 v19, s42, v23
  v_cvt_pk_bf16_f32 v66, v18, v19
  v_accvgpr_read_b32 v24, a54
  v_mfma_f32_32x32x16_bf16 v[48:63], a[24:27], v[156:159], v[48:63]
  ds_read_b64_tr_b16 a[20:21], v14 offset:4096
  ds_read_b64_tr_b16 a[22:23], v14 offset:4608
  v_accvgpr_read_b32 v25, a55
  v_exp_f32 v20, v24 clamp
  v_mfma_f32_32x32x16_bf16 v[96:111], a[28:31], v[156:159], v[96:111]
  ds_read_b64_tr_b16 a[24:25], v2 offset:43008
  ds_read_b64_tr_b16 a[26:27], v2 offset:45056
  v_exp_f32 v21, v25 clamp
  v_max_f32 v24, s43, v24
  s_waitcnt lgkmcnt(8)
  v_mfma_f32_32x32x16_bf16 v[32:47], a[0:3], v[160:163], v[32:47]
  ds_read_b64_tr_b16 a[28:29], v2 offset:43520
  ds_read_b64_tr_b16 a[30:31], v2 offset:45568
  v_max_f32 v25, s43, v25
  v_fmac_f32 v20, s42, v24
  v_fmac_f32 v21, s42, v25
  v_cvt_pk_bf16_f32 v67, v20, v21
  v_mfma_f32_32x32x16_bf16 v[48:63], a[4:7], v[160:163], v[48:63]
  ds_read_b64_tr_b16 a[0:1], v14 offset:44032
  ds_read_b64_tr_b16 a[2:3], v14 offset:44544
  v_accvgpr_read_b32 v22, a56
  v_accvgpr_read_b32 v23, a57
  v_mfma_f32_32x32x16_bf16 v[96:111], a[8:11], v[160:163], v[96:111]
  ds_read_b64_tr_b16 a[4:5], v3 offset:17408
  ds_read_b64_tr_b16 a[6:7], v3 offset:19456
  v_exp_f32 v18, v22 clamp
  s_waitcnt lgkmcnt(8)
  v_mfma_f32_32x32x16_bf16 v[32:47], a[12:15], v[164:167], v[32:47]
  ds_read_b64_tr_b16 a[8:9], v3 offset:17920
  ds_read_b64_tr_b16 a[10:11], v3 offset:19968
  v_exp_f32 v19, v23 clamp
  v_max_f32 v22, s43, v22
  v_max_f32 v23, s43, v23
  v_mfma_f32_32x32x16_bf16 v[48:63], a[16:19], v[164:167], v[48:63]
  ds_read_b64_tr_b16 a[12:13], v15 offset:18432
  ds_read_b64_tr_b16 a[14:15], v15 offset:18944
  v_fmac_f32 v18, s42, v22
  v_fmac_f32 v19, s42, v23
  v_cvt_pk_bf16_f32 v68, v18, v19
  v_mfma_f32_32x32x16_bf16 v[96:111], a[20:23], v[164:167], v[96:111]
  s_waitcnt vmcnt(9)
  s_barrier
  ds_read_b64_tr_b16 a[16:17], v1 offset:31744
  ds_read_b64_tr_b16 a[18:19], v1 offset:33792
  s_add_u32 m0, s40, 18288
  s_waitcnt lgkmcnt(8)
  v_mfma_f32_32x32x16_bf16 v[32:47], a[24:27], v[168:171], v[32:47]
  buffer_load_dwordx4 v8, s[12:15], s66 offen offset:144  lds
  ds_read_b64_tr_b16 a[20:21], v1 offset:32256
  ds_read_b64_tr_b16 a[22:23], v1 offset:34304
  v_accvgpr_read_b32 v24, a58
  v_accvgpr_read_b32 v25, a59
  v_mfma_f32_32x32x16_bf16 v[48:63], a[28:31], v[168:171], v[48:63]
  ds_read_b64_tr_b16 a[24:25], v13 offset:32768
  ds_read_b64_tr_b16 a[26:27], v13 offset:33280
  v_exp_f32 v20, v24 clamp
  v_exp_f32 v21, v25 clamp
  v_mfma_f32_32x32x16_bf16 v[96:111], a[0:3], v[168:171], v[96:111]
  ds_read_b64_tr_b16 a[28:29], v2 offset:6144
  ds_read_b64_tr_b16 a[30:31], v2 offset:8192
  v_max_f32 v24, s43, v24
  v_max_f32 v25, s43, v25
  s_add_u32 m0, s40, 19456
  s_waitcnt lgkmcnt(8)
  v_mfma_f32_32x32x16_bf16 v[32:47], a[4:7], v[172:175], v[32:47]
  buffer_load_dwordx4 v10, s[12:15], s66 offen  lds
  ds_read_b64_tr_b16 a[0:1], v2 offset:6656
  ds_read_b64_tr_b16 a[2:3], v2 offset:8704
  v_fmac_f32 v20, s42, v24
  v_fmac_f32 v21, s42, v25
  v_mfma_f32_32x32x16_bf16 v[48:63], a[8:11], v[172:175], v[48:63]
  ds_read_b64_tr_b16 a[4:5], v14 offset:7168
  ds_read_b64_tr_b16 a[6:7], v14 offset:7680
  v_cvt_pk_bf16_f32 v69, v20, v21
  v_accvgpr_read_b32 v22, a60
  v_accvgpr_read_b32 v23, a61
  v_mfma_f32_32x32x16_bf16 v[96:111], a[12:15], v[172:175], v[96:111]
  ds_read_b64_tr_b16 a[8:9], v2 offset:46080
  ds_read_b64_tr_b16 a[10:11], v2 offset:48128
  v_exp_f32 v18, v22 clamp
  s_add_u32 m0, s40, 20336
  s_waitcnt lgkmcnt(8)
  v_mfma_f32_32x32x16_bf16 v[32:47], a[16:19], v[176:179], v[32:47]
  buffer_load_dwordx4 v8, s[12:15], s67 offen offset:144  lds
  ds_read_b64_tr_b16 a[12:13], v2 offset:46592
  ds_read_b64_tr_b16 a[14:15], v2 offset:48640
  v_exp_f32 v19, v23 clamp
  v_max_f32 v22, s43, v22
  v_mfma_f32_32x32x16_bf16 v[48:63], a[20:23], v[176:179], v[48:63]
  ds_read_b64_tr_b16 a[16:17], v14 offset:47104
  ds_read_b64_tr_b16 a[18:19], v14 offset:47616
  v_max_f32 v23, s43, v23
  v_fmac_f32 v18, s42, v22
  v_fmac_f32 v19, s42, v23
  v_cvt_pk_bf16_f32 v70, v18, v19
  v_mfma_f32_32x32x16_bf16 v[96:111], a[24:27], v[176:179], v[96:111]
  ds_read_b64_tr_b16 a[20:21], v3 offset:20480
  ds_read_b64_tr_b16 a[22:23], v3 offset:22528
  v_accvgpr_read_b32 v24, a62
  v_accvgpr_read_b32 v25, a63
  s_waitcnt lgkmcnt(8)
  v_mfma_f32_32x32x16_bf16 v[32:47], a[28:31], v[180:183], v[32:47]
  ds_read_b64_tr_b16 a[24:25], v3 offset:20992
  ds_read_b64_tr_b16 a[26:27], v3 offset:23040
  v_exp_f32 v20, v24 clamp
  v_exp_f32 v21, v25 clamp
  v_mfma_f32_32x32x16_bf16 v[48:63], a[0:3], v[180:183], v[48:63]
  ds_read_b64_tr_b16 a[28:29], v15 offset:21504
  ds_read_b64_tr_b16 a[30:31], v15 offset:22016
  v_max_f32 v24, s43, v24
  v_max_f32 v25, s43, v25
  v_fmac_f32 v20, s42, v24
  v_fmac_f32 v21, s42, v25
  v_mfma_f32_32x32x16_bf16 v[96:111], a[4:7], v[180:183], v[96:111]
  ds_read_b64_tr_b16 a[0:1], v1 offset:34816
  ds_read_b64_tr_b16 a[2:3], v1 offset:36864
  v_cvt_pk_bf16_f32 v71, v20, v21
  v_accvgpr_read_b32 v22, a64
  s_waitcnt lgkmcnt(8)
  v_mfma_f32_32x32x16_bf16 v[32:47], a[8:11], v[184:187], v[32:47]
  ds_read_b64_tr_b16 a[4:5], v1 offset:35328
  ds_read_b64_tr_b16 a[6:7], v1 offset:37376
  v_accvgpr_read_b32 v23, a65
  v_exp_f32 v18, v22 clamp
  v_mfma_f32_32x32x16_bf16 v[48:63], a[12:15], v[184:187], v[48:63]
  ds_read_b64_tr_b16 a[8:9], v13 offset:35840
  ds_read_b64_tr_b16 a[10:11], v13 offset:36352
  v_exp_f32 v19, v23 clamp
  v_max_f32 v22, s43, v22
  v_max_f32 v23, s43, v23
  v_mfma_f32_32x32x16_bf16 v[96:111], a[16:19], v[184:187], v[96:111]
  ds_read_b64_tr_b16 a[12:13], v2 offset:9216
  ds_read_b64_tr_b16 a[14:15], v2 offset:11264
  v_fmac_f32 v18, s42, v22
  v_fmac_f32 v19, s42, v23
  v_cvt_pk_bf16_f32 v72, v18, v19
  s_waitcnt lgkmcnt(8)
  v_mfma_f32_32x32x16_bf16 v[32:47], a[20:23], v[188:191], v[32:47]
  ds_read_b64_tr_b16 a[16:17], v2 offset:9728
  ds_read_b64_tr_b16 a[18:19], v2 offset:11776
  v_accvgpr_read_b32 v24, a66
  v_accvgpr_read_b32 v25, a67
  v_mfma_f32_32x32x16_bf16 v[48:63], a[24:27], v[188:191], v[48:63]
  ds_read_b64_tr_b16 a[20:21], v14 offset:10240
  ds_read_b64_tr_b16 a[22:23], v14 offset:10752
  v_exp_f32 v20, v24 clamp
  v_exp_f32 v21, v25 clamp
  v_mfma_f32_32x32x16_bf16 v[96:111], a[28:31], v[188:191], v[96:111]
  ds_read_b64_tr_b16 a[24:25], v2 offset:49152
  ds_read_b64_tr_b16 a[26:27], v2 offset:51200
  v_max_f32 v24, s43, v24
  v_max_f32 v25, s43, v25
  v_fmac_f32 v20, s42, v24
  s_waitcnt lgkmcnt(8)
  v_mfma_f32_32x32x16_bf16 v[32:47], a[0:3], v[192:195], v[32:47]
  ds_read_b64_tr_b16 a[28:29], v2 offset:49664
  ds_read_b64_tr_b16 a[30:31], v2 offset:51712
  v_fmac_f32 v21, s42, v25
  v_cvt_pk_bf16_f32 v73, v20, v21
  v_accvgpr_read_b32 v22, a68
  v_mfma_f32_32x32x16_bf16 v[48:63], a[4:7], v[192:195], v[48:63]
  ds_read_b64_tr_b16 a[0:1], v14 offset:50176
  ds_read_b64_tr_b16 a[2:3], v14 offset:50688
  v_accvgpr_read_b32 v23, a69
  v_exp_f32 v18, v22 clamp
  v_mfma_f32_32x32x16_bf16 v[96:111], a[8:11], v[192:195], v[96:111]
  ds_read_b64_tr_b16 a[4:5], v3 offset:23552
  ds_read_b64_tr_b16 a[6:7], v3 offset:25600
  v_exp_f32 v19, v23 clamp
  v_max_f32 v22, s43, v22
  s_waitcnt lgkmcnt(8)
  v_mfma_f32_32x32x16_bf16 v[32:47], a[12:15], v[196:199], v[32:47]
  ds_read_b64_tr_b16 a[8:9], v3 offset:24064
  ds_read_b64_tr_b16 a[10:11], v3 offset:26112
  v_max_f32 v23, s43, v23
  v_fmac_f32 v18, s42, v22
  v_fmac_f32 v19, s42, v23
  v_cvt_pk_bf16_f32 v74, v18, v19
  v_mfma_f32_32x32x16_bf16 v[48:63], a[16:19], v[196:199], v[48:63]
  ds_read_b64_tr_b16 a[12:13], v15 offset:24576
  ds_read_b64_tr_b16 a[14:15], v15 offset:25088
  v_accvgpr_read_b32 v24, a70
  v_accvgpr_read_b32 v25, a71
  v_mfma_f32_32x32x16_bf16 v[96:111], a[20:23], v[196:199], v[96:111]
  s_waitcnt vmcnt(3)
  s_barrier
  ds_read_b64_tr_b16 a[16:17], v1 offset:37888
  ds_read_b64_tr_b16 a[18:19], v1 offset:39936
  s_waitcnt lgkmcnt(8)
  v_mfma_f32_32x32x16_bf16 v[32:47], a[24:27], v[200:203], v[32:47]
  ds_read_b64_tr_b16 a[20:21], v1 offset:38400
  ds_read_b64_tr_b16 a[22:23], v1 offset:40448
  v_exp_f32 v20, v24 clamp
  v_exp_f32 v21, v25 clamp
  v_mfma_f32_32x32x16_bf16 v[48:63], a[28:31], v[200:203], v[48:63]
  ds_read_b64_tr_b16 a[24:25], v13 offset:38912
  ds_read_b64_tr_b16 a[26:27], v13 offset:39424
  v_max_f32 v24, s43, v24
  v_max_f32 v25, s43, v25
  v_fmac_f32 v20, s42, v24
  v_fmac_f32 v21, s42, v25
  v_mfma_f32_32x32x16_bf16 v[96:111], a[0:3], v[200:203], v[96:111]
  ds_read_b64_tr_b16 a[28:29], v2 offset:12288
  ds_read_b64_tr_b16 a[30:31], v2 offset:14336
  v_cvt_pk_bf16_f32 v75, v20, v21
  v_accvgpr_read_b32 v22, a72
  s_waitcnt lgkmcnt(8)
  v_mfma_f32_32x32x16_bf16 v[32:47], a[4:7], v[204:207], v[32:47]
  ds_read_b64_tr_b16 a[0:1], v2 offset:12800
  ds_read_b64_tr_b16 a[2:3], v2 offset:14848
  v_accvgpr_read_b32 v23, a73
  v_exp_f32 v18, v22 clamp
  v_mfma_f32_32x32x16_bf16 v[48:63], a[8:11], v[204:207], v[48:63]
  ds_read_b64_tr_b16 a[4:5], v14 offset:13312
  ds_read_b64_tr_b16 a[6:7], v14 offset:13824
  v_exp_f32 v19, v23 clamp
  v_max_f32 v22, s43, v22
  v_max_f32 v23, s43, v23
  v_mfma_f32_32x32x16_bf16 v[96:111], a[12:15], v[204:207], v[96:111]
  ds_read_b64_tr_b16 a[8:9], v2 offset:52224
  ds_read_b64_tr_b16 a[10:11], v2 offset:54272
  v_fmac_f32 v18, s42, v22
  v_fmac_f32 v19, s42, v23
  v_cvt_pk_bf16_f32 v76, v18, v19
  s_waitcnt lgkmcnt(8)
  v_mfma_f32_32x32x16_bf16 v[32:47], a[16:19], v[208:211], v[32:47]
  ds_read_b64_tr_b16 a[12:13], v2 offset:52736
  ds_read_b64_tr_b16 a[14:15], v2 offset:54784
  v_accvgpr_read_b32 v24, a74
  v_accvgpr_read_b32 v25, a75
  v_mfma_f32_32x32x16_bf16 v[48:63], a[20:23], v[208:211], v[48:63]
  ds_read_b64_tr_b16 a[16:17], v14 offset:53248
  ds_read_b64_tr_b16 a[18:19], v14 offset:53760
  v_exp_f32 v20, v24 clamp
  v_exp_f32 v21, v25 clamp
  v_mfma_f32_32x32x16_bf16 v[96:111], a[24:27], v[208:211], v[96:111]
  ds_read_b64_tr_b16 a[20:21], v3 offset:26624
  ds_read_b64_tr_b16 a[22:23], v3 offset:28672
  v_max_f32 v24, s43, v24
  v_max_f32 v25, s43, v25
  v_fmac_f32 v20, s42, v24
  s_waitcnt lgkmcnt(8)
  v_mfma_f32_32x32x16_bf16 v[32:47], a[28:31], v[212:215], v[32:47]
  ds_read_b64_tr_b16 a[24:25], v3 offset:27136
  ds_read_b64_tr_b16 a[26:27], v3 offset:29184
  v_fmac_f32 v21, s42, v25
  v_cvt_pk_bf16_f32 v77, v20, v21
  v_accvgpr_read_b32 v22, a76
  v_mfma_f32_32x32x16_bf16 v[48:63], a[0:3], v[212:215], v[48:63]
  ds_read_b64_tr_b16 a[28:29], v15 offset:27648
  ds_read_b64_tr_b16 a[30:31], v15 offset:28160
  v_accvgpr_read_b32 v23, a77
  v_exp_f32 v18, v22 clamp
  v_mfma_f32_32x32x16_bf16 v[96:111], a[4:7], v[212:215], v[96:111]
  ds_read_b64_tr_b16 a[0:1], v1 offset:40960
  ds_read_b64_tr_b16 a[2:3], v1 offset:43008
  v_exp_f32 v19, v23 clamp
  v_max_f32 v22, s43, v22
  s_waitcnt lgkmcnt(8)
  v_mfma_f32_32x32x16_bf16 v[32:47], a[8:11], v[216:219], v[32:47]
  ds_read_b64_tr_b16 a[4:5], v1 offset:41472
  ds_read_b64_tr_b16 a[6:7], v1 offset:43520
  v_max_f32 v23, s43, v23
  v_fmac_f32 v18, s42, v22
  v_fmac_f32 v19, s42, v23
  v_cvt_pk_bf16_f32 v78, v18, v19
  v_mfma_f32_32x32x16_bf16 v[48:63], a[12:15], v[216:219], v[48:63]
  ds_read_b64_tr_b16 a[8:9], v13 offset:41984
  ds_read_b64_tr_b16 a[10:11], v13 offset:42496
  v_accvgpr_read_b32 v24, a78
  v_accvgpr_read_b32 v25, a79
  v_mfma_f32_32x32x16_bf16 v[96:111], a[16:19], v[216:219], v[96:111]
  ds_read_b64_tr_b16 a[12:13], v2 offset:15360
  ds_read_b64_tr_b16 a[14:15], v2 offset:17408
  v_exp_f32 v20, v24 clamp
  s_waitcnt lgkmcnt(8)
  v_mfma_f32_32x32x16_bf16 v[32:47], a[20:23], v[220:223], v[32:47]
  ds_read_b64_tr_b16 a[16:17], v2 offset:15872
  ds_read_b64_tr_b16 a[18:19], v2 offset:17920
  v_exp_f32 v21, v25 clamp
  v_max_f32 v24, s43, v24
  v_max_f32 v25, s43, v25
  v_mfma_f32_32x32x16_bf16 v[48:63], a[24:27], v[220:223], v[48:63]
  ds_read_b64_tr_b16 a[20:21], v14 offset:16384
  ds_read_b64_tr_b16 a[22:23], v14 offset:16896
  v_fmac_f32 v20, s42, v24
  v_fmac_f32 v21, s42, v25
  v_cvt_pk_bf16_f32 v79, v20, v21
  v_mfma_f32_32x32x16_bf16 v[96:111], a[28:31], v[220:223], v[96:111]
  ds_read_b64_tr_b16 a[24:25], v2 offset:55296
  ds_read_b64_tr_b16 a[26:27], v2 offset:57344
  s_waitcnt lgkmcnt(8)
  v_mfma_f32_32x32x16_bf16 v[32:47], a[0:3], v[224:227], v[32:47]
  ds_read_b64_tr_b16 a[28:29], v2 offset:55808
  ds_read_b64_tr_b16 a[30:31], v2 offset:57856
  v_mfma_f32_32x32x16_bf16 v[48:63], a[4:7], v[224:227], v[48:63]
  ds_read_b64_tr_b16 a[0:1], v14 offset:56320
  ds_read_b64_tr_b16 a[2:3], v14 offset:56832
  v_mfma_f32_32x32x16_bf16 v[96:111], a[8:11], v[224:227], v[96:111]
  ds_read_b64_tr_b16 a[4:5], v3 offset:29696
  ds_read_b64_tr_b16 a[6:7], v3 offset:31744
  s_waitcnt lgkmcnt(8)
  v_mfma_f32_32x32x16_bf16 v[32:47], a[12:15], v[228:231], v[32:47]
  ds_read_b64_tr_b16 a[8:9], v3 offset:30208
  ds_read_b64_tr_b16 a[10:11], v3 offset:32256
  v_mfma_f32_32x32x16_bf16 v[48:63], a[16:19], v[228:231], v[48:63]
  ds_read_b64_tr_b16 a[12:13], v15 offset:30720
  ds_read_b64_tr_b16 a[14:15], v15 offset:31232
  v_mfma_f32_32x32x16_bf16 v[96:111], a[20:23], v[228:231], v[96:111]
  s_waitcnt vmcnt(0)
  s_barrier
  ds_read_b64_tr_b16 a[16:17], v13 offset:23552
  ds_read_b64_tr_b16 a[18:19], v13 offset:24064
  s_waitcnt lgkmcnt(8)
  v_mfma_f32_32x32x16_bf16 v[32:47], a[24:27], v[232:235], v[32:47]
  ds_read_b64_tr_b16 a[20:21], v13 offset:63488
  ds_read_b64_tr_b16 a[22:23], v13 offset:64000
  v_mfma_f32_32x32x16_bf16 v[48:63], a[28:31], v[232:235], v[48:63]
  ds_read_b64_tr_b16 a[24:25], v14 offset:37888
  ds_read_b64_tr_b16 a[26:27], v14 offset:38400
  v_mfma_f32_32x32x16_bf16 v[96:111], a[0:3], v[232:235], v[96:111]
  ds_read_b64_tr_b16 a[28:29], v15 offset:12288
  ds_read_b64_tr_b16 a[30:31], v15 offset:12800
  s_waitcnt lgkmcnt(8)
  v_mfma_f32_32x32x16_bf16 v[32:47], a[4:7], v[236:239], v[32:47]
  ds_read_b64_tr_b16 a[0:1], v1 offset:22528
  ds_read_b64_tr_b16 a[2:3], v1 offset:24576
  v_mfma_f32_32x32x16_bf16 v[48:63], a[8:11], v[236:239], v[48:63]
  ds_read_b64_tr_b16 a[4:5], v1 offset:62464
  ds_read_b64_tr_b16 a[6:7], v1 offset:64512
  v_mfma_f32_32x32x16_bf16 v[96:111], a[12:15], v[236:239], v[96:111]
  ds_read_b64_tr_b16 a[8:9], v2 offset:36864
  ds_read_b64_tr_b16 a[10:11], v2 offset:38912
  s_waitcnt lgkmcnt(8)
  v_mfma_f32_32x32x16_bf16 v[96:111], a[16:19], v[240:243], v[96:111]
  ds_read_b64_tr_b16 a[12:13], v3 offset:11264
  ds_read_b64_tr_b16 a[14:15], v3 offset:13312
  v_mfma_f32_32x32x16_bf16 v[96:111], a[20:23], v[244:247], v[96:111]
  ds_read_b64_tr_b16 a[16:17], v1 offset:23040
  ds_read_b64_tr_b16 a[18:19], v1 offset:25088
  v_mfma_f32_32x32x16_bf16 v[96:111], a[24:27], v[248:251], v[96:111]
  ds_read_b64_tr_b16 a[20:21], v1 offset:62976
  ds_read_b64_tr_b16 a[22:23], v1 offset:65024
  s_waitcnt lgkmcnt(8)
  v_mfma_f32_32x32x16_bf16 v[96:111], a[28:31], v[252:255], v[96:111]
  ds_read_b64_tr_b16 a[24:25], v2 offset:37376
  ds_read_b64_tr_b16 a[26:27], v2 offset:39424
  v_mfma_f32_32x32x16_bf16 v[32:47], a[0:3], v[240:243], v[32:47]
  ds_read_b64_tr_b16 a[28:29], v3 offset:11776
  ds_read_b64_tr_b16 a[30:31], v3 offset:13824
  v_mfma_f32_32x32x16_bf16 v[32:47], a[4:7], v[244:247], v[32:47]
  s_waitcnt lgkmcnt(6)
  v_mfma_f32_32x32x16_bf16 v[32:47], a[8:11], v[248:251], v[32:47]
  s_nop 3
  v_exp_f32 v18, v96 clamp
  v_exp_f32 v19, v97 clamp
  v_max_f32 v96, s43, v96
  v_max_f32 v97, s43, v97
  v_fmac_f32 v18, s42, v96
  v_fmac_f32 v19, s42, v97
  v_cvt_pk_bf16_f32 v96, v18, v19
  v_mfma_f32_32x32x16_bf16 v[32:47], a[12:15], v[252:255], v[32:47]
  v_exp_f32 v20, v98 clamp
  v_exp_f32 v21, v99 clamp
  v_max_f32 v98, s43, v98
  v_max_f32 v99, s43, v99
  v_fmac_f32 v20, s42, v98
  v_fmac_f32 v21, s42, v99
  v_cvt_pk_bf16_f32 v97, v20, v21
  v_mfma_f32_32x32x16_bf16 v[48:63], a[16:19], v[240:243], v[48:63]
AT_H6:
  s_cbranch_execz AT_H10
  v_exp_f32 v18, v100 clamp
  v_exp_f32 v19, v101 clamp
  v_max_f32 v100, s43, v100
  v_max_f32 v101, s43, v101
  v_fmac_f32 v18, s42, v100
  v_fmac_f32 v19, s42, v101
  s_waitcnt lgkmcnt(0)
  v_mfma_f32_32x32x16_bf16 v[48:63], a[20:23], v[244:247], v[48:63]
  v_cvt_pk_bf16_f32 v98, v18, v19
  v_exp_f32 v20, v102 clamp
  v_exp_f32 v21, v103 clamp
  v_max_f32 v102, s43, v102
  v_max_f32 v103, s43, v103
  v_fmac_f32 v20, s42, v102
  v_fmac_f32 v21, s42, v103
  v_mfma_f32_32x32x16_bf16 v[48:63], a[24:27], v[248:251], v[48:63]
  v_cvt_pk_bf16_f32 v99, v20, v21
  s_add_u32 s49, s91, 0
  buffer_load_dwordx4 a[128:131], v4, s[28:31], s49 offen offset:0 sc1
  v_exp_f32 v18, v32 clamp
  v_exp_f32 v19, v33 clamp
  v_max_f32 v32, s43, v32
  v_max_f32 v33, s43, v33
  buffer_load_dwordx4 a[132:135], v4, s[28:31], s49 offen offset:1024 sc1
  buffer_load_dwordx4 a[136:139], v4, s[28:31], s49 offen offset:2048 sc1
  buffer_load_dwordx4 a[140:143], v4, s[28:31], s49 offen offset:3072 sc1
  s_add_u32 s49, s91, 4096
  buffer_load_dwordx4 a[144:147], v4, s[28:31], s49 offen offset:0 sc1
  buffer_load_dwordx4 a[148:151], v4, s[28:31], s49 offen offset:1024 sc1
  buffer_load_dwordx4 a[152:155], v4, s[28:31], s49 offen offset:2048 sc1
  buffer_load_dwordx4 a[156:159], v4, s[28:31], s49 offen offset:3072 sc1
  s_add_u32 s49, s91, 32768
  buffer_load_dwordx4 a[160:163], v4, s[28:31], s49 offen offset:0 sc1
  buffer_load_dwordx4 a[164:167], v4, s[28:31], s49 offen offset:1024 sc1
  buffer_load_dwordx4 a[168:171], v4, s[28:31], s49 offen offset:2048 sc1
  buffer_load_dwordx4 a[172:175], v4, s[28:31], s49 offen offset:3072 sc1
  s_add_u32 s49, s91, 36864
  buffer_load_dwordx4 a[176:179], v4, s[28:31], s49 offen offset:0 sc1
  buffer_load_dwordx4 a[180:183], v4, s[28:31], s49 offen offset:1024 sc1
  buffer_load_dwordx4 a[184:187], v4, s[28:31], s49 offen offset:2048 sc1
  buffer_load_dwordx4 a[188:191], v4, s[28:31], s49 offen offset:3072 sc1
  s_add_u32 s49, s91, 65536
  buffer_load_dwordx4 a[192:195], v4, s[28:31], s49 offen offset:0 sc1
  buffer_load_dwordx4 a[196:199], v4, s[28:31], s49 offen offset:1024 sc1
  buffer_load_dwordx4 a[200:203], v4, s[28:31], s49 offen offset:2048 sc1
  buffer_load_dwordx4 a[204:207], v4, s[28:31], s49 offen offset:3072 sc1
  s_add_u32 s49, s91, 69632
  buffer_load_dwordx4 a[208:211], v4, s[28:31], s49 offen offset:0 sc1
  buffer_load_dwordx4 a[212:215], v4, s[28:31], s49 offen offset:1024 sc1
  buffer_load_dwordx4 a[216:219], v4, s[28:31], s49 offen offset:2048 sc1
  buffer_load_dwordx4 a[220:223], v4, s[28:31], s49 offen offset:3072 sc1
  s_add_u32 s49, s91, 98304
  buffer_load_dwordx4 a[224:227], v4, s[28:31], s49 offen offset:0 sc1
  buffer_load_dwordx4 a[228:231], v4, s[28:31], s49 offen offset:1024 sc1
  buffer_load_dwordx4 a[232:235], v4, s[28:31], s49 offen offset:2048 sc1
  buffer_load_dwordx4 a[236:239], v4, s[28:31], s49 offen offset:3072 sc1
  s_add_u32 s49, s91, 102400
  buffer_load_dwordx4 a[240:243], v4, s[28:31], s49 offen offset:0 sc1
  buffer_load_dwordx4 a[244:247], v4, s[28:31], s49 offen offset:1024 sc1
  buffer_load_dwordx4 a[248:251], v4, s[28:31], s49 offen offset:2048 sc1
  buffer_load_dwordx4 a[252:255], v4, s[28:31], s49 offen offset:3072 sc1
  buffer_load_dwordx4 v[112:115], v4, s[28:31], s92 offen offset:0 sc1
  buffer_load_dwordx4 v[116:119], v4, s[28:31], s92 offen offset:1024 sc1
  buffer_load_dwordx4 v[120:123], v4, s[28:31], s92 offen offset:2048 sc1
  buffer_load_dwordx4 v[124:127], v4, s[28:31], s92 offen offset:3072 sc1
  v_mfma_f32_32x32x16_bf16 v[48:63], a[28:31], v[252:255], v[48:63]
  v_and_b32 v28, 15, v0
  v_lshlrev_b32 v28, 5, v28
  v_and_b32 v29, 16, v0
  v_add_u32 v28, v28, v29
  v_and_b32 v27, 32, v0
  s_and_b32 s46, s6, 1
  s_lshr_b32 s47, s6, 1
  s_lshl_b32 s48, s46, 9
  s_lshl_b32 s49, s47, 3
  s_add_u32 s48, s48, s49
  v_lshl_add_u32 v29, v27, 13, v28
  v_add_u32 v29, s48, v29
  s_lshl_b32 s48, s47, 10
  s_lshl_b32 s49, s46, 3
  s_add_u32 s48, s48, s49
  v_lshl_add_u32 v28, v27, 4, v28
  v_add_u32 v28, s48, v28
  s_waitcnt vmcnt(35)
  v_mfma_f32_16x16x32_bf16 v[128:131], a[32:35], a[128:131], 0
  s_waitcnt vmcnt(34)
  v_mfma_f32_16x16x32_bf16 v[128:131], a[32:35], a[132:135], v[128:131]
  s_waitcnt vmcnt(33)
  v_mfma_f32_16x16x32_bf16 v[128:131], a[32:35], a[136:139], v[128:131]
  s_waitcnt vmcnt(32)
  v_mfma_f32_16x16x32_bf16 v[128:131], a[32:35], a[140:143], v[128:131]
  s_waitcnt vmcnt(31)
  v_mfma_f32_16x16x32_bf16 v[128:131], a[36:39], a[144:147], v[128:131]
  s_waitcnt vmcnt(30)
  v_mfma_f32_16x16x32_bf16 v[128:131], a[36:39], a[148:151], v[128:131]
  s_waitcnt vmcnt(29)
  v_mfma_f32_16x16x32_bf16 v[128:131], a[36:39], a[152:155], v[128:131]
  s_waitcnt vmcnt(28)
  v_mfma_f32_16x16x32_bf16 v[128:131], a[36:39], a[156:159], v[128:131]
  s_waitcnt vmcnt(27)
  v_mfma_f32_16x16x32_bf16 v[132:135], a[32:35], a[160:163], 0
  s_waitcnt vmcnt(26)
  v_mfma_f32_16x16x32_bf16 v[132:135], a[32:35], a[164:167], v[132:135]
  s_waitcnt vmcnt(25)
  v_mfma_f32_16x16x32_bf16 v[132:135], a[32:35], a[168:171], v[132:135]
  s_waitcnt vmcnt(24)
  v_mfma_f32_16x16x32_bf16 v[132:135], a[32:35], a[172:175], v[132:135]
  s_waitcnt vmcnt(23)
  v_mfma_f32_16x16x32_bf16 v[132:135], a[36:39], a[176:179], v[132:135]
  s_waitcnt vmcnt(22)
  v_mfma_f32_16x16x32_bf16 v[132:135], a[36:39], a[180:183], v[132:135]
  s_waitcnt vmcnt(21)
  v_mfma_f32_16x16x32_bf16 v[132:135], a[36:39], a[184:187], v[132:135]
  s_waitcnt vmcnt(20)
  v_mfma_f32_16x16x32_bf16 v[132:135], a[36:39], a[188:191], v[132:135]
  s_waitcnt vmcnt(19)
  v_mfma_f32_16x16x32_bf16 v[136:139], a[32:35], a[192:195], 0
  s_waitcnt vmcnt(18)
  v_mfma_f32_16x16x32_bf16 v[136:139], a[32:35], a[196:199], v[136:139]
  s_waitcnt vmcnt(17)
  v_mfma_f32_16x16x32_bf16 v[136:139], a[32:35], a[200:203], v[136:139]
  s_waitcnt vmcnt(16)
  v_mfma_f32_16x16x32_bf16 v[136:139], a[32:35], a[204:207], v[136:139]
  s_waitcnt vmcnt(15)
  v_mfma_f32_16x16x32_bf16 v[136:139], a[36:39], a[208:211], v[136:139]
  s_waitcnt vmcnt(14)
  v_mfma_f32_16x16x32_bf16 v[136:139], a[36:39], a[212:215], v[136:139]
  s_waitcnt vmcnt(13)
  v_mfma_f32_16x16x32_bf16 v[136:139], a[36:39], a[216:219], v[136:139]
  s_waitcnt vmcnt(12)
  v_mfma_f32_16x16x32_bf16 v[136:139], a[36:39], a[220:223], v[136:139]
  s_waitcnt vmcnt(11)
  v_mfma_f32_16x16x32_bf16 v[140:143], a[32:35], a[224:227], 0
  s_waitcnt vmcnt(10)
  v_mfma_f32_16x16x32_bf16 v[140:143], a[32:35], a[228:231], v[140:143]
  s_waitcnt vmcnt(9)
  v_mfma_f32_16x16x32_bf16 v[140:143], a[32:35], a[232:235], v[140:143]
  s_waitcnt vmcnt(8)
  v_mfma_f32_16x16x32_bf16 v[140:143], a[32:35], a[236:239], v[140:143]
  s_waitcnt vmcnt(7)
  v_mfma_f32_16x16x32_bf16 v[140:143], a[36:39], a[240:243], v[140:143]
  s_waitcnt vmcnt(6)
  v_mfma_f32_16x16x32_bf16 v[140:143], a[36:39], a[244:247], v[140:143]
  s_waitcnt vmcnt(5)
  v_mfma_f32_16x16x32_bf16 v[140:143], a[36:39], a[248:251], v[140:143]
  s_waitcnt vmcnt(4)
  v_mfma_f32_16x16x32_bf16 v[140:143], a[36:39], a[252:255], v[140:143]
  s_waitcnt vmcnt(3)
  v_mfma_f32_16x16x32_bf16 v[144:147], a[32:35], v[112:115], 0
  s_waitcnt vmcnt(2)
  v_mfma_f32_16x16x32_bf16 v[144:147], a[32:35], v[116:119], v[144:147]
  s_waitcnt vmcnt(1)
  v_mfma_f32_16x16x32_bf16 v[144:147], a[32:35], v[120:123], v[144:147]
  s_waitcnt vmcnt(0)
  v_mfma_f32_16x16x32_bf16 v[144:147], a[32:35], v[124:127], v[144:147]
  v_add_f32 v148, v128, v132
  v_add_f32 v149, v136, v140
  v_add_f32 v150, v130, v134
  v_add_f32 v151, v138, v142
  v_cmp_u_f32 vcc, v148, v149
  v_cmp_u_f32 s[98:99], v150, v151
  s_nop 1
  v_cmp_u_f32 s[46:47], v144, v146
  s_nop 1
  s_or_b64 vcc, vcc, s[98:99]
  s_nop 1
  s_or_b64 vcc, vcc, s[46:47]
  s_cbranch_scc1 AT_RETRY
AT_RETRY_BACK:
  v_cvt_pk_bf16_f32 v128, v128, v129
  v_cvt_pk_bf16_f32 v129, v130, v131
  v_cvt_pk_bf16_f32 v132, v132, v133
  v_cvt_pk_bf16_f32 v133, v134, v135
  v_cvt_pk_bf16_f32 v136, v136, v137
  v_cvt_pk_bf16_f32 v137, v138, v139
  v_cvt_pk_bf16_f32 v140, v140, v141
  v_cvt_pk_bf16_f32 v141, v142, v143
  v_cvt_pk_bf16_f32 v144, v144, v145
  v_cvt_pk_bf16_f32 v145, v146, v147
  ds_write_b64 v28, v[128:129] offset:4096
  ds_write_b64 v28, v[132:133] offset:6144
  ds_write_b64 v28, v[136:137] offset:8192
  ds_write_b64 v28, v[140:141] offset:10240
  ds_write_b64 v29, v[144:145] offset:12288
  s_waitcnt lgkmcnt(0)
  s_barrier
  ds_read_b128 v[184:187], v4 offset:12288
  ds_read_b128 v[152:155], v4 offset:4096
  ds_read_b128 v[156:159], v4 offset:5120
  ds_read_b128 v[160:163], v4 offset:6144
  ds_read_b128 v[164:167], v4 offset:7168
  ds_read_b128 v[168:171], v4 offset:8192
  ds_read_b128 v[172:175], v4 offset:9216
  ds_read_b128 v[176:179], v4 offset:10240
  ds_read_b128 v[180:183], v4 offset:11264
  v_mov_b32 v220, 0
  v_mov_b32 v221, 0
  v_mov_b32 v224, 0
  v_mov_b32 v225, 0
  v_mov_b32 v226, 0
  v_mov_b32 v227, 0
  v_mov_b32 v230, 0
  v_mov_b32 v231, 0
  s_waitcnt lgkmcnt(7)
  v_cndmask_b32 v188, 0, v152, s[44:45]
  v_cndmask_b32 v196, v152, 0, s[44:45]
  v_cndmask_b32 v189, 0, v153, s[44:45]
  v_cndmask_b32 v197, v153, 0, s[44:45]
  v_cndmask_b32 v190, 0, v154, s[44:45]
  v_cndmask_b32 v198, v154, 0, s[44:45]
  v_cndmask_b32 v191, 0, v155, s[44:45]
  v_cndmask_b32 v199, v155, 0, s[44:45]
  s_waitcnt lgkmcnt(6)
  v_cndmask_b32 v192, 0, v156, s[72:73]
  v_cndmask_b32 v200, v156, 0, s[72:73]
  v_cndmask_b32 v201, 0, v157, s[44:45]
  v_cndmask_b32 v193, v157, 0, s[44:45]
  v_cndmask_b32 v202, 0, v158, s[44:45]
  v_cndmask_b32 v194, v158, 0, s[44:45]
  v_cndmask_b32 v203, 0, v159, s[44:45]
  v_cndmask_b32 v195, v159, 0, s[44:45]
  v_cndmask_b32 v222, 0, v184, s[74:75]
  v_cndmask_b32 v228, 0, v184, s[76:77]
  v_cndmask_b32 v223, 0, v185, s[74:75]
  v_cndmask_b32 v229, 0, v185, s[76:77]
  s_nop 0
  v_mfma_f32_32x32x16_bf16 v[112:127], v[222:225], v[96:99], 0
  s_waitcnt lgkmcnt(5)
  v_cndmask_b32 v204, 0, v160, s[44:45]
  v_cndmask_b32 v212, v160, 0, s[44:45]
  v_cndmask_b32 v205, 0, v161, s[44:45]
  v_cndmask_b32 v213, v161, 0, s[44:45]
  v_cndmask_b32 v206, 0, v162, s[44:45]
  v_fmac_f32 v18, s42, v32
  v_mfma_f32_32x32x16_bf16 v[128:143], v[228:231], v[96:99], 0
  v_cndmask_b32 v214, v162, 0, s[44:45]
  v_cndmask_b32 v207, 0, v163, s[44:45]
  v_cndmask_b32 v215, v163, 0, s[44:45]
  s_waitcnt lgkmcnt(4)
  v_cndmask_b32 v208, 0, v164, s[72:73]
  v_cndmask_b32 v216, v164, 0, s[72:73]
  v_cndmask_b32 v217, 0, v165, s[44:45]
  v_cndmask_b32 v209, v165, 0, s[44:45]
  v_fmac_f32 v19, s42, v33
  v_mfma_f32_32x32x16_bf16 v[112:127], v[188:191], v[64:67], v[112:127]
  v_cndmask_b32 v218, 0, v166, s[44:45]
  v_cndmask_b32 v210, v166, 0, s[44:45]
  v_cndmask_b32 v219, 0, v167, s[44:45]
  v_cndmask_b32 v211, v167, 0, s[44:45]
  v_cndmask_b32 v222, 0, v184, s[78:79]
  v_cndmask_b32 v228, 0, v184, s[80:81]
  v_cndmask_b32 v223, 0, v185, s[78:79]
  v_mfma_f32_32x32x16_bf16 v[128:143], v[196:199], v[64:67], v[128:143]
  v_cndmask_b32 v229, 0, v185, s[80:81]
  v_cvt_pk_bf16_f32 v32, v18, v19
  v_exp_f32 v20, v34 clamp
  v_exp_f32 v21, v35 clamp
  v_max_f32 v34, s43, v34
  v_max_f32 v35, s43, v35
  v_fmac_f32 v20, s42, v34
  v_mfma_f32_32x32x16_bf16 v[112:127], v[192:195], v[68:71], v[112:127]
  v_fmac_f32 v21, s42, v35
  v_cvt_pk_bf16_f32 v33, v20, v21
  v_exp_f32 v18, v36 clamp
  v_exp_f32 v19, v37 clamp
  v_max_f32 v36, s43, v36
  v_max_f32 v37, s43, v37
  v_fmac_f32 v18, s42, v36
  v_mfma_f32_32x32x16_bf16 v[128:143], v[200:203], v[68:71], v[128:143]
  v_fmac_f32 v19, s42, v37
  v_cvt_pk_bf16_f32 v34, v18, v19
  v_exp_f32 v20, v38 clamp
  v_exp_f32 v21, v39 clamp
  v_max_f32 v38, s43, v38
  v_max_f32 v39, s43, v39
  v_fmac_f32 v20, s42, v38
  v_fmac_f32 v21, s42, v39
  v_cvt_pk_bf16_f32 v35, v20, v21
  v_exp_f32 v18, v40 clamp
  v_exp_f32 v19, v41 clamp
  v_max_f32 v40, s43, v40
  v_max_f32 v41, s43, v41
  v_fmac_f32 v18, s42, v40
  v_fmac_f32 v19, s42, v41
  v_cvt_pk_bf16_f32 v36, v18, v19
  v_exp_f32 v20, v42 clamp
  v_exp_f32 v21, v43 clamp
  v_max_f32 v42, s43, v42
  v_max_f32 v43, s43, v43
  v_fmac_f32 v20, s42, v42
  v_fmac_f32 v21, s42, v43
  v_cvt_pk_bf16_f32 v37, v20, v21
  v_exp_f32 v18, v44 clamp
  v_exp_f32 v19, v45 clamp
  v_max_f32 v44, s43, v44
  v_max_f32 v45, s43, v45
  v_fmac_f32 v18, s42, v44
  v_fmac_f32 v19, s42, v45
  v_cvt_pk_bf16_f32 v38, v18, v19
  v_exp_f32 v20, v46 clamp
  v_exp_f32 v21, v47 clamp
  v_max_f32 v46, s43, v46
  v_max_f32 v47, s43, v47
  v_fmac_f32 v20, s42, v46
  v_fmac_f32 v21, s42, v47
  v_cvt_pk_bf16_f32 v39, v20, v21
  v_mfma_f32_32x32x16_bf16 v[80:95], v[222:225], v[96:99], 0
  v_exp_f32 v18, v48 clamp
  v_exp_f32 v19, v49 clamp
  v_max_f32 v48, s43, v48
  v_max_f32 v49, s43, v49
  v_fmac_f32 v18, s42, v48
  v_fmac_f32 v19, s42, v49
  v_cvt_pk_bf16_f32 v48, v18, v19
  v_mfma_f32_32x32x16_bf16 v[232:247], v[228:231], v[96:99], 0
  v_permlane32_swap_b32 v136, v137
  v_fma_f32 v136, v17, v136, v5
  v_fma_f32 v137, v17, v137, v5
  v_rcp_f32 v136, v136
  v_rcp_f32 v137, v137
  s_nop 0
  v_cndmask_b32 v138, v137, v136, s[84:85]
  v_mul_f32 v112, v112, v137
  v_mfma_f32_32x32x16_bf16 v[80:95], v[204:207], v[72:75], v[80:95]
  v_mul_f32 v113, v113, v137
  v_cvt_pk_bf16_f32 v40, v112, v113
  v_mul_f32 v114, v114, v137
  v_mul_f32 v115, v115, v137
  v_cvt_pk_bf16_f32 v41, v114, v115
  v_mul_f32 v116, v116, v137
  v_mul_f32 v117, v117, v137
  v_cvt_pk_bf16_f32 v42, v116, v117
  v_mul_f32 v118, v118, v137
  v_mfma_f32_32x32x16_bf16 v[232:247], v[212:215], v[72:75], v[232:247]
  v_mul_f32 v119, v119, v137
  v_cvt_pk_bf16_f32 v43, v118, v119
  v_mul_f32 v120, v120, v138
  v_mul_f32 v121, v121, v138
  v_cvt_pk_bf16_f32 v44, v120, v121
  v_mul_f32 v122, v122, v136
  v_mul_f32 v123, v123, v136
  v_cvt_pk_bf16_f32 v45, v122, v123
  v_mul_f32 v124, v124, v136
  v_mfma_f32_32x32x16_bf16 v[80:95], v[208:211], v[76:79], v[80:95]
  v_mul_f32 v125, v125, v136
  v_cvt_pk_bf16_f32 v46, v124, v125
  v_mul_f32 v126, v126, v136
  v_mul_f32 v127, v127, v136
  v_cvt_pk_bf16_f32 v47, v126, v127
  v_mul_f32 v128, v128, v136
  v_mul_f32 v129, v129, v136
  v_mul_f32 v130, v130, v136
  v_mul_f32 v131, v131, v136
  v_mfma_f32_32x32x16_bf16 v[232:247], v[216:219], v[76:79], v[232:247]
  v_cvt_pk_bf16_f32 v100, v128, v129
  v_cvt_pk_bf16_f32 v101, v130, v131
  v_exp_f32 v20, v50 clamp
  v_exp_f32 v21, v51 clamp
  v_max_f32 v50, s43, v50
  v_max_f32 v51, s43, v51
  v_fmac_f32 v20, s42, v50
  v_fmac_f32 v21, s42, v51
  v_cvt_pk_bf16_f32 v49, v20, v21
  v_exp_f32 v18, v52 clamp
  v_exp_f32 v19, v53 clamp
  v_max_f32 v52, s43, v52
  v_max_f32 v53, s43, v53
  v_fmac_f32 v18, s42, v52
  v_fmac_f32 v19, s42, v53
  v_cvt_pk_bf16_f32 v50, v18, v19
  v_exp_f32 v20, v54 clamp
  v_exp_f32 v21, v55 clamp
  v_max_f32 v54, s43, v54
  v_max_f32 v55, s43, v55
  v_fmac_f32 v20, s42, v54
  v_fmac_f32 v21, s42, v55
  v_cvt_pk_bf16_f32 v51, v20, v21
  v_exp_f32 v18, v56 clamp
  v_exp_f32 v19, v57 clamp
  v_max_f32 v56, s43, v56
  v_max_f32 v57, s43, v57
  v_fmac_f32 v18, s42, v56
  v_fmac_f32 v19, s42, v57
  v_cvt_pk_bf16_f32 v52, v18, v19
  v_exp_f32 v20, v58 clamp
  v_exp_f32 v21, v59 clamp
  v_max_f32 v58, s43, v58
  v_max_f32 v59, s43, v59
  v_fmac_f32 v20, s42, v58
  v_fmac_f32 v21, s42, v59
  v_cvt_pk_bf16_f32 v53, v20, v21
  v_exp_f32 v18, v60 clamp
  v_exp_f32 v19, v61 clamp
  v_max_f32 v60, s43, v60
  v_max_f32 v61, s43, v61
  v_fmac_f32 v18, s42, v60
  v_fmac_f32 v19, s42, v61
  v_cvt_pk_bf16_f32 v54, v18, v19
  v_exp_f32 v20, v62 clamp
  v_exp_f32 v21, v63 clamp
  v_max_f32 v62, s43, v62
  v_max_f32 v63, s43, v63
  v_fmac_f32 v20, s42, v62
  v_fmac_f32 v21, s42, v63
  v_cvt_pk_bf16_f32 v55, v20, v21
  s_waitcnt lgkmcnt(3)
  v_cndmask_b32 v188, 0, v168, s[44:45]
  v_cndmask_b32 v196, v168, 0, s[44:45]
  v_cndmask_b32 v189, 0, v169, s[44:45]
  v_cndmask_b32 v197, v169, 0, s[44:45]
  v_cndmask_b32 v190, 0, v170, s[44:45]
  v_cndmask_b32 v198, v170, 0, s[44:45]
  v_cndmask_b32 v191, 0, v171, s[44:45]
  v_cndmask_b32 v199, v171, 0, s[44:45]
  s_waitcnt lgkmcnt(2)
  v_cndmask_b32 v192, 0, v172, s[72:73]
  v_cndmask_b32 v200, v172, 0, s[72:73]
  v_cndmask_b32 v201, 0, v173, s[44:45]
  v_cndmask_b32 v193, v173, 0, s[44:45]
  v_cndmask_b32 v202, 0, v174, s[44:45]
  v_cndmask_b32 v194, v174, 0, s[44:45]
  v_cndmask_b32 v203, 0, v175, s[44:45]
  v_cndmask_b32 v195, v175, 0, s[44:45]
  v_cndmask_b32 v222, 0, v186, s[74:75]
  v_cndmask_b32 v228, 0, v186, s[76:77]
  v_cndmask_b32 v223, 0, v187, s[74:75]
  v_cndmask_b32 v229, 0, v187, s[76:77]
  s_nop 0
  v_mfma_f32_32x32x16_bf16 v[112:127], v[220:223], v[96:99], 0
  s_add_u32 s46, s68, 0
  buffer_store_dwordx4 v[40:43], v4, s[28:31], s46 offen offset:0 sc1
  buffer_store_dwordx4 v[44:47], v4, s[28:31], s46 offen offset:1024 sc1
  v_mfma_f32_32x32x16_bf16 v[128:143], v[226:229], v[96:99], 0
  v_permlane32_swap_b32 v240, v241
  v_fma_f32 v240, v17, v240, v5
  v_fma_f32 v241, v17, v241, v5
  v_rcp_f32 v240, v240
  v_rcp_f32 v241, v241
  s_nop 0
  v_cndmask_b32 v242, v241, v240, s[84:85]
  v_mul_f32 v80, v80, v241
  v_mfma_f32_32x32x16_bf16 v[112:127], v[188:191], v[32:35], v[112:127]
  v_mul_f32 v81, v81, v241
  v_cvt_pk_bf16_f32 v56, v80, v81
  v_mul_f32 v82, v82, v241
  v_mul_f32 v83, v83, v241
  v_cvt_pk_bf16_f32 v57, v82, v83
  v_mul_f32 v84, v84, v241
  v_mul_f32 v85, v85, v241
  v_cvt_pk_bf16_f32 v58, v84, v85
  v_mul_f32 v86, v86, v241
  v_mfma_f32_32x32x16_bf16 v[128:143], v[196:199], v[32:35], v[128:143]
  v_mul_f32 v87, v87, v241
  v_cvt_pk_bf16_f32 v59, v86, v87
  v_mul_f32 v88, v88, v242
  v_mul_f32 v89, v89, v242
  v_cvt_pk_bf16_f32 v60, v88, v89
  v_mul_f32 v90, v90, v240
  v_mul_f32 v91, v91, v240
  v_cvt_pk_bf16_f32 v61, v90, v91
  v_mul_f32 v92, v92, v240
  v_mfma_f32_32x32x16_bf16 v[112:127], v[192:195], v[36:39], v[112:127]
  v_mul_f32 v93, v93, v240
  v_cvt_pk_bf16_f32 v62, v92, v93
  v_mul_f32 v94, v94, v240
  v_mul_f32 v95, v95, v240
  v_cvt_pk_bf16_f32 v63, v94, v95
  v_mul_f32 v232, v232, v240
  v_mul_f32 v233, v233, v240
  v_mul_f32 v234, v234, v240
  v_mul_f32 v235, v235, v240
  v_mfma_f32_32x32x16_bf16 v[128:143], v[200:203], v[36:39], v[128:143]
  v_cvt_pk_bf16_f32 v232, v232, v233
  v_cvt_pk_bf16_f32 v233, v234, v235
  v_cndmask_b32 v100, v100, v232, s[84:85]
  v_cndmask_b32 v101, v101, v233, s[84:85]
  s_waitcnt lgkmcnt(1)
  v_cndmask_b32 v204, 0, v176, s[44:45]
  v_cndmask_b32 v212, v176, 0, s[44:45]
  v_cndmask_b32 v205, 0, v177, s[44:45]
  v_cndmask_b32 v213, v177, 0, s[44:45]
  v_cndmask_b32 v206, 0, v178, s[44:45]
  v_cndmask_b32 v214, v178, 0, s[44:45]
  v_cndmask_b32 v207, 0, v179, s[44:45]
  v_cndmask_b32 v215, v179, 0, s[44:45]
  s_waitcnt lgkmcnt(0)
  v_cndmask_b32 v208, 0, v180, s[72:73]
  v_cndmask_b32 v216, v180, 0, s[72:73]
  v_cndmask_b32 v217, 0, v181, s[44:45]
  v_cndmask_b32 v209, v181, 0, s[44:45]
  v_cndmask_b32 v218, 0, v182, s[44:45]
  v_cndmask_b32 v210, v182, 0, s[44:45]
  v_cndmask_b32 v219, 0, v183, s[44:45]
  v_cndmask_b32 v211, v183, 0, s[44:45]
  v_cndmask_b32 v222, 0, v186, s[78:79]
  v_cndmask_b32 v228, 0, v186, s[80:81]
  v_cndmask_b32 v223, 0, v187, s[78:79]
  v_cndmask_b32 v229, 0, v187, s[80:81]
  s_nop 0
  v_mfma_f32_32x32x16_bf16 v[80:95], v[220:223], v[96:99], 0
  s_add_u32 s46, s68, 0
  buffer_store_dwordx4 v[56:59], v4, s[28:31], s46 offen offset:2048 sc1
  buffer_store_dwordx4 v[60:63], v4, s[28:31], s46 offen offset:3072 sc1
  v_mfma_f32_32x32x16_bf16 v[232:247], v[226:229], v[96:99], 0
  v_permlane32_swap_b32 v136, v137
  v_fma_f32 v136, v17, v136, v5
  v_fma_f32 v137, v17, v137, v5
  v_rcp_f32 v136, v136
  v_rcp_f32 v137, v137
  s_nop 0
  v_cndmask_b32 v138, v137, v136, s[84:85]
  v_mul_f32 v112, v112, v137
  v_mfma_f32_32x32x16_bf16 v[80:95], v[204:207], v[48:51], v[80:95]
  v_mul_f32 v113, v113, v137
  v_cvt_pk_bf16_f32 v104, v112, v113
  v_mul_f32 v114, v114, v137
  v_mul_f32 v115, v115, v137
  v_cvt_pk_bf16_f32 v105, v114, v115
  v_mul_f32 v116, v116, v137
  v_mul_f32 v117, v117, v137
  v_cvt_pk_bf16_f32 v106, v116, v117
  v_mul_f32 v118, v118, v137
  v_mfma_f32_32x32x16_bf16 v[232:247], v[212:215], v[48:51], v[232:247]
  v_mul_f32 v119, v119, v137
  v_cvt_pk_bf16_f32 v107, v118, v119
  v_mul_f32 v120, v120, v138
  v_mul_f32 v121, v121, v138
  v_cvt_pk_bf16_f32 v108, v120, v121
  v_mul_f32 v122, v122, v136
  v_mul_f32 v123, v123, v136
  v_cvt_pk_bf16_f32 v109, v122, v123
  v_mul_f32 v124, v124, v136
  v_mfma_f32_32x32x16_bf16 v[80:95], v[208:211], v[52:55], v[80:95]
  v_mul_f32 v125, v125, v136
  v_cvt_pk_bf16_f32 v110, v124, v125
  v_mul_f32 v126, v126, v136
  v_mul_f32 v127, v127, v136
  v_cvt_pk_bf16_f32 v111, v126, v127
  v_mul_f32 v132, v132, v136
  v_mul_f32 v133, v133, v136
  v_mul_f32 v134, v134, v136
  v_mul_f32 v135, v135, v136
  v_mfma_f32_32x32x16_bf16 v[232:247], v[216:219], v[52:55], v[232:247]
  v_cvt_pk_bf16_f32 v102, v132, v133
  v_cvt_pk_bf16_f32 v103, v134, v135
  s_add_u32 s46, s68, 4096
  buffer_store_dwordx4 v[104:107], v4, s[28:31], s46 offen offset:0 sc1
  buffer_store_dwordx4 v[108:111], v4, s[28:31], s46 offen offset:1024 sc1
  s_nop 6
  v_permlane32_swap_b32 v240, v241
  v_fma_f32 v240, v17, v240, v5
  v_fma_f32 v241, v17, v241, v5
  v_rcp_f32 v240, v240
  v_rcp_f32 v241, v241
  s_nop 0
  v_cndmask_b32 v242, v241, v240, s[84:85]
  v_mul_f32 v80, v80, v241
  v_mul_f32 v81, v81, v241
  v_cvt_pk_bf16_f32 v248, v80, v81
  v_mul_f32 v82, v82, v241
  v_mul_f32 v83, v83, v241
  v_cvt_pk_bf16_f32 v249, v82, v83
  v_mul_f32 v84, v84, v241
  v_mul_f32 v85, v85, v241
  v_cvt_pk_bf16_f32 v250, v84, v85
  v_mul_f32 v86, v86, v241
  v_mul_f32 v87, v87, v241
  v_cvt_pk_bf16_f32 v251, v86, v87
  v_mul_f32 v88, v88, v242
  v_mul_f32 v89, v89, v242
  v_cvt_pk_bf16_f32 v252, v88, v89
  v_mul_f32 v90, v90, v240
  v_mul_f32 v91, v91, v240
  v_cvt_pk_bf16_f32 v253, v90, v91
  v_mul_f32 v92, v92, v240
  v_mul_f32 v93, v93, v240
  v_cvt_pk_bf16_f32 v254, v92, v93
  v_mul_f32 v94, v94, v240
  v_mul_f32 v95, v95, v240
  v_cvt_pk_bf16_f32 v255, v94, v95
  v_mul_f32 v236, v236, v240
  v_mul_f32 v237, v237, v240
  v_mul_f32 v238, v238, v240
  v_mul_f32 v239, v239, v240
  v_cvt_pk_bf16_f32 v236, v236, v237
  v_cvt_pk_bf16_f32 v237, v238, v239
  v_cndmask_b32 v102, v102, v236, s[84:85]
  v_cndmask_b32 v103, v103, v237, s[84:85]
  s_add_u32 s46, s68, 4096
  buffer_store_dwordx4 v[248:251], v4, s[28:31], s46 offen offset:2048 sc1
  buffer_store_dwordx4 v[252:255], v4, s[28:31], s46 offen offset:3072 sc1
  s_add_u32 s46, s68, 8192
  buffer_store_dwordx4 v[100:103], v4, s[28:31], s46 offen sc1
  v_and_b32 v10, 15, v0
  v_lshlrev_b32 v8, 4, v10
  v_and_b32 v13, 48, v0
  v_lshl_add_u32 v8, v13, 6, v8
  s_lshl_b32 s46, s6, 8
  v_add_u32 v8, s46, v8
  v_and_b32 v15, 24, v0
  v_and_b32 v9, 32, v0
  v_lshl_add_u32 v15, v9, 2, v15
  s_lshl_b32 s46, s6, 5
  v_add_u32 v15, s46, v15
  v_and_b32 v9, 7, v0
  v_mul_u32_u24 v9, 1152, v9
  s_lshl_b32 s46, s5, 4
  s_add_u32 s46, s46, s4
  s_mul_i32 s46, s46, 9216
  v_add3_u32 v9, v9, v15, s46
  v_and_b32 v13, 12, v0
  v_mul_u32_u24 v13, 4348, v13
  v_lshl_add_u32 v10, v10, 2, v13
  s_mul_i32 s34, s5, 589824
  s_lshl_b32 s46, s4, 12
  s_add_u32 s34, s34, s46
  s_lshl_b32 s33, s5, 4
  s_lshr_b32 s46, s4, 2
  s_add_u32 s33, s33, s46
  s_mul_i32 s33, s33, 4352
  s_add_u32 s33, s33, 46139392
  s_cmp_eq_u32 s6, 0
  s_cselect_b32 s33, s33, 1879048192
  s_mov_b32 s53, 0x7777
  s_bitset0_b32 s53, s4
  s_waitcnt vmcnt(0)
  v_accvgpr_write_b32 a45, 1
  buffer_store_dword a45, off, s[28:31], s32 sc1
  buffer_load_dwordx2 v[220:221], v9, s[8:11], 0 offen offset:0
  buffer_load_dwordx2 v[222:223], v15, s[20:23], 0 offen offset:0
  buffer_load_dwordx2 v[224:225], v9, s[8:11], 0 offen offset:256
  buffer_load_dwordx2 v[226:227], v15, s[20:23], 0 offen offset:256
  buffer_load_dwordx2 v[228:229], v9, s[8:11], 0 offen offset:512
  buffer_load_dwordx2 v[230:231], v15, s[20:23], 0 offen offset:512
  buffer_load_dwordx2 v[232:233], v9, s[8:11], 0 offen offset:768
  buffer_load_dwordx2 v[234:235], v15, s[20:23], 0 offen offset:768
  buffer_load_dwordx2 v[236:237], v9, s[8:11], 0 offen offset:1024
  buffer_load_dwordx2 v[238:239], v15, s[20:23], 0 offen offset:1024
  s_waitcnt vmcnt(9)
  v_lshlrev_b32 v128, 16, v220
  v_and_b32 v129, s41, v220
  v_lshlrev_b32 v130, 16, v221
  v_and_b32 v131, s41, v221
  s_waitcnt vmcnt(8)
  v_lshlrev_b32 v220, 16, v222
  v_and_b32 v221, s41, v222
  v_lshlrev_b32 v222, 16, v223
  v_and_b32 v223, s41, v223
  v_add_f32 v128, v128, v220
  v_add_f32 v129, v129, v221
  v_add_f32 v130, v130, v222
  v_add_f32 v131, v131, v223
  s_waitcnt vmcnt(7)
  v_lshlrev_b32 v132, 16, v224
  v_and_b32 v133, s41, v224
  v_lshlrev_b32 v134, 16, v225
  v_and_b32 v135, s41, v225
  s_waitcnt vmcnt(6)
  v_lshlrev_b32 v224, 16, v226
  v_and_b32 v225, s41, v226
  v_lshlrev_b32 v226, 16, v227
  v_and_b32 v227, s41, v227
  v_add_f32 v132, v132, v224
  v_add_f32 v133, v133, v225
AT_H7:
  s_cbranch_execz AT_H11
  v_add_f32 v134, v134, v226
  v_add_f32 v135, v135, v227
  s_waitcnt vmcnt(5)
  v_lshlrev_b32 v136, 16, v228
  v_and_b32 v137, s41, v228
  v_lshlrev_b32 v138, 16, v229
  v_and_b32 v139, s41, v229
  s_waitcnt vmcnt(4)
  v_lshlrev_b32 v228, 16, v230
  v_and_b32 v229, s41, v230
  v_lshlrev_b32 v230, 16, v231
  v_and_b32 v231, s41, v231
  v_add_f32 v136, v136, v228
  v_add_f32 v137, v137, v229
  v_add_f32 v138, v138, v230
  v_add_f32 v139, v139, v231
  s_waitcnt vmcnt(3)
  v_lshlrev_b32 v140, 16, v232
  v_and_b32 v141, s41, v232
  v_lshlrev_b32 v142, 16, v233
  v_and_b32 v143, s41, v233
  s_waitcnt vmcnt(2)
  v_lshlrev_b32 v232, 16, v234
  v_and_b32 v233, s41, v234
  v_lshlrev_b32 v234, 16, v235
  v_and_b32 v235, s41, v235
  v_add_f32 v140, v140, v232
  v_add_f32 v141, v141, v233
  v_add_f32 v142, v142, v234
  v_add_f32 v143, v143, v235
  s_waitcnt vmcnt(1)
  v_lshlrev_b32 v144, 16, v236
  v_and_b32 v145, s41, v236
  v_lshlrev_b32 v146, 16, v237
  v_and_b32 v147, s41, v237
  s_waitcnt vmcnt(0)
  v_lshlrev_b32 v236, 16, v238
  v_and_b32 v237, s41, v238
  v_lshlrev_b32 v238, 16, v239
  v_and_b32 v239, s41, v239
  v_add_f32 v144, v144, v236
  v_add_f32 v145, v145, v237
  v_add_f32 v146, v146, v238
  v_add_f32 v147, v147, v239
  buffer_load_dword v13, v10, s[28:31], s33 offen sc1
  s_mov_b32 s50, 7
  s_mov_b32 s51, 0
  s_mov_b32 s101, 0
  v_lshrrev_b32 v80, 6, v0
  v_lshlrev_b32 v80, 3, v80
  s_waitcnt vmcnt(0)
  s_branch AT_TIN
AT_TLOOP:
  s_waitcnt vmcnt(0)
  s_bitcmp1_b32 s51, 0
  s_cbranch_scc0 AT_TSa_0
  v_mfma_f32_16x16x32_bf16 v[128:131], a[32:35], a[84:87], v[128:131]
  v_mfma_f32_16x16x32_bf16 v[132:135], a[36:39], a[88:91], v[132:135]
  v_mfma_f32_16x16x32_bf16 v[140:143], a[32:35], a[92:95], v[140:143]
AT_TSa_0:
  s_bitcmp1_b32 s51, 1
  s_cbranch_scc0 AT_TSa_1
  v_mfma_f32_16x16x32_bf16 v[128:131], a[36:39], a[96:99], v[128:131]
  v_mfma_f32_16x16x32_bf16 v[136:139], a[32:35], a[100:103], v[136:139]
  v_mfma_f32_16x16x32_bf16 v[140:143], a[36:39], a[104:107], v[140:143]
AT_TSa_1:
  s_bitcmp1_b32 s51, 2
  s_cbranch_scc0 AT_TSa_2
  v_mfma_f32_16x16x32_bf16 v[132:135], a[32:35], a[108:111], v[132:135]
  v_mfma_f32_16x16x32_bf16 v[136:139], a[36:39], a[112:115], v[136:139]
  v_mfma_f32_16x16x32_bf16 v[144:147], a[32:35], a[116:119], v[144:147]
AT_TSa_2:
  s_mov_b32 s51, 0
AT_TIN:
  v_cmp_gt_u32 vcc, 4, v13
  v_cmp_gt_u32 s[46:47], 5, v13
  v_cmp_gt_u32 s[48:49], 6, v13
  s_mov_b32 s52, 6
  s_nop 2
  s_nop 0
  s_and_b32 s48, s48, s53
  s_cselect_b32 s52, 5, s52
  s_and_b32 s46, s46, s53
  s_cselect_b32 s52, 4, s52
  s_and_b32 s46, vcc_lo, s53
  s_cselect_b32 s52, 3, s52
  v_xor_b32 v80, 4, v80
  v_mov_b32 v81, s52
  ds_write_b32 v80, v81 offset:3584
  s_waitcnt lgkmcnt(0)
  s_barrier
  v_and_b32 v81, 4, v80
  ds_read_b32 v81, v81 offset:3584
  s_waitcnt lgkmcnt(0)
  v_readfirstlane_b32 s52, v81
  s_nop 4
  s_bitcmp1_b32 s50, 0
  s_cbranch_scc0 AT_TIa_0
  s_cmp_lt_u32 s52, 4
  s_cbranch_scc1 AT_TIa_0
  s_add_u32 s35, s34, 0
  buffer_load_dwordx4 a[84:87], v8, s[28:31], s35 offen offset:0 sc1
  s_add_u32 s35, s34, 196608
  buffer_load_dwordx4 a[88:91], v8, s[28:31], s35 offen offset:0 sc1
  s_add_u32 s35, s34, 393216
  buffer_load_dwordx4 a[92:95], v8, s[28:31], s35 offen offset:0 sc1
  s_bitset0_b32 s50, 0
  s_bitset1_b32 s51, 0
AT_TIa_0:
  s_bitcmp1_b32 s50, 1
  s_cbranch_scc0 AT_TIa_1
  s_cmp_lt_u32 s52, 5
  s_cbranch_scc1 AT_TIa_1
  s_add_u32 s35, s34, 65536
  buffer_load_dwordx4 a[96:99], v8, s[28:31], s35 offen offset:0 sc1
  s_add_u32 s35, s34, 262144
  buffer_load_dwordx4 a[100:103], v8, s[28:31], s35 offen offset:0 sc1
  s_add_u32 s35, s34, 458752
  buffer_load_dwordx4 a[104:107], v8, s[28:31], s35 offen offset:0 sc1
  s_bitset0_b32 s50, 1
  s_bitset1_b32 s51, 1
AT_TIa_1:
  s_bitcmp1_b32 s50, 2
  s_cbranch_scc0 AT_TIa_2
  s_cmp_lt_u32 s52, 6
  s_cbranch_scc1 AT_TIa_2
  s_add_u32 s35, s34, 131072
  buffer_load_dwordx4 a[108:111], v8, s[28:31], s35 offen offset:0 sc1
  s_add_u32 s35, s34, 327680
  buffer_load_dwordx4 a[112:115], v8, s[28:31], s35 offen offset:0 sc1
  s_add_u32 s35, s34, 524288
  buffer_load_dwordx4 a[116:119], v8, s[28:31], s35 offen offset:0 sc1
  s_bitset0_b32 s50, 2
  s_bitset1_b32 s51, 2
AT_TIa_2:
  s_cmp_eq_u32 s50, 0
  s_cbranch_scc1 AT_TDONE
  s_cmp_lg_u32 s51, 0
  s_cbranch_scc1 AT_TNS
  s_sleep 2
  s_cmp_gt_u32 s52, 3
  s_cbranch_scc1 AT_TNS
  s_sleep 30
AT_TNS:
  buffer_load_dword v13, v10, s[28:31], s33 offen sc1
  s_add_u32 s101, s101, 1
  s_cmp_lt_u32 s101, 30000
  s_cbranch_scc1 AT_TLOOP
AT_TDONE:
  s_waitcnt vmcnt(0)
  s_bitcmp1_b32 s51, 0
  s_cbranch_scc0 AT_TSb_0
  v_mfma_f32_16x16x32_bf16 v[128:131], a[32:35], a[84:87], v[128:131]
  v_mfma_f32_16x16x32_bf16 v[132:135], a[36:39], a[88:91], v[132:135]
  v_mfma_f32_16x16x32_bf16 v[140:143], a[32:35], a[92:95], v[140:143]
AT_TSb_0:
  s_bitcmp1_b32 s51, 1
  s_cbranch_scc0 AT_TSb_1
  v_mfma_f32_16x16x32_bf16 v[128:131], a[36:39], a[96:99], v[128:131]
  v_mfma_f32_16x16x32_bf16 v[136:139], a[32:35], a[100:103], v[136:139]
  v_mfma_f32_16x16x32_bf16 v[140:143], a[36:39], a[104:107], v[140:143]
AT_TSb_1:
  s_bitcmp1_b32 s51, 2
  s_cbranch_scc0 AT_TSb_2
  v_mfma_f32_16x16x32_bf16 v[132:135], a[32:35], a[108:111], v[132:135]
  v_mfma_f32_16x16x32_bf16 v[136:139], a[36:39], a[112:115], v[136:139]
  v_mfma_f32_16x16x32_bf16 v[144:147], a[32:35], a[116:119], v[144:147]
AT_TSb_2:
  s_mov_b32 s51, 0
  s_nop 7
  v_cvt_pk_bf16_f32 v128, v128, v129
  v_cvt_pk_bf16_f32 v129, v130, v131
  buffer_store_dwordx2 v[128:129], v9, s[16:19], 0 offen offset:0
  v_cvt_pk_bf16_f32 v132, v132, v133
  v_cvt_pk_bf16_f32 v133, v134, v135
  buffer_store_dwordx2 v[132:133], v9, s[16:19], 0 offen offset:256
  v_cvt_pk_bf16_f32 v136, v136, v137
  v_cvt_pk_bf16_f32 v137, v138, v139
  buffer_store_dwordx2 v[136:137], v9, s[16:19], 0 offen offset:512
  v_cvt_pk_bf16_f32 v140, v140, v141
  v_cvt_pk_bf16_f32 v141, v142, v143
  buffer_store_dwordx2 v[140:141], v9, s[16:19], 0 offen offset:768
  v_and_b32 v14, 32, v0
  v_lshl_add_u32 v9, v14, 24, v9
  v_cvt_pk_bf16_f32 v144, v144, v145
  v_cvt_pk_bf16_f32 v145, v146, v147
  buffer_store_dwordx2 v[144:145], v9, s[16:19], 0 offen offset:1024
AT_END:
  s_endpgm
AT_SP0:
  s_mov_b32 s101, 0
AT_SP0_L:
  s_sleep 48
  v_and_b32 v11, 0xc1, v0
  v_lshlrev_b32 v11, 7, v11
  buffer_load_dword v11, v11, s[36:39], 0 offen sc1
  s_waitcnt vmcnt(0)
  s_add_u32 s101, s101, 1
  s_cmp_eq_u32 s6, 0
  s_cselect_b32 s100, 128, 0
  v_cmp_gt_u32 vcc, s100, v11
  s_nop 4
  s_cmp_lg_u64 vcc, 0
  s_cbranch_scc0 AT_SP0_B
  s_cmp_lt_u32 s101, 30000
  s_cbranch_scc1 AT_SP0_L
  s_branch AT_SP0_B
AT_RETRY:
  s_mov_b32 s101, 0
AT_RETRY_LOOP:
  s_sleep 4
  s_add_u32 s49, s91, 0
  buffer_load_dwordx4 a[128:131], v4, s[28:31], s49 offen offset:0 sc1
  buffer_load_dwordx4 a[132:135], v4, s[28:31], s49 offen offset:1024 sc1
  buffer_load_dwordx4 a[136:139], v4, s[28:31], s49 offen offset:2048 sc1
  buffer_load_dwordx4 a[140:143], v4, s[28:31], s49 offen offset:3072 sc1
  s_add_u32 s49, s91, 4096
  buffer_load_dwordx4 a[144:147], v4, s[28:31], s49 offen offset:0 sc1
  buffer_load_dwordx4 a[148:151], v4, s[28:31], s49 offen offset:1024 sc1
  buffer_load_dwordx4 a[152:155], v4, s[28:31], s49 offen offset:2048 sc1
  buffer_load_dwordx4 a[156:159], v4, s[28:31], s49 offen offset:3072 sc1
  s_add_u32 s49, s91, 32768
  buffer_load_dwordx4 a[160:163], v4, s[28:31], s49 offen offset:0 sc1
  buffer_load_dwordx4 a[164:167], v4, s[28:31], s49 offen offset:1024 sc1
  buffer_load_dwordx4 a[168:171], v4, s[28:31], s49 offen offset:2048 sc1
  buffer_load_dwordx4 a[172:175], v4, s[28:31], s49 offen offset:3072 sc1
  s_add_u32 s49, s91, 36864
  buffer_load_dwordx4 a[176:179], v4, s[28:31], s49 offen offset:0 sc1
  buffer_load_dwordx4 a[180:183], v4, s[28:31], s49 offen offset:1024 sc1
  buffer_load_dwordx4 a[184:187], v4, s[28:31], s49 offen offset:2048 sc1
  buffer_load_dwordx4 a[188:191], v4, s[28:31], s49 offen offset:3072 sc1
  s_add_u32 s49, s91, 65536
  buffer_load_dwordx4 a[192:195], v4, s[28:31], s49 offen offset:0 sc1
  buffer_load_dwordx4 a[196:199], v4, s[28:31], s49 offen offset:1024 sc1
  buffer_load_dwordx4 a[200:203], v4, s[28:31], s49 offen offset:2048 sc1
  buffer_load_dwordx4 a[204:207], v4, s[28:31], s49 offen offset:3072 sc1
  s_add_u32 s49, s91, 69632
  buffer_load_dwordx4 a[208:211], v4, s[28:31], s49 offen offset:0 sc1
  buffer_load_dwordx4 a[212:215], v4, s[28:31], s49 offen offset:1024 sc1
  buffer_load_dwordx4 a[216:219], v4, s[28:31], s49 offen offset:2048 sc1
  buffer_load_dwordx4 a[220:223], v4, s[28:31], s49 offen offset:3072 sc1
  s_add_u32 s49, s91, 98304
  buffer_load_dwordx4 a[224:227], v4, s[28:31], s49 offen offset:0 sc1
  buffer_load_dwordx4 a[228:231], v4, s[28:31], s49 offen offset:1024 sc1
  buffer_load_dwordx4 a[232:235], v4, s[28:31], s49 offen offset:2048 sc1
  buffer_load_dwordx4 a[236:239], v4, s[28:31], s49 offen offset:3072 sc1
  s_add_u32 s49, s91, 102400
  buffer_load_dwordx4 a[240:243], v4, s[28:31], s49 offen offset:0 sc1
  buffer_load_dwordx4 a[244:247], v4, s[28:31], s49 offen offset:1024 sc1
  buffer_load_dwordx4 a[248:251], v4, s[28:31], s49 offen offset:2048 sc1
  buffer_load_dwordx4 a[252:255], v4, s[28:31], s49 offen offset:3072 sc1
  buffer_load_dwordx4 v[112:115], v4, s[28:31], s92 offen offset:0 sc1
  buffer_load_dwordx4 v[116:119], v4, s[28:31], s92 offen offset:1024 sc1
  buffer_load_dwordx4 v[120:123], v4, s[28:31], s92 offen offset:2048 sc1
  buffer_load_dwordx4 v[124:127], v4, s[28:31], s92 offen offset:3072 sc1
  s_waitcnt vmcnt(0)
  s_add_u32 s101, s101, 1
  v_mfma_f32_16x16x32_bf16 v[128:131], a[32:35], a[128:131], 0
  v_mfma_f32_16x16x32_bf16 v[128:131], a[32:35], a[132:135], v[128:131]
  v_mfma_f32_16x16x32_bf16 v[128:131], a[32:35], a[136:139], v[128:131]
  v_mfma_f32_16x16x32_bf16 v[128:131], a[32:35], a[140:143], v[128:131]
  v_mfma_f32_16x16x32_bf16 v[128:131], a[36:39], a[144:147], v[128:131]
  v_mfma_f32_16x16x32_bf16 v[128:131], a[36:39], a[148:151], v[128:131]
  v_mfma_f32_16x16x32_bf16 v[128:131], a[36:39], a[152:155], v[128:131]
  v_mfma_f32_16x16x32_bf16 v[128:131], a[36:39], a[156:159], v[128:131]
  v_mfma_f32_16x16x32_bf16 v[132:135], a[32:35], a[160:163], 0
  v_mfma_f32_16x16x32_bf16 v[132:135], a[32:35], a[164:167], v[132:135]
  v_mfma_f32_16x16x32_bf16 v[132:135], a[32:35], a[168:171], v[132:135]
  v_mfma_f32_16x16x32_bf16 v[132:135], a[32:35], a[172:175], v[132:135]
  v_mfma_f32_16x16x32_bf16 v[132:135], a[36:39], a[176:179], v[132:135]
  v_mfma_f32_16x16x32_bf16 v[132:135], a[36:39], a[180:183], v[132:135]
  v_mfma_f32_16x16x32_bf16 v[132:135], a[36:39], a[184:187], v[132:135]
  v_mfma_f32_16x16x32_bf16 v[132:135], a[36:39], a[188:191], v[132:135]
  v_mfma_f32_16x16x32_bf16 v[136:139], a[32:35], a[192:195], 0
  v_mfma_f32_16x16x32_bf16 v[136:139], a[32:35], a[196:199], v[136:139]
  v_mfma_f32_16x16x32_bf16 v[136:139], a[32:35], a[200:203], v[136:139]
  v_mfma_f32_16x16x32_bf16 v[136:139], a[32:35], a[204:207], v[136:139]
  v_mfma_f32_16x16x32_bf16 v[136:139], a[36:39], a[208:211], v[136:139]
  v_mfma_f32_16x16x32_bf16 v[136:139], a[36:39], a[212:215], v[136:139]
  v_mfma_f32_16x16x32_bf16 v[136:139], a[36:39], a[216:219], v[136:139]
  v_mfma_f32_16x16x32_bf16 v[136:139], a[36:39], a[220:223], v[136:139]
  v_mfma_f32_16x16x32_bf16 v[140:143], a[32:35], a[224:227], 0
  v_mfma_f32_16x16x32_bf16 v[140:143], a[32:35], a[228:231], v[140:143]
  v_mfma_f32_16x16x32_bf16 v[140:143], a[32:35], a[232:235], v[140:143]
  v_mfma_f32_16x16x32_bf16 v[140:143], a[32:35], a[236:239], v[140:143]
  v_mfma_f32_16x16x32_bf16 v[140:143], a[36:39], a[240:243], v[140:143]
  v_mfma_f32_16x16x32_bf16 v[140:143], a[36:39], a[244:247], v[140:143]
  v_mfma_f32_16x16x32_bf16 v[140:143], a[36:39], a[248:251], v[140:143]
  v_mfma_f32_16x16x32_bf16 v[140:143], a[36:39], a[252:255], v[140:143]
  v_mfma_f32_16x16x32_bf16 v[144:147], a[32:35], v[112:115], 0
  v_mfma_f32_16x16x32_bf16 v[144:147], a[32:35], v[116:119], v[144:147]
  v_mfma_f32_16x16x32_bf16 v[144:147], a[32:35], v[120:123], v[144:147]
  v_mfma_f32_16x16x32_bf16 v[144:147], a[32:35], v[124:127], v[144:147]
  v_add_f32 v148, v128, v132
  s_nop 2
  v_add_f32 v149, v136, v140
  v_add_f32 v150, v130, v134
  v_add_f32 v151, v138, v142
  v_cmp_u_f32 vcc, v148, v149
  v_cmp_u_f32 s[98:99], v150, v151
  v_cmp_u_f32 s[46:47], v144, v146
  s_nop 3
  s_or_b64 vcc, vcc, s[98:99]
  s_or_b64 vcc, vcc, s[46:47]
  s_cbranch_scc0 AT_RETRY_BACK
  s_cmp_lt_u32 s101, 2000
  s_cbranch_scc1 AT_RETRY_LOOP
  s_branch AT_RETRY_BACK
AT_LAST:
  s_endpgm
.section .rodata,"a"
.p2align 6
.amdhsa_kernel parallel_sum__linear_attn_block__dense_activation_squared_relu__prompt_kernel
  .amdhsa_next_free_vgpr 512
  .amdhsa_next_free_sgpr 102
  .amdhsa_accum_offset 256
  .amdhsa_group_segment_fixed_size 0
  .amdhsa_kernarg_size 88
  .amdhsa_user_sgpr_count 2
  .amdhsa_user_sgpr_kernarg_segment_ptr 1
  .amdhsa_system_sgpr_workgroup_id_x 1
.end_amdhsa_kernel
```
